```python
import torch

def _softmax(x, axis=-1):
    return torch.softmax(x, dim=axis)

def _gelu(x):
    return torch.nn.functional.gelu(x, approximate='tanh')

def _silu(x):
    return torch.nn.functional.silu(x)

def _sigmoid(x):
    return torch.sigmoid(x)

def _layernorm(x, axis=-1, eps=1e-05):
    m = x.mean(dim=axis, keepdim=True)
    v = x.var(dim=axis, keepdim=True, unbiased=False)
    return (x - m) / torch.sqrt(v + eps)

def _scatter_add(tgt, idx, src, axis=0):
    return tgt.clone().index_add_(axis, idx, src)

def _segment_sum(src, seg, n):
    out = torch.zeros((n,) + src.shape[1:], dtype=src.dtype)
    return out.index_add_(0, seg, src)

def _pad(x, pw):
    flat = tuple((v for pair in reversed(pw) for v in pair))
    return torch.nn.functional.pad(x, flat)
kernel_name = 'standalone__conformer_family_branchformer__speech'

def setup_inputs():

    _w = lambda a: (lambda t: t.to(torch.bfloat16) if t.is_floating_point() else t)(torch.as_tensor(a))
    B, T, D, K = (2, 4000, 144, 31)
    s = float(D) ** (-0.5)
    return {'x': _w((lambda *s: torch.randn(*s, dtype=torch.bfloat16) * 0.05)(B, T, D)), 'w_q': _w((lambda *s: torch.randn(*s, dtype=torch.bfloat16) * 1.6)(D, D) * s), 'w_k': _w((lambda *s: torch.randn(*s, dtype=torch.bfloat16) * 1.6)(D, D) * s), 'w_v': _w((lambda *s: torch.randn(*s, dtype=torch.bfloat16) * 0.8)(D, D) * s), 'w_ao': _w((lambda *s: torch.randn(*s, dtype=torch.bfloat16) * 0.8)(D, D) * s), 'w_up': _w((lambda *s: torch.randn(*s, dtype=torch.bfloat16) * 1.6)(D, 2 * D) * s), 'dw': _w((lambda *s: torch.randn(*s, dtype=torch.bfloat16) * 1.6)(K, D) * (1.0 / K)), 'w_dn': _w((lambda *s: torch.randn(*s, dtype=torch.bfloat16) * 0.8)(D, D) * s), 'w_merge': _w((lambda *s: torch.randn(*s, dtype=torch.bfloat16) * 0.8)(2 * D, D) * s)}

def reference(x, w_q, w_k, w_v, w_ao, w_up, dw, w_dn, w_merge):
    B, T, D = x.shape
    K = dw.shape[0]
    xa = _layernorm(x, axis=-1)
    q = torch.einsum('btd,de->bte', xa, w_q)
    k = torch.einsum('btd,de->bte', xa, w_k)
    v = torch.einsum('btd,de->bte', xa, w_v)
    logits = torch.einsum('btd,bsd->bts', q, k) * float(D) ** (-0.5)
    attn = _softmax(logits, axis=-1)
    ya = torch.einsum('bts,bsd->btd', attn, v)
    ya = torch.einsum('btd,de->bte', ya, w_ao)
    xc = _layernorm(x, axis=-1)
    h = _gelu(torch.einsum('btd,de->bte', xc, w_up))
    u = h[..., :D].clone()
    g = _layernorm(h[..., D:], axis=-1)
    pad = K // 2
    gp = _pad(g, ((0, 0), (pad, pad), (0, 0)))
    conv = torch.zeros_like(g)
    for i in range(K):
        conv = conv + gp[:, i:i + T, :] * dw[i][None, None, :]
    yc = torch.einsum('btd,de->bte', u * conv, w_dn)
    merged = torch.concatenate([ya, yc], axis=-1)
    out = torch.einsum('btf,fd->btd', merged, w_merge)
    return x + out
```

```asm
; @launch kernel=k1_kernel grid=(256,1,1) block=(256,1,1) lds=139264
; @launch kernel=k2_kernel grid=(252,1,1) block=(256,1,1) lds=163840
; @launch kernel=k3_kernel grid=(256,1,1) block=(256,1,1) lds=92160
.amdgcn_target "amdgcn-amd-amdhsa--gfx950"
.text
.globl k1_kernel
.p2align 8
.type k1_kernel,@function
k1_kernel:
    s_cmp_ge_u32 s2, 256
    s_cbranch_scc1 L_k1_done
    s_load_dwordx16 s[32:47], s[0:1], 0
    s_load_dwordx2 s[48:49], s[0:1], 64
    s_load_dwordx2 s[4:5], s[0:1], 88
    v_lshrrev_b32 v3, 6, v0
    v_and_b32 v1, 63, v0
    v_lshlrev_b32 v2, 4, v1
    v_readfirstlane_b32 s24, v3
    v_and_b32 v8, 31, v1
    v_lshrrev_b32 v7, 5, v1
    s_getpc_b64 s[56:57]
L_k1_pc:
    s_sub_u32 s56, s56, L_k1_pc - k1_kernel
    s_subb_u32 s57, s57, 0
    s_lshr_b32 s58, s2, 3
    s_and_b32 s58, s58, 7
    s_lshl_b32 s58, s58, 2
    s_add_u32 s58, s58, s24
    v_lshlrev_b32 v14, 6, v1
    s_lshl_b32 s58, s58, 12
    s_min_u32 s58, s58, L_code_end - k2_kernel - 4096
    s_add_u32 s58, s58, k2_kernel - k1_kernel
    v_add_u32 v14, s58, v14
    global_load_dword v14, v14, s[56:57]
    s_and_b32 s25, s24, 1
    s_lshr_b32 s26, s24, 1
    s_and_b32 s29, s2, 7
    s_lshr_b32 s30, s2, 4
    s_lshl_b32 s30, s30, 3
    s_add_u32 s60, s29, s30
    s_bfe_u32 s61, s2, 0x10003
    s_cmp_ge_u32 s60, 125
    s_cbranch_scc1 L_k1_fold
    s_cmp_eq_u32 s61, 1
    s_cbranch_scc1 L_k1_B
L_k1_A:
    s_lshl_b32 s27, s60, 1
    s_add_u32 s27, s27, s26
    s_mul_i32 s28, s24, 9216
    s_add_u32 s28, s28, 83968
    s_mul_i32 s54, s27, 9216
    s_waitcnt lgkmcnt(0)
    s_add_u32 s8, s32, s54
    s_addc_u32 s9, s33, 0
    s_mov_b32 s10, 9216
    s_mov_b32 s11, 0x20000
    s_add_u32 s12, s34, 0
    s_addc_u32 s13, s35, 0
    s_mov_b32 s14, 41472
    s_mov_b32 s15, 0x20000
    s_add_u32 s16, s36, 0
    s_addc_u32 s17, s37, 0
    s_mov_b32 s18, 41472
    s_mov_b32 s19, 0x20000
    s_add_u32 m0, s28, 0
    s_movk_i32 s29, 0
    buffer_load_dwordx4 v2, s[8:11], s29 offen offset:0 lds
    buffer_load_dwordx4 v2, s[8:11], s29 offen offset:1024 lds
    buffer_load_dwordx4 v2, s[8:11], s29 offen offset:2048 lds
    buffer_load_dwordx4 v2, s[8:11], s29 offen offset:3072 lds
    s_add_u32 m0, s28, 4096
    s_movk_i32 s29, 4096
    buffer_load_dwordx4 v2, s[8:11], s29 offen offset:0 lds
    buffer_load_dwordx4 v2, s[8:11], s29 offen offset:1024 lds
    buffer_load_dwordx4 v2, s[8:11], s29 offen offset:2048 lds
    buffer_load_dwordx4 v2, s[8:11], s29 offen offset:3072 lds
    s_add_u32 m0, s28, 8192
    s_movk_i32 s29, 8192
    buffer_load_dwordx4 v2, s[8:11], s29 offen offset:0 lds
    s_mul_i32 s31, s24, 11264
    s_mul_i32 s55, s24, 11264
    s_min_u32 s30, s31, 37888
    s_add_u32 m0, s30, 0
    s_add_u32 s31, s31, 4096
    buffer_load_dwordx4 v2, s[12:15], s30 offen offset:0 lds
    buffer_load_dwordx4 v2, s[12:15], s30 offen offset:1024 lds
    buffer_load_dwordx4 v2, s[12:15], s30 offen offset:2048 lds
    buffer_load_dwordx4 v2, s[12:15], s30 offen offset:3072 lds
    s_min_u32 s30, s31, 37888
    s_add_u32 m0, s30, 0
    s_add_u32 s31, s31, 4096
    buffer_load_dwordx4 v2, s[12:15], s30 offen offset:0 lds
    buffer_load_dwordx4 v2, s[12:15], s30 offen offset:1024 lds
    buffer_load_dwordx4 v2, s[12:15], s30 offen offset:2048 lds
    buffer_load_dwordx4 v2, s[12:15], s30 offen offset:3072 lds
    s_min_u32 s30, s31, 38912
    s_add_u32 m0, s30, 0
    s_add_u32 s31, s31, 3072
    buffer_load_dwordx4 v2, s[12:15], s30 offen offset:0 lds
    buffer_load_dwordx4 v2, s[12:15], s30 offen offset:1024 lds
    buffer_load_dwordx4 v2, s[12:15], s30 offen offset:2048 lds
    s_min_u32 s30, s55, 37888
    s_add_u32 m0, s30, 41984
    s_add_u32 s55, s55, 4096
    buffer_load_dwordx4 v2, s[16:19], s30 offen offset:0 lds
    buffer_load_dwordx4 v2, s[16:19], s30 offen offset:1024 lds
    buffer_load_dwordx4 v2, s[16:19], s30 offen offset:2048 lds
    buffer_load_dwordx4 v2, s[16:19], s30 offen offset:3072 lds
    s_min_u32 s30, s55, 37888
    s_add_u32 m0, s30, 41984
    s_add_u32 s55, s55, 4096
    buffer_load_dwordx4 v2, s[16:19], s30 offen offset:0 lds
    buffer_load_dwordx4 v2, s[16:19], s30 offen offset:1024 lds
    buffer_load_dwordx4 v2, s[16:19], s30 offen offset:2048 lds
    buffer_load_dwordx4 v2, s[16:19], s30 offen offset:3072 lds
    s_min_u32 s30, s55, 38912
    s_add_u32 m0, s30, 41984
    s_add_u32 s55, s55, 3072
    buffer_load_dwordx4 v2, s[16:19], s30 offen offset:0 lds
    buffer_load_dwordx4 v2, s[16:19], s30 offen offset:1024 lds
    buffer_load_dwordx4 v2, s[16:19], s30 offen offset:2048 lds
    v_bfe_u32 v176, v1, 2, 2
    v_lshl_add_u32 v176, v7, 3, v176
    v_mul_u32_u24 v4, 288, v176
    v_bfe_u32 v176, v1, 4, 1
    v_lshl_add_u32 v4, v176, 5, v4
    v_and_b32 v176, 1, v1
    v_lshl_add_u32 v4, v176, 4, v4
    v_bfe_u32 v176, v1, 1, 1
    v_lshl_add_u32 v4, v176, 3, v4
    v_add_u32 v4, 0, v4
    v_add_u32 v6, 18432, v4
    s_waitcnt vmcnt(22)
    v_mov_b32 v3, v8
    v_mul_u32_u24 v3, 288, v3
    v_lshl_add_u32 v3, v7, 4, v3
    v_add_u32 v3, s28, v3
    ds_read_b128 v[16:19], v3 offset:0
    ds_read_b128 v[20:23], v3 offset:32
    ds_read_b128 v[24:27], v3 offset:64
    ds_read_b128 v[28:31], v3 offset:96
    ds_read_b128 v[32:35], v3 offset:128
    ds_read_b128 v[36:39], v3 offset:160
    ds_read_b128 v[40:43], v3 offset:192
    ds_read_b128 v[44:47], v3 offset:224
    ds_read_b128 v[48:51], v3 offset:256
    v_mov_b32 v184, 0x3f803f80
    v_mov_b32 v176, 0
    v_mov_b32 v177, 0
    v_mov_b32 v178, 0
    v_mov_b32 v179, 0
    s_waitcnt lgkmcnt(8)
    v_dot2_f32_bf16 v176, v16, v184, v176
    v_dot2_f32_bf16 v178, v16, v16, v178
    v_dot2_f32_bf16 v177, v17, v184, v177
    v_dot2_f32_bf16 v179, v17, v17, v179
    v_dot2_f32_bf16 v176, v18, v184, v176
    v_dot2_f32_bf16 v178, v18, v18, v178
    v_dot2_f32_bf16 v177, v19, v184, v177
    v_dot2_f32_bf16 v179, v19, v19, v179
    s_waitcnt lgkmcnt(7)
    v_dot2_f32_bf16 v176, v20, v184, v176
    v_dot2_f32_bf16 v178, v20, v20, v178
    v_dot2_f32_bf16 v177, v21, v184, v177
    v_dot2_f32_bf16 v179, v21, v21, v179
    v_dot2_f32_bf16 v176, v22, v184, v176
    v_dot2_f32_bf16 v178, v22, v22, v178
    v_dot2_f32_bf16 v177, v23, v184, v177
    v_dot2_f32_bf16 v179, v23, v23, v179
    s_waitcnt lgkmcnt(6)
    v_dot2_f32_bf16 v176, v24, v184, v176
    v_dot2_f32_bf16 v178, v24, v24, v178
    v_dot2_f32_bf16 v177, v25, v184, v177
    v_dot2_f32_bf16 v179, v25, v25, v179
    v_dot2_f32_bf16 v176, v26, v184, v176
    v_dot2_f32_bf16 v178, v26, v26, v178
    v_dot2_f32_bf16 v177, v27, v184, v177
    v_dot2_f32_bf16 v179, v27, v27, v179
    s_waitcnt lgkmcnt(5)
    v_dot2_f32_bf16 v176, v28, v184, v176
    v_dot2_f32_bf16 v178, v28, v28, v178
    v_dot2_f32_bf16 v177, v29, v184, v177
    v_dot2_f32_bf16 v179, v29, v29, v179
    v_dot2_f32_bf16 v176, v30, v184, v176
    v_dot2_f32_bf16 v178, v30, v30, v178
    v_dot2_f32_bf16 v177, v31, v184, v177
    v_dot2_f32_bf16 v179, v31, v31, v179
    s_waitcnt lgkmcnt(4)
    v_dot2_f32_bf16 v176, v32, v184, v176
    v_dot2_f32_bf16 v178, v32, v32, v178
    v_dot2_f32_bf16 v177, v33, v184, v177
    v_dot2_f32_bf16 v179, v33, v33, v179
    v_dot2_f32_bf16 v176, v34, v184, v176
    v_dot2_f32_bf16 v178, v34, v34, v178
    v_dot2_f32_bf16 v177, v35, v184, v177
    v_dot2_f32_bf16 v179, v35, v35, v179
    s_waitcnt lgkmcnt(3)
    v_dot2_f32_bf16 v176, v36, v184, v176
    v_dot2_f32_bf16 v178, v36, v36, v178
    v_dot2_f32_bf16 v177, v37, v184, v177
    v_dot2_f32_bf16 v179, v37, v37, v179
    v_dot2_f32_bf16 v176, v38, v184, v176
    v_dot2_f32_bf16 v178, v38, v38, v178
    v_dot2_f32_bf16 v177, v39, v184, v177
    v_dot2_f32_bf16 v179, v39, v39, v179
    s_waitcnt lgkmcnt(2)
    v_dot2_f32_bf16 v176, v40, v184, v176
    v_dot2_f32_bf16 v178, v40, v40, v178
    v_dot2_f32_bf16 v177, v41, v184, v177
    v_dot2_f32_bf16 v179, v41, v41, v179
    v_dot2_f32_bf16 v176, v42, v184, v176
    v_dot2_f32_bf16 v178, v42, v42, v178
    v_dot2_f32_bf16 v177, v43, v184, v177
    v_dot2_f32_bf16 v179, v43, v43, v179
    s_waitcnt lgkmcnt(1)
    v_dot2_f32_bf16 v176, v44, v184, v176
    v_dot2_f32_bf16 v178, v44, v44, v178
    v_dot2_f32_bf16 v177, v45, v184, v177
    v_dot2_f32_bf16 v179, v45, v45, v179
    v_dot2_f32_bf16 v176, v46, v184, v176
    v_dot2_f32_bf16 v178, v46, v46, v178
    v_dot2_f32_bf16 v177, v47, v184, v177
    v_dot2_f32_bf16 v179, v47, v47, v179
    s_waitcnt lgkmcnt(0)
    v_dot2_f32_bf16 v176, v48, v184, v176
    v_dot2_f32_bf16 v178, v48, v48, v178
    v_dot2_f32_bf16 v177, v49, v184, v177
    v_dot2_f32_bf16 v179, v49, v49, v179
    v_dot2_f32_bf16 v176, v50, v184, v176
    v_dot2_f32_bf16 v178, v50, v50, v178
    v_dot2_f32_bf16 v177, v51, v184, v177
    v_dot2_f32_bf16 v179, v51, v51, v179
    s_nop 2
    v_add_f32 v176, v176, v177
    v_add_f32 v178, v178, v179
    v_mov_b32 v177, v176
    s_nop 1
    v_permlane32_swap_b32 v176, v177
    s_nop 1
    v_add_f32 v176, v176, v177
    v_mov_b32 v179, v178
    s_nop 1
    v_permlane32_swap_b32 v178, v179
    s_nop 1
    v_add_f32 v178, v178, v179
    v_mul_f32 v176, 0x3be38e39, v176
    v_mul_f32 v178, 0x3be38e39, v178
    v_fma_f32 v178, -v176, v176, v178
    v_max_f32 v178, 0, v178
    v_add_f32 v178, 0x3727c5ac, v178
    v_rsq_f32 v180, v178
    s_nop 0
    v_mul_f32 v182, v176, v180
    v_sub_f32 v182, 0, v182
    v_lshlrev_b32 v186, 16, v16
    v_and_b32 v187, 0xffff0000, v16
    v_pk_fma_f32 v[186:187], v[186:187], v[180:181], v[182:183] op_sel_hi:[1,0,0]
    v_cvt_pk_bf16_f32 v16, v186, v187
    v_lshlrev_b32 v188, 16, v17
    v_and_b32 v189, 0xffff0000, v17
    v_pk_fma_f32 v[188:189], v[188:189], v[180:181], v[182:183] op_sel_hi:[1,0,0]
    v_cvt_pk_bf16_f32 v17, v188, v189
    v_lshlrev_b32 v190, 16, v18
    v_and_b32 v191, 0xffff0000, v18
    v_pk_fma_f32 v[190:191], v[190:191], v[180:181], v[182:183] op_sel_hi:[1,0,0]
    v_cvt_pk_bf16_f32 v18, v190, v191
    v_lshlrev_b32 v192, 16, v19
    v_and_b32 v193, 0xffff0000, v19
    v_pk_fma_f32 v[192:193], v[192:193], v[180:181], v[182:183] op_sel_hi:[1,0,0]
    v_cvt_pk_bf16_f32 v19, v192, v193
    v_lshlrev_b32 v186, 16, v20
    v_and_b32 v187, 0xffff0000, v20
    v_pk_fma_f32 v[186:187], v[186:187], v[180:181], v[182:183] op_sel_hi:[1,0,0]
    v_cvt_pk_bf16_f32 v20, v186, v187
    v_lshlrev_b32 v188, 16, v21
    v_and_b32 v189, 0xffff0000, v21
    v_pk_fma_f32 v[188:189], v[188:189], v[180:181], v[182:183] op_sel_hi:[1,0,0]
    v_cvt_pk_bf16_f32 v21, v188, v189
    v_lshlrev_b32 v190, 16, v22
    v_and_b32 v191, 0xffff0000, v22
    v_pk_fma_f32 v[190:191], v[190:191], v[180:181], v[182:183] op_sel_hi:[1,0,0]
    v_cvt_pk_bf16_f32 v22, v190, v191
    v_lshlrev_b32 v192, 16, v23
    v_and_b32 v193, 0xffff0000, v23
    v_pk_fma_f32 v[192:193], v[192:193], v[180:181], v[182:183] op_sel_hi:[1,0,0]
    v_cvt_pk_bf16_f32 v23, v192, v193
    v_lshlrev_b32 v186, 16, v24
    v_and_b32 v187, 0xffff0000, v24
    v_pk_fma_f32 v[186:187], v[186:187], v[180:181], v[182:183] op_sel_hi:[1,0,0]
    v_cvt_pk_bf16_f32 v24, v186, v187
    v_lshlrev_b32 v188, 16, v25
    v_and_b32 v189, 0xffff0000, v25
    v_pk_fma_f32 v[188:189], v[188:189], v[180:181], v[182:183] op_sel_hi:[1,0,0]
    v_cvt_pk_bf16_f32 v25, v188, v189
    v_lshlrev_b32 v190, 16, v26
    v_and_b32 v191, 0xffff0000, v26
    v_pk_fma_f32 v[190:191], v[190:191], v[180:181], v[182:183] op_sel_hi:[1,0,0]
    v_cvt_pk_bf16_f32 v26, v190, v191
    v_lshlrev_b32 v192, 16, v27
    v_and_b32 v193, 0xffff0000, v27
    v_pk_fma_f32 v[192:193], v[192:193], v[180:181], v[182:183] op_sel_hi:[1,0,0]
    v_cvt_pk_bf16_f32 v27, v192, v193
    v_lshlrev_b32 v186, 16, v28
    v_and_b32 v187, 0xffff0000, v28
    v_pk_fma_f32 v[186:187], v[186:187], v[180:181], v[182:183] op_sel_hi:[1,0,0]
    v_cvt_pk_bf16_f32 v28, v186, v187
    v_lshlrev_b32 v188, 16, v29
    v_and_b32 v189, 0xffff0000, v29
    v_pk_fma_f32 v[188:189], v[188:189], v[180:181], v[182:183] op_sel_hi:[1,0,0]
    v_cvt_pk_bf16_f32 v29, v188, v189
    v_lshlrev_b32 v190, 16, v30
    v_and_b32 v191, 0xffff0000, v30
    v_pk_fma_f32 v[190:191], v[190:191], v[180:181], v[182:183] op_sel_hi:[1,0,0]
    v_cvt_pk_bf16_f32 v30, v190, v191
    v_lshlrev_b32 v192, 16, v31
    v_and_b32 v193, 0xffff0000, v31
    v_pk_fma_f32 v[192:193], v[192:193], v[180:181], v[182:183] op_sel_hi:[1,0,0]
    v_cvt_pk_bf16_f32 v31, v192, v193
    v_lshlrev_b32 v186, 16, v32
    v_and_b32 v187, 0xffff0000, v32
    v_pk_fma_f32 v[186:187], v[186:187], v[180:181], v[182:183] op_sel_hi:[1,0,0]
    v_cvt_pk_bf16_f32 v32, v186, v187
    v_lshlrev_b32 v188, 16, v33
    v_and_b32 v189, 0xffff0000, v33
    v_pk_fma_f32 v[188:189], v[188:189], v[180:181], v[182:183] op_sel_hi:[1,0,0]
    v_cvt_pk_bf16_f32 v33, v188, v189
    v_lshlrev_b32 v190, 16, v34
    v_and_b32 v191, 0xffff0000, v34
    v_pk_fma_f32 v[190:191], v[190:191], v[180:181], v[182:183] op_sel_hi:[1,0,0]
    v_cvt_pk_bf16_f32 v34, v190, v191
    v_lshlrev_b32 v192, 16, v35
    v_and_b32 v193, 0xffff0000, v35
    v_pk_fma_f32 v[192:193], v[192:193], v[180:181], v[182:183] op_sel_hi:[1,0,0]
    v_cvt_pk_bf16_f32 v35, v192, v193
    v_lshlrev_b32 v186, 16, v36
    v_and_b32 v187, 0xffff0000, v36
    v_pk_fma_f32 v[186:187], v[186:187], v[180:181], v[182:183] op_sel_hi:[1,0,0]
    v_cvt_pk_bf16_f32 v36, v186, v187
    v_lshlrev_b32 v188, 16, v37
    v_and_b32 v189, 0xffff0000, v37
    v_pk_fma_f32 v[188:189], v[188:189], v[180:181], v[182:183] op_sel_hi:[1,0,0]
    v_cvt_pk_bf16_f32 v37, v188, v189
    v_lshlrev_b32 v190, 16, v38
    v_and_b32 v191, 0xffff0000, v38
    v_pk_fma_f32 v[190:191], v[190:191], v[180:181], v[182:183] op_sel_hi:[1,0,0]
    v_cvt_pk_bf16_f32 v38, v190, v191
    v_lshlrev_b32 v192, 16, v39
    v_and_b32 v193, 0xffff0000, v39
    v_pk_fma_f32 v[192:193], v[192:193], v[180:181], v[182:183] op_sel_hi:[1,0,0]
    v_cvt_pk_bf16_f32 v39, v192, v193
    v_lshlrev_b32 v186, 16, v40
    v_and_b32 v187, 0xffff0000, v40
    v_pk_fma_f32 v[186:187], v[186:187], v[180:181], v[182:183] op_sel_hi:[1,0,0]
    v_cvt_pk_bf16_f32 v40, v186, v187
    v_lshlrev_b32 v188, 16, v41
    v_and_b32 v189, 0xffff0000, v41
    v_pk_fma_f32 v[188:189], v[188:189], v[180:181], v[182:183] op_sel_hi:[1,0,0]
    v_cvt_pk_bf16_f32 v41, v188, v189
    v_lshlrev_b32 v190, 16, v42
    v_and_b32 v191, 0xffff0000, v42
    v_pk_fma_f32 v[190:191], v[190:191], v[180:181], v[182:183] op_sel_hi:[1,0,0]
    v_cvt_pk_bf16_f32 v42, v190, v191
    v_lshlrev_b32 v192, 16, v43
    v_and_b32 v193, 0xffff0000, v43
    v_pk_fma_f32 v[192:193], v[192:193], v[180:181], v[182:183] op_sel_hi:[1,0,0]
    v_cvt_pk_bf16_f32 v43, v192, v193
    v_lshlrev_b32 v186, 16, v44
    v_and_b32 v187, 0xffff0000, v44
    v_pk_fma_f32 v[186:187], v[186:187], v[180:181], v[182:183] op_sel_hi:[1,0,0]
    v_cvt_pk_bf16_f32 v44, v186, v187
    v_lshlrev_b32 v188, 16, v45
    v_and_b32 v189, 0xffff0000, v45
    v_pk_fma_f32 v[188:189], v[188:189], v[180:181], v[182:183] op_sel_hi:[1,0,0]
    v_cvt_pk_bf16_f32 v45, v188, v189
    v_lshlrev_b32 v190, 16, v46
    v_and_b32 v191, 0xffff0000, v46
    v_pk_fma_f32 v[190:191], v[190:191], v[180:181], v[182:183] op_sel_hi:[1,0,0]
    v_cvt_pk_bf16_f32 v46, v190, v191
    v_lshlrev_b32 v192, 16, v47
    v_and_b32 v193, 0xffff0000, v47
    v_pk_fma_f32 v[192:193], v[192:193], v[180:181], v[182:183] op_sel_hi:[1,0,0]
    v_cvt_pk_bf16_f32 v47, v192, v193
    v_lshlrev_b32 v186, 16, v48
    v_and_b32 v187, 0xffff0000, v48
    v_pk_fma_f32 v[186:187], v[186:187], v[180:181], v[182:183] op_sel_hi:[1,0,0]
    v_cvt_pk_bf16_f32 v48, v186, v187
    v_lshlrev_b32 v188, 16, v49
    v_and_b32 v189, 0xffff0000, v49
    v_pk_fma_f32 v[188:189], v[188:189], v[180:181], v[182:183] op_sel_hi:[1,0,0]
    v_cvt_pk_bf16_f32 v49, v188, v189
    v_lshlrev_b32 v190, 16, v50
    v_and_b32 v191, 0xffff0000, v50
    v_pk_fma_f32 v[190:191], v[190:191], v[180:181], v[182:183] op_sel_hi:[1,0,0]
    v_cvt_pk_bf16_f32 v50, v190, v191
    v_lshlrev_b32 v192, 16, v51
    v_and_b32 v193, 0xffff0000, v51
    v_pk_fma_f32 v[192:193], v[192:193], v[180:181], v[182:183] op_sel_hi:[1,0,0]
    v_cvt_pk_bf16_f32 v51, v192, v193
    s_cmp_eq_u32 s25, 1
    s_cbranch_scc1 L_k1_A1
L_k1_A0:
    v_and_b32 v176, 3, v8
    v_lshlrev_b32 v176, 2, v176
    v_bfe_u32 v177, v8, 2, 2
    v_or_b32 v176, v176, v177
    v_xor_b32 v176, v176, v7
    v_lshlrev_b32 v176, 4, v176
    v_lshl_add_u32 v176, v8, 8, v176
    v_add_u32 v176, s28, v176
    v_xor_b32 v178, 0, v176
    ds_write_b128 v178, v[16:19]
    v_xor_b32 v179, 32, v176
    ds_write_b128 v179, v[20:23]
    v_xor_b32 v178, 64, v176
    ds_write_b128 v178, v[24:27]
    v_xor_b32 v179, 96, v176
    ds_write_b128 v179, v[28:31]
    v_xor_b32 v178, 128, v176
    ds_write_b128 v178, v[32:35]
    v_xor_b32 v179, 160, v176
    ds_write_b128 v179, v[36:39]
    v_xor_b32 v178, 192, v176
    ds_write_b128 v178, v[40:43]
    v_xor_b32 v179, 224, v176
    ds_write_b128 v179, v[44:47]
    v_bfe_u32 v177, v8, 3, 1
    v_xor_b32 v177, v177, v7
    v_lshlrev_b32 v177, 4, v177
    v_lshl_add_u32 v177, v8, 5, v177
    v_add_u32 v177, s28, v177
    ds_write_b128 v177, v[48:51] offset:8192
    v_add_u32 v176, s28, v2
    s_add_u32 s20, s4, s54
    s_addc_u32 s21, s5, 0
    s_mov_b32 s22, 9216
    s_mov_b32 s23, 0x20000
    s_waitcnt lgkmcnt(0)
    ds_read_b128 v[192:195], v176 offset:0
    ds_read_b128 v[196:199], v176 offset:1024
    ds_read_b128 v[200:203], v176 offset:2048
    ds_read_b128 v[204:207], v176 offset:3072
    ds_read_b128 v[208:211], v176 offset:4096
    ds_read_b128 v[212:215], v176 offset:5120
    ds_read_b128 v[216:219], v176 offset:6144
    ds_read_b128 v[220:223], v176 offset:7168
    ds_read_b128 v[224:227], v176 offset:8192
    s_waitcnt lgkmcnt(8)
    s_movk_i32 s29, 0
    buffer_store_dwordx4 v[192:195], v2, s[20:23], s29 offen offset:0 sc1
    s_waitcnt lgkmcnt(7)
    buffer_store_dwordx4 v[196:199], v2, s[20:23], s29 offen offset:1024 sc1
    s_waitcnt lgkmcnt(6)
    buffer_store_dwordx4 v[200:203], v2, s[20:23], s29 offen offset:2048 sc1
    s_waitcnt lgkmcnt(5)
    buffer_store_dwordx4 v[204:207], v2, s[20:23], s29 offen offset:3072 sc1
    s_waitcnt lgkmcnt(4)
    s_movk_i32 s29, 4096
    buffer_store_dwordx4 v[208:211], v2, s[20:23], s29 offen offset:0 sc1
    s_waitcnt lgkmcnt(3)
    buffer_store_dwordx4 v[212:215], v2, s[20:23], s29 offen offset:1024 sc1
    s_waitcnt lgkmcnt(2)
    buffer_store_dwordx4 v[216:219], v2, s[20:23], s29 offen offset:2048 sc1
    s_waitcnt lgkmcnt(1)
    buffer_store_dwordx4 v[220:223], v2, s[20:23], s29 offen offset:3072 sc1
    s_waitcnt lgkmcnt(0)
    s_movk_i32 s29, 8192
    buffer_store_dwordx4 v[224:227], v2, s[20:23], s29 offen offset:0 sc1
    s_waitcnt vmcnt(9)
    s_barrier
    ds_read_b64_tr_b16 v[144:145], v4 offset:0
    ds_read_b64_tr_b16 v[146:147], v4 offset:1152
    ds_read_b64_tr_b16 v[148:149], v4 offset:4608
    ds_read_b64_tr_b16 v[150:151], v4 offset:5760
    ds_read_b64_tr_b16 v[152:153], v4 offset:9216
    ds_read_b64_tr_b16 v[154:155], v4 offset:10368
    ds_read_b64_tr_b16 v[156:157], v4 offset:13824
    ds_read_b64_tr_b16 v[158:159], v4 offset:14976
    s_waitcnt lgkmcnt(6)
    v_mfma_f32_32x32x16_bf16 v[64:79], v[144:147], v[16:19], 0
    ds_read_b64_tr_b16 v[160:161], v6 offset:0
    ds_read_b64_tr_b16 v[162:163], v6 offset:1152
    s_waitcnt lgkmcnt(6)
    v_mfma_f32_32x32x16_bf16 v[64:79], v[148:151], v[20:23], v[64:79]
    ds_read_b64_tr_b16 v[164:165], v6 offset:4608
    ds_read_b64_tr_b16 v[166:167], v6 offset:5760
    s_waitcnt lgkmcnt(6)
    v_mfma_f32_32x32x16_bf16 v[64:79], v[152:155], v[24:27], v[64:79]
    ds_read_b64_tr_b16 v[168:169], v6 offset:9216
    ds_read_b64_tr_b16 v[170:171], v6 offset:10368
    s_waitcnt lgkmcnt(6)
    v_mfma_f32_32x32x16_bf16 v[64:79], v[156:159], v[28:31], v[64:79]
    ds_read_b64_tr_b16 v[172:173], v6 offset:13824
    ds_read_b64_tr_b16 v[174:175], v6 offset:14976
    s_waitcnt lgkmcnt(6)
    v_mfma_f32_32x32x16_bf16 v[64:79], v[160:163], v[32:35], v[64:79]
    ds_read_b64_tr_b16 v[144:145], v6 offset:18432
    ds_read_b64_tr_b16 v[146:147], v6 offset:19584
    s_waitcnt lgkmcnt(6)
    v_mfma_f32_32x32x16_bf16 v[64:79], v[164:167], v[36:39], v[64:79]
    ds_read_b64_tr_b16 v[148:149], v4 offset:64
    ds_read_b64_tr_b16 v[150:151], v4 offset:1216
    s_waitcnt lgkmcnt(6)
    v_mfma_f32_32x32x16_bf16 v[64:79], v[168:171], v[40:43], v[64:79]
    ds_read_b64_tr_b16 v[152:153], v4 offset:4672
    ds_read_b64_tr_b16 v[154:155], v4 offset:5824
    s_waitcnt lgkmcnt(6)
    v_mfma_f32_32x32x16_bf16 v[64:79], v[172:175], v[44:47], v[64:79]
    ds_read_b64_tr_b16 v[156:157], v4 offset:9280
    ds_read_b64_tr_b16 v[158:159], v4 offset:10432
    s_waitcnt lgkmcnt(6)
    v_mfma_f32_32x32x16_bf16 v[64:79], v[144:147], v[48:51], v[64:79]
    ds_read_b64_tr_b16 v[160:161], v4 offset:13888
    ds_read_b64_tr_b16 v[162:163], v4 offset:15040
    s_waitcnt lgkmcnt(6)
    v_mfma_f32_32x32x16_bf16 v[80:95], v[148:151], v[16:19], 0
    ds_read_b64_tr_b16 v[164:165], v6 offset:64
    ds_read_b64_tr_b16 v[166:167], v6 offset:1216
    s_waitcnt lgkmcnt(6)
    v_mfma_f32_32x32x16_bf16 v[80:95], v[152:155], v[20:23], v[80:95]
    ds_read_b64_tr_b16 v[168:169], v6 offset:4672
    ds_read_b64_tr_b16 v[170:171], v6 offset:5824
    s_waitcnt lgkmcnt(6)
    v_mfma_f32_32x32x16_bf16 v[80:95], v[156:159], v[24:27], v[80:95]
    ds_read_b64_tr_b16 v[172:173], v6 offset:9280
    ds_read_b64_tr_b16 v[174:175], v6 offset:10432
    s_waitcnt lgkmcnt(6)
    v_mfma_f32_32x32x16_bf16 v[80:95], v[160:163], v[28:31], v[80:95]
    ds_read_b64_tr_b16 v[144:145], v6 offset:13888
    ds_read_b64_tr_b16 v[146:147], v6 offset:15040
    s_waitcnt lgkmcnt(6)
    v_mfma_f32_32x32x16_bf16 v[80:95], v[164:167], v[32:35], v[80:95]
    ds_read_b64_tr_b16 v[148:149], v6 offset:18496
    ds_read_b64_tr_b16 v[150:151], v6 offset:19648
    s_waitcnt lgkmcnt(6)
    v_mfma_f32_32x32x16_bf16 v[80:95], v[168:171], v[36:39], v[80:95]
    s_waitcnt lgkmcnt(4)
    v_mfma_f32_32x32x16_bf16 v[80:95], v[172:175], v[40:43], v[80:95]
    s_waitcnt lgkmcnt(2)
    v_mfma_f32_32x32x16_bf16 v[80:95], v[144:147], v[44:47], v[80:95]
    s_waitcnt lgkmcnt(0)
    v_mfma_f32_32x32x16_bf16 v[80:95], v[148:151], v[48:51], v[80:95]
    s_nop 15
    s_mul_i32 s29, s26, 9216
    s_add_u32 s29, s29, 120832
    v_add_u32 v5, s29, v2
    v_cvt_pk_bf16_f32 v192, v64, v65
    v_cvt_pk_bf16_f32 v193, v66, v67
    v_cvt_pk_bf16_f32 v194, v68, v69
    v_cvt_pk_bf16_f32 v195, v70, v71
    ds_write_b128 v5, v[192:195] offset:0
    v_cvt_pk_bf16_f32 v196, v72, v73
    v_cvt_pk_bf16_f32 v197, v74, v75
    v_cvt_pk_bf16_f32 v198, v76, v77
    v_cvt_pk_bf16_f32 v199, v78, v79
    ds_write_b128 v5, v[196:199] offset:1024
    v_cvt_pk_bf16_f32 v200, v80, v81
    v_cvt_pk_bf16_f32 v201, v82, v83
    v_cvt_pk_bf16_f32 v202, v84, v85
    v_cvt_pk_bf16_f32 v203, v86, v87
    ds_write_b128 v5, v[200:203] offset:2048
    v_cvt_pk_bf16_f32 v204, v88, v89
    v_cvt_pk_bf16_f32 v205, v90, v91
    v_cvt_pk_bf16_f32 v206, v92, v93
    v_cvt_pk_bf16_f32 v207, v94, v95
    ds_write_b128 v5, v[204:207] offset:3072
    s_waitcnt lgkmcnt(0)
    s_barrier
    ds_read_b128 v[16:19], v5 offset:0
    ds_read_b128 v[20:23], v5 offset:1024
    ds_read_b128 v[24:27], v5 offset:2048
    ds_read_b128 v[28:31], v5 offset:3072
    ds_read_b128 v[32:35], v5 offset:4096
    ds_read_b128 v[36:39], v5 offset:5120
    ds_read_b128 v[40:43], v5 offset:6144
    ds_read_b128 v[44:47], v5 offset:7168
    ds_read_b128 v[48:51], v5 offset:8192
    v_and_b32 v3, 0x13, v8
    v_bfe_u32 v176, v8, 2, 1
    v_lshl_or_b32 v3, v176, 3, v3
    v_bfe_u32 v176, v8, 3, 1
    v_lshl_or_b32 v3, v176, 2, v3
    v_mul_u32_u24 v3, 288, v3
    v_lshl_add_u32 v3, v7, 4, v3
    v_add_u32 v3, 41984, v3
    s_mov_b32 s50, 0x3df6384f
    s_mov_b32 s51, 0x3df6384f
    s_add_u32 s20, s4, s54
    s_addc_u32 s21, s5, 0
    s_add_u32 s20, s20, 2359296
    s_addc_u32 s21, s21, 0
    s_mov_b32 s22, 9216
    s_mov_b32 s23, 0x20000
    s_waitcnt lgkmcnt(0)
    ds_read_b128 v[144:147], v3 offset:0
    ds_read_b128 v[148:151], v3 offset:32
    ds_read_b128 v[152:155], v3 offset:64
    ds_read_b128 v[156:159], v3 offset:96
    s_waitcnt lgkmcnt(3)
    v_mfma_f32_32x32x16_bf16 v[64:79], v[144:147], v[16:19], 0
    ds_read_b128 v[160:163], v3 offset:128
    s_waitcnt lgkmcnt(3)
    v_mfma_f32_32x32x16_bf16 v[64:79], v[148:151], v[20:23], v[64:79]
    ds_read_b128 v[164:167], v3 offset:160
    s_waitcnt lgkmcnt(3)
    v_mfma_f32_32x32x16_bf16 v[64:79], v[152:155], v[24:27], v[64:79]
    ds_read_b128 v[168:171], v3 offset:192
    s_waitcnt lgkmcnt(3)
    v_mfma_f32_32x32x16_bf16 v[64:79], v[156:159], v[28:31], v[64:79]
    ds_read_b128 v[172:175], v3 offset:224
    s_waitcnt lgkmcnt(3)
    v_mfma_f32_32x32x16_bf16 v[64:79], v[160:163], v[32:35], v[64:79]
    ds_read_b128 v[144:147], v3 offset:256
    s_waitcnt lgkmcnt(3)
    v_mfma_f32_32x32x16_bf16 v[64:79], v[164:167], v[36:39], v[64:79]
    ds_read_b128 v[148:151], v3 offset:9216
    s_waitcnt lgkmcnt(3)
    v_mfma_f32_32x32x16_bf16 v[64:79], v[168:171], v[40:43], v[64:79]
    ds_read_b128 v[152:155], v3 offset:9248
    s_waitcnt lgkmcnt(3)
    v_mfma_f32_32x32x16_bf16 v[64:79], v[172:175], v[44:47], v[64:79]
    ds_read_b128 v[156:159], v3 offset:9280
    s_waitcnt lgkmcnt(3)
    v_mfma_f32_32x32x16_bf16 v[64:79], v[144:147], v[48:51], v[64:79]
    ds_read_b128 v[160:163], v3 offset:9312
    s_waitcnt lgkmcnt(3)
    v_mfma_f32_32x32x16_bf16 v[80:95], v[148:151], v[16:19], 0
    ds_read_b128 v[164:167], v3 offset:9344
    s_waitcnt lgkmcnt(3)
    v_mfma_f32_32x32x16_bf16 v[80:95], v[152:155], v[20:23], v[80:95]
    ds_read_b128 v[168:171], v3 offset:9376
    s_waitcnt lgkmcnt(3)
    v_mfma_f32_32x32x16_bf16 v[80:95], v[156:159], v[24:27], v[80:95]
    ds_read_b128 v[172:175], v3 offset:9408
    s_waitcnt lgkmcnt(3)
    v_mfma_f32_32x32x16_bf16 v[80:95], v[160:163], v[28:31], v[80:95]
    ds_read_b128 v[144:147], v3 offset:9440
    s_waitcnt lgkmcnt(3)
    v_mfma_f32_32x32x16_bf16 v[80:95], v[164:167], v[32:35], v[80:95]
    ds_read_b128 v[148:151], v3 offset:9472
    s_waitcnt lgkmcnt(3)
    v_mfma_f32_32x32x16_bf16 v[80:95], v[168:171], v[36:39], v[80:95]
    ds_read_b128 v[152:155], v3 offset:18432
    s_waitcnt lgkmcnt(3)
    v_mfma_f32_32x32x16_bf16 v[80:95], v[172:175], v[40:43], v[80:95]
    ds_read_b128 v[156:159], v3 offset:18464
    s_waitcnt lgkmcnt(3)
    v_mfma_f32_32x32x16_bf16 v[80:95], v[144:147], v[44:47], v[80:95]
    ds_read_b128 v[160:163], v3 offset:18496
    s_waitcnt lgkmcnt(3)
    v_mfma_f32_32x32x16_bf16 v[80:95], v[148:151], v[48:51], v[80:95]
    ds_read_b128 v[164:167], v3 offset:18528
    s_waitcnt lgkmcnt(3)
    v_mfma_f32_32x32x16_bf16 v[96:111], v[152:155], v[16:19], 0
    ds_read_b128 v[168:171], v3 offset:18560
    s_waitcnt lgkmcnt(3)
    v_mfma_f32_32x32x16_bf16 v[96:111], v[156:159], v[20:23], v[96:111]
    ds_read_b128 v[172:175], v3 offset:18592
    s_waitcnt lgkmcnt(3)
    v_mfma_f32_32x32x16_bf16 v[96:111], v[160:163], v[24:27], v[96:111]
    ds_read_b128 v[144:147], v3 offset:18624
    s_waitcnt lgkmcnt(3)
    v_mfma_f32_32x32x16_bf16 v[96:111], v[164:167], v[28:31], v[96:111]
    ds_read_b128 v[148:151], v3 offset:18656
    s_waitcnt lgkmcnt(3)
    v_mfma_f32_32x32x16_bf16 v[96:111], v[168:171], v[32:35], v[96:111]
    ds_read_b128 v[152:155], v3 offset:18688
    s_waitcnt lgkmcnt(3)
    v_mfma_f32_32x32x16_bf16 v[96:111], v[172:175], v[36:39], v[96:111]
    s_waitcnt lgkmcnt(2)
    v_mfma_f32_32x32x16_bf16 v[96:111], v[144:147], v[40:43], v[96:111]
    s_waitcnt lgkmcnt(1)
    v_mfma_f32_32x32x16_bf16 v[96:111], v[148:151], v[44:47], v[96:111]
    s_waitcnt lgkmcnt(0)
    v_mfma_f32_32x32x16_bf16 v[96:111], v[152:155], v[48:51], v[96:111]
    s_nop 15
    v_pk_mul_f32 v[64:65], v[64:65], s[50:51]
    v_cvt_pk_bf16_f32 v192, v64, v65
    v_pk_mul_f32 v[66:67], v[66:67], s[50:51]
    v_cvt_pk_bf16_f32 v193, v66, v67
    v_pk_mul_f32 v[68:69], v[68:69], s[50:51]
    v_cvt_pk_bf16_f32 v194, v68, v69
    v_pk_mul_f32 v[70:71], v[70:71], s[50:51]
    v_cvt_pk_bf16_f32 v195, v70, v71
    s_movk_i32 s29, 0
    buffer_store_dwordx4 v[192:195], v2, s[20:23], s29 offen sc1
    v_pk_mul_f32 v[72:73], v[72:73], s[50:51]
    v_cvt_pk_bf16_f32 v196, v72, v73
    v_pk_mul_f32 v[74:75], v[74:75], s[50:51]
    v_cvt_pk_bf16_f32 v197, v74, v75
    v_pk_mul_f32 v[76:77], v[76:77], s[50:51]
    v_cvt_pk_bf16_f32 v198, v76, v77
    v_pk_mul_f32 v[78:79], v[78:79], s[50:51]
    v_cvt_pk_bf16_f32 v199, v78, v79
    s_movk_i32 s29, 1024
    buffer_store_dwordx4 v[196:199], v2, s[20:23], s29 offen sc1
    v_pk_mul_f32 v[80:81], v[80:81], s[50:51]
    v_cvt_pk_bf16_f32 v200, v80, v81
    v_pk_mul_f32 v[82:83], v[82:83], s[50:51]
    v_cvt_pk_bf16_f32 v201, v82, v83
    v_pk_mul_f32 v[84:85], v[84:85], s[50:51]
    v_cvt_pk_bf16_f32 v202, v84, v85
    v_pk_mul_f32 v[86:87], v[86:87], s[50:51]
    v_cvt_pk_bf16_f32 v203, v86, v87
    s_movk_i32 s29, 2048
    buffer_store_dwordx4 v[200:203], v2, s[20:23], s29 offen sc1
    v_pk_mul_f32 v[88:89], v[88:89], s[50:51]
    v_cvt_pk_bf16_f32 v204, v88, v89
    v_pk_mul_f32 v[90:91], v[90:91], s[50:51]
    v_cvt_pk_bf16_f32 v205, v90, v91
    v_pk_mul_f32 v[92:93], v[92:93], s[50:51]
    v_cvt_pk_bf16_f32 v206, v92, v93
    v_pk_mul_f32 v[94:95], v[94:95], s[50:51]
    v_cvt_pk_bf16_f32 v207, v94, v95
    s_movk_i32 s29, 3072
    buffer_store_dwordx4 v[204:207], v2, s[20:23], s29 offen sc1
    v_pk_mul_f32 v[96:97], v[96:97], s[50:51]
    v_cvt_pk_bf16_f32 v208, v96, v97
    v_pk_mul_f32 v[98:99], v[98:99], s[50:51]
    v_cvt_pk_bf16_f32 v209, v98, v99
    v_pk_mul_f32 v[100:101], v[100:101], s[50:51]
    v_cvt_pk_bf16_f32 v210, v100, v101
    v_pk_mul_f32 v[102:103], v[102:103], s[50:51]
    v_cvt_pk_bf16_f32 v211, v102, v103
    s_movk_i32 s29, 4096
    buffer_store_dwordx4 v[208:211], v2, s[20:23], s29 offen sc1
    v_pk_mul_f32 v[104:105], v[104:105], s[50:51]
    v_cvt_pk_bf16_f32 v212, v104, v105
    v_pk_mul_f32 v[106:107], v[106:107], s[50:51]
    v_cvt_pk_bf16_f32 v213, v106, v107
    v_pk_mul_f32 v[108:109], v[108:109], s[50:51]
    v_cvt_pk_bf16_f32 v214, v108, v109
    v_pk_mul_f32 v[110:111], v[110:111], s[50:51]
    v_cvt_pk_bf16_f32 v215, v110, v111
    s_movk_i32 s29, 5120
    buffer_store_dwordx4 v[212:215], v2, s[20:23], s29 offen sc1
    s_endpgm
L_k1_A1:
    s_waitcnt vmcnt(0)
    s_barrier
    ds_read_b64_tr_b16 v[144:145], v4 offset:128
    ds_read_b64_tr_b16 v[146:147], v4 offset:1280
    ds_read_b64_tr_b16 v[148:149], v4 offset:4736
    ds_read_b64_tr_b16 v[150:151], v4 offset:5888
    ds_read_b64_tr_b16 v[152:153], v4 offset:9344
    ds_read_b64_tr_b16 v[154:155], v4 offset:10496
    ds_read_b64_tr_b16 v[156:157], v4 offset:13952
    ds_read_b64_tr_b16 v[158:159], v4 offset:15104
    s_waitcnt lgkmcnt(6)
    v_mfma_f32_32x32x16_bf16 v[64:79], v[144:147], v[16:19], 0
    ds_read_b64_tr_b16 v[160:161], v6 offset:128
    ds_read_b64_tr_b16 v[162:163], v6 offset:1280
    s_waitcnt lgkmcnt(6)
    v_mfma_f32_32x32x16_bf16 v[64:79], v[148:151], v[20:23], v[64:79]
    ds_read_b64_tr_b16 v[164:165], v6 offset:4736
    ds_read_b64_tr_b16 v[166:167], v6 offset:5888
    s_waitcnt lgkmcnt(6)
    v_mfma_f32_32x32x16_bf16 v[64:79], v[152:155], v[24:27], v[64:79]
    ds_read_b64_tr_b16 v[168:169], v6 offset:9344
    ds_read_b64_tr_b16 v[170:171], v6 offset:10496
    s_waitcnt lgkmcnt(6)
    v_mfma_f32_32x32x16_bf16 v[64:79], v[156:159], v[28:31], v[64:79]
    ds_read_b64_tr_b16 v[172:173], v6 offset:13952
    ds_read_b64_tr_b16 v[174:175], v6 offset:15104
    s_waitcnt lgkmcnt(6)
    v_mfma_f32_32x32x16_bf16 v[64:79], v[160:163], v[32:35], v[64:79]
    ds_read_b64_tr_b16 v[144:145], v6 offset:18560
    ds_read_b64_tr_b16 v[146:147], v6 offset:19712
    s_waitcnt lgkmcnt(6)
    v_mfma_f32_32x32x16_bf16 v[64:79], v[164:167], v[36:39], v[64:79]
    ds_read_b64_tr_b16 v[148:149], v4 offset:192
    ds_read_b64_tr_b16 v[150:151], v4 offset:1344
    s_waitcnt lgkmcnt(6)
    v_mfma_f32_32x32x16_bf16 v[64:79], v[168:171], v[40:43], v[64:79]
    ds_read_b64_tr_b16 v[152:153], v4 offset:4800
    ds_read_b64_tr_b16 v[154:155], v4 offset:5952
    s_waitcnt lgkmcnt(6)
    v_mfma_f32_32x32x16_bf16 v[64:79], v[172:175], v[44:47], v[64:79]
    ds_read_b64_tr_b16 v[156:157], v4 offset:9408
    ds_read_b64_tr_b16 v[158:159], v4 offset:10560
    s_waitcnt lgkmcnt(6)
    v_mfma_f32_32x32x16_bf16 v[64:79], v[144:147], v[48:51], v[64:79]
    ds_read_b64_tr_b16 v[160:161], v4 offset:14016
    ds_read_b64_tr_b16 v[162:163], v4 offset:15168
    s_waitcnt lgkmcnt(6)
    v_mfma_f32_32x32x16_bf16 v[80:95], v[148:151], v[16:19], 0
    ds_read_b64_tr_b16 v[164:165], v6 offset:192
    ds_read_b64_tr_b16 v[166:167], v6 offset:1344
    s_waitcnt lgkmcnt(6)
    v_mfma_f32_32x32x16_bf16 v[80:95], v[152:155], v[20:23], v[80:95]
    ds_read_b64_tr_b16 v[168:169], v6 offset:4800
    ds_read_b64_tr_b16 v[170:171], v6 offset:5952
    s_waitcnt lgkmcnt(6)
    v_mfma_f32_32x32x16_bf16 v[80:95], v[156:159], v[24:27], v[80:95]
    ds_read_b64_tr_b16 v[172:173], v6 offset:9408
    ds_read_b64_tr_b16 v[174:175], v6 offset:10560
    s_waitcnt lgkmcnt(6)
    v_mfma_f32_32x32x16_bf16 v[80:95], v[160:163], v[28:31], v[80:95]
    ds_read_b64_tr_b16 v[144:145], v6 offset:14016
    ds_read_b64_tr_b16 v[146:147], v6 offset:15168
    s_waitcnt lgkmcnt(6)
    v_mfma_f32_32x32x16_bf16 v[80:95], v[164:167], v[32:35], v[80:95]
    ds_read_b64_tr_b16 v[148:149], v6 offset:18624
    ds_read_b64_tr_b16 v[150:151], v6 offset:19776
    s_waitcnt lgkmcnt(6)
    v_mfma_f32_32x32x16_bf16 v[80:95], v[168:171], v[36:39], v[80:95]
    ds_read_b64_tr_b16 v[152:153], v4 offset:256
    ds_read_b64_tr_b16 v[154:155], v4 offset:1408
    s_waitcnt lgkmcnt(6)
    v_mfma_f32_32x32x16_bf16 v[80:95], v[172:175], v[40:43], v[80:95]
    ds_read_b64_tr_b16 v[156:157], v4 offset:4864
    ds_read_b64_tr_b16 v[158:159], v4 offset:6016
    s_waitcnt lgkmcnt(6)
    v_mfma_f32_32x32x16_bf16 v[80:95], v[144:147], v[44:47], v[80:95]
    ds_read_b64_tr_b16 v[160:161], v4 offset:9472
    ds_read_b64_tr_b16 v[162:163], v4 offset:10624
    s_waitcnt lgkmcnt(6)
    v_mfma_f32_32x32x16_bf16 v[80:95], v[148:151], v[48:51], v[80:95]
    ds_read_b64_tr_b16 v[164:165], v4 offset:14080
    ds_read_b64_tr_b16 v[166:167], v4 offset:15232
    s_waitcnt lgkmcnt(6)
    v_mfma_f32_32x32x16_bf16 v[96:111], v[152:155], v[16:19], 0
    ds_read_b64_tr_b16 v[168:169], v6 offset:256
    ds_read_b64_tr_b16 v[170:171], v6 offset:1408
    s_waitcnt lgkmcnt(6)
    v_mfma_f32_32x32x16_bf16 v[96:111], v[156:159], v[20:23], v[96:111]
    ds_read_b64_tr_b16 v[172:173], v6 offset:4864
    ds_read_b64_tr_b16 v[174:175], v6 offset:6016
    s_waitcnt lgkmcnt(6)
    v_mfma_f32_32x32x16_bf16 v[96:111], v[160:163], v[24:27], v[96:111]
    ds_read_b64_tr_b16 v[144:145], v6 offset:9472
    ds_read_b64_tr_b16 v[146:147], v6 offset:10624
    s_waitcnt lgkmcnt(6)
    v_mfma_f32_32x32x16_bf16 v[96:111], v[164:167], v[28:31], v[96:111]
    ds_read_b64_tr_b16 v[148:149], v6 offset:14080
    ds_read_b64_tr_b16 v[150:151], v6 offset:15232
    s_waitcnt lgkmcnt(6)
    v_mfma_f32_32x32x16_bf16 v[96:111], v[168:171], v[32:35], v[96:111]
    ds_read_b64_tr_b16 v[152:153], v6 offset:18688
    ds_read_b64_tr_b16 v[154:155], v6 offset:19840
    s_waitcnt lgkmcnt(6)
    v_mfma_f32_32x32x16_bf16 v[96:111], v[172:175], v[36:39], v[96:111]
    s_waitcnt lgkmcnt(4)
    v_mfma_f32_32x32x16_bf16 v[96:111], v[144:147], v[40:43], v[96:111]
    s_waitcnt lgkmcnt(2)
    v_mfma_f32_32x32x16_bf16 v[96:111], v[148:151], v[44:47], v[96:111]
    s_waitcnt lgkmcnt(0)
    v_mfma_f32_32x32x16_bf16 v[96:111], v[152:155], v[48:51], v[96:111]
    s_nop 15
    s_mul_i32 s29, s26, 9216
    s_add_u32 s29, s29, 120832
    v_add_u32 v5, s29, v2
    v_cvt_pk_bf16_f32 v192, v64, v65
    v_cvt_pk_bf16_f32 v193, v66, v67
    v_cvt_pk_bf16_f32 v194, v68, v69
    v_cvt_pk_bf16_f32 v195, v70, v71
    ds_write_b128 v5, v[192:195] offset:4096
    v_cvt_pk_bf16_f32 v196, v72, v73
    v_cvt_pk_bf16_f32 v197, v74, v75
    v_cvt_pk_bf16_f32 v198, v76, v77
    v_cvt_pk_bf16_f32 v199, v78, v79
    ds_write_b128 v5, v[196:199] offset:5120
    v_cvt_pk_bf16_f32 v200, v80, v81
    v_cvt_pk_bf16_f32 v201, v82, v83
    v_cvt_pk_bf16_f32 v202, v84, v85
    v_cvt_pk_bf16_f32 v203, v86, v87
    ds_write_b128 v5, v[200:203] offset:6144
    v_cvt_pk_bf16_f32 v204, v88, v89
    v_cvt_pk_bf16_f32 v205, v90, v91
    v_cvt_pk_bf16_f32 v206, v92, v93
    v_cvt_pk_bf16_f32 v207, v94, v95
    ds_write_b128 v5, v[204:207] offset:7168
    v_cvt_pk_bf16_f32 v192, v96, v97
    v_cvt_pk_bf16_f32 v193, v98, v99
    v_cvt_pk_bf16_f32 v194, v100, v101
    v_cvt_pk_bf16_f32 v195, v102, v103
    ds_write_b128 v5, v[192:195] offset:8192
    s_waitcnt lgkmcnt(0)
    s_barrier
    ds_read_b128 v[16:19], v5 offset:0
    ds_read_b128 v[20:23], v5 offset:1024
    ds_read_b128 v[24:27], v5 offset:2048
    ds_read_b128 v[28:31], v5 offset:3072
    ds_read_b128 v[32:35], v5 offset:4096
    ds_read_b128 v[36:39], v5 offset:5120
    ds_read_b128 v[40:43], v5 offset:6144
    ds_read_b128 v[44:47], v5 offset:7168
    ds_read_b128 v[48:51], v5 offset:8192
    v_and_b32 v3, 0x13, v8
    v_bfe_u32 v176, v8, 2, 1
    v_lshl_or_b32 v3, v176, 3, v3
    v_bfe_u32 v176, v8, 3, 1
    v_lshl_or_b32 v3, v176, 2, v3
    v_mul_u32_u24 v3, 288, v3
    v_lshl_add_u32 v3, v7, 4, v3
    v_add_u32 v3, 41984, v3
    s_mov_b32 s50, 0x3df6384f
    s_mov_b32 s51, 0x3df6384f
    s_add_u32 s20, s4, s54
    s_addc_u32 s21, s5, 0
    s_add_u32 s20, s20, 2359296
    s_addc_u32 s21, s21, 0
    s_mov_b32 s22, 9216
    s_mov_b32 s23, 0x20000
    s_waitcnt lgkmcnt(0)
    ds_read_b128 v[144:147], v3 offset:27648
    ds_read_b128 v[148:151], v3 offset:27680
    ds_read_b128 v[152:155], v3 offset:27712
    ds_read_b128 v[156:159], v3 offset:27744
    s_waitcnt lgkmcnt(3)
    v_mfma_f32_32x32x16_bf16 v[64:79], v[144:147], v[16:19], 0
    ds_read_b128 v[160:163], v3 offset:27776
    s_waitcnt lgkmcnt(3)
    v_mfma_f32_32x32x16_bf16 v[64:79], v[148:151], v[20:23], v[64:79]
    ds_read_b128 v[164:167], v3 offset:27808
    s_waitcnt lgkmcnt(3)
    v_mfma_f32_32x32x16_bf16 v[64:79], v[152:155], v[24:27], v[64:79]
    ds_read_b128 v[168:171], v3 offset:27840
    s_waitcnt lgkmcnt(3)
    v_mfma_f32_32x32x16_bf16 v[64:79], v[156:159], v[28:31], v[64:79]
    ds_read_b128 v[172:175], v3 offset:27872
    s_waitcnt lgkmcnt(3)
    v_mfma_f32_32x32x16_bf16 v[64:79], v[160:163], v[32:35], v[64:79]
    ds_read_b128 v[144:147], v3 offset:27904
    s_waitcnt lgkmcnt(3)
    v_mfma_f32_32x32x16_bf16 v[64:79], v[164:167], v[36:39], v[64:79]
    ds_read_b128 v[148:151], v3 offset:36864
    s_waitcnt lgkmcnt(3)
    v_mfma_f32_32x32x16_bf16 v[64:79], v[168:171], v[40:43], v[64:79]
    ds_read_b128 v[152:155], v3 offset:36896
    s_waitcnt lgkmcnt(3)
    v_mfma_f32_32x32x16_bf16 v[64:79], v[172:175], v[44:47], v[64:79]
    ds_read_b128 v[156:159], v3 offset:36928
    s_waitcnt lgkmcnt(3)
    v_mfma_f32_32x32x16_bf16 v[64:79], v[144:147], v[48:51], v[64:79]
    ds_read_b128 v[160:163], v3 offset:36960
    s_waitcnt lgkmcnt(3)
    v_mfma_f32_32x32x16_bf16 v[80:95], v[148:151], v[16:19], 0
    ds_read_b128 v[164:167], v3 offset:36992
    s_waitcnt lgkmcnt(3)
    v_mfma_f32_32x32x16_bf16 v[80:95], v[152:155], v[20:23], v[80:95]
    ds_read_b128 v[168:171], v3 offset:37024
    s_waitcnt lgkmcnt(3)
    v_mfma_f32_32x32x16_bf16 v[80:95], v[156:159], v[24:27], v[80:95]
    ds_read_b128 v[172:175], v3 offset:37056
    s_waitcnt lgkmcnt(3)
    v_mfma_f32_32x32x16_bf16 v[80:95], v[160:163], v[28:31], v[80:95]
    ds_read_b128 v[144:147], v3 offset:37088
    s_waitcnt lgkmcnt(3)
    v_mfma_f32_32x32x16_bf16 v[80:95], v[164:167], v[32:35], v[80:95]
    ds_read_b128 v[148:151], v3 offset:37120
    s_waitcnt lgkmcnt(3)
    v_mfma_f32_32x32x16_bf16 v[80:95], v[168:171], v[36:39], v[80:95]
    s_waitcnt lgkmcnt(2)
    v_mfma_f32_32x32x16_bf16 v[80:95], v[172:175], v[40:43], v[80:95]
    s_waitcnt lgkmcnt(1)
    v_mfma_f32_32x32x16_bf16 v[80:95], v[144:147], v[44:47], v[80:95]
    s_waitcnt lgkmcnt(0)
    v_mfma_f32_32x32x16_bf16 v[80:95], v[148:151], v[48:51], v[80:95]
    s_nop 15
    v_pk_mul_f32 v[64:65], v[64:65], s[50:51]
    v_cvt_pk_bf16_f32 v192, v64, v65
    v_pk_mul_f32 v[66:67], v[66:67], s[50:51]
    v_cvt_pk_bf16_f32 v193, v66, v67
    v_pk_mul_f32 v[68:69], v[68:69], s[50:51]
    v_cvt_pk_bf16_f32 v194, v68, v69
    v_pk_mul_f32 v[70:71], v[70:71], s[50:51]
    v_cvt_pk_bf16_f32 v195, v70, v71
    s_movk_i32 s29, 6144
    buffer_store_dwordx4 v[192:195], v2, s[20:23], s29 offen sc1
    v_pk_mul_f32 v[72:73], v[72:73], s[50:51]
    v_cvt_pk_bf16_f32 v196, v72, v73
    v_pk_mul_f32 v[74:75], v[74:75], s[50:51]
    v_cvt_pk_bf16_f32 v197, v74, v75
    v_pk_mul_f32 v[76:77], v[76:77], s[50:51]
    v_cvt_pk_bf16_f32 v198, v76, v77
    v_pk_mul_f32 v[78:79], v[78:79], s[50:51]
    v_cvt_pk_bf16_f32 v199, v78, v79
    s_movk_i32 s29, 7168
    buffer_store_dwordx4 v[196:199], v2, s[20:23], s29 offen sc1
    v_pk_mul_f32 v[80:81], v[80:81], s[50:51]
    v_cvt_pk_bf16_f32 v200, v80, v81
    v_pk_mul_f32 v[82:83], v[82:83], s[50:51]
    v_cvt_pk_bf16_f32 v201, v82, v83
    v_pk_mul_f32 v[84:85], v[84:85], s[50:51]
    v_cvt_pk_bf16_f32 v202, v84, v85
    v_pk_mul_f32 v[86:87], v[86:87], s[50:51]
    v_cvt_pk_bf16_f32 v203, v86, v87
    s_movk_i32 s29, 8192
    buffer_store_dwordx4 v[200:203], v2, s[20:23], s29 offen sc1
    s_endpgm
L_k1_B:
    s_lshl_b32 s27, s60, 1
    s_add_u32 s27, s27, s26
    s_mul_i32 s28, s24, 9216
    s_add_u32 s28, s28, 82944
    s_mul_i32 s54, s27, 9216
    s_waitcnt lgkmcnt(0)
    s_add_u32 s8, s32, s54
    s_addc_u32 s9, s33, 0
    s_mov_b32 s10, 9216
    s_mov_b32 s11, 0x20000
    s_add_u32 s12, s42, 0
    s_addc_u32 s13, s43, 0
    s_mov_b32 s14, 82944
    s_mov_b32 s15, 0x20000
    s_add_u32 m0, s28, 0
    s_movk_i32 s29, 0
    buffer_load_dwordx4 v2, s[8:11], s29 offen offset:0 lds
    buffer_load_dwordx4 v2, s[8:11], s29 offen offset:1024 lds
    buffer_load_dwordx4 v2, s[8:11], s29 offen offset:2048 lds
    buffer_load_dwordx4 v2, s[8:11], s29 offen offset:3072 lds
    s_add_u32 m0, s28, 4096
    s_movk_i32 s29, 4096
    buffer_load_dwordx4 v2, s[8:11], s29 offen offset:0 lds
    buffer_load_dwordx4 v2, s[8:11], s29 offen offset:1024 lds
    buffer_load_dwordx4 v2, s[8:11], s29 offen offset:2048 lds
    buffer_load_dwordx4 v2, s[8:11], s29 offen offset:3072 lds
    s_add_u32 m0, s28, 8192
    s_movk_i32 s29, 8192
    buffer_load_dwordx4 v2, s[8:11], s29 offen offset:0 lds
    s_mul_i32 s31, s24, 21504
    s_min_u32 s30, s31, 78848
    s_add_u32 m0, s30, 0
    s_add_u32 s31, s31, 4096
    buffer_load_dwordx4 v2, s[12:15], s30 offen offset:0 lds
    buffer_load_dwordx4 v2, s[12:15], s30 offen offset:1024 lds
    buffer_load_dwordx4 v2, s[12:15], s30 offen offset:2048 lds
    buffer_load_dwordx4 v2, s[12:15], s30 offen offset:3072 lds
    s_min_u32 s30, s31, 78848
    s_add_u32 m0, s30, 0
    s_add_u32 s31, s31, 4096
    buffer_load_dwordx4 v2, s[12:15], s30 offen offset:0 lds
    buffer_load_dwordx4 v2, s[12:15], s30 offen offset:1024 lds
    buffer_load_dwordx4 v2, s[12:15], s30 offen offset:2048 lds
    buffer_load_dwordx4 v2, s[12:15], s30 offen offset:3072 lds
    s_min_u32 s30, s31, 78848
    s_add_u32 m0, s30, 0
    s_add_u32 s31, s31, 4096
    buffer_load_dwordx4 v2, s[12:15], s30 offen offset:0 lds
    buffer_load_dwordx4 v2, s[12:15], s30 offen offset:1024 lds
    buffer_load_dwordx4 v2, s[12:15], s30 offen offset:2048 lds
    buffer_load_dwordx4 v2, s[12:15], s30 offen offset:3072 lds
    s_min_u32 s30, s31, 78848
    s_add_u32 m0, s30, 0
    s_add_u32 s31, s31, 4096
    buffer_load_dwordx4 v2, s[12:15], s30 offen offset:0 lds
    buffer_load_dwordx4 v2, s[12:15], s30 offen offset:1024 lds
    buffer_load_dwordx4 v2, s[12:15], s30 offen offset:2048 lds
    buffer_load_dwordx4 v2, s[12:15], s30 offen offset:3072 lds
    s_min_u32 s30, s31, 78848
    s_add_u32 m0, s30, 0
    s_add_u32 s31, s31, 4096
    buffer_load_dwordx4 v2, s[12:15], s30 offen offset:0 lds
    buffer_load_dwordx4 v2, s[12:15], s30 offen offset:1024 lds
    buffer_load_dwordx4 v2, s[12:15], s30 offen offset:2048 lds
    buffer_load_dwordx4 v2, s[12:15], s30 offen offset:3072 lds
    s_min_u32 s30, s31, 81920
    s_add_u32 m0, s30, 0
    s_add_u32 s31, s31, 1024
    buffer_load_dwordx4 v2, s[12:15], s30 offen offset:0 lds
    v_bfe_u32 v176, v1, 2, 2
    v_lshl_add_u32 v176, v7, 3, v176
    v_mul_u32_u24 v4, 576, v176
    v_bfe_u32 v176, v1, 4, 1
    v_lshl_add_u32 v4, v176, 5, v4
    v_and_b32 v176, 1, v1
    v_lshl_add_u32 v4, v176, 4, v4
    v_bfe_u32 v176, v1, 1, 1
    v_lshl_add_u32 v4, v176, 3, v4
    v_add_u32 v4, 0, v4
    v_add_u32 v6, 36864, v4
    s_mul_i32 s29, s25, 288
    v_add_u32 v4, s29, v4
    v_add_u32 v6, s29, v6
    s_mov_b32 s52, 0xbdd2d3e8
    s_mov_b32 s53, 0xbdd2d3e8
    s_mul_i32 s55, s25, 2359296
    s_add_u32 s55, s55, s54
    s_add_u32 s20, s4, s55
    s_addc_u32 s21, s5, 0
    s_add_u32 s20, s20, 9699328
    s_addc_u32 s21, s21, 0
    s_mov_b32 s22, 9216
    s_mov_b32 s23, 0x20000
    s_waitcnt vmcnt(21)
    v_mov_b32 v3, v8
    v_mul_u32_u24 v3, 288, v3
    v_lshl_add_u32 v3, v7, 4, v3
    v_add_u32 v3, s28, v3
    ds_read_b128 v[16:19], v3 offset:0
    ds_read_b128 v[20:23], v3 offset:32
    ds_read_b128 v[24:27], v3 offset:64
    ds_read_b128 v[28:31], v3 offset:96
    ds_read_b128 v[32:35], v3 offset:128
    ds_read_b128 v[36:39], v3 offset:160
    ds_read_b128 v[40:43], v3 offset:192
    ds_read_b128 v[44:47], v3 offset:224
    ds_read_b128 v[48:51], v3 offset:256
    v_mov_b32 v184, 0x3f803f80
    v_mov_b32 v176, 0
    v_mov_b32 v177, 0
    v_mov_b32 v178, 0
    v_mov_b32 v179, 0
    s_waitcnt lgkmcnt(8)
    v_dot2_f32_bf16 v176, v16, v184, v176
    v_dot2_f32_bf16 v178, v16, v16, v178
    v_dot2_f32_bf16 v177, v17, v184, v177
    v_dot2_f32_bf16 v179, v17, v17, v179
    v_dot2_f32_bf16 v176, v18, v184, v176
    v_dot2_f32_bf16 v178, v18, v18, v178
    v_dot2_f32_bf16 v177, v19, v184, v177
    v_dot2_f32_bf16 v179, v19, v19, v179
    s_waitcnt lgkmcnt(7)
    v_dot2_f32_bf16 v176, v20, v184, v176
    v_dot2_f32_bf16 v178, v20, v20, v178
    v_dot2_f32_bf16 v177, v21, v184, v177
    v_dot2_f32_bf16 v179, v21, v21, v179
    v_dot2_f32_bf16 v176, v22, v184, v176
    v_dot2_f32_bf16 v178, v22, v22, v178
    v_dot2_f32_bf16 v177, v23, v184, v177
    v_dot2_f32_bf16 v179, v23, v23, v179
    s_waitcnt lgkmcnt(6)
    v_dot2_f32_bf16 v176, v24, v184, v176
    v_dot2_f32_bf16 v178, v24, v24, v178
    v_dot2_f32_bf16 v177, v25, v184, v177
    v_dot2_f32_bf16 v179, v25, v25, v179
    v_dot2_f32_bf16 v176, v26, v184, v176
    v_dot2_f32_bf16 v178, v26, v26, v178
    v_dot2_f32_bf16 v177, v27, v184, v177
    v_dot2_f32_bf16 v179, v27, v27, v179
    s_waitcnt lgkmcnt(5)
    v_dot2_f32_bf16 v176, v28, v184, v176
    v_dot2_f32_bf16 v178, v28, v28, v178
    v_dot2_f32_bf16 v177, v29, v184, v177
    v_dot2_f32_bf16 v179, v29, v29, v179
    v_dot2_f32_bf16 v176, v30, v184, v176
    v_dot2_f32_bf16 v178, v30, v30, v178
    v_dot2_f32_bf16 v177, v31, v184, v177
    v_dot2_f32_bf16 v179, v31, v31, v179
    s_waitcnt lgkmcnt(4)
    v_dot2_f32_bf16 v176, v32, v184, v176
    v_dot2_f32_bf16 v178, v32, v32, v178
    v_dot2_f32_bf16 v177, v33, v184, v177
    v_dot2_f32_bf16 v179, v33, v33, v179
    v_dot2_f32_bf16 v176, v34, v184, v176
    v_dot2_f32_bf16 v178, v34, v34, v178
    v_dot2_f32_bf16 v177, v35, v184, v177
    v_dot2_f32_bf16 v179, v35, v35, v179
    s_waitcnt lgkmcnt(3)
    v_dot2_f32_bf16 v176, v36, v184, v176
    v_dot2_f32_bf16 v178, v36, v36, v178
    v_dot2_f32_bf16 v177, v37, v184, v177
    v_dot2_f32_bf16 v179, v37, v37, v179
    v_dot2_f32_bf16 v176, v38, v184, v176
    v_dot2_f32_bf16 v178, v38, v38, v178
    v_dot2_f32_bf16 v177, v39, v184, v177
    v_dot2_f32_bf16 v179, v39, v39, v179
    s_waitcnt lgkmcnt(2)
    v_dot2_f32_bf16 v176, v40, v184, v176
    v_dot2_f32_bf16 v178, v40, v40, v178
    v_dot2_f32_bf16 v177, v41, v184, v177
    v_dot2_f32_bf16 v179, v41, v41, v179
    v_dot2_f32_bf16 v176, v42, v184, v176
    v_dot2_f32_bf16 v178, v42, v42, v178
    v_dot2_f32_bf16 v177, v43, v184, v177
    v_dot2_f32_bf16 v179, v43, v43, v179
    s_waitcnt lgkmcnt(1)
    v_dot2_f32_bf16 v176, v44, v184, v176
    v_dot2_f32_bf16 v178, v44, v44, v178
    v_dot2_f32_bf16 v177, v45, v184, v177
    v_dot2_f32_bf16 v179, v45, v45, v179
    v_dot2_f32_bf16 v176, v46, v184, v176
    v_dot2_f32_bf16 v178, v46, v46, v178
    v_dot2_f32_bf16 v177, v47, v184, v177
    v_dot2_f32_bf16 v179, v47, v47, v179
    s_waitcnt lgkmcnt(0)
    v_dot2_f32_bf16 v176, v48, v184, v176
    v_dot2_f32_bf16 v178, v48, v48, v178
    v_dot2_f32_bf16 v177, v49, v184, v177
    v_dot2_f32_bf16 v179, v49, v49, v179
    v_dot2_f32_bf16 v176, v50, v184, v176
    v_dot2_f32_bf16 v178, v50, v50, v178
    v_dot2_f32_bf16 v177, v51, v184, v177
    v_dot2_f32_bf16 v179, v51, v51, v179
    s_nop 2
    v_add_f32 v176, v176, v177
    v_add_f32 v178, v178, v179
    v_mov_b32 v177, v176
    s_nop 1
    v_permlane32_swap_b32 v176, v177
    s_nop 1
    v_add_f32 v176, v176, v177
    v_mov_b32 v179, v178
    s_nop 1
    v_permlane32_swap_b32 v178, v179
    s_nop 1
    v_add_f32 v178, v178, v179
    v_mul_f32 v176, 0x3be38e39, v176
    v_mul_f32 v178, 0x3be38e39, v178
    v_fma_f32 v178, -v176, v176, v178
    v_max_f32 v178, 0, v178
    v_add_f32 v178, 0x3727c5ac, v178
    v_rsq_f32 v180, v178
    s_nop 0
    v_mul_f32 v182, v176, v180
    v_sub_f32 v182, 0, v182
    v_lshlrev_b32 v186, 16, v16
    v_and_b32 v187, 0xffff0000, v16
    v_pk_fma_f32 v[186:187], v[186:187], v[180:181], v[182:183] op_sel_hi:[1,0,0]
    v_cvt_pk_bf16_f32 v16, v186, v187
    v_lshlrev_b32 v188, 16, v17
    v_and_b32 v189, 0xffff0000, v17
    v_pk_fma_f32 v[188:189], v[188:189], v[180:181], v[182:183] op_sel_hi:[1,0,0]
    v_cvt_pk_bf16_f32 v17, v188, v189
    v_lshlrev_b32 v190, 16, v18
    v_and_b32 v191, 0xffff0000, v18
    v_pk_fma_f32 v[190:191], v[190:191], v[180:181], v[182:183] op_sel_hi:[1,0,0]
    v_cvt_pk_bf16_f32 v18, v190, v191
    v_lshlrev_b32 v192, 16, v19
    v_and_b32 v193, 0xffff0000, v19
    v_pk_fma_f32 v[192:193], v[192:193], v[180:181], v[182:183] op_sel_hi:[1,0,0]
    v_cvt_pk_bf16_f32 v19, v192, v193
    v_lshlrev_b32 v186, 16, v20
    v_and_b32 v187, 0xffff0000, v20
    v_pk_fma_f32 v[186:187], v[186:187], v[180:181], v[182:183] op_sel_hi:[1,0,0]
    v_cvt_pk_bf16_f32 v20, v186, v187
    v_lshlrev_b32 v188, 16, v21
    v_and_b32 v189, 0xffff0000, v21
    v_pk_fma_f32 v[188:189], v[188:189], v[180:181], v[182:183] op_sel_hi:[1,0,0]
    v_cvt_pk_bf16_f32 v21, v188, v189
    v_lshlrev_b32 v190, 16, v22
    v_and_b32 v191, 0xffff0000, v22
    v_pk_fma_f32 v[190:191], v[190:191], v[180:181], v[182:183] op_sel_hi:[1,0,0]
    v_cvt_pk_bf16_f32 v22, v190, v191
    v_lshlrev_b32 v192, 16, v23
    v_and_b32 v193, 0xffff0000, v23
    v_pk_fma_f32 v[192:193], v[192:193], v[180:181], v[182:183] op_sel_hi:[1,0,0]
    v_cvt_pk_bf16_f32 v23, v192, v193
    v_lshlrev_b32 v186, 16, v24
    v_and_b32 v187, 0xffff0000, v24
    v_pk_fma_f32 v[186:187], v[186:187], v[180:181], v[182:183] op_sel_hi:[1,0,0]
    v_cvt_pk_bf16_f32 v24, v186, v187
    v_lshlrev_b32 v188, 16, v25
    v_and_b32 v189, 0xffff0000, v25
    v_pk_fma_f32 v[188:189], v[188:189], v[180:181], v[182:183] op_sel_hi:[1,0,0]
    v_cvt_pk_bf16_f32 v25, v188, v189
    v_lshlrev_b32 v190, 16, v26
    v_and_b32 v191, 0xffff0000, v26
    v_pk_fma_f32 v[190:191], v[190:191], v[180:181], v[182:183] op_sel_hi:[1,0,0]
    v_cvt_pk_bf16_f32 v26, v190, v191
    v_lshlrev_b32 v192, 16, v27
    v_and_b32 v193, 0xffff0000, v27
    v_pk_fma_f32 v[192:193], v[192:193], v[180:181], v[182:183] op_sel_hi:[1,0,0]
    v_cvt_pk_bf16_f32 v27, v192, v193
    v_lshlrev_b32 v186, 16, v28
    v_and_b32 v187, 0xffff0000, v28
    v_pk_fma_f32 v[186:187], v[186:187], v[180:181], v[182:183] op_sel_hi:[1,0,0]
    v_cvt_pk_bf16_f32 v28, v186, v187
    v_lshlrev_b32 v188, 16, v29
    v_and_b32 v189, 0xffff0000, v29
    v_pk_fma_f32 v[188:189], v[188:189], v[180:181], v[182:183] op_sel_hi:[1,0,0]
    v_cvt_pk_bf16_f32 v29, v188, v189
    v_lshlrev_b32 v190, 16, v30
    v_and_b32 v191, 0xffff0000, v30
    v_pk_fma_f32 v[190:191], v[190:191], v[180:181], v[182:183] op_sel_hi:[1,0,0]
    v_cvt_pk_bf16_f32 v30, v190, v191
    v_lshlrev_b32 v192, 16, v31
    v_and_b32 v193, 0xffff0000, v31
    v_pk_fma_f32 v[192:193], v[192:193], v[180:181], v[182:183] op_sel_hi:[1,0,0]
    v_cvt_pk_bf16_f32 v31, v192, v193
    v_lshlrev_b32 v186, 16, v32
    v_and_b32 v187, 0xffff0000, v32
    v_pk_fma_f32 v[186:187], v[186:187], v[180:181], v[182:183] op_sel_hi:[1,0,0]
    v_cvt_pk_bf16_f32 v32, v186, v187
    v_lshlrev_b32 v188, 16, v33
    v_and_b32 v189, 0xffff0000, v33
    v_pk_fma_f32 v[188:189], v[188:189], v[180:181], v[182:183] op_sel_hi:[1,0,0]
    v_cvt_pk_bf16_f32 v33, v188, v189
    v_lshlrev_b32 v190, 16, v34
    v_and_b32 v191, 0xffff0000, v34
    v_pk_fma_f32 v[190:191], v[190:191], v[180:181], v[182:183] op_sel_hi:[1,0,0]
    v_cvt_pk_bf16_f32 v34, v190, v191
    v_lshlrev_b32 v192, 16, v35
    v_and_b32 v193, 0xffff0000, v35
    v_pk_fma_f32 v[192:193], v[192:193], v[180:181], v[182:183] op_sel_hi:[1,0,0]
    v_cvt_pk_bf16_f32 v35, v192, v193
    v_lshlrev_b32 v186, 16, v36
    v_and_b32 v187, 0xffff0000, v36
    v_pk_fma_f32 v[186:187], v[186:187], v[180:181], v[182:183] op_sel_hi:[1,0,0]
    v_cvt_pk_bf16_f32 v36, v186, v187
    v_lshlrev_b32 v188, 16, v37
    v_and_b32 v189, 0xffff0000, v37
    v_pk_fma_f32 v[188:189], v[188:189], v[180:181], v[182:183] op_sel_hi:[1,0,0]
    v_cvt_pk_bf16_f32 v37, v188, v189
    v_lshlrev_b32 v190, 16, v38
    v_and_b32 v191, 0xffff0000, v38
    v_pk_fma_f32 v[190:191], v[190:191], v[180:181], v[182:183] op_sel_hi:[1,0,0]
    v_cvt_pk_bf16_f32 v38, v190, v191
    v_lshlrev_b32 v192, 16, v39
    v_and_b32 v193, 0xffff0000, v39
    v_pk_fma_f32 v[192:193], v[192:193], v[180:181], v[182:183] op_sel_hi:[1,0,0]
    v_cvt_pk_bf16_f32 v39, v192, v193
    v_lshlrev_b32 v186, 16, v40
    v_and_b32 v187, 0xffff0000, v40
    v_pk_fma_f32 v[186:187], v[186:187], v[180:181], v[182:183] op_sel_hi:[1,0,0]
    v_cvt_pk_bf16_f32 v40, v186, v187
    v_lshlrev_b32 v188, 16, v41
    v_and_b32 v189, 0xffff0000, v41
    v_pk_fma_f32 v[188:189], v[188:189], v[180:181], v[182:183] op_sel_hi:[1,0,0]
    v_cvt_pk_bf16_f32 v41, v188, v189
    v_lshlrev_b32 v190, 16, v42
    v_and_b32 v191, 0xffff0000, v42
    v_pk_fma_f32 v[190:191], v[190:191], v[180:181], v[182:183] op_sel_hi:[1,0,0]
    v_cvt_pk_bf16_f32 v42, v190, v191
    v_lshlrev_b32 v192, 16, v43
    v_and_b32 v193, 0xffff0000, v43
    v_pk_fma_f32 v[192:193], v[192:193], v[180:181], v[182:183] op_sel_hi:[1,0,0]
    v_cvt_pk_bf16_f32 v43, v192, v193
    v_lshlrev_b32 v186, 16, v44
    v_and_b32 v187, 0xffff0000, v44
    v_pk_fma_f32 v[186:187], v[186:187], v[180:181], v[182:183] op_sel_hi:[1,0,0]
    v_cvt_pk_bf16_f32 v44, v186, v187
    v_lshlrev_b32 v188, 16, v45
    v_and_b32 v189, 0xffff0000, v45
    v_pk_fma_f32 v[188:189], v[188:189], v[180:181], v[182:183] op_sel_hi:[1,0,0]
    v_cvt_pk_bf16_f32 v45, v188, v189
    v_lshlrev_b32 v190, 16, v46
    v_and_b32 v191, 0xffff0000, v46
    v_pk_fma_f32 v[190:191], v[190:191], v[180:181], v[182:183] op_sel_hi:[1,0,0]
    v_cvt_pk_bf16_f32 v46, v190, v191
    v_lshlrev_b32 v192, 16, v47
    v_and_b32 v193, 0xffff0000, v47
    v_pk_fma_f32 v[192:193], v[192:193], v[180:181], v[182:183] op_sel_hi:[1,0,0]
    v_cvt_pk_bf16_f32 v47, v192, v193
    v_lshlrev_b32 v186, 16, v48
    v_and_b32 v187, 0xffff0000, v48
    v_pk_fma_f32 v[186:187], v[186:187], v[180:181], v[182:183] op_sel_hi:[1,0,0]
    v_cvt_pk_bf16_f32 v48, v186, v187
    v_lshlrev_b32 v188, 16, v49
    v_and_b32 v189, 0xffff0000, v49
    v_pk_fma_f32 v[188:189], v[188:189], v[180:181], v[182:183] op_sel_hi:[1,0,0]
    v_cvt_pk_bf16_f32 v49, v188, v189
    v_lshlrev_b32 v190, 16, v50
    v_and_b32 v191, 0xffff0000, v50
    v_pk_fma_f32 v[190:191], v[190:191], v[180:181], v[182:183] op_sel_hi:[1,0,0]
    v_cvt_pk_bf16_f32 v50, v190, v191
    v_lshlrev_b32 v192, 16, v51
    v_and_b32 v193, 0xffff0000, v51
    v_pk_fma_f32 v[192:193], v[192:193], v[180:181], v[182:183] op_sel_hi:[1,0,0]
    v_cvt_pk_bf16_f32 v51, v192, v193
    s_waitcnt vmcnt(0)
    s_barrier
    v_mov_b32 v188, 0xc0135761
    v_mov_b32 v189, 0xc0135761
    ds_read_b64_tr_b16 v[144:145], v4 offset:0
    ds_read_b64_tr_b16 v[146:147], v4 offset:2304
    ds_read_b64_tr_b16 v[148:149], v4 offset:9216
    ds_read_b64_tr_b16 v[150:151], v4 offset:11520
    ds_read_b64_tr_b16 v[152:153], v4 offset:18432
    ds_read_b64_tr_b16 v[154:155], v4 offset:20736
    ds_read_b64_tr_b16 v[156:157], v4 offset:27648
    ds_read_b64_tr_b16 v[158:159], v4 offset:29952
    s_waitcnt lgkmcnt(6)
    v_mfma_f32_32x32x16_bf16 v[64:79], v[144:147], v[16:19], 0
    ds_read_b64_tr_b16 v[160:161], v6 offset:0
    ds_read_b64_tr_b16 v[162:163], v6 offset:2304
    s_waitcnt lgkmcnt(6)
    v_mfma_f32_32x32x16_bf16 v[64:79], v[148:151], v[20:23], v[64:79]
    ds_read_b64_tr_b16 v[164:165], v6 offset:9216
    ds_read_b64_tr_b16 v[166:167], v6 offset:11520
    s_waitcnt lgkmcnt(6)
    v_mfma_f32_32x32x16_bf16 v[64:79], v[152:155], v[24:27], v[64:79]
    ds_read_b64_tr_b16 v[168:169], v6 offset:18432
    ds_read_b64_tr_b16 v[170:171], v6 offset:20736
    s_waitcnt lgkmcnt(6)
    v_mfma_f32_32x32x16_bf16 v[64:79], v[156:159], v[28:31], v[64:79]
    ds_read_b64_tr_b16 v[172:173], v6 offset:27648
    ds_read_b64_tr_b16 v[174:175], v6 offset:29952
    s_waitcnt lgkmcnt(6)
    v_mfma_f32_32x32x16_bf16 v[64:79], v[160:163], v[32:35], v[64:79]
    ds_read_b64_tr_b16 v[144:145], v6 offset:36864
    ds_read_b64_tr_b16 v[146:147], v6 offset:39168
    s_waitcnt lgkmcnt(6)
    v_mfma_f32_32x32x16_bf16 v[64:79], v[164:167], v[36:39], v[64:79]
    ds_read_b64_tr_b16 v[148:149], v4 offset:64
    ds_read_b64_tr_b16 v[150:151], v4 offset:2368
    s_waitcnt lgkmcnt(6)
    v_mfma_f32_32x32x16_bf16 v[64:79], v[168:171], v[40:43], v[64:79]
    ds_read_b64_tr_b16 v[152:153], v4 offset:9280
    ds_read_b64_tr_b16 v[154:155], v4 offset:11584
    s_waitcnt lgkmcnt(6)
    v_mfma_f32_32x32x16_bf16 v[64:79], v[172:175], v[44:47], v[64:79]
    ds_read_b64_tr_b16 v[156:157], v4 offset:18496
    ds_read_b64_tr_b16 v[158:159], v4 offset:20800
    s_waitcnt lgkmcnt(6)
    v_mfma_f32_32x32x16_bf16 v[64:79], v[144:147], v[48:51], v[64:79]
    ds_read_b64_tr_b16 v[160:161], v4 offset:27712
    ds_read_b64_tr_b16 v[162:163], v4 offset:30016
    s_waitcnt lgkmcnt(6)
    v_mfma_f32_32x32x16_bf16 v[80:95], v[148:151], v[16:19], 0
    ds_read_b64_tr_b16 v[164:165], v6 offset:64
    ds_read_b64_tr_b16 v[166:167], v6 offset:2368
    s_waitcnt lgkmcnt(6)
    v_mfma_f32_32x32x16_bf16 v[80:95], v[152:155], v[20:23], v[80:95]
    ds_read_b64_tr_b16 v[168:169], v6 offset:9280
    ds_read_b64_tr_b16 v[170:171], v6 offset:11584
    s_waitcnt lgkmcnt(6)
    v_mfma_f32_32x32x16_bf16 v[80:95], v[156:159], v[24:27], v[80:95]
    ds_read_b64_tr_b16 v[172:173], v6 offset:18496
    ds_read_b64_tr_b16 v[174:175], v6 offset:20800
    s_waitcnt lgkmcnt(6)
    v_mfma_f32_32x32x16_bf16 v[80:95], v[160:163], v[28:31], v[80:95]
    ds_read_b64_tr_b16 v[144:145], v6 offset:27712
    ds_read_b64_tr_b16 v[146:147], v6 offset:30016
    v_pk_mul_f32 v[192:193], v[64:65], v[64:65]
    v_pk_mul_f32 v[196:197], v[66:67], v[66:67]
    v_pk_mul_f32 v[200:201], v[68:69], v[68:69]
    v_pk_mul_f32 v[204:205], v[70:71], v[70:71]
    v_pk_fma_f32 v[192:193], v[192:193], s[52:53], v[188:189]
    v_pk_fma_f32 v[196:197], v[196:197], s[52:53], v[188:189]
    v_pk_fma_f32 v[200:201], v[200:201], s[52:53], v[188:189]
    v_pk_fma_f32 v[204:205], v[204:205], s[52:53], v[188:189]
    s_waitcnt lgkmcnt(6)
    v_mfma_f32_32x32x16_bf16 v[80:95], v[164:167], v[32:35], v[80:95]
    ds_read_b64_tr_b16 v[148:149], v6 offset:36928
    ds_read_b64_tr_b16 v[150:151], v6 offset:39232
    v_pk_mul_f32 v[192:193], v[192:193], v[64:65]
    v_pk_mul_f32 v[196:197], v[196:197], v[66:67]
    v_pk_mul_f32 v[200:201], v[200:201], v[68:69]
    v_pk_mul_f32 v[204:205], v[204:205], v[70:71]
    v_exp_f32 v192, v192
    v_exp_f32 v193, v193
    v_exp_f32 v196, v196
    v_exp_f32 v197, v197
    s_waitcnt lgkmcnt(6)
    v_mfma_f32_32x32x16_bf16 v[80:95], v[168:171], v[36:39], v[80:95]
    ds_read_b64_tr_b16 v[152:153], v4 offset:128
    ds_read_b64_tr_b16 v[154:155], v4 offset:2432
    v_exp_f32 v200, v200
    v_exp_f32 v201, v201
    v_exp_f32 v204, v204
    v_exp_f32 v205, v205
    v_pk_add_f32 v[192:193], v[192:193], 1.0 op_sel_hi:[1,0]
    v_pk_add_f32 v[196:197], v[196:197], 1.0 op_sel_hi:[1,0]
    v_pk_add_f32 v[200:201], v[200:201], 1.0 op_sel_hi:[1,0]
    v_pk_add_f32 v[204:205], v[204:205], 1.0 op_sel_hi:[1,0]
    s_waitcnt lgkmcnt(6)
    v_mfma_f32_32x32x16_bf16 v[80:95], v[172:175], v[40:43], v[80:95]
    ds_read_b64_tr_b16 v[156:157], v4 offset:9344
    ds_read_b64_tr_b16 v[158:159], v4 offset:11648
    v_rcp_f32 v192, v192
    v_rcp_f32 v193, v193
    v_rcp_f32 v196, v196
    v_rcp_f32 v197, v197
    v_rcp_f32 v200, v200
    v_rcp_f32 v201, v201
    v_rcp_f32 v204, v204
    v_rcp_f32 v205, v205
    s_waitcnt lgkmcnt(6)
    v_mfma_f32_32x32x16_bf16 v[80:95], v[144:147], v[44:47], v[80:95]
    ds_read_b64_tr_b16 v[160:161], v4 offset:18560
    ds_read_b64_tr_b16 v[162:163], v4 offset:20864
    v_pk_mul_f32 v[64:65], v[64:65], v[192:193]
    v_pk_mul_f32 v[66:67], v[66:67], v[196:197]
    v_pk_mul_f32 v[68:69], v[68:69], v[200:201]
    v_pk_mul_f32 v[70:71], v[70:71], v[204:205]
    v_pk_mul_f32 v[192:193], v[72:73], v[72:73]
    v_pk_mul_f32 v[196:197], v[74:75], v[74:75]
    v_pk_mul_f32 v[200:201], v[76:77], v[76:77]
    v_pk_mul_f32 v[204:205], v[78:79], v[78:79]
    s_waitcnt lgkmcnt(6)
    v_mfma_f32_32x32x16_bf16 v[80:95], v[148:151], v[48:51], v[80:95]
    ds_read_b64_tr_b16 v[164:165], v4 offset:27776
    ds_read_b64_tr_b16 v[166:167], v4 offset:30080
    v_pk_fma_f32 v[192:193], v[192:193], s[52:53], v[188:189]
    v_pk_fma_f32 v[196:197], v[196:197], s[52:53], v[188:189]
    v_pk_fma_f32 v[200:201], v[200:201], s[52:53], v[188:189]
    v_pk_fma_f32 v[204:205], v[204:205], s[52:53], v[188:189]
    v_pk_mul_f32 v[192:193], v[192:193], v[72:73]
    v_pk_mul_f32 v[196:197], v[196:197], v[74:75]
    v_pk_mul_f32 v[200:201], v[200:201], v[76:77]
    v_pk_mul_f32 v[204:205], v[204:205], v[78:79]
    s_waitcnt lgkmcnt(6)
    v_mfma_f32_32x32x16_bf16 v[96:111], v[152:155], v[16:19], 0
    ds_read_b64_tr_b16 v[168:169], v6 offset:128
    ds_read_b64_tr_b16 v[170:171], v6 offset:2432
    v_exp_f32 v192, v192
    v_exp_f32 v193, v193
    v_exp_f32 v196, v196
    v_exp_f32 v197, v197
    v_exp_f32 v200, v200
    v_exp_f32 v201, v201
    v_exp_f32 v204, v204
    v_exp_f32 v205, v205
    s_waitcnt lgkmcnt(6)
    v_mfma_f32_32x32x16_bf16 v[96:111], v[156:159], v[20:23], v[96:111]
    ds_read_b64_tr_b16 v[172:173], v6 offset:9344
    ds_read_b64_tr_b16 v[174:175], v6 offset:11648
    v_pk_add_f32 v[192:193], v[192:193], 1.0 op_sel_hi:[1,0]
    v_pk_add_f32 v[196:197], v[196:197], 1.0 op_sel_hi:[1,0]
    v_pk_add_f32 v[200:201], v[200:201], 1.0 op_sel_hi:[1,0]
    v_pk_add_f32 v[204:205], v[204:205], 1.0 op_sel_hi:[1,0]
    v_rcp_f32 v192, v192
    v_rcp_f32 v193, v193
    v_rcp_f32 v196, v196
    v_rcp_f32 v197, v197
    s_waitcnt lgkmcnt(6)
    v_mfma_f32_32x32x16_bf16 v[96:111], v[160:163], v[24:27], v[96:111]
    ds_read_b64_tr_b16 v[144:145], v6 offset:18560
    ds_read_b64_tr_b16 v[146:147], v6 offset:20864
    v_rcp_f32 v200, v200
    v_rcp_f32 v201, v201
    v_rcp_f32 v204, v204
    v_rcp_f32 v205, v205
    v_pk_mul_f32 v[72:73], v[72:73], v[192:193]
    v_pk_mul_f32 v[74:75], v[74:75], v[196:197]
    v_pk_mul_f32 v[76:77], v[76:77], v[200:201]
    v_pk_mul_f32 v[78:79], v[78:79], v[204:205]
    s_waitcnt lgkmcnt(6)
    v_mfma_f32_32x32x16_bf16 v[96:111], v[164:167], v[28:31], v[96:111]
    ds_read_b64_tr_b16 v[148:149], v6 offset:27776
    ds_read_b64_tr_b16 v[150:151], v6 offset:30080
    v_pk_mul_f32 v[192:193], v[80:81], v[80:81]
    v_pk_mul_f32 v[196:197], v[82:83], v[82:83]
    v_pk_mul_f32 v[200:201], v[84:85], v[84:85]
    v_pk_mul_f32 v[204:205], v[86:87], v[86:87]
    v_pk_fma_f32 v[192:193], v[192:193], s[52:53], v[188:189]
    v_pk_fma_f32 v[196:197], v[196:197], s[52:53], v[188:189]
    v_pk_fma_f32 v[200:201], v[200:201], s[52:53], v[188:189]
    v_pk_fma_f32 v[204:205], v[204:205], s[52:53], v[188:189]
    s_waitcnt lgkmcnt(6)
    v_mfma_f32_32x32x16_bf16 v[96:111], v[168:171], v[32:35], v[96:111]
    ds_read_b64_tr_b16 v[152:153], v6 offset:36992
    ds_read_b64_tr_b16 v[154:155], v6 offset:39296
    v_pk_mul_f32 v[192:193], v[192:193], v[80:81]
    v_pk_mul_f32 v[196:197], v[196:197], v[82:83]
    v_pk_mul_f32 v[200:201], v[200:201], v[84:85]
    v_pk_mul_f32 v[204:205], v[204:205], v[86:87]
    v_exp_f32 v192, v192
    v_exp_f32 v193, v193
    v_exp_f32 v196, v196
    v_exp_f32 v197, v197
    s_waitcnt lgkmcnt(6)
    v_mfma_f32_32x32x16_bf16 v[96:111], v[172:175], v[36:39], v[96:111]
    ds_read_b64_tr_b16 v[156:157], v4 offset:192
    ds_read_b64_tr_b16 v[158:159], v4 offset:2496
    v_exp_f32 v200, v200
    v_exp_f32 v201, v201
    v_exp_f32 v204, v204
    v_exp_f32 v205, v205
    v_pk_add_f32 v[192:193], v[192:193], 1.0 op_sel_hi:[1,0]
    v_pk_add_f32 v[196:197], v[196:197], 1.0 op_sel_hi:[1,0]
    v_pk_add_f32 v[200:201], v[200:201], 1.0 op_sel_hi:[1,0]
    v_pk_add_f32 v[204:205], v[204:205], 1.0 op_sel_hi:[1,0]
    s_waitcnt lgkmcnt(6)
    v_mfma_f32_32x32x16_bf16 v[96:111], v[144:147], v[40:43], v[96:111]
    ds_read_b64_tr_b16 v[160:161], v4 offset:9408
    ds_read_b64_tr_b16 v[162:163], v4 offset:11712
    v_rcp_f32 v192, v192
    v_rcp_f32 v193, v193
    v_rcp_f32 v196, v196
    v_rcp_f32 v197, v197
    v_rcp_f32 v200, v200
    v_rcp_f32 v201, v201
    v_rcp_f32 v204, v204
    v_rcp_f32 v205, v205
    s_waitcnt lgkmcnt(6)
    v_mfma_f32_32x32x16_bf16 v[96:111], v[148:151], v[44:47], v[96:111]
    ds_read_b64_tr_b16 v[164:165], v4 offset:18624
    ds_read_b64_tr_b16 v[166:167], v4 offset:20928
    v_pk_mul_f32 v[80:81], v[80:81], v[192:193]
    v_pk_mul_f32 v[82:83], v[82:83], v[196:197]
    v_pk_mul_f32 v[84:85], v[84:85], v[200:201]
    v_pk_mul_f32 v[86:87], v[86:87], v[204:205]
    v_pk_mul_f32 v[192:193], v[88:89], v[88:89]
    v_pk_mul_f32 v[196:197], v[90:91], v[90:91]
    v_pk_mul_f32 v[200:201], v[92:93], v[92:93]
    v_pk_mul_f32 v[204:205], v[94:95], v[94:95]
    s_waitcnt lgkmcnt(6)
    v_mfma_f32_32x32x16_bf16 v[96:111], v[152:155], v[48:51], v[96:111]
    ds_read_b64_tr_b16 v[168:169], v4 offset:27840
    ds_read_b64_tr_b16 v[170:171], v4 offset:30144
    v_pk_fma_f32 v[192:193], v[192:193], s[52:53], v[188:189]
    v_pk_fma_f32 v[196:197], v[196:197], s[52:53], v[188:189]
    v_pk_fma_f32 v[200:201], v[200:201], s[52:53], v[188:189]
    v_pk_fma_f32 v[204:205], v[204:205], s[52:53], v[188:189]
    v_pk_mul_f32 v[192:193], v[192:193], v[88:89]
    v_pk_mul_f32 v[196:197], v[196:197], v[90:91]
    v_pk_mul_f32 v[200:201], v[200:201], v[92:93]
    v_pk_mul_f32 v[204:205], v[204:205], v[94:95]
    s_waitcnt lgkmcnt(6)
    v_mfma_f32_32x32x16_bf16 v[112:127], v[156:159], v[16:19], 0
    ds_read_b64_tr_b16 v[172:173], v6 offset:192
    ds_read_b64_tr_b16 v[174:175], v6 offset:2496
    v_exp_f32 v192, v192
    v_exp_f32 v193, v193
    v_exp_f32 v196, v196
    v_exp_f32 v197, v197
    v_exp_f32 v200, v200
    v_exp_f32 v201, v201
    v_exp_f32 v204, v204
    v_exp_f32 v205, v205
    s_waitcnt lgkmcnt(6)
    v_mfma_f32_32x32x16_bf16 v[112:127], v[160:163], v[20:23], v[112:127]
    ds_read_b64_tr_b16 v[144:145], v6 offset:9408
    ds_read_b64_tr_b16 v[146:147], v6 offset:11712
    v_pk_add_f32 v[192:193], v[192:193], 1.0 op_sel_hi:[1,0]
    v_pk_add_f32 v[196:197], v[196:197], 1.0 op_sel_hi:[1,0]
    v_pk_add_f32 v[200:201], v[200:201], 1.0 op_sel_hi:[1,0]
    v_pk_add_f32 v[204:205], v[204:205], 1.0 op_sel_hi:[1,0]
    v_rcp_f32 v192, v192
    v_rcp_f32 v193, v193
    v_rcp_f32 v196, v196
    v_rcp_f32 v197, v197
    s_waitcnt lgkmcnt(6)
    v_mfma_f32_32x32x16_bf16 v[112:127], v[164:167], v[24:27], v[112:127]
    ds_read_b64_tr_b16 v[148:149], v6 offset:18624
    ds_read_b64_tr_b16 v[150:151], v6 offset:20928
    v_rcp_f32 v200, v200
    v_rcp_f32 v201, v201
    v_rcp_f32 v204, v204
    v_rcp_f32 v205, v205
    v_pk_mul_f32 v[88:89], v[88:89], v[192:193]
    v_pk_mul_f32 v[90:91], v[90:91], v[196:197]
    v_pk_mul_f32 v[92:93], v[92:93], v[200:201]
    v_pk_mul_f32 v[94:95], v[94:95], v[204:205]
    s_waitcnt lgkmcnt(6)
    v_mfma_f32_32x32x16_bf16 v[112:127], v[168:171], v[28:31], v[112:127]
    ds_read_b64_tr_b16 v[152:153], v6 offset:27840
    ds_read_b64_tr_b16 v[154:155], v6 offset:30144
    v_pk_mul_f32 v[192:193], v[96:97], v[96:97]
    v_pk_mul_f32 v[196:197], v[98:99], v[98:99]
    v_pk_mul_f32 v[200:201], v[100:101], v[100:101]
    v_pk_mul_f32 v[204:205], v[102:103], v[102:103]
    v_pk_fma_f32 v[192:193], v[192:193], s[52:53], v[188:189]
    v_pk_fma_f32 v[196:197], v[196:197], s[52:53], v[188:189]
    v_pk_fma_f32 v[200:201], v[200:201], s[52:53], v[188:189]
    v_pk_fma_f32 v[204:205], v[204:205], s[52:53], v[188:189]
    s_waitcnt lgkmcnt(6)
    v_mfma_f32_32x32x16_bf16 v[112:127], v[172:175], v[32:35], v[112:127]
    ds_read_b64_tr_b16 v[156:157], v6 offset:37056
    ds_read_b64_tr_b16 v[158:159], v6 offset:39360
    v_pk_mul_f32 v[192:193], v[192:193], v[96:97]
    v_pk_mul_f32 v[196:197], v[196:197], v[98:99]
    v_pk_mul_f32 v[200:201], v[200:201], v[100:101]
    v_pk_mul_f32 v[204:205], v[204:205], v[102:103]
    v_exp_f32 v192, v192
    v_exp_f32 v193, v193
    v_exp_f32 v196, v196
    v_exp_f32 v197, v197
    s_waitcnt lgkmcnt(6)
    v_mfma_f32_32x32x16_bf16 v[112:127], v[144:147], v[36:39], v[112:127]
    ds_read_b64_tr_b16 v[160:161], v4 offset:256
    ds_read_b64_tr_b16 v[162:163], v4 offset:2560
    v_exp_f32 v200, v200
    v_exp_f32 v201, v201
    v_exp_f32 v204, v204
    v_exp_f32 v205, v205
    v_pk_add_f32 v[192:193], v[192:193], 1.0 op_sel_hi:[1,0]
    v_pk_add_f32 v[196:197], v[196:197], 1.0 op_sel_hi:[1,0]
    v_pk_add_f32 v[200:201], v[200:201], 1.0 op_sel_hi:[1,0]
    v_pk_add_f32 v[204:205], v[204:205], 1.0 op_sel_hi:[1,0]
    s_waitcnt lgkmcnt(6)
    v_mfma_f32_32x32x16_bf16 v[112:127], v[148:151], v[40:43], v[112:127]
    ds_read_b64_tr_b16 v[164:165], v4 offset:9472
    ds_read_b64_tr_b16 v[166:167], v4 offset:11776
    v_rcp_f32 v192, v192
    v_rcp_f32 v193, v193
    v_rcp_f32 v196, v196
    v_rcp_f32 v197, v197
    v_rcp_f32 v200, v200
    v_rcp_f32 v201, v201
    v_rcp_f32 v204, v204
    v_rcp_f32 v205, v205
    s_waitcnt lgkmcnt(6)
    v_mfma_f32_32x32x16_bf16 v[112:127], v[152:155], v[44:47], v[112:127]
    ds_read_b64_tr_b16 v[168:169], v4 offset:18688
    ds_read_b64_tr_b16 v[170:171], v4 offset:20992
    v_pk_mul_f32 v[96:97], v[96:97], v[192:193]
    v_pk_mul_f32 v[98:99], v[98:99], v[196:197]
    v_pk_mul_f32 v[100:101], v[100:101], v[200:201]
    v_pk_mul_f32 v[102:103], v[102:103], v[204:205]
    v_pk_mul_f32 v[192:193], v[104:105], v[104:105]
    v_pk_mul_f32 v[196:197], v[106:107], v[106:107]
    v_pk_mul_f32 v[200:201], v[108:109], v[108:109]
    v_pk_mul_f32 v[204:205], v[110:111], v[110:111]
    s_waitcnt lgkmcnt(6)
    v_mfma_f32_32x32x16_bf16 v[112:127], v[156:159], v[48:51], v[112:127]
    ds_read_b64_tr_b16 v[172:173], v4 offset:27904
    ds_read_b64_tr_b16 v[174:175], v4 offset:30208
    v_pk_fma_f32 v[192:193], v[192:193], s[52:53], v[188:189]
    v_pk_fma_f32 v[196:197], v[196:197], s[52:53], v[188:189]
    v_pk_fma_f32 v[200:201], v[200:201], s[52:53], v[188:189]
    v_pk_fma_f32 v[204:205], v[204:205], s[52:53], v[188:189]
    v_pk_mul_f32 v[192:193], v[192:193], v[104:105]
    v_pk_mul_f32 v[196:197], v[196:197], v[106:107]
    v_pk_mul_f32 v[200:201], v[200:201], v[108:109]
    v_pk_mul_f32 v[204:205], v[204:205], v[110:111]
    s_waitcnt lgkmcnt(6)
    v_mfma_f32_32x32x16_bf16 v[128:143], v[160:163], v[16:19], 0
    ds_read_b64_tr_b16 v[144:145], v6 offset:256
    ds_read_b64_tr_b16 v[146:147], v6 offset:2560
    v_exp_f32 v192, v192
    v_exp_f32 v193, v193
    v_exp_f32 v196, v196
    v_exp_f32 v197, v197
    v_exp_f32 v200, v200
    v_exp_f32 v201, v201
    v_exp_f32 v204, v204
    v_exp_f32 v205, v205
    s_waitcnt lgkmcnt(6)
    v_mfma_f32_32x32x16_bf16 v[128:143], v[164:167], v[20:23], v[128:143]
    ds_read_b64_tr_b16 v[148:149], v6 offset:9472
    ds_read_b64_tr_b16 v[150:151], v6 offset:11776
    v_pk_add_f32 v[192:193], v[192:193], 1.0 op_sel_hi:[1,0]
    v_pk_add_f32 v[196:197], v[196:197], 1.0 op_sel_hi:[1,0]
    v_pk_add_f32 v[200:201], v[200:201], 1.0 op_sel_hi:[1,0]
    v_pk_add_f32 v[204:205], v[204:205], 1.0 op_sel_hi:[1,0]
    v_rcp_f32 v192, v192
    v_rcp_f32 v193, v193
    v_rcp_f32 v196, v196
    v_rcp_f32 v197, v197
    s_waitcnt lgkmcnt(6)
    v_mfma_f32_32x32x16_bf16 v[128:143], v[168:171], v[24:27], v[128:143]
    ds_read_b64_tr_b16 v[152:153], v6 offset:18688
    ds_read_b64_tr_b16 v[154:155], v6 offset:20992
    v_rcp_f32 v200, v200
    v_rcp_f32 v201, v201
    v_rcp_f32 v204, v204
    v_rcp_f32 v205, v205
    v_pk_mul_f32 v[104:105], v[104:105], v[192:193]
    v_pk_mul_f32 v[106:107], v[106:107], v[196:197]
    v_pk_mul_f32 v[108:109], v[108:109], v[200:201]
    v_pk_mul_f32 v[110:111], v[110:111], v[204:205]
    s_waitcnt lgkmcnt(6)
    v_mfma_f32_32x32x16_bf16 v[128:143], v[172:175], v[28:31], v[128:143]
    ds_read_b64_tr_b16 v[156:157], v6 offset:27904
    ds_read_b64_tr_b16 v[158:159], v6 offset:30208
    v_pk_mul_f32 v[192:193], v[112:113], v[112:113]
    v_pk_mul_f32 v[196:197], v[114:115], v[114:115]
    v_pk_mul_f32 v[200:201], v[116:117], v[116:117]
    v_pk_mul_f32 v[204:205], v[118:119], v[118:119]
    v_pk_fma_f32 v[192:193], v[192:193], s[52:53], v[188:189]
    v_pk_fma_f32 v[196:197], v[196:197], s[52:53], v[188:189]
    v_pk_fma_f32 v[200:201], v[200:201], s[52:53], v[188:189]
    v_pk_fma_f32 v[204:205], v[204:205], s[52:53], v[188:189]
    s_waitcnt lgkmcnt(6)
    v_mfma_f32_32x32x16_bf16 v[128:143], v[144:147], v[32:35], v[128:143]
    ds_read_b64_tr_b16 v[160:161], v6 offset:37120
    ds_read_b64_tr_b16 v[162:163], v6 offset:39424
    v_pk_mul_f32 v[192:193], v[192:193], v[112:113]
    v_pk_mul_f32 v[196:197], v[196:197], v[114:115]
    v_pk_mul_f32 v[200:201], v[200:201], v[116:117]
    v_pk_mul_f32 v[204:205], v[204:205], v[118:119]
    v_exp_f32 v192, v192
    v_exp_f32 v193, v193
    v_exp_f32 v196, v196
    v_exp_f32 v197, v197
    s_waitcnt lgkmcnt(6)
    v_mfma_f32_32x32x16_bf16 v[128:143], v[148:151], v[36:39], v[128:143]
    v_exp_f32 v200, v200
    v_exp_f32 v201, v201
    v_exp_f32 v204, v204
    v_exp_f32 v205, v205
    v_pk_add_f32 v[192:193], v[192:193], 1.0 op_sel_hi:[1,0]
    v_pk_add_f32 v[196:197], v[196:197], 1.0 op_sel_hi:[1,0]
    v_pk_add_f32 v[200:201], v[200:201], 1.0 op_sel_hi:[1,0]
    v_pk_add_f32 v[204:205], v[204:205], 1.0 op_sel_hi:[1,0]
    s_waitcnt lgkmcnt(4)
    v_mfma_f32_32x32x16_bf16 v[128:143], v[152:155], v[40:43], v[128:143]
    v_rcp_f32 v192, v192
    v_rcp_f32 v193, v193
    v_rcp_f32 v196, v196
    v_rcp_f32 v197, v197
    v_rcp_f32 v200, v200
    v_rcp_f32 v201, v201
    v_rcp_f32 v204, v204
    v_rcp_f32 v205, v205
    s_waitcnt lgkmcnt(2)
    v_mfma_f32_32x32x16_bf16 v[128:143], v[156:159], v[44:47], v[128:143]
    v_pk_mul_f32 v[112:113], v[112:113], v[192:193]
    v_pk_mul_f32 v[114:115], v[114:115], v[196:197]
    v_pk_mul_f32 v[116:117], v[116:117], v[200:201]
    v_pk_mul_f32 v[118:119], v[118:119], v[204:205]
    v_pk_mul_f32 v[192:193], v[120:121], v[120:121]
    v_pk_mul_f32 v[196:197], v[122:123], v[122:123]
    v_pk_mul_f32 v[200:201], v[124:125], v[124:125]
    v_pk_mul_f32 v[204:205], v[126:127], v[126:127]
    s_waitcnt lgkmcnt(0)
    v_mfma_f32_32x32x16_bf16 v[128:143], v[160:163], v[48:51], v[128:143]
    v_pk_fma_f32 v[192:193], v[192:193], s[52:53], v[188:189]
    v_pk_fma_f32 v[196:197], v[196:197], s[52:53], v[188:189]
    v_pk_fma_f32 v[200:201], v[200:201], s[52:53], v[188:189]
    v_pk_fma_f32 v[204:205], v[204:205], s[52:53], v[188:189]
    v_pk_mul_f32 v[192:193], v[192:193], v[120:121]
    v_pk_mul_f32 v[196:197], v[196:197], v[122:123]
    v_pk_mul_f32 v[200:201], v[200:201], v[124:125]
    v_pk_mul_f32 v[204:205], v[204:205], v[126:127]
    s_nop 15
    v_exp_f32 v192, v192
    v_exp_f32 v193, v193
    v_exp_f32 v196, v196
    v_exp_f32 v197, v197
    v_exp_f32 v200, v200
    v_exp_f32 v201, v201
    v_exp_f32 v204, v204
    v_exp_f32 v205, v205
    v_pk_add_f32 v[192:193], v[192:193], 1.0 op_sel_hi:[1,0]
    v_pk_add_f32 v[196:197], v[196:197], 1.0 op_sel_hi:[1,0]
    v_pk_add_f32 v[200:201], v[200:201], 1.0 op_sel_hi:[1,0]
    v_pk_add_f32 v[204:205], v[204:205], 1.0 op_sel_hi:[1,0]
    v_rcp_f32 v192, v192
    v_rcp_f32 v193, v193
    v_rcp_f32 v196, v196
    v_rcp_f32 v197, v197
    v_rcp_f32 v200, v200
    v_rcp_f32 v201, v201
    v_rcp_f32 v204, v204
    v_rcp_f32 v205, v205
    v_pk_mul_f32 v[120:121], v[120:121], v[192:193]
    v_pk_mul_f32 v[122:123], v[122:123], v[196:197]
    v_pk_mul_f32 v[124:125], v[124:125], v[200:201]
    v_pk_mul_f32 v[126:127], v[126:127], v[204:205]
    v_pk_mul_f32 v[192:193], v[128:129], v[128:129]
    v_pk_mul_f32 v[196:197], v[130:131], v[130:131]
    v_pk_mul_f32 v[200:201], v[132:133], v[132:133]
    v_pk_mul_f32 v[204:205], v[134:135], v[134:135]
    v_pk_fma_f32 v[192:193], v[192:193], s[52:53], v[188:189]
    v_pk_fma_f32 v[196:197], v[196:197], s[52:53], v[188:189]
    v_pk_fma_f32 v[200:201], v[200:201], s[52:53], v[188:189]
    v_pk_fma_f32 v[204:205], v[204:205], s[52:53], v[188:189]
    v_pk_mul_f32 v[192:193], v[192:193], v[128:129]
    v_pk_mul_f32 v[196:197], v[196:197], v[130:131]
    v_pk_mul_f32 v[200:201], v[200:201], v[132:133]
    v_pk_mul_f32 v[204:205], v[204:205], v[134:135]
    v_exp_f32 v192, v192
    v_exp_f32 v193, v193
    v_exp_f32 v196, v196
    v_exp_f32 v197, v197
    v_exp_f32 v200, v200
    v_exp_f32 v201, v201
    v_exp_f32 v204, v204
    v_exp_f32 v205, v205
    v_pk_add_f32 v[192:193], v[192:193], 1.0 op_sel_hi:[1,0]
    v_pk_add_f32 v[196:197], v[196:197], 1.0 op_sel_hi:[1,0]
    v_pk_add_f32 v[200:201], v[200:201], 1.0 op_sel_hi:[1,0]
    v_pk_add_f32 v[204:205], v[204:205], 1.0 op_sel_hi:[1,0]
    v_rcp_f32 v192, v192
    v_rcp_f32 v193, v193
    v_rcp_f32 v196, v196
    v_rcp_f32 v197, v197
    v_rcp_f32 v200, v200
    v_rcp_f32 v201, v201
    v_rcp_f32 v204, v204
    v_rcp_f32 v205, v205
    v_pk_mul_f32 v[128:129], v[128:129], v[192:193]
    v_pk_mul_f32 v[130:131], v[130:131], v[196:197]
    v_pk_mul_f32 v[132:133], v[132:133], v[200:201]
    v_pk_mul_f32 v[134:135], v[134:135], v[204:205]
    s_cmp_eq_u32 s25, 0
    s_cbranch_scc1 L_k1_Bout
    v_pk_mul_f32 v[178:179], v[64:65], v[64:65]
    v_mov_b32 v176, v64
    v_mov_b32 v177, v65
    v_pk_add_f32 v[176:177], v[176:177], v[66:67]
    v_pk_fma_f32 v[178:179], v[66:67], v[66:67], v[178:179]
    v_pk_add_f32 v[176:177], v[176:177], v[68:69]
    v_pk_fma_f32 v[178:179], v[68:69], v[68:69], v[178:179]
    v_pk_add_f32 v[176:177], v[176:177], v[70:71]
    v_pk_fma_f32 v[178:179], v[70:71], v[70:71], v[178:179]
    v_pk_add_f32 v[176:177], v[176:177], v[72:73]
    v_pk_fma_f32 v[178:179], v[72:73], v[72:73], v[178:179]
    v_pk_add_f32 v[176:177], v[176:177], v[74:75]
    v_pk_fma_f32 v[178:179], v[74:75], v[74:75], v[178:179]
    v_pk_add_f32 v[176:177], v[176:177], v[76:77]
    v_pk_fma_f32 v[178:179], v[76:77], v[76:77], v[178:179]
    v_pk_add_f32 v[176:177], v[176:177], v[78:79]
    v_pk_fma_f32 v[178:179], v[78:79], v[78:79], v[178:179]
    v_pk_add_f32 v[176:177], v[176:177], v[80:81]
    v_pk_fma_f32 v[178:179], v[80:81], v[80:81], v[178:179]
    v_pk_add_f32 v[176:177], v[176:177], v[82:83]
    v_pk_fma_f32 v[178:179], v[82:83], v[82:83], v[178:179]
    v_pk_add_f32 v[176:177], v[176:177], v[84:85]
    v_pk_fma_f32 v[178:179], v[84:85], v[84:85], v[178:179]
    v_pk_add_f32 v[176:177], v[176:177], v[86:87]
    v_pk_fma_f32 v[178:179], v[86:87], v[86:87], v[178:179]
    v_pk_add_f32 v[176:177], v[176:177], v[88:89]
    v_pk_fma_f32 v[178:179], v[88:89], v[88:89], v[178:179]
    v_pk_add_f32 v[176:177], v[176:177], v[90:91]
    v_pk_fma_f32 v[178:179], v[90:91], v[90:91], v[178:179]
    v_pk_add_f32 v[176:177], v[176:177], v[92:93]
    v_pk_fma_f32 v[178:179], v[92:93], v[92:93], v[178:179]
    v_pk_add_f32 v[176:177], v[176:177], v[94:95]
    v_pk_fma_f32 v[178:179], v[94:95], v[94:95], v[178:179]
    v_pk_add_f32 v[176:177], v[176:177], v[96:97]
    v_pk_fma_f32 v[178:179], v[96:97], v[96:97], v[178:179]
    v_pk_add_f32 v[176:177], v[176:177], v[98:99]
    v_pk_fma_f32 v[178:179], v[98:99], v[98:99], v[178:179]
    v_pk_add_f32 v[176:177], v[176:177], v[100:101]
    v_pk_fma_f32 v[178:179], v[100:101], v[100:101], v[178:179]
    v_pk_add_f32 v[176:177], v[176:177], v[102:103]
    v_pk_fma_f32 v[178:179], v[102:103], v[102:103], v[178:179]
    v_pk_add_f32 v[176:177], v[176:177], v[104:105]
    v_pk_fma_f32 v[178:179], v[104:105], v[104:105], v[178:179]
    v_pk_add_f32 v[176:177], v[176:177], v[106:107]
    v_pk_fma_f32 v[178:179], v[106:107], v[106:107], v[178:179]
    v_pk_add_f32 v[176:177], v[176:177], v[108:109]
    v_pk_fma_f32 v[178:179], v[108:109], v[108:109], v[178:179]
    v_pk_add_f32 v[176:177], v[176:177], v[110:111]
    v_pk_fma_f32 v[178:179], v[110:111], v[110:111], v[178:179]
    v_pk_add_f32 v[176:177], v[176:177], v[112:113]
    v_pk_fma_f32 v[178:179], v[112:113], v[112:113], v[178:179]
    v_pk_add_f32 v[176:177], v[176:177], v[114:115]
    v_pk_fma_f32 v[178:179], v[114:115], v[114:115], v[178:179]
    v_pk_add_f32 v[176:177], v[176:177], v[116:117]
    v_pk_fma_f32 v[178:179], v[116:117], v[116:117], v[178:179]
    v_pk_add_f32 v[176:177], v[176:177], v[118:119]
    v_pk_fma_f32 v[178:179], v[118:119], v[118:119], v[178:179]
    v_pk_add_f32 v[176:177], v[176:177], v[120:121]
    v_pk_fma_f32 v[178:179], v[120:121], v[120:121], v[178:179]
    v_pk_add_f32 v[176:177], v[176:177], v[122:123]
    v_pk_fma_f32 v[178:179], v[122:123], v[122:123], v[178:179]
    v_pk_add_f32 v[176:177], v[176:177], v[124:125]
    v_pk_fma_f32 v[178:179], v[124:125], v[124:125], v[178:179]
    v_pk_add_f32 v[176:177], v[176:177], v[126:127]
    v_pk_fma_f32 v[178:179], v[126:127], v[126:127], v[178:179]
    v_pk_add_f32 v[176:177], v[176:177], v[128:129]
    v_pk_fma_f32 v[178:179], v[128:129], v[128:129], v[178:179]
    v_pk_add_f32 v[176:177], v[176:177], v[130:131]
    v_pk_fma_f32 v[178:179], v[130:131], v[130:131], v[178:179]
    v_pk_add_f32 v[176:177], v[176:177], v[132:133]
    v_pk_fma_f32 v[178:179], v[132:133], v[132:133], v[178:179]
    v_pk_add_f32 v[176:177], v[176:177], v[134:135]
    v_pk_fma_f32 v[178:179], v[134:135], v[134:135], v[178:179]
    v_add_f32 v176, v176, v177
    v_add_f32 v178, v178, v179
    v_mov_b32 v177, v176
    s_nop 1
    v_permlane32_swap_b32 v176, v177
    s_nop 1
    v_add_f32 v176, v176, v177
    v_mov_b32 v179, v178
    s_nop 1
    v_permlane32_swap_b32 v178, v179
    s_nop 1
    v_add_f32 v178, v178, v179
    v_mul_f32 v176, 0x3be38e39, v176
    v_mul_f32 v178, 0x3be38e39, v178
    v_fma_f32 v178, -v176, v176, v178
    v_max_f32 v178, 0, v178
    v_add_f32 v178, 0x3727c5ac, v178
    v_rsq_f32 v180, v178
    s_nop 0
    v_mul_f32 v182, v176, v180
    v_sub_f32 v182, 0, v182
    v_pk_fma_f32 v[64:65], v[64:65], v[180:181], v[182:183] op_sel_hi:[1,0,0]
    v_pk_fma_f32 v[66:67], v[66:67], v[180:181], v[182:183] op_sel_hi:[1,0,0]
    v_pk_fma_f32 v[68:69], v[68:69], v[180:181], v[182:183] op_sel_hi:[1,0,0]
    v_pk_fma_f32 v[70:71], v[70:71], v[180:181], v[182:183] op_sel_hi:[1,0,0]
    v_pk_fma_f32 v[72:73], v[72:73], v[180:181], v[182:183] op_sel_hi:[1,0,0]
    v_pk_fma_f32 v[74:75], v[74:75], v[180:181], v[182:183] op_sel_hi:[1,0,0]
    v_pk_fma_f32 v[76:77], v[76:77], v[180:181], v[182:183] op_sel_hi:[1,0,0]
    v_pk_fma_f32 v[78:79], v[78:79], v[180:181], v[182:183] op_sel_hi:[1,0,0]
    v_pk_fma_f32 v[80:81], v[80:81], v[180:181], v[182:183] op_sel_hi:[1,0,0]
    v_pk_fma_f32 v[82:83], v[82:83], v[180:181], v[182:183] op_sel_hi:[1,0,0]
    v_pk_fma_f32 v[84:85], v[84:85], v[180:181], v[182:183] op_sel_hi:[1,0,0]
    v_pk_fma_f32 v[86:87], v[86:87], v[180:181], v[182:183] op_sel_hi:[1,0,0]
    v_pk_fma_f32 v[88:89], v[88:89], v[180:181], v[182:183] op_sel_hi:[1,0,0]
    v_pk_fma_f32 v[90:91], v[90:91], v[180:181], v[182:183] op_sel_hi:[1,0,0]
    v_pk_fma_f32 v[92:93], v[92:93], v[180:181], v[182:183] op_sel_hi:[1,0,0]
    v_pk_fma_f32 v[94:95], v[94:95], v[180:181], v[182:183] op_sel_hi:[1,0,0]
    v_pk_fma_f32 v[96:97], v[96:97], v[180:181], v[182:183] op_sel_hi:[1,0,0]
    v_pk_fma_f32 v[98:99], v[98:99], v[180:181], v[182:183] op_sel_hi:[1,0,0]
    v_pk_fma_f32 v[100:101], v[100:101], v[180:181], v[182:183] op_sel_hi:[1,0,0]
    v_pk_fma_f32 v[102:103], v[102:103], v[180:181], v[182:183] op_sel_hi:[1,0,0]
    v_pk_fma_f32 v[104:105], v[104:105], v[180:181], v[182:183] op_sel_hi:[1,0,0]
    v_pk_fma_f32 v[106:107], v[106:107], v[180:181], v[182:183] op_sel_hi:[1,0,0]
    v_pk_fma_f32 v[108:109], v[108:109], v[180:181], v[182:183] op_sel_hi:[1,0,0]
    v_pk_fma_f32 v[110:111], v[110:111], v[180:181], v[182:183] op_sel_hi:[1,0,0]
    v_pk_fma_f32 v[112:113], v[112:113], v[180:181], v[182:183] op_sel_hi:[1,0,0]
    v_pk_fma_f32 v[114:115], v[114:115], v[180:181], v[182:183] op_sel_hi:[1,0,0]
    v_pk_fma_f32 v[116:117], v[116:117], v[180:181], v[182:183] op_sel_hi:[1,0,0]
    v_pk_fma_f32 v[118:119], v[118:119], v[180:181], v[182:183] op_sel_hi:[1,0,0]
    v_pk_fma_f32 v[120:121], v[120:121], v[180:181], v[182:183] op_sel_hi:[1,0,0]
    v_pk_fma_f32 v[122:123], v[122:123], v[180:181], v[182:183] op_sel_hi:[1,0,0]
    v_pk_fma_f32 v[124:125], v[124:125], v[180:181], v[182:183] op_sel_hi:[1,0,0]
    v_pk_fma_f32 v[126:127], v[126:127], v[180:181], v[182:183] op_sel_hi:[1,0,0]
    v_pk_fma_f32 v[128:129], v[128:129], v[180:181], v[182:183] op_sel_hi:[1,0,0]
    v_pk_fma_f32 v[130:131], v[130:131], v[180:181], v[182:183] op_sel_hi:[1,0,0]
    v_pk_fma_f32 v[132:133], v[132:133], v[180:181], v[182:183] op_sel_hi:[1,0,0]
    v_pk_fma_f32 v[134:135], v[134:135], v[180:181], v[182:183] op_sel_hi:[1,0,0]
L_k1_Bout:
    v_cvt_pk_bf16_f32 v192, v64, v65
    v_cvt_pk_bf16_f32 v193, v66, v67
    v_cvt_pk_bf16_f32 v194, v68, v69
    v_cvt_pk_bf16_f32 v195, v70, v71
    ds_write_b128 v3, v[192:195] offset:0
    v_cvt_pk_bf16_f32 v196, v72, v73
    v_cvt_pk_bf16_f32 v197, v74, v75
    v_cvt_pk_bf16_f32 v198, v76, v77
    v_cvt_pk_bf16_f32 v199, v78, v79
    ds_write_b128 v3, v[196:199] offset:32
    v_cvt_pk_bf16_f32 v200, v80, v81
    v_cvt_pk_bf16_f32 v201, v82, v83
    v_cvt_pk_bf16_f32 v202, v84, v85
    v_cvt_pk_bf16_f32 v203, v86, v87
    ds_write_b128 v3, v[200:203] offset:64
    v_cvt_pk_bf16_f32 v204, v88, v89
    v_cvt_pk_bf16_f32 v205, v90, v91
    v_cvt_pk_bf16_f32 v206, v92, v93
    v_cvt_pk_bf16_f32 v207, v94, v95
    ds_write_b128 v3, v[204:207] offset:96
    v_cvt_pk_bf16_f32 v192, v96, v97
    v_cvt_pk_bf16_f32 v193, v98, v99
    v_cvt_pk_bf16_f32 v194, v100, v101
    v_cvt_pk_bf16_f32 v195, v102, v103
    ds_write_b128 v3, v[192:195] offset:128
    v_cvt_pk_bf16_f32 v196, v104, v105
    v_cvt_pk_bf16_f32 v197, v106, v107
    v_cvt_pk_bf16_f32 v198, v108, v109
    v_cvt_pk_bf16_f32 v199, v110, v111
    ds_write_b128 v3, v[196:199] offset:160
    v_cvt_pk_bf16_f32 v200, v112, v113
    v_cvt_pk_bf16_f32 v201, v114, v115
    v_cvt_pk_bf16_f32 v202, v116, v117
    v_cvt_pk_bf16_f32 v203, v118, v119
    ds_write_b128 v3, v[200:203] offset:192
    v_cvt_pk_bf16_f32 v204, v120, v121
    v_cvt_pk_bf16_f32 v205, v122, v123
    v_cvt_pk_bf16_f32 v206, v124, v125
    v_cvt_pk_bf16_f32 v207, v126, v127
    ds_write_b128 v3, v[204:207] offset:224
    v_cvt_pk_bf16_f32 v192, v128, v129
    v_cvt_pk_bf16_f32 v193, v130, v131
    v_cvt_pk_bf16_f32 v194, v132, v133
    v_cvt_pk_bf16_f32 v195, v134, v135
    ds_write_b128 v3, v[192:195] offset:256
    v_lshrrev_b32 v176, 4, v1
    v_bfe_u32 v177, v1, 2, 2
    v_lshl_add_u32 v177, v176, 3, v177
    v_mul_u32_u24 v177, 288, v177
    v_and_b32 v178, 3, v1
    v_lshl_add_u32 v177, v178, 3, v177
    v_add_u32 v177, s28, v177
    v_and_b32 v178, 15, v1
    v_lshlrev_b32 v178, 6, v178
    v_lshl_add_u32 v178, v176, 4, v178
    s_waitcnt lgkmcnt(0)
    ds_read_b64_tr_b16 v[16:17], v177 offset:0
    ds_read_b64_tr_b16 v[18:19], v177 offset:1152
    ds_read_b64_tr_b16 v[20:21], v177 offset:32
    ds_read_b64_tr_b16 v[22:23], v177 offset:1184
    ds_read_b64_tr_b16 v[24:25], v177 offset:64
    ds_read_b64_tr_b16 v[26:27], v177 offset:1216
    ds_read_b64_tr_b16 v[28:29], v177 offset:96
    ds_read_b64_tr_b16 v[30:31], v177 offset:1248
    ds_read_b64_tr_b16 v[32:33], v177 offset:128
    ds_read_b64_tr_b16 v[34:35], v177 offset:1280
    ds_read_b64_tr_b16 v[36:37], v177 offset:160
    ds_read_b64_tr_b16 v[38:39], v177 offset:1312
    ds_read_b64_tr_b16 v[40:41], v177 offset:192
    ds_read_b64_tr_b16 v[42:43], v177 offset:1344
    ds_read_b64_tr_b16 v[44:45], v177 offset:224
    ds_read_b64_tr_b16 v[46:47], v177 offset:1376
    ds_read_b64_tr_b16 v[48:49], v177 offset:256
    ds_read_b64_tr_b16 v[50:51], v177 offset:1408
    s_waitcnt lgkmcnt(15)
    s_movk_i32 s29, 0
    buffer_store_dwordx4 v[16:19], v178, s[20:23], s29 offen offset:0 sc1
    s_waitcnt lgkmcnt(14)
    buffer_store_dwordx4 v[20:23], v178, s[20:23], s29 offen offset:1024 sc1
    s_waitcnt lgkmcnt(12)
    buffer_store_dwordx4 v[24:27], v178, s[20:23], s29 offen offset:2048 sc1
    s_waitcnt lgkmcnt(10)
    buffer_store_dwordx4 v[28:31], v178, s[20:23], s29 offen offset:3072 sc1
    s_waitcnt lgkmcnt(8)
    s_movk_i32 s29, 4096
    buffer_store_dwordx4 v[32:35], v178, s[20:23], s29 offen offset:0 sc1
    s_waitcnt lgkmcnt(6)
    buffer_store_dwordx4 v[36:39], v178, s[20:23], s29 offen offset:1024 sc1
    s_waitcnt lgkmcnt(4)
    buffer_store_dwordx4 v[40:43], v178, s[20:23], s29 offen offset:2048 sc1
    s_waitcnt lgkmcnt(2)
    buffer_store_dwordx4 v[44:47], v178, s[20:23], s29 offen offset:3072 sc1
    s_waitcnt lgkmcnt(0)
    s_movk_i32 s29, 8192
    buffer_store_dwordx4 v[48:51], v178, s[20:23], s29 offen offset:0 sc1
    s_endpgm
L_k1_fold:
    s_sub_u32 s27, s60, 125
    s_mov_b32 s55, s61
    s_lshl_b32 s27, s27, 1
    s_add_u32 s27, s27, s26
    s_mul_i32 s28, s24, 9216
    s_add_u32 s28, s28, 83968
    s_mul_i32 s54, s27, 9216
    s_sub_i32 s31, 41472, s54
    s_max_i32 s31, s31, 0
    s_min_i32 s31, s31, 9216
    s_min_u32 s54, s54, 36864
    s_waitcnt lgkmcnt(0)
    s_add_u32 s20, s4, 14417920
    s_addc_u32 s21, s5, 0
    s_mov_b32 s22, 92160
    s_mov_b32 s23, 0x20000
    s_cmp_eq_u32 s55, 1
    s_cbranch_scc1 L_k1_foldC
    s_add_u32 s8, s38, s54
    s_addc_u32 s9, s39, 0
    s_mov_b32 s10, s31
    s_mov_b32 s11, 0x20000
    s_add_u32 s12, s40, 0
    s_addc_u32 s13, s41, 0
    s_mov_b32 s14, 41472
    s_mov_b32 s15, 0x20000
    s_add_u32 s16, s48, 0
    s_addc_u32 s17, s49, 0
    s_mov_b32 s18, 41472
    s_mov_b32 s19, 0x20000
    s_add_u32 m0, s28, 0
    s_movk_i32 s29, 0
    buffer_load_dwordx4 v2, s[8:11], s29 offen offset:0 lds
    buffer_load_dwordx4 v2, s[8:11], s29 offen offset:1024 lds
    buffer_load_dwordx4 v2, s[8:11], s29 offen offset:2048 lds
    buffer_load_dwordx4 v2, s[8:11], s29 offen offset:3072 lds
    s_add_u32 m0, s28, 4096
    s_movk_i32 s29, 4096
    buffer_load_dwordx4 v2, s[8:11], s29 offen offset:0 lds
    buffer_load_dwordx4 v2, s[8:11], s29 offen offset:1024 lds
    buffer_load_dwordx4 v2, s[8:11], s29 offen offset:2048 lds
    buffer_load_dwordx4 v2, s[8:11], s29 offen offset:3072 lds
    s_add_u32 m0, s28, 8192
    s_movk_i32 s29, 8192
    buffer_load_dwordx4 v2, s[8:11], s29 offen offset:0 lds
    s_mul_i32 s29, s24, 11264
    s_min_u32 s30, s29, 37888
    s_add_u32 m0, s30, 0
    s_add_u32 s29, s29, 4096
    buffer_load_dwordx4 v2, s[12:15], s30 offen offset:0 lds
    buffer_load_dwordx4 v2, s[12:15], s30 offen offset:1024 lds
    buffer_load_dwordx4 v2, s[12:15], s30 offen offset:2048 lds
    buffer_load_dwordx4 v2, s[12:15], s30 offen offset:3072 lds
    s_min_u32 s30, s29, 37888
    s_add_u32 m0, s30, 0
    s_add_u32 s29, s29, 4096
    buffer_load_dwordx4 v2, s[12:15], s30 offen offset:0 lds
    buffer_load_dwordx4 v2, s[12:15], s30 offen offset:1024 lds
    buffer_load_dwordx4 v2, s[12:15], s30 offen offset:2048 lds
    buffer_load_dwordx4 v2, s[12:15], s30 offen offset:3072 lds
    s_min_u32 s30, s29, 38912
    s_add_u32 m0, s30, 0
    s_add_u32 s29, s29, 3072
    buffer_load_dwordx4 v2, s[12:15], s30 offen offset:0 lds
    buffer_load_dwordx4 v2, s[12:15], s30 offen offset:1024 lds
    buffer_load_dwordx4 v2, s[12:15], s30 offen offset:2048 lds
    s_mul_i32 s29, s24, 11264
    s_min_u32 s30, s29, 37888
    s_add_u32 m0, s30, 41984
    s_add_u32 s29, s29, 4096
    buffer_load_dwordx4 v2, s[16:19], s30 offen offset:0 lds
    buffer_load_dwordx4 v2, s[16:19], s30 offen offset:1024 lds
    buffer_load_dwordx4 v2, s[16:19], s30 offen offset:2048 lds
    buffer_load_dwordx4 v2, s[16:19], s30 offen offset:3072 lds
    s_min_u32 s30, s29, 37888
    s_add_u32 m0, s30, 41984
    s_add_u32 s29, s29, 4096
    buffer_load_dwordx4 v2, s[16:19], s30 offen offset:0 lds
    buffer_load_dwordx4 v2, s[16:19], s30 offen offset:1024 lds
    buffer_load_dwordx4 v2, s[16:19], s30 offen offset:2048 lds
    buffer_load_dwordx4 v2, s[16:19], s30 offen offset:3072 lds
    s_min_u32 s30, s29, 38912
    s_add_u32 m0, s30, 41984
    s_add_u32 s29, s29, 3072
    buffer_load_dwordx4 v2, s[16:19], s30 offen offset:0 lds
    buffer_load_dwordx4 v2, s[16:19], s30 offen offset:1024 lds
    buffer_load_dwordx4 v2, s[16:19], s30 offen offset:2048 lds
    s_cmp_eq_u32 s27, 5
    s_cbranch_scc1 L_k1_tapsV
    v_bfe_u32 v176, v1, 2, 2
    v_lshl_add_u32 v176, v7, 3, v176
    v_mul_u32_u24 v4, 288, v176
    v_bfe_u32 v176, v1, 4, 1
    v_lshl_add_u32 v4, v176, 5, v4
    v_and_b32 v176, 1, v1
    v_lshl_add_u32 v4, v176, 4, v4
    v_bfe_u32 v176, v1, 1, 1
    v_lshl_add_u32 v4, v176, 3, v4
    v_add_u32 v4, 0, v4
    v_add_u32 v6, 18432, v4
    s_waitcnt vmcnt(0)
    s_barrier
    v_mov_b32 v3, v8
    v_mul_u32_u24 v3, 288, v3
    v_lshl_add_u32 v3, v7, 4, v3
    v_add_u32 v3, s28, v3
    ds_read_b128 v[16:19], v3 offset:0
    ds_read_b128 v[20:23], v3 offset:32
    ds_read_b128 v[24:27], v3 offset:64
    ds_read_b128 v[28:31], v3 offset:96
    ds_read_b128 v[32:35], v3 offset:128
    ds_read_b128 v[36:39], v3 offset:160
    ds_read_b128 v[40:43], v3 offset:192
    ds_read_b128 v[44:47], v3 offset:224
    ds_read_b128 v[48:51], v3 offset:256
    s_waitcnt lgkmcnt(0)
    s_cmp_eq_u32 s25, 1
    s_cbranch_scc1 L_k1_V1
L_k1_V0:
    ds_read_b64_tr_b16 v[144:145], v4 offset:0
    ds_read_b64_tr_b16 v[146:147], v4 offset:1152
    ds_read_b64_tr_b16 v[148:149], v4 offset:4608
    ds_read_b64_tr_b16 v[150:151], v4 offset:5760
    ds_read_b64_tr_b16 v[152:153], v4 offset:9216
    ds_read_b64_tr_b16 v[154:155], v4 offset:10368
    ds_read_b64_tr_b16 v[156:157], v4 offset:13824
    ds_read_b64_tr_b16 v[158:159], v4 offset:14976
    s_waitcnt lgkmcnt(6)
    v_mfma_f32_32x32x16_bf16 v[64:79], v[144:147], v[16:19], 0
    ds_read_b64_tr_b16 v[160:161], v6 offset:0
    ds_read_b64_tr_b16 v[162:163], v6 offset:1152
    s_waitcnt lgkmcnt(6)
    v_mfma_f32_32x32x16_bf16 v[64:79], v[148:151], v[20:23], v[64:79]
    ds_read_b64_tr_b16 v[164:165], v6 offset:4608
    ds_read_b64_tr_b16 v[166:167], v6 offset:5760
    s_waitcnt lgkmcnt(6)
    v_mfma_f32_32x32x16_bf16 v[64:79], v[152:155], v[24:27], v[64:79]
    ds_read_b64_tr_b16 v[168:169], v6 offset:9216
    ds_read_b64_tr_b16 v[170:171], v6 offset:10368
    s_waitcnt lgkmcnt(6)
    v_mfma_f32_32x32x16_bf16 v[64:79], v[156:159], v[28:31], v[64:79]
    ds_read_b64_tr_b16 v[172:173], v6 offset:13824
    ds_read_b64_tr_b16 v[174:175], v6 offset:14976
    s_waitcnt lgkmcnt(6)
    v_mfma_f32_32x32x16_bf16 v[64:79], v[160:163], v[32:35], v[64:79]
    ds_read_b64_tr_b16 v[144:145], v6 offset:18432
    ds_read_b64_tr_b16 v[146:147], v6 offset:19584
    s_waitcnt lgkmcnt(6)
    v_mfma_f32_32x32x16_bf16 v[64:79], v[164:167], v[36:39], v[64:79]
    ds_read_b64_tr_b16 v[148:149], v4 offset:64
    ds_read_b64_tr_b16 v[150:151], v4 offset:1216
    s_waitcnt lgkmcnt(6)
    v_mfma_f32_32x32x16_bf16 v[64:79], v[168:171], v[40:43], v[64:79]
    ds_read_b64_tr_b16 v[152:153], v4 offset:4672
    ds_read_b64_tr_b16 v[154:155], v4 offset:5824
    s_waitcnt lgkmcnt(6)
    v_mfma_f32_32x32x16_bf16 v[64:79], v[172:175], v[44:47], v[64:79]
    ds_read_b64_tr_b16 v[156:157], v4 offset:9280
    ds_read_b64_tr_b16 v[158:159], v4 offset:10432
    s_waitcnt lgkmcnt(6)
    v_mfma_f32_32x32x16_bf16 v[64:79], v[144:147], v[48:51], v[64:79]
    ds_read_b64_tr_b16 v[160:161], v4 offset:13888
    ds_read_b64_tr_b16 v[162:163], v4 offset:15040
    s_waitcnt lgkmcnt(6)
    v_mfma_f32_32x32x16_bf16 v[80:95], v[148:151], v[16:19], 0
    ds_read_b64_tr_b16 v[164:165], v6 offset:64
    ds_read_b64_tr_b16 v[166:167], v6 offset:1216
    s_waitcnt lgkmcnt(6)
    v_mfma_f32_32x32x16_bf16 v[80:95], v[152:155], v[20:23], v[80:95]
    ds_read_b64_tr_b16 v[168:169], v6 offset:4672
    ds_read_b64_tr_b16 v[170:171], v6 offset:5824
    s_waitcnt lgkmcnt(6)
    v_mfma_f32_32x32x16_bf16 v[80:95], v[156:159], v[24:27], v[80:95]
    ds_read_b64_tr_b16 v[172:173], v6 offset:9280
    ds_read_b64_tr_b16 v[174:175], v6 offset:10432
    s_waitcnt lgkmcnt(6)
    v_mfma_f32_32x32x16_bf16 v[80:95], v[160:163], v[28:31], v[80:95]
    ds_read_b64_tr_b16 v[144:145], v6 offset:13888
    ds_read_b64_tr_b16 v[146:147], v6 offset:15040
    s_waitcnt lgkmcnt(6)
    v_mfma_f32_32x32x16_bf16 v[80:95], v[164:167], v[32:35], v[80:95]
    ds_read_b64_tr_b16 v[148:149], v6 offset:18496
    ds_read_b64_tr_b16 v[150:151], v6 offset:19648
    s_waitcnt lgkmcnt(6)
    v_mfma_f32_32x32x16_bf16 v[80:95], v[168:171], v[36:39], v[80:95]
    s_waitcnt lgkmcnt(4)
    v_mfma_f32_32x32x16_bf16 v[80:95], v[172:175], v[40:43], v[80:95]
    s_waitcnt lgkmcnt(2)
    v_mfma_f32_32x32x16_bf16 v[80:95], v[144:147], v[44:47], v[80:95]
    s_waitcnt lgkmcnt(0)
    v_mfma_f32_32x32x16_bf16 v[80:95], v[148:151], v[48:51], v[80:95]
    s_nop 15
    s_mul_i32 s29, s26, 9216
    s_add_u32 s29, s29, 120832
    v_add_u32 v5, s29, v2
    v_cvt_pk_bf16_f32 v192, v64, v65
    v_cvt_pk_bf16_f32 v193, v66, v67
    v_cvt_pk_bf16_f32 v194, v68, v69
    v_cvt_pk_bf16_f32 v195, v70, v71
    ds_write_b128 v5, v[192:195] offset:0
    v_cvt_pk_bf16_f32 v196, v72, v73
    v_cvt_pk_bf16_f32 v197, v74, v75
    v_cvt_pk_bf16_f32 v198, v76, v77
    v_cvt_pk_bf16_f32 v199, v78, v79
    ds_write_b128 v5, v[196:199] offset:1024
    v_cvt_pk_bf16_f32 v200, v80, v81
    v_cvt_pk_bf16_f32 v201, v82, v83
    v_cvt_pk_bf16_f32 v202, v84, v85
    v_cvt_pk_bf16_f32 v203, v86, v87
    ds_write_b128 v5, v[200:203] offset:2048
    v_cvt_pk_bf16_f32 v204, v88, v89
    v_cvt_pk_bf16_f32 v205, v90, v91
    v_cvt_pk_bf16_f32 v206, v92, v93
    v_cvt_pk_bf16_f32 v207, v94, v95
    ds_write_b128 v5, v[204:207] offset:3072
    s_waitcnt lgkmcnt(0)
    s_barrier
    ds_read_b128 v[16:19], v5 offset:0
    ds_read_b128 v[20:23], v5 offset:1024
    ds_read_b128 v[24:27], v5 offset:2048
    ds_read_b128 v[28:31], v5 offset:3072
    ds_read_b128 v[32:35], v5 offset:4096
    ds_read_b128 v[36:39], v5 offset:5120
    ds_read_b128 v[40:43], v5 offset:6144
    ds_read_b128 v[44:47], v5 offset:7168
    ds_read_b128 v[48:51], v5 offset:8192
    v_bfe_u32 v176, v1, 2, 2
    v_lshl_add_u32 v176, v7, 3, v176
    v_mul_u32_u24 v4, 288, v176
    v_bfe_u32 v176, v1, 4, 1
    v_lshl_add_u32 v4, v176, 5, v4
    v_and_b32 v176, 1, v1
    v_lshl_add_u32 v4, v176, 4, v4
    v_bfe_u32 v176, v1, 1, 1
    v_lshl_add_u32 v4, v176, 3, v4
    v_add_u32 v4, 41984, v4
    v_add_u32 v6, 18432, v4
    s_waitcnt lgkmcnt(0)
    ds_read_b64_tr_b16 v[144:145], v4 offset:0
    ds_read_b64_tr_b16 v[146:147], v4 offset:1152
    ds_read_b64_tr_b16 v[148:149], v4 offset:4608
    ds_read_b64_tr_b16 v[150:151], v4 offset:5760
    ds_read_b64_tr_b16 v[152:153], v4 offset:9216
    ds_read_b64_tr_b16 v[154:155], v4 offset:10368
    ds_read_b64_tr_b16 v[156:157], v4 offset:13824
    ds_read_b64_tr_b16 v[158:159], v4 offset:14976
    s_waitcnt lgkmcnt(6)
    v_mfma_f32_32x32x16_bf16 v[64:79], v[16:19], v[144:147], 0
    ds_read_b64_tr_b16 v[160:161], v6 offset:0
    ds_read_b64_tr_b16 v[162:163], v6 offset:1152
    s_waitcnt lgkmcnt(6)
    v_mfma_f32_32x32x16_bf16 v[64:79], v[20:23], v[148:151], v[64:79]
    ds_read_b64_tr_b16 v[164:165], v6 offset:4608
    ds_read_b64_tr_b16 v[166:167], v6 offset:5760
    s_waitcnt lgkmcnt(6)
    v_mfma_f32_32x32x16_bf16 v[64:79], v[24:27], v[152:155], v[64:79]
    ds_read_b64_tr_b16 v[168:169], v6 offset:9216
    ds_read_b64_tr_b16 v[170:171], v6 offset:10368
    s_waitcnt lgkmcnt(6)
    v_mfma_f32_32x32x16_bf16 v[64:79], v[28:31], v[156:159], v[64:79]
    ds_read_b64_tr_b16 v[172:173], v6 offset:13824
    ds_read_b64_tr_b16 v[174:175], v6 offset:14976
    s_waitcnt lgkmcnt(6)
    v_mfma_f32_32x32x16_bf16 v[64:79], v[32:35], v[160:163], v[64:79]
    ds_read_b64_tr_b16 v[144:145], v6 offset:18432
    ds_read_b64_tr_b16 v[146:147], v6 offset:19584
    s_waitcnt lgkmcnt(6)
    v_mfma_f32_32x32x16_bf16 v[64:79], v[36:39], v[164:167], v[64:79]
    ds_read_b64_tr_b16 v[148:149], v4 offset:64
    ds_read_b64_tr_b16 v[150:151], v4 offset:1216
    s_waitcnt lgkmcnt(6)
    v_mfma_f32_32x32x16_bf16 v[64:79], v[40:43], v[168:171], v[64:79]
    ds_read_b64_tr_b16 v[152:153], v4 offset:4672
    ds_read_b64_tr_b16 v[154:155], v4 offset:5824
    s_waitcnt lgkmcnt(6)
    v_mfma_f32_32x32x16_bf16 v[64:79], v[44:47], v[172:175], v[64:79]
    ds_read_b64_tr_b16 v[156:157], v4 offset:9280
    ds_read_b64_tr_b16 v[158:159], v4 offset:10432
    s_waitcnt lgkmcnt(6)
    v_mfma_f32_32x32x16_bf16 v[64:79], v[48:51], v[144:147], v[64:79]
    ds_read_b64_tr_b16 v[160:161], v4 offset:13888
    ds_read_b64_tr_b16 v[162:163], v4 offset:15040
    s_waitcnt lgkmcnt(6)
    v_mfma_f32_32x32x16_bf16 v[80:95], v[16:19], v[148:151], 0
    ds_read_b64_tr_b16 v[164:165], v6 offset:64
    ds_read_b64_tr_b16 v[166:167], v6 offset:1216
    s_waitcnt lgkmcnt(6)
    v_mfma_f32_32x32x16_bf16 v[80:95], v[20:23], v[152:155], v[80:95]
    ds_read_b64_tr_b16 v[168:169], v6 offset:4672
    ds_read_b64_tr_b16 v[170:171], v6 offset:5824
    s_waitcnt lgkmcnt(6)
    v_mfma_f32_32x32x16_bf16 v[80:95], v[24:27], v[156:159], v[80:95]
    ds_read_b64_tr_b16 v[172:173], v6 offset:9280
    ds_read_b64_tr_b16 v[174:175], v6 offset:10432
    s_waitcnt lgkmcnt(6)
    v_mfma_f32_32x32x16_bf16 v[80:95], v[28:31], v[160:163], v[80:95]
    ds_read_b64_tr_b16 v[144:145], v6 offset:13888
    ds_read_b64_tr_b16 v[146:147], v6 offset:15040
    s_waitcnt lgkmcnt(6)
    v_mfma_f32_32x32x16_bf16 v[80:95], v[32:35], v[164:167], v[80:95]
    ds_read_b64_tr_b16 v[148:149], v6 offset:18496
    ds_read_b64_tr_b16 v[150:151], v6 offset:19648
    s_waitcnt lgkmcnt(6)
    v_mfma_f32_32x32x16_bf16 v[80:95], v[36:39], v[168:171], v[80:95]
    ds_read_b64_tr_b16 v[152:153], v4 offset:128
    ds_read_b64_tr_b16 v[154:155], v4 offset:1280
    s_waitcnt lgkmcnt(6)
    v_mfma_f32_32x32x16_bf16 v[80:95], v[40:43], v[172:175], v[80:95]
    ds_read_b64_tr_b16 v[156:157], v4 offset:4736
    ds_read_b64_tr_b16 v[158:159], v4 offset:5888
    s_waitcnt lgkmcnt(6)
    v_mfma_f32_32x32x16_bf16 v[80:95], v[44:47], v[144:147], v[80:95]
    ds_read_b64_tr_b16 v[160:161], v4 offset:9344
    ds_read_b64_tr_b16 v[162:163], v4 offset:10496
    s_waitcnt lgkmcnt(6)
    v_mfma_f32_32x32x16_bf16 v[80:95], v[48:51], v[148:151], v[80:95]
    ds_read_b64_tr_b16 v[164:165], v4 offset:13952
    ds_read_b64_tr_b16 v[166:167], v4 offset:15104
    s_waitcnt lgkmcnt(6)
    v_mfma_f32_32x32x16_bf16 v[96:111], v[16:19], v[152:155], 0
    ds_read_b64_tr_b16 v[168:169], v6 offset:128
    ds_read_b64_tr_b16 v[170:171], v6 offset:1280
    s_waitcnt lgkmcnt(6)
    v_mfma_f32_32x32x16_bf16 v[96:111], v[20:23], v[156:159], v[96:111]
    ds_read_b64_tr_b16 v[172:173], v6 offset:4736
    ds_read_b64_tr_b16 v[174:175], v6 offset:5888
    s_waitcnt lgkmcnt(6)
    v_mfma_f32_32x32x16_bf16 v[96:111], v[24:27], v[160:163], v[96:111]
    ds_read_b64_tr_b16 v[144:145], v6 offset:9344
    ds_read_b64_tr_b16 v[146:147], v6 offset:10496
    s_waitcnt lgkmcnt(6)
    v_mfma_f32_32x32x16_bf16 v[96:111], v[28:31], v[164:167], v[96:111]
    ds_read_b64_tr_b16 v[148:149], v6 offset:13952
    ds_read_b64_tr_b16 v[150:151], v6 offset:15104
    s_waitcnt lgkmcnt(6)
    v_mfma_f32_32x32x16_bf16 v[96:111], v[32:35], v[168:171], v[96:111]
    ds_read_b64_tr_b16 v[152:153], v6 offset:18560
    ds_read_b64_tr_b16 v[154:155], v6 offset:19712
    s_waitcnt lgkmcnt(6)
    v_mfma_f32_32x32x16_bf16 v[96:111], v[36:39], v[172:175], v[96:111]
    s_waitcnt lgkmcnt(4)
    v_mfma_f32_32x32x16_bf16 v[96:111], v[40:43], v[144:147], v[96:111]
    s_waitcnt lgkmcnt(2)
    v_mfma_f32_32x32x16_bf16 v[96:111], v[44:47], v[148:151], v[96:111]
    s_waitcnt lgkmcnt(0)
    v_mfma_f32_32x32x16_bf16 v[96:111], v[48:51], v[152:155], v[96:111]
    s_nop 15
    s_lshl_b32 s29, s27, 1
    s_add_u32 s30, s29, 1
    s_cmp_lt_u32 s29, 9
    s_cselect_b32 s29, s29, 100
    s_cmp_lt_u32 s30, 9
    s_cselect_b32 s30, s30, 100
    s_add_u32 s29, s29, 0
    s_add_u32 s30, s30, 0
    s_mul_i32 s29, s29, 5120
    s_mul_i32 s30, s30, 5120
    v_cvt_pk_bf16_f32 v192, v64, v65
    v_cvt_pk_bf16_f32 v193, v66, v67
    v_cvt_pk_bf16_f32 v194, v68, v69
    v_cvt_pk_bf16_f32 v195, v70, v71
    buffer_store_dwordx4 v[192:195], v2, s[20:23], s29 offen offset:0 sc1
    v_cvt_pk_bf16_f32 v196, v72, v73
    v_cvt_pk_bf16_f32 v197, v74, v75
    v_cvt_pk_bf16_f32 v198, v76, v77
    v_cvt_pk_bf16_f32 v199, v78, v79
    buffer_store_dwordx4 v[196:199], v2, s[20:23], s30 offen offset:0 sc1
    v_cvt_pk_bf16_f32 v200, v80, v81
    v_cvt_pk_bf16_f32 v201, v82, v83
    v_cvt_pk_bf16_f32 v202, v84, v85
    v_cvt_pk_bf16_f32 v203, v86, v87
    buffer_store_dwordx4 v[200:203], v2, s[20:23], s29 offen offset:1024 sc1
    v_cvt_pk_bf16_f32 v204, v88, v89
    v_cvt_pk_bf16_f32 v205, v90, v91
    v_cvt_pk_bf16_f32 v206, v92, v93
    v_cvt_pk_bf16_f32 v207, v94, v95
    buffer_store_dwordx4 v[204:207], v2, s[20:23], s30 offen offset:1024 sc1
    v_cvt_pk_bf16_f32 v208, v96, v97
    v_cvt_pk_bf16_f32 v209, v98, v99
    v_cvt_pk_bf16_f32 v210, v100, v101
    v_cvt_pk_bf16_f32 v211, v102, v103
    buffer_store_dwordx4 v[208:211], v2, s[20:23], s29 offen offset:2048 sc1
    v_cvt_pk_bf16_f32 v212, v104, v105
    v_cvt_pk_bf16_f32 v213, v106, v107
    v_cvt_pk_bf16_f32 v214, v108, v109
    v_cvt_pk_bf16_f32 v215, v110, v111
    buffer_store_dwordx4 v[212:215], v2, s[20:23], s30 offen offset:2048 sc1
    s_endpgm
L_k1_V1:
    ds_read_b64_tr_b16 v[144:145], v4 offset:128
    ds_read_b64_tr_b16 v[146:147], v4 offset:1280
    ds_read_b64_tr_b16 v[148:149], v4 offset:4736
    ds_read_b64_tr_b16 v[150:151], v4 offset:5888
    ds_read_b64_tr_b16 v[152:153], v4 offset:9344
    ds_read_b64_tr_b16 v[154:155], v4 offset:10496
    ds_read_b64_tr_b16 v[156:157], v4 offset:13952
    ds_read_b64_tr_b16 v[158:159], v4 offset:15104
    s_waitcnt lgkmcnt(6)
    v_mfma_f32_32x32x16_bf16 v[64:79], v[144:147], v[16:19], 0
    ds_read_b64_tr_b16 v[160:161], v6 offset:128
    ds_read_b64_tr_b16 v[162:163], v6 offset:1280
    s_waitcnt lgkmcnt(6)
    v_mfma_f32_32x32x16_bf16 v[64:79], v[148:151], v[20:23], v[64:79]
    ds_read_b64_tr_b16 v[164:165], v6 offset:4736
    ds_read_b64_tr_b16 v[166:167], v6 offset:5888
    s_waitcnt lgkmcnt(6)
    v_mfma_f32_32x32x16_bf16 v[64:79], v[152:155], v[24:27], v[64:79]
    ds_read_b64_tr_b16 v[168:169], v6 offset:9344
    ds_read_b64_tr_b16 v[170:171], v6 offset:10496
    s_waitcnt lgkmcnt(6)
    v_mfma_f32_32x32x16_bf16 v[64:79], v[156:159], v[28:31], v[64:79]
    ds_read_b64_tr_b16 v[172:173], v6 offset:13952
    ds_read_b64_tr_b16 v[174:175], v6 offset:15104
    s_waitcnt lgkmcnt(6)
    v_mfma_f32_32x32x16_bf16 v[64:79], v[160:163], v[32:35], v[64:79]
    ds_read_b64_tr_b16 v[144:145], v6 offset:18560
    ds_read_b64_tr_b16 v[146:147], v6 offset:19712
    s_waitcnt lgkmcnt(6)
    v_mfma_f32_32x32x16_bf16 v[64:79], v[164:167], v[36:39], v[64:79]
    ds_read_b64_tr_b16 v[148:149], v4 offset:192
    ds_read_b64_tr_b16 v[150:151], v4 offset:1344
    s_waitcnt lgkmcnt(6)
    v_mfma_f32_32x32x16_bf16 v[64:79], v[168:171], v[40:43], v[64:79]
    ds_read_b64_tr_b16 v[152:153], v4 offset:4800
    ds_read_b64_tr_b16 v[154:155], v4 offset:5952
    s_waitcnt lgkmcnt(6)
    v_mfma_f32_32x32x16_bf16 v[64:79], v[172:175], v[44:47], v[64:79]
    ds_read_b64_tr_b16 v[156:157], v4 offset:9408
    ds_read_b64_tr_b16 v[158:159], v4 offset:10560
    s_waitcnt lgkmcnt(6)
    v_mfma_f32_32x32x16_bf16 v[64:79], v[144:147], v[48:51], v[64:79]
    ds_read_b64_tr_b16 v[160:161], v4 offset:14016
    ds_read_b64_tr_b16 v[162:163], v4 offset:15168
    s_waitcnt lgkmcnt(6)
    v_mfma_f32_32x32x16_bf16 v[80:95], v[148:151], v[16:19], 0
    ds_read_b64_tr_b16 v[164:165], v6 offset:192
    ds_read_b64_tr_b16 v[166:167], v6 offset:1344
    s_waitcnt lgkmcnt(6)
    v_mfma_f32_32x32x16_bf16 v[80:95], v[152:155], v[20:23], v[80:95]
    ds_read_b64_tr_b16 v[168:169], v6 offset:4800
    ds_read_b64_tr_b16 v[170:171], v6 offset:5952
    s_waitcnt lgkmcnt(6)
    v_mfma_f32_32x32x16_bf16 v[80:95], v[156:159], v[24:27], v[80:95]
    ds_read_b64_tr_b16 v[172:173], v6 offset:9408
    ds_read_b64_tr_b16 v[174:175], v6 offset:10560
    s_waitcnt lgkmcnt(6)
    v_mfma_f32_32x32x16_bf16 v[80:95], v[160:163], v[28:31], v[80:95]
    ds_read_b64_tr_b16 v[144:145], v6 offset:14016
    ds_read_b64_tr_b16 v[146:147], v6 offset:15168
    s_waitcnt lgkmcnt(6)
    v_mfma_f32_32x32x16_bf16 v[80:95], v[164:167], v[32:35], v[80:95]
    ds_read_b64_tr_b16 v[148:149], v6 offset:18624
    ds_read_b64_tr_b16 v[150:151], v6 offset:19776
    s_waitcnt lgkmcnt(6)
    v_mfma_f32_32x32x16_bf16 v[80:95], v[168:171], v[36:39], v[80:95]
    ds_read_b64_tr_b16 v[152:153], v4 offset:256
    ds_read_b64_tr_b16 v[154:155], v4 offset:1408
    s_waitcnt lgkmcnt(6)
    v_mfma_f32_32x32x16_bf16 v[80:95], v[172:175], v[40:43], v[80:95]
    ds_read_b64_tr_b16 v[156:157], v4 offset:4864
    ds_read_b64_tr_b16 v[158:159], v4 offset:6016
    s_waitcnt lgkmcnt(6)
    v_mfma_f32_32x32x16_bf16 v[80:95], v[144:147], v[44:47], v[80:95]
    ds_read_b64_tr_b16 v[160:161], v4 offset:9472
    ds_read_b64_tr_b16 v[162:163], v4 offset:10624
    s_waitcnt lgkmcnt(6)
    v_mfma_f32_32x32x16_bf16 v[80:95], v[148:151], v[48:51], v[80:95]
    ds_read_b64_tr_b16 v[164:165], v4 offset:14080
    ds_read_b64_tr_b16 v[166:167], v4 offset:15232
    s_waitcnt lgkmcnt(6)
    v_mfma_f32_32x32x16_bf16 v[96:111], v[152:155], v[16:19], 0
    ds_read_b64_tr_b16 v[168:169], v6 offset:256
    ds_read_b64_tr_b16 v[170:171], v6 offset:1408
    s_waitcnt lgkmcnt(6)
    v_mfma_f32_32x32x16_bf16 v[96:111], v[156:159], v[20:23], v[96:111]
    ds_read_b64_tr_b16 v[172:173], v6 offset:4864
    ds_read_b64_tr_b16 v[174:175], v6 offset:6016
    s_waitcnt lgkmcnt(6)
    v_mfma_f32_32x32x16_bf16 v[96:111], v[160:163], v[24:27], v[96:111]
    ds_read_b64_tr_b16 v[144:145], v6 offset:9472
    ds_read_b64_tr_b16 v[146:147], v6 offset:10624
    s_waitcnt lgkmcnt(6)
    v_mfma_f32_32x32x16_bf16 v[96:111], v[164:167], v[28:31], v[96:111]
    ds_read_b64_tr_b16 v[148:149], v6 offset:14080
    ds_read_b64_tr_b16 v[150:151], v6 offset:15232
    s_waitcnt lgkmcnt(6)
    v_mfma_f32_32x32x16_bf16 v[96:111], v[168:171], v[32:35], v[96:111]
    ds_read_b64_tr_b16 v[152:153], v6 offset:18688
    ds_read_b64_tr_b16 v[154:155], v6 offset:19840
    s_waitcnt lgkmcnt(6)
    v_mfma_f32_32x32x16_bf16 v[96:111], v[172:175], v[36:39], v[96:111]
    s_waitcnt lgkmcnt(4)
    v_mfma_f32_32x32x16_bf16 v[96:111], v[144:147], v[40:43], v[96:111]
    s_waitcnt lgkmcnt(2)
    v_mfma_f32_32x32x16_bf16 v[96:111], v[148:151], v[44:47], v[96:111]
    s_waitcnt lgkmcnt(0)
    v_mfma_f32_32x32x16_bf16 v[96:111], v[152:155], v[48:51], v[96:111]
    s_nop 15
    s_mul_i32 s29, s26, 9216
    s_add_u32 s29, s29, 120832
    v_add_u32 v5, s29, v2
    v_cvt_pk_bf16_f32 v192, v64, v65
    v_cvt_pk_bf16_f32 v193, v66, v67
    v_cvt_pk_bf16_f32 v194, v68, v69
    v_cvt_pk_bf16_f32 v195, v70, v71
    ds_write_b128 v5, v[192:195] offset:4096
    v_cvt_pk_bf16_f32 v196, v72, v73
    v_cvt_pk_bf16_f32 v197, v74, v75
    v_cvt_pk_bf16_f32 v198, v76, v77
    v_cvt_pk_bf16_f32 v199, v78, v79
    ds_write_b128 v5, v[196:199] offset:5120
    v_cvt_pk_bf16_f32 v200, v80, v81
    v_cvt_pk_bf16_f32 v201, v82, v83
    v_cvt_pk_bf16_f32 v202, v84, v85
    v_cvt_pk_bf16_f32 v203, v86, v87
    ds_write_b128 v5, v[200:203] offset:6144
    v_cvt_pk_bf16_f32 v204, v88, v89
    v_cvt_pk_bf16_f32 v205, v90, v91
    v_cvt_pk_bf16_f32 v206, v92, v93
    v_cvt_pk_bf16_f32 v207, v94, v95
    ds_write_b128 v5, v[204:207] offset:7168
    v_cvt_pk_bf16_f32 v192, v96, v97
    v_cvt_pk_bf16_f32 v193, v98, v99
    v_cvt_pk_bf16_f32 v194, v100, v101
    v_cvt_pk_bf16_f32 v195, v102, v103
    ds_write_b128 v5, v[192:195] offset:8192
    s_waitcnt lgkmcnt(0)
    s_barrier
    ds_read_b128 v[16:19], v5 offset:0
    ds_read_b128 v[20:23], v5 offset:1024
    ds_read_b128 v[24:27], v5 offset:2048
    ds_read_b128 v[28:31], v5 offset:3072
    ds_read_b128 v[32:35], v5 offset:4096
    ds_read_b128 v[36:39], v5 offset:5120
    ds_read_b128 v[40:43], v5 offset:6144
    ds_read_b128 v[44:47], v5 offset:7168
    ds_read_b128 v[48:51], v5 offset:8192
    v_bfe_u32 v176, v1, 2, 2
    v_lshl_add_u32 v176, v7, 3, v176
    v_mul_u32_u24 v4, 288, v176
    v_bfe_u32 v176, v1, 4, 1
    v_lshl_add_u32 v4, v176, 5, v4
    v_and_b32 v176, 1, v1
    v_lshl_add_u32 v4, v176, 4, v4
    v_bfe_u32 v176, v1, 1, 1
    v_lshl_add_u32 v4, v176, 3, v4
    v_add_u32 v4, 41984, v4
    v_add_u32 v6, 18432, v4
    s_waitcnt lgkmcnt(0)
    ds_read_b64_tr_b16 v[144:145], v4 offset:192
    ds_read_b64_tr_b16 v[146:147], v4 offset:1344
    ds_read_b64_tr_b16 v[148:149], v4 offset:4800
    ds_read_b64_tr_b16 v[150:151], v4 offset:5952
    ds_read_b64_tr_b16 v[152:153], v4 offset:9408
    ds_read_b64_tr_b16 v[154:155], v4 offset:10560
    ds_read_b64_tr_b16 v[156:157], v4 offset:14016
    ds_read_b64_tr_b16 v[158:159], v4 offset:15168
    s_waitcnt lgkmcnt(6)
    v_mfma_f32_32x32x16_bf16 v[64:79], v[16:19], v[144:147], 0
    ds_read_b64_tr_b16 v[160:161], v6 offset:192
    ds_read_b64_tr_b16 v[162:163], v6 offset:1344
    s_waitcnt lgkmcnt(6)
    v_mfma_f32_32x32x16_bf16 v[64:79], v[20:23], v[148:151], v[64:79]
    ds_read_b64_tr_b16 v[164:165], v6 offset:4800
    ds_read_b64_tr_b16 v[166:167], v6 offset:5952
    s_waitcnt lgkmcnt(6)
    v_mfma_f32_32x32x16_bf16 v[64:79], v[24:27], v[152:155], v[64:79]
    ds_read_b64_tr_b16 v[168:169], v6 offset:9408
    ds_read_b64_tr_b16 v[170:171], v6 offset:10560
    s_waitcnt lgkmcnt(6)
    v_mfma_f32_32x32x16_bf16 v[64:79], v[28:31], v[156:159], v[64:79]
    ds_read_b64_tr_b16 v[172:173], v6 offset:14016
    ds_read_b64_tr_b16 v[174:175], v6 offset:15168
    s_waitcnt lgkmcnt(6)
    v_mfma_f32_32x32x16_bf16 v[64:79], v[32:35], v[160:163], v[64:79]
    ds_read_b64_tr_b16 v[144:145], v6 offset:18624
    ds_read_b64_tr_b16 v[146:147], v6 offset:19776
    s_waitcnt lgkmcnt(6)
    v_mfma_f32_32x32x16_bf16 v[64:79], v[36:39], v[164:167], v[64:79]
    ds_read_b64_tr_b16 v[148:149], v4 offset:256
    ds_read_b64_tr_b16 v[150:151], v4 offset:1408
    s_waitcnt lgkmcnt(6)
    v_mfma_f32_32x32x16_bf16 v[64:79], v[40:43], v[168:171], v[64:79]
    ds_read_b64_tr_b16 v[152:153], v4 offset:4864
    ds_read_b64_tr_b16 v[154:155], v4 offset:6016
    s_waitcnt lgkmcnt(6)
    v_mfma_f32_32x32x16_bf16 v[64:79], v[44:47], v[172:175], v[64:79]
    ds_read_b64_tr_b16 v[156:157], v4 offset:9472
    ds_read_b64_tr_b16 v[158:159], v4 offset:10624
    s_waitcnt lgkmcnt(6)
    v_mfma_f32_32x32x16_bf16 v[64:79], v[48:51], v[144:147], v[64:79]
    ds_read_b64_tr_b16 v[160:161], v4 offset:14080
    ds_read_b64_tr_b16 v[162:163], v4 offset:15232
    s_waitcnt lgkmcnt(6)
    v_mfma_f32_32x32x16_bf16 v[80:95], v[16:19], v[148:151], 0
    ds_read_b64_tr_b16 v[164:165], v6 offset:256
    ds_read_b64_tr_b16 v[166:167], v6 offset:1408
    s_waitcnt lgkmcnt(6)
    v_mfma_f32_32x32x16_bf16 v[80:95], v[20:23], v[152:155], v[80:95]
    ds_read_b64_tr_b16 v[168:169], v6 offset:4864
    ds_read_b64_tr_b16 v[170:171], v6 offset:6016
    s_waitcnt lgkmcnt(6)
    v_mfma_f32_32x32x16_bf16 v[80:95], v[24:27], v[156:159], v[80:95]
    ds_read_b64_tr_b16 v[172:173], v6 offset:9472
    ds_read_b64_tr_b16 v[174:175], v6 offset:10624
    s_waitcnt lgkmcnt(6)
    v_mfma_f32_32x32x16_bf16 v[80:95], v[28:31], v[160:163], v[80:95]
    ds_read_b64_tr_b16 v[144:145], v6 offset:14080
    ds_read_b64_tr_b16 v[146:147], v6 offset:15232
    s_waitcnt lgkmcnt(6)
    v_mfma_f32_32x32x16_bf16 v[80:95], v[32:35], v[164:167], v[80:95]
    ds_read_b64_tr_b16 v[148:149], v6 offset:18688
    ds_read_b64_tr_b16 v[150:151], v6 offset:19840
    s_waitcnt lgkmcnt(6)
    v_mfma_f32_32x32x16_bf16 v[80:95], v[36:39], v[168:171], v[80:95]
    s_waitcnt lgkmcnt(4)
    v_mfma_f32_32x32x16_bf16 v[80:95], v[40:43], v[172:175], v[80:95]
    s_waitcnt lgkmcnt(2)
    v_mfma_f32_32x32x16_bf16 v[80:95], v[44:47], v[144:147], v[80:95]
    s_waitcnt lgkmcnt(0)
    v_mfma_f32_32x32x16_bf16 v[80:95], v[48:51], v[148:151], v[80:95]
    s_nop 15
    s_lshl_b32 s29, s27, 1
    s_add_u32 s30, s29, 1
    s_cmp_lt_u32 s29, 9
    s_cselect_b32 s29, s29, 100
    s_cmp_lt_u32 s30, 9
    s_cselect_b32 s30, s30, 100
    s_add_u32 s29, s29, 0
    s_add_u32 s30, s30, 0
    s_mul_i32 s29, s29, 5120
    s_mul_i32 s30, s30, 5120
    v_cvt_pk_bf16_f32 v192, v64, v65
    v_cvt_pk_bf16_f32 v193, v66, v67
    v_cvt_pk_bf16_f32 v194, v68, v69
    v_cvt_pk_bf16_f32 v195, v70, v71
    buffer_store_dwordx4 v[192:195], v2, s[20:23], s29 offen offset:3072 sc1
    v_cvt_pk_bf16_f32 v196, v72, v73
    v_cvt_pk_bf16_f32 v197, v74, v75
    v_cvt_pk_bf16_f32 v198, v76, v77
    v_cvt_pk_bf16_f32 v199, v78, v79
    buffer_store_dwordx4 v[196:199], v2, s[20:23], s30 offen offset:3072 sc1
    v_cvt_pk_bf16_f32 v200, v80, v81
    v_cvt_pk_bf16_f32 v201, v82, v83
    v_cvt_pk_bf16_f32 v202, v84, v85
    v_cvt_pk_bf16_f32 v203, v86, v87
    s_add_u32 s31, s29, 4096
    buffer_store_dwordx4 v[200:203], v2, s[20:23], s31 offen sc1
    v_cvt_pk_bf16_f32 v204, v88, v89
    v_cvt_pk_bf16_f32 v205, v90, v91
    v_cvt_pk_bf16_f32 v206, v92, v93
    v_cvt_pk_bf16_f32 v207, v94, v95
    s_add_u32 s31, s30, 4096
    buffer_store_dwordx4 v[204:207], v2, s[20:23], s31 offen sc1
    s_endpgm
L_k1_foldC:
    s_add_u32 s8, s46, s54
    s_addc_u32 s9, s47, 0
    s_mov_b32 s10, s31
    s_mov_b32 s11, 0x20000
    s_add_u32 s16, s48, 41472
    s_addc_u32 s17, s49, 0
    s_mov_b32 s18, 41472
    s_mov_b32 s19, 0x20000
    s_add_u32 m0, s28, 0
    s_movk_i32 s29, 0
    buffer_load_dwordx4 v2, s[8:11], s29 offen offset:0 lds
    buffer_load_dwordx4 v2, s[8:11], s29 offen offset:1024 lds
    buffer_load_dwordx4 v2, s[8:11], s29 offen offset:2048 lds
    buffer_load_dwordx4 v2, s[8:11], s29 offen offset:3072 lds
    s_add_u32 m0, s28, 4096
    s_movk_i32 s29, 4096
    buffer_load_dwordx4 v2, s[8:11], s29 offen offset:0 lds
    buffer_load_dwordx4 v2, s[8:11], s29 offen offset:1024 lds
    buffer_load_dwordx4 v2, s[8:11], s29 offen offset:2048 lds
    buffer_load_dwordx4 v2, s[8:11], s29 offen offset:3072 lds
    s_add_u32 m0, s28, 8192
    s_movk_i32 s29, 8192
    buffer_load_dwordx4 v2, s[8:11], s29 offen offset:0 lds
    s_mul_i32 s29, s24, 11264
    s_min_u32 s30, s29, 37888
    s_add_u32 m0, s30, 41984
    s_add_u32 s29, s29, 4096
    buffer_load_dwordx4 v2, s[16:19], s30 offen offset:0 lds
    buffer_load_dwordx4 v2, s[16:19], s30 offen offset:1024 lds
    buffer_load_dwordx4 v2, s[16:19], s30 offen offset:2048 lds
    buffer_load_dwordx4 v2, s[16:19], s30 offen offset:3072 lds
    s_min_u32 s30, s29, 37888
    s_add_u32 m0, s30, 41984
    s_add_u32 s29, s29, 4096
    buffer_load_dwordx4 v2, s[16:19], s30 offen offset:0 lds
    buffer_load_dwordx4 v2, s[16:19], s30 offen offset:1024 lds
    buffer_load_dwordx4 v2, s[16:19], s30 offen offset:2048 lds
    buffer_load_dwordx4 v2, s[16:19], s30 offen offset:3072 lds
    s_min_u32 s30, s29, 38912
    s_add_u32 m0, s30, 41984
    s_add_u32 s29, s29, 3072
    buffer_load_dwordx4 v2, s[16:19], s30 offen offset:0 lds
    buffer_load_dwordx4 v2, s[16:19], s30 offen offset:1024 lds
    buffer_load_dwordx4 v2, s[16:19], s30 offen offset:2048 lds
    s_cmp_eq_u32 s27, 5
    s_cbranch_scc1 L_k1_tapsC
    v_bfe_u32 v176, v1, 2, 2
    v_lshl_add_u32 v176, v7, 3, v176
    v_mul_u32_u24 v4, 288, v176
    v_bfe_u32 v176, v1, 4, 1
    v_lshl_add_u32 v4, v176, 5, v4
    v_and_b32 v176, 1, v1
    v_lshl_add_u32 v4, v176, 4, v4
    v_bfe_u32 v176, v1, 1, 1
    v_lshl_add_u32 v4, v176, 3, v4
    v_add_u32 v4, 41984, v4
    v_add_u32 v6, 18432, v4
    s_waitcnt vmcnt(0)
    s_barrier
    v_and_b32 v3, 0x13, v8
    v_bfe_u32 v176, v8, 2, 1
    v_lshl_or_b32 v3, v176, 3, v3
    v_bfe_u32 v176, v8, 3, 1
    v_lshl_or_b32 v3, v176, 2, v3
    v_mul_u32_u24 v3, 288, v3
    v_lshl_add_u32 v3, v7, 4, v3
    v_add_u32 v3, s28, v3
    ds_read_b128 v[16:19], v3 offset:0
    ds_read_b128 v[20:23], v3 offset:32
    ds_read_b128 v[24:27], v3 offset:64
    ds_read_b128 v[28:31], v3 offset:96
    ds_read_b128 v[32:35], v3 offset:128
    ds_read_b128 v[36:39], v3 offset:160
    ds_read_b128 v[40:43], v3 offset:192
    ds_read_b128 v[44:47], v3 offset:224
    ds_read_b128 v[48:51], v3 offset:256
    s_waitcnt lgkmcnt(0)
    s_cmp_eq_u32 s25, 1
    s_cbranch_scc1 L_k1_C1
L_k1_C0:
    ds_read_b64_tr_b16 v[144:145], v4 offset:0
    ds_read_b64_tr_b16 v[146:147], v4 offset:1152
    ds_read_b64_tr_b16 v[148:149], v4 offset:4608
    ds_read_b64_tr_b16 v[150:151], v4 offset:5760
    ds_read_b64_tr_b16 v[152:153], v4 offset:9216
    ds_read_b64_tr_b16 v[154:155], v4 offset:10368
    ds_read_b64_tr_b16 v[156:157], v4 offset:13824
    ds_read_b64_tr_b16 v[158:159], v4 offset:14976
    s_waitcnt lgkmcnt(6)
    v_mfma_f32_32x32x16_bf16 v[64:79], v[16:19], v[144:147], 0
    ds_read_b64_tr_b16 v[160:161], v6 offset:0
    ds_read_b64_tr_b16 v[162:163], v6 offset:1152
    s_waitcnt lgkmcnt(6)
    v_mfma_f32_32x32x16_bf16 v[64:79], v[20:23], v[148:151], v[64:79]
    ds_read_b64_tr_b16 v[164:165], v6 offset:4608
    ds_read_b64_tr_b16 v[166:167], v6 offset:5760
    s_waitcnt lgkmcnt(6)
    v_mfma_f32_32x32x16_bf16 v[64:79], v[24:27], v[152:155], v[64:79]
    ds_read_b64_tr_b16 v[168:169], v6 offset:9216
    ds_read_b64_tr_b16 v[170:171], v6 offset:10368
    s_waitcnt lgkmcnt(6)
    v_mfma_f32_32x32x16_bf16 v[64:79], v[28:31], v[156:159], v[64:79]
    ds_read_b64_tr_b16 v[172:173], v6 offset:13824
    ds_read_b64_tr_b16 v[174:175], v6 offset:14976
    s_waitcnt lgkmcnt(6)
    v_mfma_f32_32x32x16_bf16 v[64:79], v[32:35], v[160:163], v[64:79]
    ds_read_b64_tr_b16 v[144:145], v6 offset:18432
    ds_read_b64_tr_b16 v[146:147], v6 offset:19584
    s_waitcnt lgkmcnt(6)
    v_mfma_f32_32x32x16_bf16 v[64:79], v[36:39], v[164:167], v[64:79]
    ds_read_b64_tr_b16 v[148:149], v4 offset:64
    ds_read_b64_tr_b16 v[150:151], v4 offset:1216
    s_waitcnt lgkmcnt(6)
    v_mfma_f32_32x32x16_bf16 v[64:79], v[40:43], v[168:171], v[64:79]
    ds_read_b64_tr_b16 v[152:153], v4 offset:4672
    ds_read_b64_tr_b16 v[154:155], v4 offset:5824
    s_waitcnt lgkmcnt(6)
    v_mfma_f32_32x32x16_bf16 v[64:79], v[44:47], v[172:175], v[64:79]
    ds_read_b64_tr_b16 v[156:157], v4 offset:9280
    ds_read_b64_tr_b16 v[158:159], v4 offset:10432
    s_waitcnt lgkmcnt(6)
    v_mfma_f32_32x32x16_bf16 v[64:79], v[48:51], v[144:147], v[64:79]
    ds_read_b64_tr_b16 v[160:161], v4 offset:13888
    ds_read_b64_tr_b16 v[162:163], v4 offset:15040
    s_waitcnt lgkmcnt(6)
    v_mfma_f32_32x32x16_bf16 v[80:95], v[16:19], v[148:151], 0
    ds_read_b64_tr_b16 v[164:165], v6 offset:64
    ds_read_b64_tr_b16 v[166:167], v6 offset:1216
    s_waitcnt lgkmcnt(6)
    v_mfma_f32_32x32x16_bf16 v[80:95], v[20:23], v[152:155], v[80:95]
    ds_read_b64_tr_b16 v[168:169], v6 offset:4672
    ds_read_b64_tr_b16 v[170:171], v6 offset:5824
    s_waitcnt lgkmcnt(6)
    v_mfma_f32_32x32x16_bf16 v[80:95], v[24:27], v[156:159], v[80:95]
    ds_read_b64_tr_b16 v[172:173], v6 offset:9280
    ds_read_b64_tr_b16 v[174:175], v6 offset:10432
    s_waitcnt lgkmcnt(6)
    v_mfma_f32_32x32x16_bf16 v[80:95], v[28:31], v[160:163], v[80:95]
    ds_read_b64_tr_b16 v[144:145], v6 offset:13888
    ds_read_b64_tr_b16 v[146:147], v6 offset:15040
    s_waitcnt lgkmcnt(6)
    v_mfma_f32_32x32x16_bf16 v[80:95], v[32:35], v[164:167], v[80:95]
    ds_read_b64_tr_b16 v[148:149], v6 offset:18496
    ds_read_b64_tr_b16 v[150:151], v6 offset:19648
    s_waitcnt lgkmcnt(6)
    v_mfma_f32_32x32x16_bf16 v[80:95], v[36:39], v[168:171], v[80:95]
    ds_read_b64_tr_b16 v[152:153], v4 offset:128
    ds_read_b64_tr_b16 v[154:155], v4 offset:1280
    s_waitcnt lgkmcnt(6)
    v_mfma_f32_32x32x16_bf16 v[80:95], v[40:43], v[172:175], v[80:95]
    ds_read_b64_tr_b16 v[156:157], v4 offset:4736
    ds_read_b64_tr_b16 v[158:159], v4 offset:5888
    s_waitcnt lgkmcnt(6)
    v_mfma_f32_32x32x16_bf16 v[80:95], v[44:47], v[144:147], v[80:95]
    ds_read_b64_tr_b16 v[160:161], v4 offset:9344
    ds_read_b64_tr_b16 v[162:163], v4 offset:10496
    s_waitcnt lgkmcnt(6)
    v_mfma_f32_32x32x16_bf16 v[80:95], v[48:51], v[148:151], v[80:95]
    ds_read_b64_tr_b16 v[164:165], v4 offset:13952
    ds_read_b64_tr_b16 v[166:167], v4 offset:15104
    s_waitcnt lgkmcnt(6)
    v_mfma_f32_32x32x16_bf16 v[96:111], v[16:19], v[152:155], 0
    ds_read_b64_tr_b16 v[168:169], v6 offset:128
    ds_read_b64_tr_b16 v[170:171], v6 offset:1280
    s_waitcnt lgkmcnt(6)
    v_mfma_f32_32x32x16_bf16 v[96:111], v[20:23], v[156:159], v[96:111]
    ds_read_b64_tr_b16 v[172:173], v6 offset:4736
    ds_read_b64_tr_b16 v[174:175], v6 offset:5888
    s_waitcnt lgkmcnt(6)
    v_mfma_f32_32x32x16_bf16 v[96:111], v[24:27], v[160:163], v[96:111]
    ds_read_b64_tr_b16 v[144:145], v6 offset:9344
    ds_read_b64_tr_b16 v[146:147], v6 offset:10496
    s_waitcnt lgkmcnt(6)
    v_mfma_f32_32x32x16_bf16 v[96:111], v[28:31], v[164:167], v[96:111]
    ds_read_b64_tr_b16 v[148:149], v6 offset:13952
    ds_read_b64_tr_b16 v[150:151], v6 offset:15104
    s_waitcnt lgkmcnt(6)
    v_mfma_f32_32x32x16_bf16 v[96:111], v[32:35], v[168:171], v[96:111]
    ds_read_b64_tr_b16 v[152:153], v6 offset:18560
    ds_read_b64_tr_b16 v[154:155], v6 offset:19712
    s_waitcnt lgkmcnt(6)
    v_mfma_f32_32x32x16_bf16 v[96:111], v[36:39], v[172:175], v[96:111]
    s_waitcnt lgkmcnt(4)
    v_mfma_f32_32x32x16_bf16 v[96:111], v[40:43], v[144:147], v[96:111]
    s_waitcnt lgkmcnt(2)
    v_mfma_f32_32x32x16_bf16 v[96:111], v[44:47], v[148:151], v[96:111]
    s_waitcnt lgkmcnt(0)
    v_mfma_f32_32x32x16_bf16 v[96:111], v[48:51], v[152:155], v[96:111]
    s_nop 15
    s_lshl_b32 s29, s27, 1
    s_add_u32 s30, s29, 1
    s_cmp_lt_u32 s29, 9
    s_cselect_b32 s29, s29, 100
    s_cmp_lt_u32 s30, 9
    s_cselect_b32 s30, s30, 100
    s_add_u32 s29, s29, 9
    s_add_u32 s30, s30, 9
    s_mul_i32 s29, s29, 5120
    s_mul_i32 s30, s30, 5120
    v_cvt_pk_bf16_f32 v192, v64, v65
    v_cvt_pk_bf16_f32 v193, v66, v67
    v_cvt_pk_bf16_f32 v194, v68, v69
    v_cvt_pk_bf16_f32 v195, v70, v71
    buffer_store_dwordx4 v[192:195], v2, s[20:23], s29 offen offset:0 sc1
    v_cvt_pk_bf16_f32 v196, v72, v73
    v_cvt_pk_bf16_f32 v197, v74, v75
    v_cvt_pk_bf16_f32 v198, v76, v77
    v_cvt_pk_bf16_f32 v199, v78, v79
    buffer_store_dwordx4 v[196:199], v2, s[20:23], s30 offen offset:0 sc1
    v_cvt_pk_bf16_f32 v200, v80, v81
    v_cvt_pk_bf16_f32 v201, v82, v83
    v_cvt_pk_bf16_f32 v202, v84, v85
    v_cvt_pk_bf16_f32 v203, v86, v87
    buffer_store_dwordx4 v[200:203], v2, s[20:23], s29 offen offset:1024 sc1
    v_cvt_pk_bf16_f32 v204, v88, v89
    v_cvt_pk_bf16_f32 v205, v90, v91
    v_cvt_pk_bf16_f32 v206, v92, v93
    v_cvt_pk_bf16_f32 v207, v94, v95
    buffer_store_dwordx4 v[204:207], v2, s[20:23], s30 offen offset:1024 sc1
    v_cvt_pk_bf16_f32 v208, v96, v97
    v_cvt_pk_bf16_f32 v209, v98, v99
    v_cvt_pk_bf16_f32 v210, v100, v101
    v_cvt_pk_bf16_f32 v211, v102, v103
    buffer_store_dwordx4 v[208:211], v2, s[20:23], s29 offen offset:2048 sc1
    v_cvt_pk_bf16_f32 v212, v104, v105
    v_cvt_pk_bf16_f32 v213, v106, v107
    v_cvt_pk_bf16_f32 v214, v108, v109
    v_cvt_pk_bf16_f32 v215, v110, v111
    buffer_store_dwordx4 v[212:215], v2, s[20:23], s30 offen offset:2048 sc1
    s_endpgm
L_k1_C1:
    ds_read_b64_tr_b16 v[144:145], v4 offset:192
    ds_read_b64_tr_b16 v[146:147], v4 offset:1344
    ds_read_b64_tr_b16 v[148:149], v4 offset:4800
    ds_read_b64_tr_b16 v[150:151], v4 offset:5952
    ds_read_b64_tr_b16 v[152:153], v4 offset:9408
    ds_read_b64_tr_b16 v[154:155], v4 offset:10560
    ds_read_b64_tr_b16 v[156:157], v4 offset:14016
    ds_read_b64_tr_b16 v[158:159], v4 offset:15168
    s_waitcnt lgkmcnt(6)
    v_mfma_f32_32x32x16_bf16 v[64:79], v[16:19], v[144:147], 0
    ds_read_b64_tr_b16 v[160:161], v6 offset:192
    ds_read_b64_tr_b16 v[162:163], v6 offset:1344
    s_waitcnt lgkmcnt(6)
    v_mfma_f32_32x32x16_bf16 v[64:79], v[20:23], v[148:151], v[64:79]
    ds_read_b64_tr_b16 v[164:165], v6 offset:4800
    ds_read_b64_tr_b16 v[166:167], v6 offset:5952
    s_waitcnt lgkmcnt(6)
    v_mfma_f32_32x32x16_bf16 v[64:79], v[24:27], v[152:155], v[64:79]
    ds_read_b64_tr_b16 v[168:169], v6 offset:9408
    ds_read_b64_tr_b16 v[170:171], v6 offset:10560
    s_waitcnt lgkmcnt(6)
    v_mfma_f32_32x32x16_bf16 v[64:79], v[28:31], v[156:159], v[64:79]
    ds_read_b64_tr_b16 v[172:173], v6 offset:14016
    ds_read_b64_tr_b16 v[174:175], v6 offset:15168
    s_waitcnt lgkmcnt(6)
    v_mfma_f32_32x32x16_bf16 v[64:79], v[32:35], v[160:163], v[64:79]
    ds_read_b64_tr_b16 v[144:145], v6 offset:18624
    ds_read_b64_tr_b16 v[146:147], v6 offset:19776
    s_waitcnt lgkmcnt(6)
    v_mfma_f32_32x32x16_bf16 v[64:79], v[36:39], v[164:167], v[64:79]
    ds_read_b64_tr_b16 v[148:149], v4 offset:256
    ds_read_b64_tr_b16 v[150:151], v4 offset:1408
    s_waitcnt lgkmcnt(6)
    v_mfma_f32_32x32x16_bf16 v[64:79], v[40:43], v[168:171], v[64:79]
    ds_read_b64_tr_b16 v[152:153], v4 offset:4864
    ds_read_b64_tr_b16 v[154:155], v4 offset:6016
    s_waitcnt lgkmcnt(6)
    v_mfma_f32_32x32x16_bf16 v[64:79], v[44:47], v[172:175], v[64:79]
    ds_read_b64_tr_b16 v[156:157], v4 offset:9472
    ds_read_b64_tr_b16 v[158:159], v4 offset:10624
    s_waitcnt lgkmcnt(6)
    v_mfma_f32_32x32x16_bf16 v[64:79], v[48:51], v[144:147], v[64:79]
    ds_read_b64_tr_b16 v[160:161], v4 offset:14080
    ds_read_b64_tr_b16 v[162:163], v4 offset:15232
    s_waitcnt lgkmcnt(6)
    v_mfma_f32_32x32x16_bf16 v[80:95], v[16:19], v[148:151], 0
    ds_read_b64_tr_b16 v[164:165], v6 offset:256
    ds_read_b64_tr_b16 v[166:167], v6 offset:1408
    s_waitcnt lgkmcnt(6)
    v_mfma_f32_32x32x16_bf16 v[80:95], v[20:23], v[152:155], v[80:95]
    ds_read_b64_tr_b16 v[168:169], v6 offset:4864
    ds_read_b64_tr_b16 v[170:171], v6 offset:6016
    s_waitcnt lgkmcnt(6)
    v_mfma_f32_32x32x16_bf16 v[80:95], v[24:27], v[156:159], v[80:95]
    ds_read_b64_tr_b16 v[172:173], v6 offset:9472
    ds_read_b64_tr_b16 v[174:175], v6 offset:10624
    s_waitcnt lgkmcnt(6)
    v_mfma_f32_32x32x16_bf16 v[80:95], v[28:31], v[160:163], v[80:95]
    ds_read_b64_tr_b16 v[144:145], v6 offset:14080
    ds_read_b64_tr_b16 v[146:147], v6 offset:15232
    s_waitcnt lgkmcnt(6)
    v_mfma_f32_32x32x16_bf16 v[80:95], v[32:35], v[164:167], v[80:95]
    ds_read_b64_tr_b16 v[148:149], v6 offset:18688
    ds_read_b64_tr_b16 v[150:151], v6 offset:19840
    s_waitcnt lgkmcnt(6)
    v_mfma_f32_32x32x16_bf16 v[80:95], v[36:39], v[168:171], v[80:95]
    s_waitcnt lgkmcnt(4)
    v_mfma_f32_32x32x16_bf16 v[80:95], v[40:43], v[172:175], v[80:95]
    s_waitcnt lgkmcnt(2)
    v_mfma_f32_32x32x16_bf16 v[80:95], v[44:47], v[144:147], v[80:95]
    s_waitcnt lgkmcnt(0)
    v_mfma_f32_32x32x16_bf16 v[80:95], v[48:51], v[148:151], v[80:95]
    s_nop 15
    s_lshl_b32 s29, s27, 1
    s_add_u32 s30, s29, 1
    s_cmp_lt_u32 s29, 9
    s_cselect_b32 s29, s29, 100
    s_cmp_lt_u32 s30, 9
    s_cselect_b32 s30, s30, 100
    s_add_u32 s29, s29, 9
    s_add_u32 s30, s30, 9
    s_mul_i32 s29, s29, 5120
    s_mul_i32 s30, s30, 5120
    v_cvt_pk_bf16_f32 v192, v64, v65
    v_cvt_pk_bf16_f32 v193, v66, v67
    v_cvt_pk_bf16_f32 v194, v68, v69
    v_cvt_pk_bf16_f32 v195, v70, v71
    buffer_store_dwordx4 v[192:195], v2, s[20:23], s29 offen offset:3072 sc1
    v_cvt_pk_bf16_f32 v196, v72, v73
    v_cvt_pk_bf16_f32 v197, v74, v75
    v_cvt_pk_bf16_f32 v198, v76, v77
    v_cvt_pk_bf16_f32 v199, v78, v79
    buffer_store_dwordx4 v[196:199], v2, s[20:23], s30 offen offset:3072 sc1
    v_cvt_pk_bf16_f32 v200, v80, v81
    v_cvt_pk_bf16_f32 v201, v82, v83
    v_cvt_pk_bf16_f32 v202, v84, v85
    v_cvt_pk_bf16_f32 v203, v86, v87
    s_add_u32 s31, s29, 4096
    buffer_store_dwordx4 v[200:203], v2, s[20:23], s31 offen sc1
    v_cvt_pk_bf16_f32 v204, v88, v89
    v_cvt_pk_bf16_f32 v205, v90, v91
    v_cvt_pk_bf16_f32 v206, v92, v93
    v_cvt_pk_bf16_f32 v207, v94, v95
    s_add_u32 s31, s30, 4096
    buffer_store_dwordx4 v[204:207], v2, s[20:23], s31 offen sc1
    s_endpgm
L_k1_tapsV:
    s_lshl_b32 s29, s55, 1
    s_add_u32 s29, s29, s25
    s_mul_i32 s29, s29, 36
    v_min_u32 v3, 35, v1
    v_add_u32 v3, s29, v3
    v_lshlrev_b32 v4, 1, v3
    s_add_u32 s8, s44, 0
    s_addc_u32 s9, s45, 0
    s_mov_b32 s10, 8928
    s_mov_b32 s11, 0x20000
    s_add_u32 s20, s4, 14548992
    s_addc_u32 s21, s5, 0
    s_mov_b32 s22, 23040
    s_mov_b32 s23, 0x20000
    buffer_load_ushort v16, v4, s[8:11], 0 offen offset:0
    buffer_load_ushort v17, v4, s[8:11], 0 offen offset:288
    buffer_load_ushort v18, v4, s[8:11], 0 offen offset:576
    buffer_load_ushort v19, v4, s[8:11], 0 offen offset:864
    buffer_load_ushort v20, v4, s[8:11], 0 offen offset:1152
    buffer_load_ushort v21, v4, s[8:11], 0 offen offset:1440
    buffer_load_ushort v22, v4, s[8:11], 0 offen offset:1728
    buffer_load_ushort v23, v4, s[8:11], 0 offen offset:2016
    buffer_load_ushort v24, v4, s[8:11], 0 offen offset:2304
    buffer_load_ushort v25, v4, s[8:11], 0 offen offset:2592
    buffer_load_ushort v26, v4, s[8:11], 0 offen offset:2880
    buffer_load_ushort v27, v4, s[8:11], 0 offen offset:3168
    buffer_load_ushort v28, v4, s[8:11], 0 offen offset:3456
    buffer_load_ushort v29, v4, s[8:11], 0 offen offset:3744
    buffer_load_ushort v30, v4, s[8:11], 0 offen offset:4032
    s_movk_i32 s30, 4320
    buffer_load_ushort v31, v4, s[8:11], s30 offen
    s_movk_i32 s30, 4608
    buffer_load_ushort v32, v4, s[8:11], s30 offen
    s_movk_i32 s30, 4896
    buffer_load_ushort v33, v4, s[8:11], s30 offen
    s_movk_i32 s30, 5184
    buffer_load_ushort v34, v4, s[8:11], s30 offen
    s_movk_i32 s30, 5472
    buffer_load_ushort v35, v4, s[8:11], s30 offen
    s_movk_i32 s30, 5760
    buffer_load_ushort v36, v4, s[8:11], s30 offen
    s_movk_i32 s30, 6048
    buffer_load_ushort v37, v4, s[8:11], s30 offen
    s_movk_i32 s30, 6336
    buffer_load_ushort v38, v4, s[8:11], s30 offen
    s_movk_i32 s30, 6624
    buffer_load_ushort v39, v4, s[8:11], s30 offen
    s_movk_i32 s30, 6912
    buffer_load_ushort v40, v4, s[8:11], s30 offen
    s_movk_i32 s30, 7200
    buffer_load_ushort v41, v4, s[8:11], s30 offen
    s_movk_i32 s30, 7488
    buffer_load_ushort v42, v4, s[8:11], s30 offen
    s_movk_i32 s30, 7776
    buffer_load_ushort v43, v4, s[8:11], s30 offen
    s_movk_i32 s30, 8064
    buffer_load_ushort v44, v4, s[8:11], s30 offen
    s_movk_i32 s30, 8352
    buffer_load_ushort v45, v4, s[8:11], s30 offen
    s_movk_i32 s30, 8640
    buffer_load_ushort v46, v4, s[8:11], s30 offen
    v_mov_b32 v5, 0
    v_lshrrev_b32 v6, 4, v3
    v_mul_u32_u24 v6, 1280, v6
    v_mul_u32_u24 v7, 80, v3
    v_add_u32 v6, v6, v7
    s_waitcnt vmcnt(0)
    v_lshl_or_b32 v64, v5, 16, v5
    v_lshl_or_b32 v65, v5, 16, v5
    v_lshl_or_b32 v66, v17, 16, v16
    v_lshl_or_b32 v67, v19, 16, v18
    v_lshl_or_b32 v68, v21, 16, v20
    v_lshl_or_b32 v69, v23, 16, v22
    v_lshl_or_b32 v70, v25, 16, v24
    v_lshl_or_b32 v71, v27, 16, v26
    v_lshl_or_b32 v72, v29, 16, v28
    v_lshl_or_b32 v73, v31, 16, v30
    v_lshl_or_b32 v74, v33, 16, v32
    v_lshl_or_b32 v75, v35, 16, v34
    v_lshl_or_b32 v76, v37, 16, v36
    v_lshl_or_b32 v77, v39, 16, v38
    v_lshl_or_b32 v78, v41, 16, v40
    v_lshl_or_b32 v79, v43, 16, v42
    v_lshl_or_b32 v80, v45, 16, v44
    v_lshl_or_b32 v81, v5, 16, v46
    v_lshl_or_b32 v82, v5, 16, v5
    v_lshl_or_b32 v83, v5, 16, v5
    s_movk_i32 s30, 0
    buffer_store_dwordx4 v[64:67], v6, s[20:23], s30 offen offset:0 sc1
    buffer_store_dwordx4 v[68:71], v6, s[20:23], s30 offen offset:16 sc1
    buffer_store_dwordx4 v[72:75], v6, s[20:23], s30 offen offset:32 sc1
    buffer_store_dwordx4 v[76:79], v6, s[20:23], s30 offen offset:48 sc1
    buffer_store_dwordx4 v[80:83], v6, s[20:23], s30 offen offset:64 sc1
    v_lshl_or_b32 v84, v5, 16, v5
    v_lshl_or_b32 v85, v16, 16, v5
    v_lshl_or_b32 v86, v18, 16, v17
    v_lshl_or_b32 v87, v20, 16, v19
    v_lshl_or_b32 v88, v22, 16, v21
    v_lshl_or_b32 v89, v24, 16, v23
    v_lshl_or_b32 v90, v26, 16, v25
    v_lshl_or_b32 v91, v28, 16, v27
    v_lshl_or_b32 v92, v30, 16, v29
    v_lshl_or_b32 v93, v32, 16, v31
    v_lshl_or_b32 v94, v34, 16, v33
    v_lshl_or_b32 v95, v36, 16, v35
    v_lshl_or_b32 v96, v38, 16, v37
    v_lshl_or_b32 v97, v40, 16, v39
    v_lshl_or_b32 v98, v42, 16, v41
    v_lshl_or_b32 v99, v44, 16, v43
    v_lshl_or_b32 v100, v46, 16, v45
    v_lshl_or_b32 v101, v5, 16, v5
    v_lshl_or_b32 v102, v5, 16, v5
    v_lshl_or_b32 v103, v5, 16, v5
    s_movk_i32 s30, 1280
    buffer_store_dwordx4 v[84:87], v6, s[20:23], s30 offen offset:0 sc1
    buffer_store_dwordx4 v[88:91], v6, s[20:23], s30 offen offset:16 sc1
    buffer_store_dwordx4 v[92:95], v6, s[20:23], s30 offen offset:32 sc1
    buffer_store_dwordx4 v[96:99], v6, s[20:23], s30 offen offset:48 sc1
    buffer_store_dwordx4 v[100:103], v6, s[20:23], s30 offen offset:64 sc1
    s_add_u32 s20, s4, 14614528
    s_addc_u32 s21, s5, 0
    s_mov_b32 s22, 16384
    s_mov_b32 s23, 0x20000
    s_lshl_b32 s29, s55, 1
    s_add_u32 s29, s29, s25
    s_lshl_b32 s29, s29, 12
    v_mov_b32 v8, 0
    v_mov_b32 v9, 0
    v_mov_b32 v10, 0
    v_mov_b32 v11, 0
    buffer_store_dwordx4 v[8:11], v2, s[20:23], s29 offen offset:0 sc1
    buffer_store_dwordx4 v[8:11], v2, s[20:23], s29 offen offset:1024 sc1
    buffer_store_dwordx4 v[8:11], v2, s[20:23], s29 offen offset:2048 sc1
    buffer_store_dwordx4 v[8:11], v2, s[20:23], s29 offen offset:3072 sc1
    s_barrier
    s_barrier
    s_endpgm
L_k1_tapsC:
    s_lshl_b32 s29, s55, 1
    s_add_u32 s29, s29, s25
    s_mul_i32 s29, s29, 36
    v_min_u32 v3, 35, v1
    v_add_u32 v3, s29, v3
    v_lshlrev_b32 v4, 1, v3
    s_add_u32 s8, s44, 0
    s_addc_u32 s9, s45, 0
    s_mov_b32 s10, 8928
    s_mov_b32 s11, 0x20000
    s_add_u32 s20, s4, 14548992
    s_addc_u32 s21, s5, 0
    s_mov_b32 s22, 23040
    s_mov_b32 s23, 0x20000
    buffer_load_ushort v16, v4, s[8:11], 0 offen offset:0
    buffer_load_ushort v17, v4, s[8:11], 0 offen offset:288
    buffer_load_ushort v18, v4, s[8:11], 0 offen offset:576
    buffer_load_ushort v19, v4, s[8:11], 0 offen offset:864
    buffer_load_ushort v20, v4, s[8:11], 0 offen offset:1152
    buffer_load_ushort v21, v4, s[8:11], 0 offen offset:1440
    buffer_load_ushort v22, v4, s[8:11], 0 offen offset:1728
    buffer_load_ushort v23, v4, s[8:11], 0 offen offset:2016
    buffer_load_ushort v24, v4, s[8:11], 0 offen offset:2304
    buffer_load_ushort v25, v4, s[8:11], 0 offen offset:2592
    buffer_load_ushort v26, v4, s[8:11], 0 offen offset:2880
    buffer_load_ushort v27, v4, s[8:11], 0 offen offset:3168
    buffer_load_ushort v28, v4, s[8:11], 0 offen offset:3456
    buffer_load_ushort v29, v4, s[8:11], 0 offen offset:3744
    buffer_load_ushort v30, v4, s[8:11], 0 offen offset:4032
    s_movk_i32 s30, 4320
    buffer_load_ushort v31, v4, s[8:11], s30 offen
    s_movk_i32 s30, 4608
    buffer_load_ushort v32, v4, s[8:11], s30 offen
    s_movk_i32 s30, 4896
    buffer_load_ushort v33, v4, s[8:11], s30 offen
    s_movk_i32 s30, 5184
    buffer_load_ushort v34, v4, s[8:11], s30 offen
    s_movk_i32 s30, 5472
    buffer_load_ushort v35, v4, s[8:11], s30 offen
    s_movk_i32 s30, 5760
    buffer_load_ushort v36, v4, s[8:11], s30 offen
    s_movk_i32 s30, 6048
    buffer_load_ushort v37, v4, s[8:11], s30 offen
    s_movk_i32 s30, 6336
    buffer_load_ushort v38, v4, s[8:11], s30 offen
    s_movk_i32 s30, 6624
    buffer_load_ushort v39, v4, s[8:11], s30 offen
    s_movk_i32 s30, 6912
    buffer_load_ushort v40, v4, s[8:11], s30 offen
    s_movk_i32 s30, 7200
    buffer_load_ushort v41, v4, s[8:11], s30 offen
    s_movk_i32 s30, 7488
    buffer_load_ushort v42, v4, s[8:11], s30 offen
    s_movk_i32 s30, 7776
    buffer_load_ushort v43, v4, s[8:11], s30 offen
    s_movk_i32 s30, 8064
    buffer_load_ushort v44, v4, s[8:11], s30 offen
    s_movk_i32 s30, 8352
    buffer_load_ushort v45, v4, s[8:11], s30 offen
    s_movk_i32 s30, 8640
    buffer_load_ushort v46, v4, s[8:11], s30 offen
    v_mov_b32 v5, 0
    v_lshrrev_b32 v6, 4, v3
    v_mul_u32_u24 v6, 1280, v6
    v_mul_u32_u24 v7, 80, v3
    v_add_u32 v6, v6, v7
    s_waitcnt vmcnt(0)
    v_lshl_or_b32 v64, v5, 16, v5
    v_lshl_or_b32 v65, v5, 16, v5
    v_lshl_or_b32 v66, v17, 16, v16
    v_lshl_or_b32 v67, v19, 16, v18
    v_lshl_or_b32 v68, v21, 16, v20
    v_lshl_or_b32 v69, v23, 16, v22
    v_lshl_or_b32 v70, v25, 16, v24
    v_lshl_or_b32 v71, v27, 16, v26
    v_lshl_or_b32 v72, v29, 16, v28
    v_lshl_or_b32 v73, v31, 16, v30
    v_lshl_or_b32 v74, v33, 16, v32
    v_lshl_or_b32 v75, v35, 16, v34
    v_lshl_or_b32 v76, v37, 16, v36
    v_lshl_or_b32 v77, v39, 16, v38
    v_lshl_or_b32 v78, v41, 16, v40
    v_lshl_or_b32 v79, v43, 16, v42
    v_lshl_or_b32 v80, v45, 16, v44
    v_lshl_or_b32 v81, v5, 16, v46
    v_lshl_or_b32 v82, v5, 16, v5
    v_lshl_or_b32 v83, v5, 16, v5
    s_movk_i32 s30, 0
    buffer_store_dwordx4 v[64:67], v6, s[20:23], s30 offen offset:0 sc1
    buffer_store_dwordx4 v[68:71], v6, s[20:23], s30 offen offset:16 sc1
    buffer_store_dwordx4 v[72:75], v6, s[20:23], s30 offen offset:32 sc1
    buffer_store_dwordx4 v[76:79], v6, s[20:23], s30 offen offset:48 sc1
    buffer_store_dwordx4 v[80:83], v6, s[20:23], s30 offen offset:64 sc1
    v_lshl_or_b32 v84, v5, 16, v5
    v_lshl_or_b32 v85, v16, 16, v5
    v_lshl_or_b32 v86, v18, 16, v17
    v_lshl_or_b32 v87, v20, 16, v19
    v_lshl_or_b32 v88, v22, 16, v21
    v_lshl_or_b32 v89, v24, 16, v23
    v_lshl_or_b32 v90, v26, 16, v25
    v_lshl_or_b32 v91, v28, 16, v27
    v_lshl_or_b32 v92, v30, 16, v29
    v_lshl_or_b32 v93, v32, 16, v31
    v_lshl_or_b32 v94, v34, 16, v33
    v_lshl_or_b32 v95, v36, 16, v35
    v_lshl_or_b32 v96, v38, 16, v37
    v_lshl_or_b32 v97, v40, 16, v39
    v_lshl_or_b32 v98, v42, 16, v41
    v_lshl_or_b32 v99, v44, 16, v43
    v_lshl_or_b32 v100, v46, 16, v45
    v_lshl_or_b32 v101, v5, 16, v5
    v_lshl_or_b32 v102, v5, 16, v5
    v_lshl_or_b32 v103, v5, 16, v5
    s_movk_i32 s30, 1280
    buffer_store_dwordx4 v[84:87], v6, s[20:23], s30 offen offset:0 sc1
    buffer_store_dwordx4 v[88:91], v6, s[20:23], s30 offen offset:16 sc1
    buffer_store_dwordx4 v[92:95], v6, s[20:23], s30 offen offset:32 sc1
    buffer_store_dwordx4 v[96:99], v6, s[20:23], s30 offen offset:48 sc1
    buffer_store_dwordx4 v[100:103], v6, s[20:23], s30 offen offset:64 sc1
    s_add_u32 s20, s4, 14614528
    s_addc_u32 s21, s5, 0
    s_mov_b32 s22, 16384
    s_mov_b32 s23, 0x20000
    s_lshl_b32 s29, s55, 1
    s_add_u32 s29, s29, s25
    s_lshl_b32 s29, s29, 12
    v_mov_b32 v8, 0
    v_mov_b32 v9, 0
    v_mov_b32 v10, 0
    v_mov_b32 v11, 0
    buffer_store_dwordx4 v[8:11], v2, s[20:23], s29 offen offset:0 sc1
    buffer_store_dwordx4 v[8:11], v2, s[20:23], s29 offen offset:1024 sc1
    buffer_store_dwordx4 v[8:11], v2, s[20:23], s29 offen offset:2048 sc1
    buffer_store_dwordx4 v[8:11], v2, s[20:23], s29 offen offset:3072 sc1
    s_barrier
    s_endpgm
L_k1_done:
    s_endpgm
.globl k2_kernel
.p2align 8
.type k2_kernel,@function
k2_kernel:
    s_cmp_ge_u32 s2, 252
    s_cbranch_scc1 L_k2_done
    s_load_dwordx2 s[4:5], s[0:1], 88
    v_lshrrev_b32 v1, 6, v0
    v_and_b32 v13, 63, v0
    s_lshr_b32 s40, s2, 2
    v_readfirstlane_b32 s20, v1
    v_lshlrev_b32 v12, 4, v13
    s_and_b32 s42, s2, 1
    s_lshr_b32 s41, s2, 1
    s_and_b32 s41, s41, 1
    s_add_u32 s44, s20, s42
    s_cmp_ge_u32 s44, 3
    s_cselect_b32 s25, 1, 0
    s_cmp_eq_u32 s44, 4
    s_cselect_b32 s45, 1, 0
    s_mul_i32 s46, s42, 63
    s_lshl_b32 s47, s20, 4
    s_add_u32 s46, s46, s47
    s_sub_u32 s46, s46, s45
    s_mul_i32 s46, s46, 9216
    s_mul_i32 s47, s41, 1152000
    s_add_u32 s46, s46, s47
    s_mul_i32 s26, s20, 40960
    s_sub_u32 s44, 16, s25
    s_mul_i32 s10, s44, 9216
    s_mov_b32 s11, 0x20000
    s_mov_b32 s14, 1152000
    s_mov_b32 s15, 0x20000
    s_add_u32 s47, s47, 2359296
    s_add_u32 s28, s26, 0
    s_add_u32 s29, s26, 4096
    s_add_u32 s30, s26, 8192
    s_add_u32 s31, s26, 10240
    s_add_u32 s32, s26, 14336
    s_add_u32 s33, s26, 18432
    s_add_u32 s34, s26, 20480
    s_add_u32 s35, s26, 24576
    s_add_u32 s36, s26, 28672
    s_add_u32 s37, s26, 30720
    s_add_u32 s38, s26, 34816
    s_add_u32 s39, s26, 38912
    s_mul_i32 s44, s25, 10240
    s_add_u32 s44, s44, s26
    s_mov_b32 s22, 0
    s_mov_b32 s23, 4096
    s_mov_b32 s24, 8192
    s_mov_b32 s21, 4
    s_waitcnt lgkmcnt(0)
    s_add_u32 s8, s4, s46
    s_addc_u32 s9, s5, 0
    s_add_u32 s12, s4, s47
    s_addc_u32 s13, s5, 0
    s_add_u32 m0, s44, 0
    s_nop 0
    buffer_load_dwordx4 v12, s[8:11], s22 offen offset:0 lds
    buffer_load_dwordx4 v12, s[8:11], s22 offen offset:1024 lds
    buffer_load_dwordx4 v12, s[8:11], s22 offen offset:2048 lds
    buffer_load_dwordx4 v12, s[8:11], s22 offen offset:3072 lds
    s_add_u32 m0, s44, 4096
    s_nop 0
    buffer_load_dwordx4 v12, s[8:11], s23 offen offset:0 lds
    buffer_load_dwordx4 v12, s[8:11], s23 offen offset:1024 lds
    buffer_load_dwordx4 v12, s[8:11], s23 offen offset:2048 lds
    buffer_load_dwordx4 v12, s[8:11], s23 offen offset:3072 lds
    s_add_u32 m0, s44, 8192
    s_nop 0
    buffer_load_dwordx4 v12, s[8:11], s24 offen offset:0 lds
    s_add_u32 s22, s22, 9216
    s_add_u32 s23, s23, 9216
    s_add_u32 s24, s24, 9216
    s_add_u32 s44, s44, 10240
    s_mul_i32 s43, s40, 18432
    s_add_u32 s45, s20, 0
    s_lshl_b32 s46, s45, 10
    s_cmp_ge_u32 s45, 9
    s_cselect_b32 s47, 31744, 0
    s_add_u32 s47, s47, s46
    s_add_u32 m0, s47, 30720
    s_add_u32 s46, s46, s43
    buffer_load_dwordx4 v12, s[12:15], s46 offen lds
    s_add_u32 s45, s20, 4
    s_lshl_b32 s46, s45, 10
    s_cmp_ge_u32 s45, 9
    s_cselect_b32 s47, 31744, 0
    s_add_u32 s47, s47, s46
    s_add_u32 m0, s47, 30720
    s_add_u32 s46, s46, s43
    buffer_load_dwordx4 v12, s[12:15], s46 offen lds
    s_add_u32 s45, s20, 8
    s_lshl_b32 s46, s45, 10
    s_cmp_ge_u32 s45, 9
    s_cselect_b32 s47, 31744, 0
    s_add_u32 s47, s47, s46
    s_add_u32 m0, s47, 30720
    s_add_u32 s46, s46, s43
    buffer_load_dwordx4 v12, s[12:15], s46 offen lds
    s_add_u32 s45, s20, 12
    s_lshl_b32 s46, s45, 10
    s_cmp_ge_u32 s45, 9
    s_cselect_b32 s47, 31744, 0
    s_add_u32 s47, s47, s46
    s_add_u32 m0, s47, 30720
    s_add_u32 s46, s46, s43
    buffer_load_dwordx4 v12, s[12:15], s46 offen lds
    s_add_u32 s45, s20, 16
    s_min_u32 s45, s45, 17
    s_lshl_b32 s46, s45, 10
    s_cmp_ge_u32 s45, 9
    s_cselect_b32 s47, 31744, 0
    s_add_u32 s47, s47, s46
    s_add_u32 m0, s47, 30720
    s_add_u32 s46, s46, s43
    buffer_load_dwordx4 v12, s[12:15], s46 offen lds
    v_mov_b32 v180, 0
    v_mov_b32 v181, 0
    v_mov_b32 v182, 0
    v_mov_b32 v183, 0
    s_nop 1
    v_mfma_f32_32x32x16_bf16 a[0:15], v[180:183], v[180:183], 0
    v_mfma_f32_32x32x16_bf16 a[16:31], v[180:183], v[180:183], 0
    v_and_b32 v1, 31, v13
    v_lshrrev_b32 v2, 5, v13
    v_and_b32 v3, 3, v1
    v_lshlrev_b32 v3, 2, v3
    v_bfe_u32 v4, v1, 2, 2
    v_or_b32 v3, v3, v4
    v_xor_b32 v3, v3, v2
    v_lshlrev_b32 v3, 4, v3
    v_lshl_add_u32 v3, v1, 8, v3
    v_add_u32 v3, s26, v3
    v_xor_b32 v154, 0, v3
    v_xor_b32 v155, 32, v3
    v_xor_b32 v156, 64, v3
    v_xor_b32 v157, 96, v3
    v_xor_b32 v158, 128, v3
    v_xor_b32 v159, 160, v3
    v_xor_b32 v160, 192, v3
    v_xor_b32 v161, 224, v3
    v_bfe_u32 v4, v1, 3, 1
    v_xor_b32 v4, v4, v2
    v_lshlrev_b32 v4, 4, v4
    v_lshl_add_u32 v4, v1, 5, v4
    v_add_u32 v4, s26, v4
    v_add_u32 v162, 8192, v4
    v_mfma_f32_32x32x16_bf16 a[32:47], v[180:183], v[180:183], 0
    v_mfma_f32_32x32x16_bf16 a[48:63], v[180:183], v[180:183], 0
    v_bfe_u32 v4, v13, 2, 2
    v_bfe_u32 v5, v13, 4, 1
    v_bfe_u32 v6, v13, 1, 1
    v_and_b32 v7, 1, v13
    v_lshl_add_u32 v8, v2, 2, v4
    v_lshl_add_u32 v9, v5, 1, v6
    v_xor_b32 v9, v9, v2
    v_lshl_add_u32 v9, v4, 2, v9
    v_lshlrev_b32 v9, 4, v9
    v_lshl_add_u32 v9, v7, 3, v9
    v_lshl_add_u32 v9, v8, 8, v9
    v_add_u32 v9, s26, v9
    v_xor_b32 v163, 0, v9
    v_xor_b32 v164, 32, v9
    v_add_u32 v164, 2048, v164
    v_xor_b32 v165, 64, v9
    v_xor_b32 v166, 96, v9
    v_add_u32 v166, 2048, v166
    v_xor_b32 v167, 128, v9
    v_xor_b32 v168, 160, v9
    v_add_u32 v168, 2048, v168
    v_xor_b32 v169, 192, v9
    v_xor_b32 v170, 224, v9
    v_add_u32 v170, 2048, v170
    v_lshlrev_b32 v10, 4, v6
    v_lshl_add_u32 v10, v7, 3, v10
    v_lshl_add_u32 v10, v8, 5, v10
    v_lshlrev_b32 v11, 7, v5
    v_xor_b32 v10, v10, v11
    v_lshl_add_u32 v10, v5, 10, v10
    v_add_u32 v10, s26, v10
    v_add_u32 v171, 8192, v10
    v_xor_b32 v10, 16, v10
    v_add_u32 v172, 8448, v10
    v_mfma_f32_32x32x16_bf16 a[64:79], v[180:183], v[180:183], 0
    v_mfma_f32_32x32x16_bf16 a[80:95], v[180:183], v[180:183], 0
    v_mov_b32 v4, 0x3f803f80
    v_mov_b32 v5, 0x3f803f80
    v_mov_b32 v6, 0x3f803f80
    v_mov_b32 v7, 0x3f803f80
    v_add_u32 v14, s26, v12
    ds_write_b128 v14, v[4:7] offset:9216
    ds_write_b128 v14, v[4:7] offset:19456
    ds_write_b128 v14, v[4:7] offset:29696
    ds_write_b128 v14, v[4:7] offset:39936
    v_mfma_f32_32x32x16_bf16 a[96:111], v[180:183], v[180:183], 0
    v_mfma_f32_32x32x16_bf16 a[112:127], v[180:183], v[180:183], 0
    v_mfma_f32_32x32x16_bf16 a[128:143], v[180:183], v[180:183], 0
    v_mfma_f32_32x32x16_bf16 a[144:159], v[180:183], v[180:183], 0
    s_add_u32 m0, s44, 0
    s_nop 0
    buffer_load_dwordx4 v12, s[8:11], s22 offen offset:0 lds
    buffer_load_dwordx4 v12, s[8:11], s22 offen offset:1024 lds
    buffer_load_dwordx4 v12, s[8:11], s22 offen offset:2048 lds
    buffer_load_dwordx4 v12, s[8:11], s22 offen offset:3072 lds
    s_add_u32 m0, s44, 4096
    s_nop 0
    buffer_load_dwordx4 v12, s[8:11], s23 offen offset:0 lds
    buffer_load_dwordx4 v12, s[8:11], s23 offen offset:1024 lds
    buffer_load_dwordx4 v12, s[8:11], s23 offen offset:2048 lds
    buffer_load_dwordx4 v12, s[8:11], s23 offen offset:3072 lds
    s_add_u32 m0, s44, 8192
    s_nop 0
    buffer_load_dwordx4 v12, s[8:11], s24 offen offset:0 lds
    s_add_u32 s22, s22, 9216
    s_add_u32 s23, s23, 9216
    s_add_u32 s24, s24, 9216
    s_add_u32 s44, s44, 10240
    v_add_u32 v3, 40960, v12
    s_waitcnt vmcnt(9) lgkmcnt(0)
    s_barrier
    s_cmp_eq_u32 s25, 1
    s_cbranch_scc1 L_k2_pro1
L_k2_pro0:
    ds_read_b128 a[160:163], v12 offset:30720
    ds_read_b128 a[196:199], v3 offset:30720
    ds_read_b128 v[180:183], v154 offset:0
    ds_read_b128 a[164:167], v12 offset:31744
    ds_read_b128 a[200:203], v3 offset:31744
    ds_read_b128 v[184:187], v155 offset:0
    ds_read_b128 a[168:171], v12 offset:32768
    ds_read_b128 a[204:207], v3 offset:32768
    ds_read_b128 v[188:191], v156 offset:0
    s_waitcnt lgkmcnt(6)
    v_mfma_f32_32x32x16_bf16 v[16:31], v[180:183], a[160:163], 0
    v_mfma_f32_32x32x16_bf16 v[32:47], v[180:183], a[196:199], 0
    ds_read_b128 a[172:175], v12 offset:33792
    ds_read_b128 a[208:211], v3 offset:33792
    ds_read_b128 v[192:195], v157 offset:0
    s_add_u32 m0, s44, 0
    s_nop 0
    buffer_load_dwordx4 v12, s[8:11], s22 offen offset:0 lds
    s_waitcnt lgkmcnt(6)
    v_mfma_f32_32x32x16_bf16 v[16:31], v[184:187], a[164:167], v[16:31]
    v_mfma_f32_32x32x16_bf16 v[32:47], v[184:187], a[200:203], v[32:47]
    ds_read_b128 a[176:179], v12 offset:34816
    ds_read_b128 a[212:215], v3 offset:34816
    ds_read_b128 v[196:199], v158 offset:0
    buffer_load_dwordx4 v12, s[8:11], s22 offen offset:1024 lds
    s_waitcnt lgkmcnt(6)
    v_mfma_f32_32x32x16_bf16 v[16:31], v[188:191], a[168:171], v[16:31]
    v_mfma_f32_32x32x16_bf16 v[32:47], v[188:191], a[204:207], v[32:47]
    ds_read_b128 a[180:183], v12 offset:35840
    ds_read_b128 a[216:219], v3 offset:35840
    ds_read_b128 v[200:203], v159 offset:0
    buffer_load_dwordx4 v12, s[8:11], s22 offen offset:2048 lds
    s_waitcnt lgkmcnt(6)
    v_mfma_f32_32x32x16_bf16 v[16:31], v[192:195], a[172:175], v[16:31]
    v_mfma_f32_32x32x16_bf16 v[32:47], v[192:195], a[208:211], v[32:47]
    ds_read_b128 a[184:187], v12 offset:36864
    ds_read_b128 a[220:223], v3 offset:36864
    ds_read_b128 v[204:207], v160 offset:0
    buffer_load_dwordx4 v12, s[8:11], s22 offen offset:3072 lds
    s_waitcnt lgkmcnt(6)
    v_mfma_f32_32x32x16_bf16 v[16:31], v[196:199], a[176:179], v[16:31]
    v_mfma_f32_32x32x16_bf16 v[32:47], v[196:199], a[212:215], v[32:47]
    ds_read_b128 a[188:191], v12 offset:37888
    ds_read_b128 a[224:227], v3 offset:37888
    ds_read_b128 v[208:211], v161 offset:0
    s_add_u32 m0, s44, 4096
    s_nop 0
    buffer_load_dwordx4 v12, s[8:11], s23 offen offset:0 lds
    s_waitcnt lgkmcnt(6)
    v_mfma_f32_32x32x16_bf16 v[16:31], v[200:203], a[180:183], v[16:31]
    v_mfma_f32_32x32x16_bf16 v[32:47], v[200:203], a[216:219], v[32:47]
    ds_read_b128 a[192:195], v12 offset:38912
    ds_read_b128 a[228:231], v3 offset:38912
    ds_read_b128 v[212:215], v162 offset:0
    buffer_load_dwordx4 v12, s[8:11], s23 offen offset:1024 lds
    s_waitcnt lgkmcnt(6)
    v_mfma_f32_32x32x16_bf16 v[16:31], v[204:207], a[184:187], v[16:31]
    v_mfma_f32_32x32x16_bf16 v[32:47], v[204:207], a[220:223], v[32:47]
    buffer_load_dwordx4 v12, s[8:11], s23 offen offset:2048 lds
    s_waitcnt lgkmcnt(3)
    v_mfma_f32_32x32x16_bf16 v[16:31], v[208:211], a[188:191], v[16:31]
    v_mfma_f32_32x32x16_bf16 v[32:47], v[208:211], a[224:227], v[32:47]
    buffer_load_dwordx4 v12, s[8:11], s23 offen offset:3072 lds
    s_waitcnt lgkmcnt(0)
    v_mfma_f32_32x32x16_bf16 v[16:31], v[212:215], a[192:195], v[16:31]
    v_mfma_f32_32x32x16_bf16 v[32:47], v[212:215], a[228:231], v[32:47]
    s_add_u32 m0, s44, 8192
    s_nop 0
    buffer_load_dwordx4 v12, s[8:11], s24 offen offset:0 lds
    s_add_u32 s22, s22, 9216
    s_add_u32 s23, s23, 9216
    s_add_u32 s24, s24, 9216
    s_barrier
    s_nop 15
    v_max3_f32 v4, v16, v17, v18
    v_max3_f32 v4, v4, v19, v20
    v_max3_f32 v4, v4, v21, v22
    v_max3_f32 v4, v4, v23, v24
    v_max3_f32 v4, v4, v25, v26
    v_max3_f32 v4, v4, v27, v28
    v_max3_f32 v4, v4, v29, v30
    v_max_f32 v4, v4, v31
    v_mov_b32 v5, v4
    s_nop 1
    v_permlane32_swap_b32 v4, v5
    s_nop 1
    v_max_f32 v4, v4, v5
    v_max3_f32 v6, v32, v33, v34
    v_max3_f32 v6, v6, v35, v36
    v_max3_f32 v6, v6, v37, v38
    v_max3_f32 v6, v6, v39, v40
    v_max3_f32 v6, v6, v41, v42
    v_max3_f32 v6, v6, v43, v44
    v_max3_f32 v6, v6, v45, v46
    v_max_f32 v6, v6, v47
    v_mov_b32 v7, v6
    s_nop 1
    v_permlane32_swap_b32 v6, v7
    s_nop 1
    v_max_f32 v6, v6, v7
    v_sub_f32 v80, 0xc2200000, v4
    v_sub_f32 v96, 0xc2200000, v6
    v_add_f32 v16, v16, v80
    v_add_f32 v32, v32, v96
    v_add_f32 v17, v17, v80
    v_add_f32 v33, v33, v96
    v_add_f32 v18, v18, v80
    v_add_f32 v34, v34, v96
    v_add_f32 v19, v19, v80
    v_add_f32 v35, v35, v96
    v_add_f32 v20, v20, v80
    v_add_f32 v36, v36, v96
    v_add_f32 v21, v21, v80
    v_add_f32 v37, v37, v96
    v_add_f32 v22, v22, v80
    v_add_f32 v38, v38, v96
    v_add_f32 v23, v23, v80
    v_add_f32 v39, v39, v96
    v_add_f32 v24, v24, v80
    v_add_f32 v40, v40, v96
    v_add_f32 v25, v25, v80
    v_add_f32 v41, v41, v96
    v_add_f32 v26, v26, v80
    v_add_f32 v42, v42, v96
    v_add_f32 v27, v27, v80
    v_add_f32 v43, v43, v96
    v_add_f32 v28, v28, v80
    v_add_f32 v44, v44, v96
    v_add_f32 v29, v29, v80
    v_add_f32 v45, v45, v96
    v_add_f32 v30, v30, v80
    v_add_f32 v46, v46, v96
    v_add_f32 v31, v31, v80
    v_add_f32 v47, v47, v96
    s_waitcnt vmcnt(9)
    ds_read_b128 v[180:183], v154 offset:10240
    ds_read_b128 v[184:187], v155 offset:10240
    ds_read_b128 v[188:191], v156 offset:10240
    ds_read_b128 v[192:195], v157 offset:10240
    ds_read_b128 v[196:199], v158 offset:10240
    ds_read_b128 v[200:203], v159 offset:10240
    v_exp_f32 v144, v16
    v_exp_f32 v145, v17
    s_nop 0
    v_cvt_pk_bf16_f32 v112, v144, v145
    v_exp_f32 v146, v32
    v_exp_f32 v147, v33
    s_nop 0
    v_cvt_pk_bf16_f32 v120, v146, v147
    v_or_b32 v152, v112, v120
    v_exp_f32 v148, v18
    v_exp_f32 v149, v19
    s_nop 0
    v_cvt_pk_bf16_f32 v113, v148, v149
    v_exp_f32 v150, v34
    v_exp_f32 v151, v35
    s_nop 0
    v_cvt_pk_bf16_f32 v121, v150, v151
    v_or3_b32 v152, v113, v121, v152
    v_exp_f32 v144, v20
    v_exp_f32 v145, v21
    s_nop 0
    v_cvt_pk_bf16_f32 v114, v144, v145
    v_exp_f32 v146, v36
    v_exp_f32 v147, v37
    s_nop 0
    v_cvt_pk_bf16_f32 v122, v146, v147
    v_or3_b32 v152, v114, v122, v152
    v_exp_f32 v148, v22
    v_exp_f32 v149, v23
    s_nop 0
    v_cvt_pk_bf16_f32 v115, v148, v149
    v_exp_f32 v150, v38
    v_exp_f32 v151, v39
    s_nop 0
    v_cvt_pk_bf16_f32 v123, v150, v151
    v_or3_b32 v152, v115, v123, v152
    v_exp_f32 v144, v24
    v_mov_b32 v81, v80
    v_mov_b32 v97, v96
    v_mov_b32 v82, v80
    v_mov_b32 v98, v96
    v_mov_b32 v83, v80
    v_mov_b32 v99, v96
    v_mov_b32 v84, v80
    v_mov_b32 v100, v96
    v_mov_b32 v85, v80
    v_mov_b32 v101, v96
    v_mov_b32 v86, v80
    v_mov_b32 v102, v96
    v_mov_b32 v87, v80
    v_mov_b32 v103, v96
    v_mov_b32 v88, v80
    v_mov_b32 v104, v96
    v_mov_b32 v89, v80
    v_mov_b32 v105, v96
    v_mov_b32 v90, v80
    v_mov_b32 v106, v96
    v_mov_b32 v91, v80
    v_mov_b32 v107, v96
    v_mov_b32 v92, v80
    v_mov_b32 v108, v96
    v_mov_b32 v93, v80
    v_mov_b32 v109, v96
    v_mov_b32 v94, v80
    v_mov_b32 v110, v96
    v_mov_b32 v95, v80
    v_mov_b32 v111, v96
    s_nop 1
    s_branch L_k2_body0
L_k2_pro1:
    ds_read_b128 a[160:163], v12 offset:30720
    ds_read_b128 a[196:199], v3 offset:30720
    ds_read_b128 v[180:183], v154 offset:10240
    ds_read_b128 a[164:167], v12 offset:31744
    ds_read_b128 a[200:203], v3 offset:31744
    ds_read_b128 v[184:187], v155 offset:10240
    ds_read_b128 a[168:171], v12 offset:32768
    ds_read_b128 a[204:207], v3 offset:32768
    ds_read_b128 v[188:191], v156 offset:10240
    s_waitcnt lgkmcnt(6)
    v_mfma_f32_32x32x16_bf16 v[48:63], v[180:183], a[160:163], 0
    v_mfma_f32_32x32x16_bf16 v[64:79], v[180:183], a[196:199], 0
    ds_read_b128 a[172:175], v12 offset:33792
    ds_read_b128 a[208:211], v3 offset:33792
    ds_read_b128 v[192:195], v157 offset:10240
    s_add_u32 m0, s44, 0
    s_nop 0
    buffer_load_dwordx4 v12, s[8:11], s22 offen offset:0 lds
    s_waitcnt lgkmcnt(6)
    v_mfma_f32_32x32x16_bf16 v[48:63], v[184:187], a[164:167], v[48:63]
    v_mfma_f32_32x32x16_bf16 v[64:79], v[184:187], a[200:203], v[64:79]
    ds_read_b128 a[176:179], v12 offset:34816
    ds_read_b128 a[212:215], v3 offset:34816
    ds_read_b128 v[196:199], v158 offset:10240
    buffer_load_dwordx4 v12, s[8:11], s22 offen offset:1024 lds
    s_waitcnt lgkmcnt(6)
    v_mfma_f32_32x32x16_bf16 v[48:63], v[188:191], a[168:171], v[48:63]
    v_mfma_f32_32x32x16_bf16 v[64:79], v[188:191], a[204:207], v[64:79]
    ds_read_b128 a[180:183], v12 offset:35840
    ds_read_b128 a[216:219], v3 offset:35840
    ds_read_b128 v[200:203], v159 offset:10240
    buffer_load_dwordx4 v12, s[8:11], s22 offen offset:2048 lds
    s_waitcnt lgkmcnt(6)
    v_mfma_f32_32x32x16_bf16 v[48:63], v[192:195], a[172:175], v[48:63]
    v_mfma_f32_32x32x16_bf16 v[64:79], v[192:195], a[208:211], v[64:79]
    ds_read_b128 a[184:187], v12 offset:36864
    ds_read_b128 a[220:223], v3 offset:36864
    ds_read_b128 v[204:207], v160 offset:10240
    buffer_load_dwordx4 v12, s[8:11], s22 offen offset:3072 lds
    s_waitcnt lgkmcnt(6)
    v_mfma_f32_32x32x16_bf16 v[48:63], v[196:199], a[176:179], v[48:63]
    v_mfma_f32_32x32x16_bf16 v[64:79], v[196:199], a[212:215], v[64:79]
    ds_read_b128 a[188:191], v12 offset:37888
    ds_read_b128 a[224:227], v3 offset:37888
    ds_read_b128 v[208:211], v161 offset:10240
    s_add_u32 m0, s44, 4096
    s_nop 0
    buffer_load_dwordx4 v12, s[8:11], s23 offen offset:0 lds
    s_waitcnt lgkmcnt(6)
    v_mfma_f32_32x32x16_bf16 v[48:63], v[200:203], a[180:183], v[48:63]
    v_mfma_f32_32x32x16_bf16 v[64:79], v[200:203], a[216:219], v[64:79]
    ds_read_b128 a[192:195], v12 offset:38912
    ds_read_b128 a[228:231], v3 offset:38912
    ds_read_b128 v[212:215], v162 offset:10240
    buffer_load_dwordx4 v12, s[8:11], s23 offen offset:1024 lds
    s_waitcnt lgkmcnt(6)
    v_mfma_f32_32x32x16_bf16 v[48:63], v[204:207], a[184:187], v[48:63]
    v_mfma_f32_32x32x16_bf16 v[64:79], v[204:207], a[220:223], v[64:79]
    buffer_load_dwordx4 v12, s[8:11], s23 offen offset:2048 lds
    s_waitcnt lgkmcnt(3)
    v_mfma_f32_32x32x16_bf16 v[48:63], v[208:211], a[188:191], v[48:63]
    v_mfma_f32_32x32x16_bf16 v[64:79], v[208:211], a[224:227], v[64:79]
    buffer_load_dwordx4 v12, s[8:11], s23 offen offset:3072 lds
    s_waitcnt lgkmcnt(0)
    v_mfma_f32_32x32x16_bf16 v[48:63], v[212:215], a[192:195], v[48:63]
    v_mfma_f32_32x32x16_bf16 v[64:79], v[212:215], a[228:231], v[64:79]
    s_add_u32 m0, s44, 8192
    s_nop 0
    buffer_load_dwordx4 v12, s[8:11], s24 offen offset:0 lds
    s_add_u32 s22, s22, 9216
    s_add_u32 s23, s23, 9216
    s_add_u32 s24, s24, 9216
    s_barrier
    s_nop 15
    v_max3_f32 v4, v48, v49, v50
    v_max3_f32 v4, v4, v51, v52
    v_max3_f32 v4, v4, v53, v54
    v_max3_f32 v4, v4, v55, v56
    v_max3_f32 v4, v4, v57, v58
    v_max3_f32 v4, v4, v59, v60
    v_max3_f32 v4, v4, v61, v62
    v_max_f32 v4, v4, v63
    v_mov_b32 v5, v4
    s_nop 1
    v_permlane32_swap_b32 v4, v5
    s_nop 1
    v_max_f32 v4, v4, v5
    v_max3_f32 v6, v64, v65, v66
    v_max3_f32 v6, v6, v67, v68
    v_max3_f32 v6, v6, v69, v70
    v_max3_f32 v6, v6, v71, v72
    v_max3_f32 v6, v6, v73, v74
    v_max3_f32 v6, v6, v75, v76
    v_max3_f32 v6, v6, v77, v78
    v_max_f32 v6, v6, v79
    v_mov_b32 v7, v6
    s_nop 1
    v_permlane32_swap_b32 v6, v7
    s_nop 1
    v_max_f32 v6, v6, v7
    v_sub_f32 v80, 0xc2200000, v4
    v_sub_f32 v96, 0xc2200000, v6
    v_add_f32 v48, v48, v80
    v_add_f32 v64, v64, v96
    v_add_f32 v49, v49, v80
    v_add_f32 v65, v65, v96
    v_add_f32 v50, v50, v80
    v_add_f32 v66, v66, v96
    v_add_f32 v51, v51, v80
    v_add_f32 v67, v67, v96
    v_add_f32 v52, v52, v80
    v_add_f32 v68, v68, v96
    v_add_f32 v53, v53, v80
    v_add_f32 v69, v69, v96
    v_add_f32 v54, v54, v80
    v_add_f32 v70, v70, v96
    v_add_f32 v55, v55, v80
    v_add_f32 v71, v71, v96
    v_add_f32 v56, v56, v80
    v_add_f32 v72, v72, v96
    v_add_f32 v57, v57, v80
    v_add_f32 v73, v73, v96
    v_add_f32 v58, v58, v80
    v_add_f32 v74, v74, v96
    v_add_f32 v59, v59, v80
    v_add_f32 v75, v75, v96
    v_add_f32 v60, v60, v80
    v_add_f32 v76, v76, v96
    v_add_f32 v61, v61, v80
    v_add_f32 v77, v77, v96
    v_add_f32 v62, v62, v80
    v_add_f32 v78, v78, v96
    v_add_f32 v63, v63, v80
    v_add_f32 v79, v79, v96
    s_waitcnt vmcnt(9)
    ds_read_b128 v[180:183], v154 offset:20480
    ds_read_b128 v[184:187], v155 offset:20480
    ds_read_b128 v[188:191], v156 offset:20480
    ds_read_b128 v[192:195], v157 offset:20480
    ds_read_b128 v[196:199], v158 offset:20480
    ds_read_b128 v[200:203], v159 offset:20480
    v_exp_f32 v144, v48
    v_exp_f32 v145, v49
    s_nop 0
    v_cvt_pk_bf16_f32 v128, v144, v145
    v_exp_f32 v146, v64
    v_exp_f32 v147, v65
    s_nop 0
    v_cvt_pk_bf16_f32 v136, v146, v147
    v_or_b32 v152, v128, v136
    v_exp_f32 v148, v50
    v_exp_f32 v149, v51
    s_nop 0
    v_cvt_pk_bf16_f32 v129, v148, v149
    v_exp_f32 v150, v66
    v_exp_f32 v151, v67
    s_nop 0
    v_cvt_pk_bf16_f32 v137, v150, v151
    v_or3_b32 v152, v129, v137, v152
    v_exp_f32 v144, v52
    v_exp_f32 v145, v53
    s_nop 0
    v_cvt_pk_bf16_f32 v130, v144, v145
    v_exp_f32 v146, v68
    v_exp_f32 v147, v69
    s_nop 0
    v_cvt_pk_bf16_f32 v138, v146, v147
    v_or3_b32 v152, v130, v138, v152
    v_exp_f32 v148, v54
    v_exp_f32 v149, v55
    s_nop 0
    v_cvt_pk_bf16_f32 v131, v148, v149
    v_exp_f32 v150, v70
    v_exp_f32 v151, v71
    s_nop 0
    v_cvt_pk_bf16_f32 v139, v150, v151
    v_or3_b32 v152, v131, v139, v152
    v_exp_f32 v144, v56
    v_mov_b32 v81, v80
    v_mov_b32 v97, v96
    v_mov_b32 v82, v80
    v_mov_b32 v98, v96
    v_mov_b32 v83, v80
    v_mov_b32 v99, v96
    v_mov_b32 v84, v80
    v_mov_b32 v100, v96
    v_mov_b32 v85, v80
    v_mov_b32 v101, v96
    v_mov_b32 v86, v80
    v_mov_b32 v102, v96
    v_mov_b32 v87, v80
    v_mov_b32 v103, v96
    v_mov_b32 v88, v80
    v_mov_b32 v104, v96
    v_mov_b32 v89, v80
    v_mov_b32 v105, v96
    v_mov_b32 v90, v80
    v_mov_b32 v106, v96
    v_mov_b32 v91, v80
    v_mov_b32 v107, v96
    v_mov_b32 v92, v80
    v_mov_b32 v108, v96
    v_mov_b32 v93, v80
    v_mov_b32 v109, v96
    v_mov_b32 v94, v80
    v_mov_b32 v110, v96
    v_mov_b32 v95, v80
    v_mov_b32 v111, v96
    s_nop 1
    s_branch L_k2_body1
.p2align 6
L_k2_body0:
    s_waitcnt lgkmcnt(4)
    v_mfma_f32_32x32x16_bf16 v[48:63], v[180:183], a[160:163], v[80:95]
    s_mov_b32 m0, s37
    ds_read_b128 v[204:207], v160 offset:10240
    v_exp_f32 v145, v25
    v_mfma_f32_32x32x16_bf16 v[64:79], v[180:183], a[196:199], v[96:111]
    buffer_load_dwordx4 v12, s[8:11], s22 offen offset:0 lds
    v_cvt_pk_bf16_f32 v116, v144, v145
    v_exp_f32 v146, v40
    v_mfma_f32_32x32x16_bf16 v[48:63], v[184:187], a[164:167], v[48:63]
    ds_read_b128 v[208:211], v161 offset:10240
    v_exp_f32 v147, v41
    v_mfma_f32_32x32x16_bf16 v[64:79], v[184:187], a[200:203], v[64:79]
    v_cvt_pk_bf16_f32 v124, v146, v147
    v_or3_b32 v152, v116, v124, v152
    v_exp_f32 v148, v26
    s_waitcnt lgkmcnt(4)
    v_mfma_f32_32x32x16_bf16 v[48:63], v[188:191], a[168:171], v[48:63]
    ds_read_b128 v[212:215], v162 offset:10240
    v_exp_f32 v149, v27
    v_mfma_f32_32x32x16_bf16 v[64:79], v[188:191], a[204:207], v[64:79]
    buffer_load_dwordx4 v12, s[8:11], s22 offen offset:1024 lds
    v_cvt_pk_bf16_f32 v117, v148, v149
    v_exp_f32 v150, v42
    v_mfma_f32_32x32x16_bf16 v[48:63], v[192:195], a[172:175], v[48:63]
    ds_read_b64_tr_b16 v[216:217], v163 offset:0
    ds_read_b64_tr_b16 v[218:219], v164 offset:0
    v_exp_f32 v151, v43
    v_mfma_f32_32x32x16_bf16 v[64:79], v[192:195], a[208:211], v[64:79]
    v_cvt_pk_bf16_f32 v125, v150, v151
    v_or3_b32 v152, v117, v125, v152
    v_exp_f32 v144, v28
    s_waitcnt lgkmcnt(5)
    v_mfma_f32_32x32x16_bf16 v[48:63], v[196:199], a[176:179], v[48:63]
    ds_read_b64_tr_b16 v[220:221], v165 offset:0
    ds_read_b64_tr_b16 v[222:223], v166 offset:0
    v_exp_f32 v145, v29
    v_mfma_f32_32x32x16_bf16 v[64:79], v[196:199], a[212:215], v[64:79]
    buffer_load_dwordx4 v12, s[8:11], s22 offen offset:2048 lds
    v_cvt_pk_bf16_f32 v118, v144, v145
    v_exp_f32 v146, v44
    v_mfma_f32_32x32x16_bf16 v[48:63], v[200:203], a[180:183], v[48:63]
    ds_read_b64_tr_b16 v[224:225], v167 offset:0
    ds_read_b64_tr_b16 v[226:227], v168 offset:0
    v_exp_f32 v147, v45
    v_mfma_f32_32x32x16_bf16 v[64:79], v[200:203], a[216:219], v[64:79]
    v_cvt_pk_bf16_f32 v126, v146, v147
    v_or3_b32 v152, v118, v126, v152
    v_exp_f32 v148, v30
    s_waitcnt lgkmcnt(7)
    v_mfma_f32_32x32x16_bf16 v[48:63], v[204:207], a[184:187], v[48:63]
    ds_read_b64_tr_b16 v[228:229], v169 offset:0
    ds_read_b64_tr_b16 v[230:231], v170 offset:0
    v_exp_f32 v149, v31
    v_mfma_f32_32x32x16_bf16 v[64:79], v[204:207], a[220:223], v[64:79]
    buffer_load_dwordx4 v12, s[8:11], s22 offen offset:3072 lds
    v_cvt_pk_bf16_f32 v119, v148, v149
    v_exp_f32 v150, v46
    v_mfma_f32_32x32x16_bf16 v[48:63], v[208:211], a[188:191], v[48:63]
    ds_read_b64_tr_b16 v[232:233], v171 offset:0
    ds_read_b64_tr_b16 v[234:235], v172 offset:0
    v_exp_f32 v151, v47
    v_mfma_f32_32x32x16_bf16 v[64:79], v[208:211], a[224:227], v[64:79]
    v_cvt_pk_bf16_f32 v127, v150, v151
    v_or3_b32 v152, v119, v127, v152
    s_waitcnt lgkmcnt(8)
    v_mfma_f32_32x32x16_bf16 v[48:63], v[212:215], a[192:195], v[48:63]
    s_mov_b32 m0, s38
    ds_read_b64_tr_b16 v[236:237], v163 offset:4096
    ds_read_b64_tr_b16 v[238:239], v164 offset:4096
    v_mfma_f32_32x32x16_bf16 v[64:79], v[212:215], a[228:231], v[64:79]
    buffer_load_dwordx4 v12, s[8:11], s23 offen offset:0 lds
    v_lshl_or_b32 v153, v152, 16, v152
    v_cmp_le_u32 vcc, 0x40000000, v153
    s_cbranch_vccnz L_k2_rare0
L_k2_ret0:
    v_mfma_f32_32x32x16_bf16 a[0:15], v[216:219], v[112:115], a[0:15]
    ds_read_b64_tr_b16 v[240:241], v165 offset:4096
    ds_read_b64_tr_b16 v[242:243], v166 offset:4096
    v_mfma_f32_32x32x16_bf16 a[80:95], v[216:219], v[120:123], a[80:95]
    s_waitcnt lgkmcnt(8)
    v_mfma_f32_32x32x16_bf16 a[16:31], v[220:223], v[112:115], a[16:31]
    ds_read_b64_tr_b16 v[244:245], v167 offset:4096
    ds_read_b64_tr_b16 v[246:247], v168 offset:4096
    v_exp_f32 v144, v48
    v_mfma_f32_32x32x16_bf16 a[96:111], v[220:223], v[120:123], a[96:111]
    buffer_load_dwordx4 v12, s[8:11], s23 offen offset:1024 lds
    v_exp_f32 v145, v49
    v_mfma_f32_32x32x16_bf16 a[32:47], v[224:227], v[112:115], a[32:47]
    v_cvt_pk_bf16_f32 v128, v144, v145
    s_waitcnt vmcnt(6)
    ds_read_b64_tr_b16 v[248:249], v169 offset:4096
    v_exp_f32 v146, v64
    v_mfma_f32_32x32x16_bf16 a[112:127], v[224:227], v[120:123], a[112:127]
    ds_read_b64_tr_b16 v[250:251], v170 offset:4096
    v_exp_f32 v147, v65
    s_waitcnt lgkmcnt(8)
    v_mfma_f32_32x32x16_bf16 a[48:63], v[228:231], v[112:115], a[48:63]
    v_cvt_pk_bf16_f32 v136, v146, v147
    v_or_b32 v152, v128, v136
    ds_read_b64_tr_b16 v[252:253], v171 offset:512
    v_exp_f32 v148, v50
    v_mfma_f32_32x32x16_bf16 a[128:143], v[228:231], v[120:123], a[128:143]
    buffer_load_dwordx4 v12, s[8:11], s23 offen offset:2048 lds
    ds_read_b64_tr_b16 v[254:255], v172 offset:512
    v_exp_f32 v149, v51
    v_mfma_f32_32x32x16_bf16 a[64:79], v[232:235], v[112:115], a[64:79]
    v_cvt_pk_bf16_f32 v129, v148, v149
    ds_read_b128 v[180:183], v154 offset:20480
    v_exp_f32 v150, v66
    v_mfma_f32_32x32x16_bf16 a[144:159], v[232:235], v[120:123], a[144:159]
    v_exp_f32 v151, v67
    s_waitcnt lgkmcnt(7)
    v_mfma_f32_32x32x16_bf16 a[0:15], v[236:239], v[116:119], a[0:15]
    v_cvt_pk_bf16_f32 v137, v150, v151
    v_or3_b32 v152, v129, v137, v152
    ds_read_b128 v[184:187], v155 offset:20480
    v_exp_f32 v144, v52
    v_mfma_f32_32x32x16_bf16 a[80:95], v[236:239], v[124:127], a[80:95]
    buffer_load_dwordx4 v12, s[8:11], s23 offen offset:3072 lds
    v_exp_f32 v145, v53
    v_mfma_f32_32x32x16_bf16 a[16:31], v[240:243], v[116:119], a[16:31]
    v_cvt_pk_bf16_f32 v130, v144, v145
    ds_read_b128 v[188:191], v156 offset:20480
    v_exp_f32 v146, v68
    v_mfma_f32_32x32x16_bf16 a[96:111], v[240:243], v[124:127], a[96:111]
    v_exp_f32 v147, v69
    s_waitcnt lgkmcnt(5)
    v_mfma_f32_32x32x16_bf16 a[32:47], v[244:247], v[116:119], a[32:47]
    s_mov_b32 m0, s39
    v_cvt_pk_bf16_f32 v138, v146, v147
    v_or3_b32 v152, v130, v138, v152
    v_exp_f32 v148, v54
    v_mfma_f32_32x32x16_bf16 a[112:127], v[244:247], v[124:127], a[112:127]
    buffer_load_dwordx4 v12, s[8:11], s24 offen offset:0 lds
    ds_read_b128 v[192:195], v157 offset:20480
    v_exp_f32 v149, v55
    v_mfma_f32_32x32x16_bf16 a[48:63], v[248:251], v[116:119], a[48:63]
    s_add_u32 s22, s22, 9216
    s_add_u32 s23, s23, 9216
    v_cvt_pk_bf16_f32 v131, v148, v149
    v_exp_f32 v150, v70
    v_mfma_f32_32x32x16_bf16 a[128:143], v[248:251], v[124:127], a[128:143]
    s_add_u32 s24, s24, 9216
    ds_read_b128 v[196:199], v158 offset:20480
    v_exp_f32 v151, v71
    s_waitcnt lgkmcnt(5)
    v_mfma_f32_32x32x16_bf16 a[64:79], v[252:255], v[116:119], a[64:79]
    v_cvt_pk_bf16_f32 v139, v150, v151
    v_or3_b32 v152, v131, v139, v152
    ds_read_b128 v[200:203], v159 offset:20480
    v_mfma_f32_32x32x16_bf16 a[144:159], v[252:255], v[124:127], a[144:159]
    v_exp_f32 v144, v56
L_k2_body1:
    s_waitcnt lgkmcnt(4)
    v_mfma_f32_32x32x16_bf16 v[16:31], v[180:183], a[160:163], v[80:95]
    s_mov_b32 m0, s28
    ds_read_b128 v[204:207], v160 offset:20480
    v_exp_f32 v145, v57
    v_mfma_f32_32x32x16_bf16 v[32:47], v[180:183], a[196:199], v[96:111]
    buffer_load_dwordx4 v12, s[8:11], s22 offen offset:0 lds
    v_cvt_pk_bf16_f32 v132, v144, v145
    v_exp_f32 v146, v72
    v_mfma_f32_32x32x16_bf16 v[16:31], v[184:187], a[164:167], v[16:31]
    ds_read_b128 v[208:211], v161 offset:20480
    v_exp_f32 v147, v73
    v_mfma_f32_32x32x16_bf16 v[32:47], v[184:187], a[200:203], v[32:47]
    v_cvt_pk_bf16_f32 v140, v146, v147
    v_or3_b32 v152, v132, v140, v152
    v_exp_f32 v148, v58
    s_waitcnt lgkmcnt(4)
    v_mfma_f32_32x32x16_bf16 v[16:31], v[188:191], a[168:171], v[16:31]
    ds_read_b128 v[212:215], v162 offset:20480
    v_exp_f32 v149, v59
    v_mfma_f32_32x32x16_bf16 v[32:47], v[188:191], a[204:207], v[32:47]
    buffer_load_dwordx4 v12, s[8:11], s22 offen offset:1024 lds
    v_cvt_pk_bf16_f32 v133, v148, v149
    v_exp_f32 v150, v74
    v_mfma_f32_32x32x16_bf16 v[16:31], v[192:195], a[172:175], v[16:31]
    ds_read_b64_tr_b16 v[216:217], v163 offset:10240
    ds_read_b64_tr_b16 v[218:219], v164 offset:10240
    v_exp_f32 v151, v75
    v_mfma_f32_32x32x16_bf16 v[32:47], v[192:195], a[208:211], v[32:47]
    v_cvt_pk_bf16_f32 v141, v150, v151
    v_or3_b32 v152, v133, v141, v152
    v_exp_f32 v144, v60
    s_waitcnt lgkmcnt(5)
    v_mfma_f32_32x32x16_bf16 v[16:31], v[196:199], a[176:179], v[16:31]
    ds_read_b64_tr_b16 v[220:221], v165 offset:10240
    ds_read_b64_tr_b16 v[222:223], v166 offset:10240
    v_exp_f32 v145, v61
    v_mfma_f32_32x32x16_bf16 v[32:47], v[196:199], a[212:215], v[32:47]
    buffer_load_dwordx4 v12, s[8:11], s22 offen offset:2048 lds
    v_cvt_pk_bf16_f32 v134, v144, v145
    v_exp_f32 v146, v76
    v_mfma_f32_32x32x16_bf16 v[16:31], v[200:203], a[180:183], v[16:31]
    ds_read_b64_tr_b16 v[224:225], v167 offset:10240
    ds_read_b64_tr_b16 v[226:227], v168 offset:10240
    v_exp_f32 v147, v77
    v_mfma_f32_32x32x16_bf16 v[32:47], v[200:203], a[216:219], v[32:47]
    v_cvt_pk_bf16_f32 v142, v146, v147
    v_or3_b32 v152, v134, v142, v152
    v_exp_f32 v148, v62
    s_waitcnt lgkmcnt(7)
    v_mfma_f32_32x32x16_bf16 v[16:31], v[204:207], a[184:187], v[16:31]
    ds_read_b64_tr_b16 v[228:229], v169 offset:10240
    ds_read_b64_tr_b16 v[230:231], v170 offset:10240
    v_exp_f32 v149, v63
    v_mfma_f32_32x32x16_bf16 v[32:47], v[204:207], a[220:223], v[32:47]
    buffer_load_dwordx4 v12, s[8:11], s22 offen offset:3072 lds
    v_cvt_pk_bf16_f32 v135, v148, v149
    v_exp_f32 v150, v78
    v_mfma_f32_32x32x16_bf16 v[16:31], v[208:211], a[188:191], v[16:31]
    ds_read_b64_tr_b16 v[232:233], v171 offset:10240
    ds_read_b64_tr_b16 v[234:235], v172 offset:10240
    v_exp_f32 v151, v79
    v_mfma_f32_32x32x16_bf16 v[32:47], v[208:211], a[224:227], v[32:47]
    v_cvt_pk_bf16_f32 v143, v150, v151
    v_or3_b32 v152, v135, v143, v152
    s_waitcnt lgkmcnt(8)
    v_mfma_f32_32x32x16_bf16 v[16:31], v[212:215], a[192:195], v[16:31]
    s_mov_b32 m0, s29
    ds_read_b64_tr_b16 v[236:237], v163 offset:14336
    ds_read_b64_tr_b16 v[238:239], v164 offset:14336
    v_mfma_f32_32x32x16_bf16 v[32:47], v[212:215], a[228:231], v[32:47]
    buffer_load_dwordx4 v12, s[8:11], s23 offen offset:0 lds
    v_lshl_or_b32 v153, v152, 16, v152
    v_cmp_le_u32 vcc, 0x40000000, v153
    s_cbranch_vccnz L_k2_rare1
L_k2_ret1:
    v_mfma_f32_32x32x16_bf16 a[0:15], v[216:219], v[128:131], a[0:15]
    ds_read_b64_tr_b16 v[240:241], v165 offset:14336
    ds_read_b64_tr_b16 v[242:243], v166 offset:14336
    v_mfma_f32_32x32x16_bf16 a[80:95], v[216:219], v[136:139], a[80:95]
    s_waitcnt lgkmcnt(8)
    v_mfma_f32_32x32x16_bf16 a[16:31], v[220:223], v[128:131], a[16:31]
    ds_read_b64_tr_b16 v[244:245], v167 offset:14336
    ds_read_b64_tr_b16 v[246:247], v168 offset:14336
    v_exp_f32 v144, v16
    v_mfma_f32_32x32x16_bf16 a[96:111], v[220:223], v[136:139], a[96:111]
    buffer_load_dwordx4 v12, s[8:11], s23 offen offset:1024 lds
    v_exp_f32 v145, v17
    v_mfma_f32_32x32x16_bf16 a[32:47], v[224:227], v[128:131], a[32:47]
    v_cvt_pk_bf16_f32 v112, v144, v145
    s_waitcnt vmcnt(6)
    ds_read_b64_tr_b16 v[248:249], v169 offset:14336
    v_exp_f32 v146, v32
    v_mfma_f32_32x32x16_bf16 a[112:127], v[224:227], v[136:139], a[112:127]
    ds_read_b64_tr_b16 v[250:251], v170 offset:14336
    v_exp_f32 v147, v33
    s_waitcnt lgkmcnt(8)
    v_mfma_f32_32x32x16_bf16 a[48:63], v[228:231], v[128:131], a[48:63]
    v_cvt_pk_bf16_f32 v120, v146, v147
    v_or_b32 v152, v112, v120
    ds_read_b64_tr_b16 v[252:253], v171 offset:10752
    v_exp_f32 v148, v18
    v_mfma_f32_32x32x16_bf16 a[128:143], v[228:231], v[136:139], a[128:143]
    buffer_load_dwordx4 v12, s[8:11], s23 offen offset:2048 lds
    ds_read_b64_tr_b16 v[254:255], v172 offset:10752
    v_exp_f32 v149, v19
    v_mfma_f32_32x32x16_bf16 a[64:79], v[232:235], v[128:131], a[64:79]
    v_cvt_pk_bf16_f32 v113, v148, v149
    ds_read_b128 v[180:183], v154 offset:30720
    v_exp_f32 v150, v34
    v_mfma_f32_32x32x16_bf16 a[144:159], v[232:235], v[136:139], a[144:159]
    v_exp_f32 v151, v35
    s_waitcnt lgkmcnt(7)
    v_mfma_f32_32x32x16_bf16 a[0:15], v[236:239], v[132:135], a[0:15]
    v_cvt_pk_bf16_f32 v121, v150, v151
    v_or3_b32 v152, v113, v121, v152
    ds_read_b128 v[184:187], v155 offset:30720
    v_exp_f32 v144, v20
    v_mfma_f32_32x32x16_bf16 a[80:95], v[236:239], v[140:143], a[80:95]
    buffer_load_dwordx4 v12, s[8:11], s23 offen offset:3072 lds
    v_exp_f32 v145, v21
    v_mfma_f32_32x32x16_bf16 a[16:31], v[240:243], v[132:135], a[16:31]
    v_cvt_pk_bf16_f32 v114, v144, v145
    ds_read_b128 v[188:191], v156 offset:30720
    v_exp_f32 v146, v36
    v_mfma_f32_32x32x16_bf16 a[96:111], v[240:243], v[140:143], a[96:111]
    v_exp_f32 v147, v37
    s_waitcnt lgkmcnt(5)
    v_mfma_f32_32x32x16_bf16 a[32:47], v[244:247], v[132:135], a[32:47]
    s_mov_b32 m0, s30
    v_cvt_pk_bf16_f32 v122, v146, v147
    v_or3_b32 v152, v114, v122, v152
    v_exp_f32 v148, v22
    v_mfma_f32_32x32x16_bf16 a[112:127], v[244:247], v[140:143], a[112:127]
    buffer_load_dwordx4 v12, s[8:11], s24 offen offset:0 lds
    ds_read_b128 v[192:195], v157 offset:30720
    v_exp_f32 v149, v23
    v_mfma_f32_32x32x16_bf16 a[48:63], v[248:251], v[132:135], a[48:63]
    s_add_u32 s22, s22, 9216
    s_add_u32 s23, s23, 9216
    v_cvt_pk_bf16_f32 v115, v148, v149
    v_exp_f32 v150, v38
    v_mfma_f32_32x32x16_bf16 a[128:143], v[248:251], v[140:143], a[128:143]
    s_add_u32 s24, s24, 9216
    ds_read_b128 v[196:199], v158 offset:30720
    v_exp_f32 v151, v39
    s_waitcnt lgkmcnt(5)
    v_mfma_f32_32x32x16_bf16 a[64:79], v[252:255], v[132:135], a[64:79]
    v_cvt_pk_bf16_f32 v123, v150, v151
    v_or3_b32 v152, v115, v123, v152
    ds_read_b128 v[200:203], v159 offset:30720
    v_mfma_f32_32x32x16_bf16 a[144:159], v[252:255], v[140:143], a[144:159]
    v_exp_f32 v144, v24
L_k2_body2:
    s_waitcnt lgkmcnt(4)
    v_mfma_f32_32x32x16_bf16 v[48:63], v[180:183], a[160:163], v[80:95]
    s_mov_b32 m0, s31
    ds_read_b128 v[204:207], v160 offset:30720
    v_exp_f32 v145, v25
    v_mfma_f32_32x32x16_bf16 v[64:79], v[180:183], a[196:199], v[96:111]
    buffer_load_dwordx4 v12, s[8:11], s22 offen offset:0 lds
    v_cvt_pk_bf16_f32 v116, v144, v145
    v_exp_f32 v146, v40
    v_mfma_f32_32x32x16_bf16 v[48:63], v[184:187], a[164:167], v[48:63]
    ds_read_b128 v[208:211], v161 offset:30720
    v_exp_f32 v147, v41
    v_mfma_f32_32x32x16_bf16 v[64:79], v[184:187], a[200:203], v[64:79]
    v_cvt_pk_bf16_f32 v124, v146, v147
    v_or3_b32 v152, v116, v124, v152
    v_exp_f32 v148, v26
    s_waitcnt lgkmcnt(4)
    v_mfma_f32_32x32x16_bf16 v[48:63], v[188:191], a[168:171], v[48:63]
    ds_read_b128 v[212:215], v162 offset:30720
    v_exp_f32 v149, v27
    v_mfma_f32_32x32x16_bf16 v[64:79], v[188:191], a[204:207], v[64:79]
    buffer_load_dwordx4 v12, s[8:11], s22 offen offset:1024 lds
    v_cvt_pk_bf16_f32 v117, v148, v149
    v_exp_f32 v150, v42
    v_mfma_f32_32x32x16_bf16 v[48:63], v[192:195], a[172:175], v[48:63]
    ds_read_b64_tr_b16 v[216:217], v163 offset:20480
    ds_read_b64_tr_b16 v[218:219], v164 offset:20480
    v_exp_f32 v151, v43
    v_mfma_f32_32x32x16_bf16 v[64:79], v[192:195], a[208:211], v[64:79]
    v_cvt_pk_bf16_f32 v125, v150, v151
    v_or3_b32 v152, v117, v125, v152
    v_exp_f32 v144, v28
    s_waitcnt lgkmcnt(5)
    v_mfma_f32_32x32x16_bf16 v[48:63], v[196:199], a[176:179], v[48:63]
    ds_read_b64_tr_b16 v[220:221], v165 offset:20480
    ds_read_b64_tr_b16 v[222:223], v166 offset:20480
    v_exp_f32 v145, v29
    v_mfma_f32_32x32x16_bf16 v[64:79], v[196:199], a[212:215], v[64:79]
    buffer_load_dwordx4 v12, s[8:11], s22 offen offset:2048 lds
    v_cvt_pk_bf16_f32 v118, v144, v145
    v_exp_f32 v146, v44
    v_mfma_f32_32x32x16_bf16 v[48:63], v[200:203], a[180:183], v[48:63]
    ds_read_b64_tr_b16 v[224:225], v167 offset:20480
    ds_read_b64_tr_b16 v[226:227], v168 offset:20480
    v_exp_f32 v147, v45
    v_mfma_f32_32x32x16_bf16 v[64:79], v[200:203], a[216:219], v[64:79]
    v_cvt_pk_bf16_f32 v126, v146, v147
    v_or3_b32 v152, v118, v126, v152
    v_exp_f32 v148, v30
    s_waitcnt lgkmcnt(7)
    v_mfma_f32_32x32x16_bf16 v[48:63], v[204:207], a[184:187], v[48:63]
    ds_read_b64_tr_b16 v[228:229], v169 offset:20480
    ds_read_b64_tr_b16 v[230:231], v170 offset:20480
    v_exp_f32 v149, v31
    v_mfma_f32_32x32x16_bf16 v[64:79], v[204:207], a[220:223], v[64:79]
    buffer_load_dwordx4 v12, s[8:11], s22 offen offset:3072 lds
    v_cvt_pk_bf16_f32 v119, v148, v149
    v_exp_f32 v150, v46
    v_mfma_f32_32x32x16_bf16 v[48:63], v[208:211], a[188:191], v[48:63]
    ds_read_b64_tr_b16 v[232:233], v171 offset:20480
    ds_read_b64_tr_b16 v[234:235], v172 offset:20480
    v_exp_f32 v151, v47
    v_mfma_f32_32x32x16_bf16 v[64:79], v[208:211], a[224:227], v[64:79]
    v_cvt_pk_bf16_f32 v127, v150, v151
    v_or3_b32 v152, v119, v127, v152
    s_waitcnt lgkmcnt(8)
    v_mfma_f32_32x32x16_bf16 v[48:63], v[212:215], a[192:195], v[48:63]
    s_mov_b32 m0, s32
    ds_read_b64_tr_b16 v[236:237], v163 offset:24576
    ds_read_b64_tr_b16 v[238:239], v164 offset:24576
    v_mfma_f32_32x32x16_bf16 v[64:79], v[212:215], a[228:231], v[64:79]
    buffer_load_dwordx4 v12, s[8:11], s23 offen offset:0 lds
    v_lshl_or_b32 v153, v152, 16, v152
    v_cmp_le_u32 vcc, 0x40000000, v153
    s_cbranch_vccnz L_k2_rare2
L_k2_ret2:
    v_mfma_f32_32x32x16_bf16 a[0:15], v[216:219], v[112:115], a[0:15]
    ds_read_b64_tr_b16 v[240:241], v165 offset:24576
    ds_read_b64_tr_b16 v[242:243], v166 offset:24576
    v_mfma_f32_32x32x16_bf16 a[80:95], v[216:219], v[120:123], a[80:95]
    s_waitcnt lgkmcnt(8)
    v_mfma_f32_32x32x16_bf16 a[16:31], v[220:223], v[112:115], a[16:31]
    ds_read_b64_tr_b16 v[244:245], v167 offset:24576
    ds_read_b64_tr_b16 v[246:247], v168 offset:24576
    v_exp_f32 v144, v48
    v_mfma_f32_32x32x16_bf16 a[96:111], v[220:223], v[120:123], a[96:111]
    buffer_load_dwordx4 v12, s[8:11], s23 offen offset:1024 lds
    v_exp_f32 v145, v49
    v_mfma_f32_32x32x16_bf16 a[32:47], v[224:227], v[112:115], a[32:47]
    v_cvt_pk_bf16_f32 v128, v144, v145
    s_waitcnt vmcnt(6)
    ds_read_b64_tr_b16 v[248:249], v169 offset:24576
    v_exp_f32 v146, v64
    v_mfma_f32_32x32x16_bf16 a[112:127], v[224:227], v[120:123], a[112:127]
    ds_read_b64_tr_b16 v[250:251], v170 offset:24576
    v_exp_f32 v147, v65
    s_waitcnt lgkmcnt(8)
    v_mfma_f32_32x32x16_bf16 a[48:63], v[228:231], v[112:115], a[48:63]
    v_cvt_pk_bf16_f32 v136, v146, v147
    v_or_b32 v152, v128, v136
    ds_read_b64_tr_b16 v[252:253], v171 offset:20992
    v_exp_f32 v148, v50
    v_mfma_f32_32x32x16_bf16 a[128:143], v[228:231], v[120:123], a[128:143]
    buffer_load_dwordx4 v12, s[8:11], s23 offen offset:2048 lds
    ds_read_b64_tr_b16 v[254:255], v172 offset:20992
    v_exp_f32 v149, v51
    v_mfma_f32_32x32x16_bf16 a[64:79], v[232:235], v[112:115], a[64:79]
    v_cvt_pk_bf16_f32 v129, v148, v149
    ds_read_b128 v[180:183], v154 offset:0
    v_exp_f32 v150, v66
    v_mfma_f32_32x32x16_bf16 a[144:159], v[232:235], v[120:123], a[144:159]
    v_exp_f32 v151, v67
    s_waitcnt lgkmcnt(7)
    v_mfma_f32_32x32x16_bf16 a[0:15], v[236:239], v[116:119], a[0:15]
    v_cvt_pk_bf16_f32 v137, v150, v151
    v_or3_b32 v152, v129, v137, v152
    ds_read_b128 v[184:187], v155 offset:0
    v_exp_f32 v144, v52
    v_mfma_f32_32x32x16_bf16 a[80:95], v[236:239], v[124:127], a[80:95]
    buffer_load_dwordx4 v12, s[8:11], s23 offen offset:3072 lds
    v_exp_f32 v145, v53
    v_mfma_f32_32x32x16_bf16 a[16:31], v[240:243], v[116:119], a[16:31]
    v_cvt_pk_bf16_f32 v130, v144, v145
    ds_read_b128 v[188:191], v156 offset:0
    v_exp_f32 v146, v68
    v_mfma_f32_32x32x16_bf16 a[96:111], v[240:243], v[124:127], a[96:111]
    v_exp_f32 v147, v69
    s_waitcnt lgkmcnt(5)
    v_mfma_f32_32x32x16_bf16 a[32:47], v[244:247], v[116:119], a[32:47]
    s_mov_b32 m0, s33
    v_cvt_pk_bf16_f32 v138, v146, v147
    v_or3_b32 v152, v130, v138, v152
    v_exp_f32 v148, v54
    v_mfma_f32_32x32x16_bf16 a[112:127], v[244:247], v[124:127], a[112:127]
    buffer_load_dwordx4 v12, s[8:11], s24 offen offset:0 lds
    ds_read_b128 v[192:195], v157 offset:0
    v_exp_f32 v149, v55
    v_mfma_f32_32x32x16_bf16 a[48:63], v[248:251], v[116:119], a[48:63]
    s_add_u32 s22, s22, 9216
    s_add_u32 s23, s23, 9216
    v_cvt_pk_bf16_f32 v131, v148, v149
    v_exp_f32 v150, v70
    v_mfma_f32_32x32x16_bf16 a[128:143], v[248:251], v[124:127], a[128:143]
    s_add_u32 s24, s24, 9216
    ds_read_b128 v[196:199], v158 offset:0
    v_exp_f32 v151, v71
    s_waitcnt lgkmcnt(5)
    v_mfma_f32_32x32x16_bf16 a[64:79], v[252:255], v[116:119], a[64:79]
    v_cvt_pk_bf16_f32 v139, v150, v151
    v_or3_b32 v152, v131, v139, v152
    ds_read_b128 v[200:203], v159 offset:0
    v_mfma_f32_32x32x16_bf16 a[144:159], v[252:255], v[124:127], a[144:159]
    v_exp_f32 v144, v56
    s_sub_u32 s21, s21, 1
    s_cmp_eq_u32 s21, 0
    s_cbranch_scc1 L_k2_last
L_k2_body3:
    s_waitcnt lgkmcnt(4)
    v_mfma_f32_32x32x16_bf16 v[16:31], v[180:183], a[160:163], v[80:95]
    s_mov_b32 m0, s34
    ds_read_b128 v[204:207], v160 offset:0
    v_exp_f32 v145, v57
    v_mfma_f32_32x32x16_bf16 v[32:47], v[180:183], a[196:199], v[96:111]
    buffer_load_dwordx4 v12, s[8:11], s22 offen offset:0 lds
    v_cvt_pk_bf16_f32 v132, v144, v145
    v_exp_f32 v146, v72
    v_mfma_f32_32x32x16_bf16 v[16:31], v[184:187], a[164:167], v[16:31]
    ds_read_b128 v[208:211], v161 offset:0
    v_exp_f32 v147, v73
    v_mfma_f32_32x32x16_bf16 v[32:47], v[184:187], a[200:203], v[32:47]
    v_cvt_pk_bf16_f32 v140, v146, v147
    v_or3_b32 v152, v132, v140, v152
    v_exp_f32 v148, v58
    s_waitcnt lgkmcnt(4)
    v_mfma_f32_32x32x16_bf16 v[16:31], v[188:191], a[168:171], v[16:31]
    ds_read_b128 v[212:215], v162 offset:0
    v_exp_f32 v149, v59
    v_mfma_f32_32x32x16_bf16 v[32:47], v[188:191], a[204:207], v[32:47]
    buffer_load_dwordx4 v12, s[8:11], s22 offen offset:1024 lds
    v_cvt_pk_bf16_f32 v133, v148, v149
    v_exp_f32 v150, v74
    v_mfma_f32_32x32x16_bf16 v[16:31], v[192:195], a[172:175], v[16:31]
    ds_read_b64_tr_b16 v[216:217], v163 offset:30720
    ds_read_b64_tr_b16 v[218:219], v164 offset:30720
    v_exp_f32 v151, v75
    v_mfma_f32_32x32x16_bf16 v[32:47], v[192:195], a[208:211], v[32:47]
    v_cvt_pk_bf16_f32 v141, v150, v151
    v_or3_b32 v152, v133, v141, v152
    v_exp_f32 v144, v60
    s_waitcnt lgkmcnt(5)
    v_mfma_f32_32x32x16_bf16 v[16:31], v[196:199], a[176:179], v[16:31]
    ds_read_b64_tr_b16 v[220:221], v165 offset:30720
    ds_read_b64_tr_b16 v[222:223], v166 offset:30720
    v_exp_f32 v145, v61
    v_mfma_f32_32x32x16_bf16 v[32:47], v[196:199], a[212:215], v[32:47]
    buffer_load_dwordx4 v12, s[8:11], s22 offen offset:2048 lds
    v_cvt_pk_bf16_f32 v134, v144, v145
    v_exp_f32 v146, v76
    v_mfma_f32_32x32x16_bf16 v[16:31], v[200:203], a[180:183], v[16:31]
    ds_read_b64_tr_b16 v[224:225], v167 offset:30720
    ds_read_b64_tr_b16 v[226:227], v168 offset:30720
    v_exp_f32 v147, v77
    v_mfma_f32_32x32x16_bf16 v[32:47], v[200:203], a[216:219], v[32:47]
    v_cvt_pk_bf16_f32 v142, v146, v147
    v_or3_b32 v152, v134, v142, v152
    v_exp_f32 v148, v62
    s_waitcnt lgkmcnt(7)
    v_mfma_f32_32x32x16_bf16 v[16:31], v[204:207], a[184:187], v[16:31]
    ds_read_b64_tr_b16 v[228:229], v169 offset:30720
    ds_read_b64_tr_b16 v[230:231], v170 offset:30720
    v_exp_f32 v149, v63
    v_mfma_f32_32x32x16_bf16 v[32:47], v[204:207], a[220:223], v[32:47]
    buffer_load_dwordx4 v12, s[8:11], s22 offen offset:3072 lds
    v_cvt_pk_bf16_f32 v135, v148, v149
    v_exp_f32 v150, v78
    v_mfma_f32_32x32x16_bf16 v[16:31], v[208:211], a[188:191], v[16:31]
    ds_read_b64_tr_b16 v[232:233], v171 offset:30720
    ds_read_b64_tr_b16 v[234:235], v172 offset:30720
    v_exp_f32 v151, v79
    v_mfma_f32_32x32x16_bf16 v[32:47], v[208:211], a[224:227], v[32:47]
    v_cvt_pk_bf16_f32 v143, v150, v151
    v_or3_b32 v152, v135, v143, v152
    s_waitcnt lgkmcnt(8)
    v_mfma_f32_32x32x16_bf16 v[16:31], v[212:215], a[192:195], v[16:31]
    s_mov_b32 m0, s35
    ds_read_b64_tr_b16 v[236:237], v163 offset:34816
    ds_read_b64_tr_b16 v[238:239], v164 offset:34816
    v_mfma_f32_32x32x16_bf16 v[32:47], v[212:215], a[228:231], v[32:47]
    buffer_load_dwordx4 v12, s[8:11], s23 offen offset:0 lds
    v_lshl_or_b32 v153, v152, 16, v152
    v_cmp_le_u32 vcc, 0x40000000, v153
    s_cbranch_vccnz L_k2_rare3
L_k2_ret3:
    v_mfma_f32_32x32x16_bf16 a[0:15], v[216:219], v[128:131], a[0:15]
    ds_read_b64_tr_b16 v[240:241], v165 offset:34816
    ds_read_b64_tr_b16 v[242:243], v166 offset:34816
    v_mfma_f32_32x32x16_bf16 a[80:95], v[216:219], v[136:139], a[80:95]
    s_waitcnt lgkmcnt(8)
    v_mfma_f32_32x32x16_bf16 a[16:31], v[220:223], v[128:131], a[16:31]
    ds_read_b64_tr_b16 v[244:245], v167 offset:34816
    ds_read_b64_tr_b16 v[246:247], v168 offset:34816
    v_exp_f32 v144, v16
    v_mfma_f32_32x32x16_bf16 a[96:111], v[220:223], v[136:139], a[96:111]
    buffer_load_dwordx4 v12, s[8:11], s23 offen offset:1024 lds
    v_exp_f32 v145, v17
    v_mfma_f32_32x32x16_bf16 a[32:47], v[224:227], v[128:131], a[32:47]
    v_cvt_pk_bf16_f32 v112, v144, v145
    s_waitcnt vmcnt(6)
    ds_read_b64_tr_b16 v[248:249], v169 offset:34816
    v_exp_f32 v146, v32
    v_mfma_f32_32x32x16_bf16 a[112:127], v[224:227], v[136:139], a[112:127]
    ds_read_b64_tr_b16 v[250:251], v170 offset:34816
    v_exp_f32 v147, v33
    s_waitcnt lgkmcnt(8)
    v_mfma_f32_32x32x16_bf16 a[48:63], v[228:231], v[128:131], a[48:63]
    v_cvt_pk_bf16_f32 v120, v146, v147
    v_or_b32 v152, v112, v120
    ds_read_b64_tr_b16 v[252:253], v171 offset:31232
    v_exp_f32 v148, v18
    v_mfma_f32_32x32x16_bf16 a[128:143], v[228:231], v[136:139], a[128:143]
    buffer_load_dwordx4 v12, s[8:11], s23 offen offset:2048 lds
    ds_read_b64_tr_b16 v[254:255], v172 offset:31232
    v_exp_f32 v149, v19
    v_mfma_f32_32x32x16_bf16 a[64:79], v[232:235], v[128:131], a[64:79]
    v_cvt_pk_bf16_f32 v113, v148, v149
    ds_read_b128 v[180:183], v154 offset:10240
    v_exp_f32 v150, v34
    v_mfma_f32_32x32x16_bf16 a[144:159], v[232:235], v[136:139], a[144:159]
    v_exp_f32 v151, v35
    s_waitcnt lgkmcnt(7)
    v_mfma_f32_32x32x16_bf16 a[0:15], v[236:239], v[132:135], a[0:15]
    v_cvt_pk_bf16_f32 v121, v150, v151
    v_or3_b32 v152, v113, v121, v152
    ds_read_b128 v[184:187], v155 offset:10240
    v_exp_f32 v144, v20
    v_mfma_f32_32x32x16_bf16 a[80:95], v[236:239], v[140:143], a[80:95]
    buffer_load_dwordx4 v12, s[8:11], s23 offen offset:3072 lds
    v_exp_f32 v145, v21
    v_mfma_f32_32x32x16_bf16 a[16:31], v[240:243], v[132:135], a[16:31]
    v_cvt_pk_bf16_f32 v114, v144, v145
    ds_read_b128 v[188:191], v156 offset:10240
    v_exp_f32 v146, v36
    v_mfma_f32_32x32x16_bf16 a[96:111], v[240:243], v[140:143], a[96:111]
    v_exp_f32 v147, v37
    s_waitcnt lgkmcnt(5)
    v_mfma_f32_32x32x16_bf16 a[32:47], v[244:247], v[132:135], a[32:47]
    s_mov_b32 m0, s36
    v_cvt_pk_bf16_f32 v122, v146, v147
    v_or3_b32 v152, v114, v122, v152
    v_exp_f32 v148, v22
    v_mfma_f32_32x32x16_bf16 a[112:127], v[244:247], v[140:143], a[112:127]
    buffer_load_dwordx4 v12, s[8:11], s24 offen offset:0 lds
    ds_read_b128 v[192:195], v157 offset:10240
    v_exp_f32 v149, v23
    v_mfma_f32_32x32x16_bf16 a[48:63], v[248:251], v[132:135], a[48:63]
    s_add_u32 s22, s22, 9216
    s_add_u32 s23, s23, 9216
    v_cvt_pk_bf16_f32 v115, v148, v149
    v_exp_f32 v150, v38
    v_mfma_f32_32x32x16_bf16 a[128:143], v[248:251], v[140:143], a[128:143]
    s_add_u32 s24, s24, 9216
    ds_read_b128 v[196:199], v158 offset:10240
    v_exp_f32 v151, v39
    s_waitcnt lgkmcnt(5)
    v_mfma_f32_32x32x16_bf16 a[64:79], v[252:255], v[132:135], a[64:79]
    v_cvt_pk_bf16_f32 v123, v150, v151
    v_or3_b32 v152, v115, v123, v152
    ds_read_b128 v[200:203], v159 offset:10240
    v_mfma_f32_32x32x16_bf16 a[144:159], v[252:255], v[140:143], a[144:159]
    v_exp_f32 v144, v24
    s_branch L_k2_body0
L_k2_rare0:
    s_nop 15
    v_max3_f32 v4, v16, v17, v18
    v_max3_f32 v4, v4, v19, v20
    v_max3_f32 v4, v4, v21, v22
    v_max3_f32 v4, v4, v23, v24
    v_max3_f32 v4, v4, v25, v26
    v_max3_f32 v4, v4, v27, v28
    v_max3_f32 v4, v4, v29, v30
    v_max_f32 v4, v4, v31
    v_mov_b32 v5, v4
    s_nop 1
    v_permlane32_swap_b32 v4, v5
    s_nop 1
    v_max_f32 v4, v4, v5
    v_add_f32 v4, 0x42200000, v4
    v_max_f32 v4, 0, v4
    v_sub_f32 v5, 0, v4
    v_exp_f32 v5, v5
    v_sub_f32 v16, v16, v4
    v_sub_f32 v48, v48, v4
    v_sub_f32 v80, v80, v4
    v_sub_f32 v17, v17, v4
    v_sub_f32 v49, v49, v4
    v_sub_f32 v81, v81, v4
    v_sub_f32 v18, v18, v4
    v_sub_f32 v50, v50, v4
    v_sub_f32 v82, v82, v4
    v_sub_f32 v19, v19, v4
    v_sub_f32 v51, v51, v4
    v_sub_f32 v83, v83, v4
    v_sub_f32 v20, v20, v4
    v_sub_f32 v52, v52, v4
    v_sub_f32 v84, v84, v4
    v_sub_f32 v21, v21, v4
    v_sub_f32 v53, v53, v4
    v_sub_f32 v85, v85, v4
    v_sub_f32 v22, v22, v4
    v_sub_f32 v54, v54, v4
    v_sub_f32 v86, v86, v4
    v_sub_f32 v23, v23, v4
    v_sub_f32 v55, v55, v4
    v_sub_f32 v87, v87, v4
    v_sub_f32 v24, v24, v4
    v_sub_f32 v56, v56, v4
    v_sub_f32 v88, v88, v4
    v_sub_f32 v25, v25, v4
    v_sub_f32 v57, v57, v4
    v_sub_f32 v89, v89, v4
    v_sub_f32 v26, v26, v4
    v_sub_f32 v58, v58, v4
    v_sub_f32 v90, v90, v4
    v_sub_f32 v27, v27, v4
    v_sub_f32 v59, v59, v4
    v_sub_f32 v91, v91, v4
    v_sub_f32 v28, v28, v4
    v_sub_f32 v60, v60, v4
    v_sub_f32 v92, v92, v4
    v_sub_f32 v29, v29, v4
    v_sub_f32 v61, v61, v4
    v_sub_f32 v93, v93, v4
    v_sub_f32 v30, v30, v4
    v_sub_f32 v62, v62, v4
    v_sub_f32 v94, v94, v4
    v_sub_f32 v31, v31, v4
    v_sub_f32 v63, v63, v4
    v_sub_f32 v95, v95, v4
    v_accvgpr_read_b32 v6, a0
    v_accvgpr_read_b32 v7, a1
    v_accvgpr_read_b32 v8, a2
    v_accvgpr_read_b32 v9, a3
    v_mul_f32 v6, v6, v5
    v_mul_f32 v7, v7, v5
    v_mul_f32 v8, v8, v5
    v_mul_f32 v9, v9, v5
    v_accvgpr_write_b32 a0, v6
    v_accvgpr_write_b32 a1, v7
    v_accvgpr_write_b32 a2, v8
    v_accvgpr_write_b32 a3, v9
    v_accvgpr_read_b32 v6, a4
    v_accvgpr_read_b32 v7, a5
    v_accvgpr_read_b32 v8, a6
    v_accvgpr_read_b32 v9, a7
    v_mul_f32 v6, v6, v5
    v_mul_f32 v7, v7, v5
    v_mul_f32 v8, v8, v5
    v_mul_f32 v9, v9, v5
    v_accvgpr_write_b32 a4, v6
    v_accvgpr_write_b32 a5, v7
    v_accvgpr_write_b32 a6, v8
    v_accvgpr_write_b32 a7, v9
    v_accvgpr_read_b32 v6, a8
    v_accvgpr_read_b32 v7, a9
    v_accvgpr_read_b32 v8, a10
    v_accvgpr_read_b32 v9, a11
    v_mul_f32 v6, v6, v5
    v_mul_f32 v7, v7, v5
    v_mul_f32 v8, v8, v5
    v_mul_f32 v9, v9, v5
    v_accvgpr_write_b32 a8, v6
    v_accvgpr_write_b32 a9, v7
    v_accvgpr_write_b32 a10, v8
    v_accvgpr_write_b32 a11, v9
    v_accvgpr_read_b32 v6, a12
    v_accvgpr_read_b32 v7, a13
    v_accvgpr_read_b32 v8, a14
    v_accvgpr_read_b32 v9, a15
    v_mul_f32 v6, v6, v5
    v_mul_f32 v7, v7, v5
    v_mul_f32 v8, v8, v5
    v_mul_f32 v9, v9, v5
    v_accvgpr_write_b32 a12, v6
    v_accvgpr_write_b32 a13, v7
    v_accvgpr_write_b32 a14, v8
    v_accvgpr_write_b32 a15, v9
    v_accvgpr_read_b32 v6, a16
    v_accvgpr_read_b32 v7, a17
    v_accvgpr_read_b32 v8, a18
    v_accvgpr_read_b32 v9, a19
    v_mul_f32 v6, v6, v5
    v_mul_f32 v7, v7, v5
    v_mul_f32 v8, v8, v5
    v_mul_f32 v9, v9, v5
    v_accvgpr_write_b32 a16, v6
    v_accvgpr_write_b32 a17, v7
    v_accvgpr_write_b32 a18, v8
    v_accvgpr_write_b32 a19, v9
    v_accvgpr_read_b32 v6, a20
    v_accvgpr_read_b32 v7, a21
    v_accvgpr_read_b32 v8, a22
    v_accvgpr_read_b32 v9, a23
    v_mul_f32 v6, v6, v5
    v_mul_f32 v7, v7, v5
    v_mul_f32 v8, v8, v5
    v_mul_f32 v9, v9, v5
    v_accvgpr_write_b32 a20, v6
    v_accvgpr_write_b32 a21, v7
    v_accvgpr_write_b32 a22, v8
    v_accvgpr_write_b32 a23, v9
    v_accvgpr_read_b32 v6, a24
    v_accvgpr_read_b32 v7, a25
    v_accvgpr_read_b32 v8, a26
    v_accvgpr_read_b32 v9, a27
    v_mul_f32 v6, v6, v5
    v_mul_f32 v7, v7, v5
    v_mul_f32 v8, v8, v5
    v_mul_f32 v9, v9, v5
    v_accvgpr_write_b32 a24, v6
    v_accvgpr_write_b32 a25, v7
    v_accvgpr_write_b32 a26, v8
    v_accvgpr_write_b32 a27, v9
    v_accvgpr_read_b32 v6, a28
    v_accvgpr_read_b32 v7, a29
    v_accvgpr_read_b32 v8, a30
    v_accvgpr_read_b32 v9, a31
    v_mul_f32 v6, v6, v5
    v_mul_f32 v7, v7, v5
    v_mul_f32 v8, v8, v5
    v_mul_f32 v9, v9, v5
    v_accvgpr_write_b32 a28, v6
    v_accvgpr_write_b32 a29, v7
    v_accvgpr_write_b32 a30, v8
    v_accvgpr_write_b32 a31, v9
    v_accvgpr_read_b32 v6, a32
    v_accvgpr_read_b32 v7, a33
    v_accvgpr_read_b32 v8, a34
    v_accvgpr_read_b32 v9, a35
    v_mul_f32 v6, v6, v5
    v_mul_f32 v7, v7, v5
    v_mul_f32 v8, v8, v5
    v_mul_f32 v9, v9, v5
    v_accvgpr_write_b32 a32, v6
    v_accvgpr_write_b32 a33, v7
    v_accvgpr_write_b32 a34, v8
    v_accvgpr_write_b32 a35, v9
    v_accvgpr_read_b32 v6, a36
    v_accvgpr_read_b32 v7, a37
    v_accvgpr_read_b32 v8, a38
    v_accvgpr_read_b32 v9, a39
    v_mul_f32 v6, v6, v5
    v_mul_f32 v7, v7, v5
    v_mul_f32 v8, v8, v5
    v_mul_f32 v9, v9, v5
    v_accvgpr_write_b32 a36, v6
    v_accvgpr_write_b32 a37, v7
    v_accvgpr_write_b32 a38, v8
    v_accvgpr_write_b32 a39, v9
    v_accvgpr_read_b32 v6, a40
    v_accvgpr_read_b32 v7, a41
    v_accvgpr_read_b32 v8, a42
    v_accvgpr_read_b32 v9, a43
    v_mul_f32 v6, v6, v5
    v_mul_f32 v7, v7, v5
    v_mul_f32 v8, v8, v5
    v_mul_f32 v9, v9, v5
    v_accvgpr_write_b32 a40, v6
    v_accvgpr_write_b32 a41, v7
    v_accvgpr_write_b32 a42, v8
    v_accvgpr_write_b32 a43, v9
    v_accvgpr_read_b32 v6, a44
    v_accvgpr_read_b32 v7, a45
    v_accvgpr_read_b32 v8, a46
    v_accvgpr_read_b32 v9, a47
    v_mul_f32 v6, v6, v5
    v_mul_f32 v7, v7, v5
    v_mul_f32 v8, v8, v5
    v_mul_f32 v9, v9, v5
    v_accvgpr_write_b32 a44, v6
    v_accvgpr_write_b32 a45, v7
    v_accvgpr_write_b32 a46, v8
    v_accvgpr_write_b32 a47, v9
    v_accvgpr_read_b32 v6, a48
    v_accvgpr_read_b32 v7, a49
    v_accvgpr_read_b32 v8, a50
    v_accvgpr_read_b32 v9, a51
    v_mul_f32 v6, v6, v5
    v_mul_f32 v7, v7, v5
    v_mul_f32 v8, v8, v5
    v_mul_f32 v9, v9, v5
    v_accvgpr_write_b32 a48, v6
    v_accvgpr_write_b32 a49, v7
    v_accvgpr_write_b32 a50, v8
    v_accvgpr_write_b32 a51, v9
    v_accvgpr_read_b32 v6, a52
    v_accvgpr_read_b32 v7, a53
    v_accvgpr_read_b32 v8, a54
    v_accvgpr_read_b32 v9, a55
    v_mul_f32 v6, v6, v5
    v_mul_f32 v7, v7, v5
    v_mul_f32 v8, v8, v5
    v_mul_f32 v9, v9, v5
    v_accvgpr_write_b32 a52, v6
    v_accvgpr_write_b32 a53, v7
    v_accvgpr_write_b32 a54, v8
    v_accvgpr_write_b32 a55, v9
    v_accvgpr_read_b32 v6, a56
    v_accvgpr_read_b32 v7, a57
    v_accvgpr_read_b32 v8, a58
    v_accvgpr_read_b32 v9, a59
    v_mul_f32 v6, v6, v5
    v_mul_f32 v7, v7, v5
    v_mul_f32 v8, v8, v5
    v_mul_f32 v9, v9, v5
    v_accvgpr_write_b32 a56, v6
    v_accvgpr_write_b32 a57, v7
    v_accvgpr_write_b32 a58, v8
    v_accvgpr_write_b32 a59, v9
    v_accvgpr_read_b32 v6, a60
    v_accvgpr_read_b32 v7, a61
    v_accvgpr_read_b32 v8, a62
    v_accvgpr_read_b32 v9, a63
    v_mul_f32 v6, v6, v5
    v_mul_f32 v7, v7, v5
    v_mul_f32 v8, v8, v5
    v_mul_f32 v9, v9, v5
    v_accvgpr_write_b32 a60, v6
    v_accvgpr_write_b32 a61, v7
    v_accvgpr_write_b32 a62, v8
    v_accvgpr_write_b32 a63, v9
    v_accvgpr_read_b32 v6, a64
    v_accvgpr_read_b32 v7, a65
    v_accvgpr_read_b32 v8, a66
    v_accvgpr_read_b32 v9, a67
    v_mul_f32 v6, v6, v5
    v_mul_f32 v7, v7, v5
    v_mul_f32 v8, v8, v5
    v_mul_f32 v9, v9, v5
    v_accvgpr_write_b32 a64, v6
    v_accvgpr_write_b32 a65, v7
    v_accvgpr_write_b32 a66, v8
    v_accvgpr_write_b32 a67, v9
    v_accvgpr_read_b32 v6, a68
    v_accvgpr_read_b32 v7, a69
    v_accvgpr_read_b32 v8, a70
    v_accvgpr_read_b32 v9, a71
    v_mul_f32 v6, v6, v5
    v_mul_f32 v7, v7, v5
    v_mul_f32 v8, v8, v5
    v_mul_f32 v9, v9, v5
    v_accvgpr_write_b32 a68, v6
    v_accvgpr_write_b32 a69, v7
    v_accvgpr_write_b32 a70, v8
    v_accvgpr_write_b32 a71, v9
    v_accvgpr_read_b32 v6, a72
    v_accvgpr_read_b32 v7, a73
    v_accvgpr_read_b32 v8, a74
    v_accvgpr_read_b32 v9, a75
    v_mul_f32 v6, v6, v5
    v_mul_f32 v7, v7, v5
    v_mul_f32 v8, v8, v5
    v_mul_f32 v9, v9, v5
    v_accvgpr_write_b32 a72, v6
    v_accvgpr_write_b32 a73, v7
    v_accvgpr_write_b32 a74, v8
    v_accvgpr_write_b32 a75, v9
    v_accvgpr_read_b32 v6, a76
    v_accvgpr_read_b32 v7, a77
    v_accvgpr_read_b32 v8, a78
    v_accvgpr_read_b32 v9, a79
    v_mul_f32 v6, v6, v5
    v_mul_f32 v7, v7, v5
    v_mul_f32 v8, v8, v5
    v_mul_f32 v9, v9, v5
    v_accvgpr_write_b32 a76, v6
    v_accvgpr_write_b32 a77, v7
    v_accvgpr_write_b32 a78, v8
    v_accvgpr_write_b32 a79, v9
    v_exp_f32 v6, v16
    v_exp_f32 v7, v17
    s_nop 0
    v_cvt_pk_bf16_f32 v112, v6, v7
    v_exp_f32 v6, v18
    v_exp_f32 v7, v19
    s_nop 0
    v_cvt_pk_bf16_f32 v113, v6, v7
    v_exp_f32 v6, v20
    v_exp_f32 v7, v21
    s_nop 0
    v_cvt_pk_bf16_f32 v114, v6, v7
    v_exp_f32 v6, v22
    v_exp_f32 v7, v23
    s_nop 0
    v_cvt_pk_bf16_f32 v115, v6, v7
    v_exp_f32 v6, v24
    v_exp_f32 v7, v25
    s_nop 0
    v_cvt_pk_bf16_f32 v116, v6, v7
    v_exp_f32 v6, v26
    v_exp_f32 v7, v27
    s_nop 0
    v_cvt_pk_bf16_f32 v117, v6, v7
    v_exp_f32 v6, v28
    v_exp_f32 v7, v29
    s_nop 0
    v_cvt_pk_bf16_f32 v118, v6, v7
    v_exp_f32 v6, v30
    v_exp_f32 v7, v31
    s_nop 0
    v_cvt_pk_bf16_f32 v119, v6, v7
    v_max3_f32 v4, v32, v33, v34
    v_max3_f32 v4, v4, v35, v36
    v_max3_f32 v4, v4, v37, v38
    v_max3_f32 v4, v4, v39, v40
    v_max3_f32 v4, v4, v41, v42
    v_max3_f32 v4, v4, v43, v44
    v_max3_f32 v4, v4, v45, v46
    v_max_f32 v4, v4, v47
    v_mov_b32 v5, v4
    s_nop 1
    v_permlane32_swap_b32 v4, v5
    s_nop 1
    v_max_f32 v4, v4, v5
    v_add_f32 v4, 0x42200000, v4
    v_max_f32 v4, 0, v4
    v_sub_f32 v5, 0, v4
    v_exp_f32 v5, v5
    v_sub_f32 v32, v32, v4
    v_sub_f32 v64, v64, v4
    v_sub_f32 v96, v96, v4
    v_sub_f32 v33, v33, v4
    v_sub_f32 v65, v65, v4
    v_sub_f32 v97, v97, v4
    v_sub_f32 v34, v34, v4
    v_sub_f32 v66, v66, v4
    v_sub_f32 v98, v98, v4
    v_sub_f32 v35, v35, v4
    v_sub_f32 v67, v67, v4
    v_sub_f32 v99, v99, v4
    v_sub_f32 v36, v36, v4
    v_sub_f32 v68, v68, v4
    v_sub_f32 v100, v100, v4
    v_sub_f32 v37, v37, v4
    v_sub_f32 v69, v69, v4
    v_sub_f32 v101, v101, v4
    v_sub_f32 v38, v38, v4
    v_sub_f32 v70, v70, v4
    v_sub_f32 v102, v102, v4
    v_sub_f32 v39, v39, v4
    v_sub_f32 v71, v71, v4
    v_sub_f32 v103, v103, v4
    v_sub_f32 v40, v40, v4
    v_sub_f32 v72, v72, v4
    v_sub_f32 v104, v104, v4
    v_sub_f32 v41, v41, v4
    v_sub_f32 v73, v73, v4
    v_sub_f32 v105, v105, v4
    v_sub_f32 v42, v42, v4
    v_sub_f32 v74, v74, v4
    v_sub_f32 v106, v106, v4
    v_sub_f32 v43, v43, v4
    v_sub_f32 v75, v75, v4
    v_sub_f32 v107, v107, v4
    v_sub_f32 v44, v44, v4
    v_sub_f32 v76, v76, v4
    v_sub_f32 v108, v108, v4
    v_sub_f32 v45, v45, v4
    v_sub_f32 v77, v77, v4
    v_sub_f32 v109, v109, v4
    v_sub_f32 v46, v46, v4
    v_sub_f32 v78, v78, v4
    v_sub_f32 v110, v110, v4
    v_sub_f32 v47, v47, v4
    v_sub_f32 v79, v79, v4
    v_sub_f32 v111, v111, v4
    v_accvgpr_read_b32 v6, a80
    v_accvgpr_read_b32 v7, a81
    v_accvgpr_read_b32 v8, a82
    v_accvgpr_read_b32 v9, a83
    v_mul_f32 v6, v6, v5
    v_mul_f32 v7, v7, v5
    v_mul_f32 v8, v8, v5
    v_mul_f32 v9, v9, v5
    v_accvgpr_write_b32 a80, v6
    v_accvgpr_write_b32 a81, v7
    v_accvgpr_write_b32 a82, v8
    v_accvgpr_write_b32 a83, v9
    v_accvgpr_read_b32 v6, a84
    v_accvgpr_read_b32 v7, a85
    v_accvgpr_read_b32 v8, a86
    v_accvgpr_read_b32 v9, a87
    v_mul_f32 v6, v6, v5
    v_mul_f32 v7, v7, v5
    v_mul_f32 v8, v8, v5
    v_mul_f32 v9, v9, v5
    v_accvgpr_write_b32 a84, v6
    v_accvgpr_write_b32 a85, v7
    v_accvgpr_write_b32 a86, v8
    v_accvgpr_write_b32 a87, v9
    v_accvgpr_read_b32 v6, a88
    v_accvgpr_read_b32 v7, a89
    v_accvgpr_read_b32 v8, a90
    v_accvgpr_read_b32 v9, a91
    v_mul_f32 v6, v6, v5
    v_mul_f32 v7, v7, v5
    v_mul_f32 v8, v8, v5
    v_mul_f32 v9, v9, v5
    v_accvgpr_write_b32 a88, v6
    v_accvgpr_write_b32 a89, v7
    v_accvgpr_write_b32 a90, v8
    v_accvgpr_write_b32 a91, v9
    v_accvgpr_read_b32 v6, a92
    v_accvgpr_read_b32 v7, a93
    v_accvgpr_read_b32 v8, a94
    v_accvgpr_read_b32 v9, a95
    v_mul_f32 v6, v6, v5
    v_mul_f32 v7, v7, v5
    v_mul_f32 v8, v8, v5
    v_mul_f32 v9, v9, v5
    v_accvgpr_write_b32 a92, v6
    v_accvgpr_write_b32 a93, v7
    v_accvgpr_write_b32 a94, v8
    v_accvgpr_write_b32 a95, v9
    v_accvgpr_read_b32 v6, a96
    v_accvgpr_read_b32 v7, a97
    v_accvgpr_read_b32 v8, a98
    v_accvgpr_read_b32 v9, a99
    v_mul_f32 v6, v6, v5
    v_mul_f32 v7, v7, v5
    v_mul_f32 v8, v8, v5
    v_mul_f32 v9, v9, v5
    v_accvgpr_write_b32 a96, v6
    v_accvgpr_write_b32 a97, v7
    v_accvgpr_write_b32 a98, v8
    v_accvgpr_write_b32 a99, v9
    v_accvgpr_read_b32 v6, a100
    v_accvgpr_read_b32 v7, a101
    v_accvgpr_read_b32 v8, a102
    v_accvgpr_read_b32 v9, a103
    v_mul_f32 v6, v6, v5
    v_mul_f32 v7, v7, v5
    v_mul_f32 v8, v8, v5
    v_mul_f32 v9, v9, v5
    v_accvgpr_write_b32 a100, v6
    v_accvgpr_write_b32 a101, v7
    v_accvgpr_write_b32 a102, v8
    v_accvgpr_write_b32 a103, v9
    v_accvgpr_read_b32 v6, a104
    v_accvgpr_read_b32 v7, a105
    v_accvgpr_read_b32 v8, a106
    v_accvgpr_read_b32 v9, a107
    v_mul_f32 v6, v6, v5
    v_mul_f32 v7, v7, v5
    v_mul_f32 v8, v8, v5
    v_mul_f32 v9, v9, v5
    v_accvgpr_write_b32 a104, v6
    v_accvgpr_write_b32 a105, v7
    v_accvgpr_write_b32 a106, v8
    v_accvgpr_write_b32 a107, v9
    v_accvgpr_read_b32 v6, a108
    v_accvgpr_read_b32 v7, a109
    v_accvgpr_read_b32 v8, a110
    v_accvgpr_read_b32 v9, a111
    v_mul_f32 v6, v6, v5
    v_mul_f32 v7, v7, v5
    v_mul_f32 v8, v8, v5
    v_mul_f32 v9, v9, v5
    v_accvgpr_write_b32 a108, v6
    v_accvgpr_write_b32 a109, v7
    v_accvgpr_write_b32 a110, v8
    v_accvgpr_write_b32 a111, v9
    v_accvgpr_read_b32 v6, a112
    v_accvgpr_read_b32 v7, a113
    v_accvgpr_read_b32 v8, a114
    v_accvgpr_read_b32 v9, a115
    v_mul_f32 v6, v6, v5
    v_mul_f32 v7, v7, v5
    v_mul_f32 v8, v8, v5
    v_mul_f32 v9, v9, v5
    v_accvgpr_write_b32 a112, v6
    v_accvgpr_write_b32 a113, v7
    v_accvgpr_write_b32 a114, v8
    v_accvgpr_write_b32 a115, v9
    v_accvgpr_read_b32 v6, a116
    v_accvgpr_read_b32 v7, a117
    v_accvgpr_read_b32 v8, a118
    v_accvgpr_read_b32 v9, a119
    v_mul_f32 v6, v6, v5
    v_mul_f32 v7, v7, v5
    v_mul_f32 v8, v8, v5
    v_mul_f32 v9, v9, v5
    v_accvgpr_write_b32 a116, v6
    v_accvgpr_write_b32 a117, v7
    v_accvgpr_write_b32 a118, v8
    v_accvgpr_write_b32 a119, v9
    v_accvgpr_read_b32 v6, a120
    v_accvgpr_read_b32 v7, a121
    v_accvgpr_read_b32 v8, a122
    v_accvgpr_read_b32 v9, a123
    v_mul_f32 v6, v6, v5
    v_mul_f32 v7, v7, v5
    v_mul_f32 v8, v8, v5
    v_mul_f32 v9, v9, v5
    v_accvgpr_write_b32 a120, v6
    v_accvgpr_write_b32 a121, v7
    v_accvgpr_write_b32 a122, v8
    v_accvgpr_write_b32 a123, v9
    v_accvgpr_read_b32 v6, a124
    v_accvgpr_read_b32 v7, a125
    v_accvgpr_read_b32 v8, a126
    v_accvgpr_read_b32 v9, a127
    v_mul_f32 v6, v6, v5
    v_mul_f32 v7, v7, v5
    v_mul_f32 v8, v8, v5
    v_mul_f32 v9, v9, v5
    v_accvgpr_write_b32 a124, v6
    v_accvgpr_write_b32 a125, v7
    v_accvgpr_write_b32 a126, v8
    v_accvgpr_write_b32 a127, v9
    v_accvgpr_read_b32 v6, a128
    v_accvgpr_read_b32 v7, a129
    v_accvgpr_read_b32 v8, a130
    v_accvgpr_read_b32 v9, a131
    v_mul_f32 v6, v6, v5
    v_mul_f32 v7, v7, v5
    v_mul_f32 v8, v8, v5
    v_mul_f32 v9, v9, v5
    v_accvgpr_write_b32 a128, v6
    v_accvgpr_write_b32 a129, v7
    v_accvgpr_write_b32 a130, v8
    v_accvgpr_write_b32 a131, v9
    v_accvgpr_read_b32 v6, a132
    v_accvgpr_read_b32 v7, a133
    v_accvgpr_read_b32 v8, a134
    v_accvgpr_read_b32 v9, a135
    v_mul_f32 v6, v6, v5
    v_mul_f32 v7, v7, v5
    v_mul_f32 v8, v8, v5
    v_mul_f32 v9, v9, v5
    v_accvgpr_write_b32 a132, v6
    v_accvgpr_write_b32 a133, v7
    v_accvgpr_write_b32 a134, v8
    v_accvgpr_write_b32 a135, v9
    v_accvgpr_read_b32 v6, a136
    v_accvgpr_read_b32 v7, a137
    v_accvgpr_read_b32 v8, a138
    v_accvgpr_read_b32 v9, a139
    v_mul_f32 v6, v6, v5
    v_mul_f32 v7, v7, v5
    v_mul_f32 v8, v8, v5
    v_mul_f32 v9, v9, v5
    v_accvgpr_write_b32 a136, v6
    v_accvgpr_write_b32 a137, v7
    v_accvgpr_write_b32 a138, v8
    v_accvgpr_write_b32 a139, v9
    v_accvgpr_read_b32 v6, a140
    v_accvgpr_read_b32 v7, a141
    v_accvgpr_read_b32 v8, a142
    v_accvgpr_read_b32 v9, a143
    v_mul_f32 v6, v6, v5
    v_mul_f32 v7, v7, v5
    v_mul_f32 v8, v8, v5
    v_mul_f32 v9, v9, v5
    v_accvgpr_write_b32 a140, v6
    v_accvgpr_write_b32 a141, v7
    v_accvgpr_write_b32 a142, v8
    v_accvgpr_write_b32 a143, v9
    v_accvgpr_read_b32 v6, a144
    v_accvgpr_read_b32 v7, a145
    v_accvgpr_read_b32 v8, a146
    v_accvgpr_read_b32 v9, a147
    v_mul_f32 v6, v6, v5
    v_mul_f32 v7, v7, v5
    v_mul_f32 v8, v8, v5
    v_mul_f32 v9, v9, v5
    v_accvgpr_write_b32 a144, v6
    v_accvgpr_write_b32 a145, v7
    v_accvgpr_write_b32 a146, v8
    v_accvgpr_write_b32 a147, v9
    v_accvgpr_read_b32 v6, a148
    v_accvgpr_read_b32 v7, a149
    v_accvgpr_read_b32 v8, a150
    v_accvgpr_read_b32 v9, a151
    v_mul_f32 v6, v6, v5
    v_mul_f32 v7, v7, v5
    v_mul_f32 v8, v8, v5
    v_mul_f32 v9, v9, v5
    v_accvgpr_write_b32 a148, v6
    v_accvgpr_write_b32 a149, v7
    v_accvgpr_write_b32 a150, v8
    v_accvgpr_write_b32 a151, v9
    v_accvgpr_read_b32 v6, a152
    v_accvgpr_read_b32 v7, a153
    v_accvgpr_read_b32 v8, a154
    v_accvgpr_read_b32 v9, a155
    v_mul_f32 v6, v6, v5
    v_mul_f32 v7, v7, v5
    v_mul_f32 v8, v8, v5
    v_mul_f32 v9, v9, v5
    v_accvgpr_write_b32 a152, v6
    v_accvgpr_write_b32 a153, v7
    v_accvgpr_write_b32 a154, v8
    v_accvgpr_write_b32 a155, v9
    v_accvgpr_read_b32 v6, a156
    v_accvgpr_read_b32 v7, a157
    v_accvgpr_read_b32 v8, a158
    v_accvgpr_read_b32 v9, a159
    v_mul_f32 v6, v6, v5
    v_mul_f32 v7, v7, v5
    v_mul_f32 v8, v8, v5
    v_mul_f32 v9, v9, v5
    v_accvgpr_write_b32 a156, v6
    v_accvgpr_write_b32 a157, v7
    v_accvgpr_write_b32 a158, v8
    v_accvgpr_write_b32 a159, v9
    v_exp_f32 v6, v32
    v_exp_f32 v7, v33
    s_nop 0
    v_cvt_pk_bf16_f32 v120, v6, v7
    v_exp_f32 v6, v34
    v_exp_f32 v7, v35
    s_nop 0
    v_cvt_pk_bf16_f32 v121, v6, v7
    v_exp_f32 v6, v36
    v_exp_f32 v7, v37
    s_nop 0
    v_cvt_pk_bf16_f32 v122, v6, v7
    v_exp_f32 v6, v38
    v_exp_f32 v7, v39
    s_nop 0
    v_cvt_pk_bf16_f32 v123, v6, v7
    v_exp_f32 v6, v40
    v_exp_f32 v7, v41
    s_nop 0
    v_cvt_pk_bf16_f32 v124, v6, v7
    v_exp_f32 v6, v42
    v_exp_f32 v7, v43
    s_nop 0
    v_cvt_pk_bf16_f32 v125, v6, v7
    v_exp_f32 v6, v44
    v_exp_f32 v7, v45
    s_nop 0
    v_cvt_pk_bf16_f32 v126, v6, v7
    v_exp_f32 v6, v46
    v_exp_f32 v7, v47
    s_nop 0
    v_cvt_pk_bf16_f32 v127, v6, v7
    s_nop 7
    s_branch L_k2_ret0
L_k2_rare1:
    s_nop 15
    v_max3_f32 v4, v48, v49, v50
    v_max3_f32 v4, v4, v51, v52
    v_max3_f32 v4, v4, v53, v54
    v_max3_f32 v4, v4, v55, v56
    v_max3_f32 v4, v4, v57, v58
    v_max3_f32 v4, v4, v59, v60
    v_max3_f32 v4, v4, v61, v62
    v_max_f32 v4, v4, v63
    v_mov_b32 v5, v4
    s_nop 1
    v_permlane32_swap_b32 v4, v5
    s_nop 1
    v_max_f32 v4, v4, v5
    v_add_f32 v4, 0x42200000, v4
    v_max_f32 v4, 0, v4
    v_sub_f32 v5, 0, v4
    v_exp_f32 v5, v5
    v_sub_f32 v48, v48, v4
    v_sub_f32 v16, v16, v4
    v_sub_f32 v80, v80, v4
    v_sub_f32 v49, v49, v4
    v_sub_f32 v17, v17, v4
    v_sub_f32 v81, v81, v4
    v_sub_f32 v50, v50, v4
    v_sub_f32 v18, v18, v4
    v_sub_f32 v82, v82, v4
    v_sub_f32 v51, v51, v4
    v_sub_f32 v19, v19, v4
    v_sub_f32 v83, v83, v4
    v_sub_f32 v52, v52, v4
    v_sub_f32 v20, v20, v4
    v_sub_f32 v84, v84, v4
    v_sub_f32 v53, v53, v4
    v_sub_f32 v21, v21, v4
    v_sub_f32 v85, v85, v4
    v_sub_f32 v54, v54, v4
    v_sub_f32 v22, v22, v4
    v_sub_f32 v86, v86, v4
    v_sub_f32 v55, v55, v4
    v_sub_f32 v23, v23, v4
    v_sub_f32 v87, v87, v4
    v_sub_f32 v56, v56, v4
    v_sub_f32 v24, v24, v4
    v_sub_f32 v88, v88, v4
    v_sub_f32 v57, v57, v4
    v_sub_f32 v25, v25, v4
    v_sub_f32 v89, v89, v4
    v_sub_f32 v58, v58, v4
    v_sub_f32 v26, v26, v4
    v_sub_f32 v90, v90, v4
    v_sub_f32 v59, v59, v4
    v_sub_f32 v27, v27, v4
    v_sub_f32 v91, v91, v4
    v_sub_f32 v60, v60, v4
    v_sub_f32 v28, v28, v4
    v_sub_f32 v92, v92, v4
    v_sub_f32 v61, v61, v4
    v_sub_f32 v29, v29, v4
    v_sub_f32 v93, v93, v4
    v_sub_f32 v62, v62, v4
    v_sub_f32 v30, v30, v4
    v_sub_f32 v94, v94, v4
    v_sub_f32 v63, v63, v4
    v_sub_f32 v31, v31, v4
    v_sub_f32 v95, v95, v4
    v_accvgpr_read_b32 v6, a0
    v_accvgpr_read_b32 v7, a1
    v_accvgpr_read_b32 v8, a2
    v_accvgpr_read_b32 v9, a3
    v_mul_f32 v6, v6, v5
    v_mul_f32 v7, v7, v5
    v_mul_f32 v8, v8, v5
    v_mul_f32 v9, v9, v5
    v_accvgpr_write_b32 a0, v6
    v_accvgpr_write_b32 a1, v7
    v_accvgpr_write_b32 a2, v8
    v_accvgpr_write_b32 a3, v9
    v_accvgpr_read_b32 v6, a4
    v_accvgpr_read_b32 v7, a5
    v_accvgpr_read_b32 v8, a6
    v_accvgpr_read_b32 v9, a7
    v_mul_f32 v6, v6, v5
    v_mul_f32 v7, v7, v5
    v_mul_f32 v8, v8, v5
    v_mul_f32 v9, v9, v5
    v_accvgpr_write_b32 a4, v6
    v_accvgpr_write_b32 a5, v7
    v_accvgpr_write_b32 a6, v8
    v_accvgpr_write_b32 a7, v9
    v_accvgpr_read_b32 v6, a8
    v_accvgpr_read_b32 v7, a9
    v_accvgpr_read_b32 v8, a10
    v_accvgpr_read_b32 v9, a11
    v_mul_f32 v6, v6, v5
    v_mul_f32 v7, v7, v5
    v_mul_f32 v8, v8, v5
    v_mul_f32 v9, v9, v5
    v_accvgpr_write_b32 a8, v6
    v_accvgpr_write_b32 a9, v7
    v_accvgpr_write_b32 a10, v8
    v_accvgpr_write_b32 a11, v9
    v_accvgpr_read_b32 v6, a12
    v_accvgpr_read_b32 v7, a13
    v_accvgpr_read_b32 v8, a14
    v_accvgpr_read_b32 v9, a15
    v_mul_f32 v6, v6, v5
    v_mul_f32 v7, v7, v5
    v_mul_f32 v8, v8, v5
    v_mul_f32 v9, v9, v5
    v_accvgpr_write_b32 a12, v6
    v_accvgpr_write_b32 a13, v7
    v_accvgpr_write_b32 a14, v8
    v_accvgpr_write_b32 a15, v9
    v_accvgpr_read_b32 v6, a16
    v_accvgpr_read_b32 v7, a17
    v_accvgpr_read_b32 v8, a18
    v_accvgpr_read_b32 v9, a19
    v_mul_f32 v6, v6, v5
    v_mul_f32 v7, v7, v5
    v_mul_f32 v8, v8, v5
    v_mul_f32 v9, v9, v5
    v_accvgpr_write_b32 a16, v6
    v_accvgpr_write_b32 a17, v7
    v_accvgpr_write_b32 a18, v8
    v_accvgpr_write_b32 a19, v9
    v_accvgpr_read_b32 v6, a20
    v_accvgpr_read_b32 v7, a21
    v_accvgpr_read_b32 v8, a22
    v_accvgpr_read_b32 v9, a23
    v_mul_f32 v6, v6, v5
    v_mul_f32 v7, v7, v5
    v_mul_f32 v8, v8, v5
    v_mul_f32 v9, v9, v5
    v_accvgpr_write_b32 a20, v6
    v_accvgpr_write_b32 a21, v7
    v_accvgpr_write_b32 a22, v8
    v_accvgpr_write_b32 a23, v9
    v_accvgpr_read_b32 v6, a24
    v_accvgpr_read_b32 v7, a25
    v_accvgpr_read_b32 v8, a26
    v_accvgpr_read_b32 v9, a27
    v_mul_f32 v6, v6, v5
    v_mul_f32 v7, v7, v5
    v_mul_f32 v8, v8, v5
    v_mul_f32 v9, v9, v5
    v_accvgpr_write_b32 a24, v6
    v_accvgpr_write_b32 a25, v7
    v_accvgpr_write_b32 a26, v8
    v_accvgpr_write_b32 a27, v9
    v_accvgpr_read_b32 v6, a28
    v_accvgpr_read_b32 v7, a29
    v_accvgpr_read_b32 v8, a30
    v_accvgpr_read_b32 v9, a31
    v_mul_f32 v6, v6, v5
    v_mul_f32 v7, v7, v5
    v_mul_f32 v8, v8, v5
    v_mul_f32 v9, v9, v5
    v_accvgpr_write_b32 a28, v6
    v_accvgpr_write_b32 a29, v7
    v_accvgpr_write_b32 a30, v8
    v_accvgpr_write_b32 a31, v9
    v_accvgpr_read_b32 v6, a32
    v_accvgpr_read_b32 v7, a33
    v_accvgpr_read_b32 v8, a34
    v_accvgpr_read_b32 v9, a35
    v_mul_f32 v6, v6, v5
    v_mul_f32 v7, v7, v5
    v_mul_f32 v8, v8, v5
    v_mul_f32 v9, v9, v5
    v_accvgpr_write_b32 a32, v6
    v_accvgpr_write_b32 a33, v7
    v_accvgpr_write_b32 a34, v8
    v_accvgpr_write_b32 a35, v9
    v_accvgpr_read_b32 v6, a36
    v_accvgpr_read_b32 v7, a37
    v_accvgpr_read_b32 v8, a38
    v_accvgpr_read_b32 v9, a39
    v_mul_f32 v6, v6, v5
    v_mul_f32 v7, v7, v5
    v_mul_f32 v8, v8, v5
    v_mul_f32 v9, v9, v5
    v_accvgpr_write_b32 a36, v6
    v_accvgpr_write_b32 a37, v7
    v_accvgpr_write_b32 a38, v8
    v_accvgpr_write_b32 a39, v9
    v_accvgpr_read_b32 v6, a40
    v_accvgpr_read_b32 v7, a41
    v_accvgpr_read_b32 v8, a42
    v_accvgpr_read_b32 v9, a43
    v_mul_f32 v6, v6, v5
    v_mul_f32 v7, v7, v5
    v_mul_f32 v8, v8, v5
    v_mul_f32 v9, v9, v5
    v_accvgpr_write_b32 a40, v6
    v_accvgpr_write_b32 a41, v7
    v_accvgpr_write_b32 a42, v8
    v_accvgpr_write_b32 a43, v9
    v_accvgpr_read_b32 v6, a44
    v_accvgpr_read_b32 v7, a45
    v_accvgpr_read_b32 v8, a46
    v_accvgpr_read_b32 v9, a47
    v_mul_f32 v6, v6, v5
    v_mul_f32 v7, v7, v5
    v_mul_f32 v8, v8, v5
    v_mul_f32 v9, v9, v5
    v_accvgpr_write_b32 a44, v6
    v_accvgpr_write_b32 a45, v7
    v_accvgpr_write_b32 a46, v8
    v_accvgpr_write_b32 a47, v9
    v_accvgpr_read_b32 v6, a48
    v_accvgpr_read_b32 v7, a49
    v_accvgpr_read_b32 v8, a50
    v_accvgpr_read_b32 v9, a51
    v_mul_f32 v6, v6, v5
    v_mul_f32 v7, v7, v5
    v_mul_f32 v8, v8, v5
    v_mul_f32 v9, v9, v5
    v_accvgpr_write_b32 a48, v6
    v_accvgpr_write_b32 a49, v7
    v_accvgpr_write_b32 a50, v8
    v_accvgpr_write_b32 a51, v9
    v_accvgpr_read_b32 v6, a52
    v_accvgpr_read_b32 v7, a53
    v_accvgpr_read_b32 v8, a54
    v_accvgpr_read_b32 v9, a55
    v_mul_f32 v6, v6, v5
    v_mul_f32 v7, v7, v5
    v_mul_f32 v8, v8, v5
    v_mul_f32 v9, v9, v5
    v_accvgpr_write_b32 a52, v6
    v_accvgpr_write_b32 a53, v7
    v_accvgpr_write_b32 a54, v8
    v_accvgpr_write_b32 a55, v9
    v_accvgpr_read_b32 v6, a56
    v_accvgpr_read_b32 v7, a57
    v_accvgpr_read_b32 v8, a58
    v_accvgpr_read_b32 v9, a59
    v_mul_f32 v6, v6, v5
    v_mul_f32 v7, v7, v5
    v_mul_f32 v8, v8, v5
    v_mul_f32 v9, v9, v5
    v_accvgpr_write_b32 a56, v6
    v_accvgpr_write_b32 a57, v7
    v_accvgpr_write_b32 a58, v8
    v_accvgpr_write_b32 a59, v9
    v_accvgpr_read_b32 v6, a60
    v_accvgpr_read_b32 v7, a61
    v_accvgpr_read_b32 v8, a62
    v_accvgpr_read_b32 v9, a63
    v_mul_f32 v6, v6, v5
    v_mul_f32 v7, v7, v5
    v_mul_f32 v8, v8, v5
    v_mul_f32 v9, v9, v5
    v_accvgpr_write_b32 a60, v6
    v_accvgpr_write_b32 a61, v7
    v_accvgpr_write_b32 a62, v8
    v_accvgpr_write_b32 a63, v9
    v_accvgpr_read_b32 v6, a64
    v_accvgpr_read_b32 v7, a65
    v_accvgpr_read_b32 v8, a66
    v_accvgpr_read_b32 v9, a67
    v_mul_f32 v6, v6, v5
    v_mul_f32 v7, v7, v5
    v_mul_f32 v8, v8, v5
    v_mul_f32 v9, v9, v5
    v_accvgpr_write_b32 a64, v6
    v_accvgpr_write_b32 a65, v7
    v_accvgpr_write_b32 a66, v8
    v_accvgpr_write_b32 a67, v9
    v_accvgpr_read_b32 v6, a68
    v_accvgpr_read_b32 v7, a69
    v_accvgpr_read_b32 v8, a70
    v_accvgpr_read_b32 v9, a71
    v_mul_f32 v6, v6, v5
    v_mul_f32 v7, v7, v5
    v_mul_f32 v8, v8, v5
    v_mul_f32 v9, v9, v5
    v_accvgpr_write_b32 a68, v6
    v_accvgpr_write_b32 a69, v7
    v_accvgpr_write_b32 a70, v8
    v_accvgpr_write_b32 a71, v9
    v_accvgpr_read_b32 v6, a72
    v_accvgpr_read_b32 v7, a73
    v_accvgpr_read_b32 v8, a74
    v_accvgpr_read_b32 v9, a75
    v_mul_f32 v6, v6, v5
    v_mul_f32 v7, v7, v5
    v_mul_f32 v8, v8, v5
    v_mul_f32 v9, v9, v5
    v_accvgpr_write_b32 a72, v6
    v_accvgpr_write_b32 a73, v7
    v_accvgpr_write_b32 a74, v8
    v_accvgpr_write_b32 a75, v9
    v_accvgpr_read_b32 v6, a76
    v_accvgpr_read_b32 v7, a77
    v_accvgpr_read_b32 v8, a78
    v_accvgpr_read_b32 v9, a79
    v_mul_f32 v6, v6, v5
    v_mul_f32 v7, v7, v5
    v_mul_f32 v8, v8, v5
    v_mul_f32 v9, v9, v5
    v_accvgpr_write_b32 a76, v6
    v_accvgpr_write_b32 a77, v7
    v_accvgpr_write_b32 a78, v8
    v_accvgpr_write_b32 a79, v9
    v_exp_f32 v6, v48
    v_exp_f32 v7, v49
    s_nop 0
    v_cvt_pk_bf16_f32 v128, v6, v7
    v_exp_f32 v6, v50
    v_exp_f32 v7, v51
    s_nop 0
    v_cvt_pk_bf16_f32 v129, v6, v7
    v_exp_f32 v6, v52
    v_exp_f32 v7, v53
    s_nop 0
    v_cvt_pk_bf16_f32 v130, v6, v7
    v_exp_f32 v6, v54
    v_exp_f32 v7, v55
    s_nop 0
    v_cvt_pk_bf16_f32 v131, v6, v7
    v_exp_f32 v6, v56
    v_exp_f32 v7, v57
    s_nop 0
    v_cvt_pk_bf16_f32 v132, v6, v7
    v_exp_f32 v6, v58
    v_exp_f32 v7, v59
    s_nop 0
    v_cvt_pk_bf16_f32 v133, v6, v7
    v_exp_f32 v6, v60
    v_exp_f32 v7, v61
    s_nop 0
    v_cvt_pk_bf16_f32 v134, v6, v7
    v_exp_f32 v6, v62
    v_exp_f32 v7, v63
    s_nop 0
    v_cvt_pk_bf16_f32 v135, v6, v7
    v_max3_f32 v4, v64, v65, v66
    v_max3_f32 v4, v4, v67, v68
    v_max3_f32 v4, v4, v69, v70
    v_max3_f32 v4, v4, v71, v72
    v_max3_f32 v4, v4, v73, v74
    v_max3_f32 v4, v4, v75, v76
    v_max3_f32 v4, v4, v77, v78
    v_max_f32 v4, v4, v79
    v_mov_b32 v5, v4
    s_nop 1
    v_permlane32_swap_b32 v4, v5
    s_nop 1
    v_max_f32 v4, v4, v5
    v_add_f32 v4, 0x42200000, v4
    v_max_f32 v4, 0, v4
    v_sub_f32 v5, 0, v4
    v_exp_f32 v5, v5
    v_sub_f32 v64, v64, v4
    v_sub_f32 v32, v32, v4
    v_sub_f32 v96, v96, v4
    v_sub_f32 v65, v65, v4
    v_sub_f32 v33, v33, v4
    v_sub_f32 v97, v97, v4
    v_sub_f32 v66, v66, v4
    v_sub_f32 v34, v34, v4
    v_sub_f32 v98, v98, v4
    v_sub_f32 v67, v67, v4
    v_sub_f32 v35, v35, v4
    v_sub_f32 v99, v99, v4
    v_sub_f32 v68, v68, v4
    v_sub_f32 v36, v36, v4
    v_sub_f32 v100, v100, v4
    v_sub_f32 v69, v69, v4
    v_sub_f32 v37, v37, v4
    v_sub_f32 v101, v101, v4
    v_sub_f32 v70, v70, v4
    v_sub_f32 v38, v38, v4
    v_sub_f32 v102, v102, v4
    v_sub_f32 v71, v71, v4
    v_sub_f32 v39, v39, v4
    v_sub_f32 v103, v103, v4
    v_sub_f32 v72, v72, v4
    v_sub_f32 v40, v40, v4
    v_sub_f32 v104, v104, v4
    v_sub_f32 v73, v73, v4
    v_sub_f32 v41, v41, v4
    v_sub_f32 v105, v105, v4
    v_sub_f32 v74, v74, v4
    v_sub_f32 v42, v42, v4
    v_sub_f32 v106, v106, v4
    v_sub_f32 v75, v75, v4
    v_sub_f32 v43, v43, v4
    v_sub_f32 v107, v107, v4
    v_sub_f32 v76, v76, v4
    v_sub_f32 v44, v44, v4
    v_sub_f32 v108, v108, v4
    v_sub_f32 v77, v77, v4
    v_sub_f32 v45, v45, v4
    v_sub_f32 v109, v109, v4
    v_sub_f32 v78, v78, v4
    v_sub_f32 v46, v46, v4
    v_sub_f32 v110, v110, v4
    v_sub_f32 v79, v79, v4
    v_sub_f32 v47, v47, v4
    v_sub_f32 v111, v111, v4
    v_accvgpr_read_b32 v6, a80
    v_accvgpr_read_b32 v7, a81
    v_accvgpr_read_b32 v8, a82
    v_accvgpr_read_b32 v9, a83
    v_mul_f32 v6, v6, v5
    v_mul_f32 v7, v7, v5
    v_mul_f32 v8, v8, v5
    v_mul_f32 v9, v9, v5
    v_accvgpr_write_b32 a80, v6
    v_accvgpr_write_b32 a81, v7
    v_accvgpr_write_b32 a82, v8
    v_accvgpr_write_b32 a83, v9
    v_accvgpr_read_b32 v6, a84
    v_accvgpr_read_b32 v7, a85
    v_accvgpr_read_b32 v8, a86
    v_accvgpr_read_b32 v9, a87
    v_mul_f32 v6, v6, v5
    v_mul_f32 v7, v7, v5
    v_mul_f32 v8, v8, v5
    v_mul_f32 v9, v9, v5
    v_accvgpr_write_b32 a84, v6
    v_accvgpr_write_b32 a85, v7
    v_accvgpr_write_b32 a86, v8
    v_accvgpr_write_b32 a87, v9
    v_accvgpr_read_b32 v6, a88
    v_accvgpr_read_b32 v7, a89
    v_accvgpr_read_b32 v8, a90
    v_accvgpr_read_b32 v9, a91
    v_mul_f32 v6, v6, v5
    v_mul_f32 v7, v7, v5
    v_mul_f32 v8, v8, v5
    v_mul_f32 v9, v9, v5
    v_accvgpr_write_b32 a88, v6
    v_accvgpr_write_b32 a89, v7
    v_accvgpr_write_b32 a90, v8
    v_accvgpr_write_b32 a91, v9
    v_accvgpr_read_b32 v6, a92
    v_accvgpr_read_b32 v7, a93
    v_accvgpr_read_b32 v8, a94
    v_accvgpr_read_b32 v9, a95
    v_mul_f32 v6, v6, v5
    v_mul_f32 v7, v7, v5
    v_mul_f32 v8, v8, v5
    v_mul_f32 v9, v9, v5
    v_accvgpr_write_b32 a92, v6
    v_accvgpr_write_b32 a93, v7
    v_accvgpr_write_b32 a94, v8
    v_accvgpr_write_b32 a95, v9
    v_accvgpr_read_b32 v6, a96
    v_accvgpr_read_b32 v7, a97
    v_accvgpr_read_b32 v8, a98
    v_accvgpr_read_b32 v9, a99
    v_mul_f32 v6, v6, v5
    v_mul_f32 v7, v7, v5
    v_mul_f32 v8, v8, v5
    v_mul_f32 v9, v9, v5
    v_accvgpr_write_b32 a96, v6
    v_accvgpr_write_b32 a97, v7
    v_accvgpr_write_b32 a98, v8
    v_accvgpr_write_b32 a99, v9
    v_accvgpr_read_b32 v6, a100
    v_accvgpr_read_b32 v7, a101
    v_accvgpr_read_b32 v8, a102
    v_accvgpr_read_b32 v9, a103
    v_mul_f32 v6, v6, v5
    v_mul_f32 v7, v7, v5
    v_mul_f32 v8, v8, v5
    v_mul_f32 v9, v9, v5
    v_accvgpr_write_b32 a100, v6
    v_accvgpr_write_b32 a101, v7
    v_accvgpr_write_b32 a102, v8
    v_accvgpr_write_b32 a103, v9
    v_accvgpr_read_b32 v6, a104
    v_accvgpr_read_b32 v7, a105
    v_accvgpr_read_b32 v8, a106
    v_accvgpr_read_b32 v9, a107
    v_mul_f32 v6, v6, v5
    v_mul_f32 v7, v7, v5
    v_mul_f32 v8, v8, v5
    v_mul_f32 v9, v9, v5
    v_accvgpr_write_b32 a104, v6
    v_accvgpr_write_b32 a105, v7
    v_accvgpr_write_b32 a106, v8
    v_accvgpr_write_b32 a107, v9
    v_accvgpr_read_b32 v6, a108
    v_accvgpr_read_b32 v7, a109
    v_accvgpr_read_b32 v8, a110
    v_accvgpr_read_b32 v9, a111
    v_mul_f32 v6, v6, v5
    v_mul_f32 v7, v7, v5
    v_mul_f32 v8, v8, v5
    v_mul_f32 v9, v9, v5
    v_accvgpr_write_b32 a108, v6
    v_accvgpr_write_b32 a109, v7
    v_accvgpr_write_b32 a110, v8
    v_accvgpr_write_b32 a111, v9
    v_accvgpr_read_b32 v6, a112
    v_accvgpr_read_b32 v7, a113
    v_accvgpr_read_b32 v8, a114
    v_accvgpr_read_b32 v9, a115
    v_mul_f32 v6, v6, v5
    v_mul_f32 v7, v7, v5
    v_mul_f32 v8, v8, v5
    v_mul_f32 v9, v9, v5
    v_accvgpr_write_b32 a112, v6
    v_accvgpr_write_b32 a113, v7
    v_accvgpr_write_b32 a114, v8
    v_accvgpr_write_b32 a115, v9
    v_accvgpr_read_b32 v6, a116
    v_accvgpr_read_b32 v7, a117
    v_accvgpr_read_b32 v8, a118
    v_accvgpr_read_b32 v9, a119
    v_mul_f32 v6, v6, v5
    v_mul_f32 v7, v7, v5
    v_mul_f32 v8, v8, v5
    v_mul_f32 v9, v9, v5
    v_accvgpr_write_b32 a116, v6
    v_accvgpr_write_b32 a117, v7
    v_accvgpr_write_b32 a118, v8
    v_accvgpr_write_b32 a119, v9
    v_accvgpr_read_b32 v6, a120
    v_accvgpr_read_b32 v7, a121
    v_accvgpr_read_b32 v8, a122
    v_accvgpr_read_b32 v9, a123
    v_mul_f32 v6, v6, v5
    v_mul_f32 v7, v7, v5
    v_mul_f32 v8, v8, v5
    v_mul_f32 v9, v9, v5
    v_accvgpr_write_b32 a120, v6
    v_accvgpr_write_b32 a121, v7
    v_accvgpr_write_b32 a122, v8
    v_accvgpr_write_b32 a123, v9
    v_accvgpr_read_b32 v6, a124
    v_accvgpr_read_b32 v7, a125
    v_accvgpr_read_b32 v8, a126
    v_accvgpr_read_b32 v9, a127
    v_mul_f32 v6, v6, v5
    v_mul_f32 v7, v7, v5
    v_mul_f32 v8, v8, v5
    v_mul_f32 v9, v9, v5
    v_accvgpr_write_b32 a124, v6
    v_accvgpr_write_b32 a125, v7
    v_accvgpr_write_b32 a126, v8
    v_accvgpr_write_b32 a127, v9
    v_accvgpr_read_b32 v6, a128
    v_accvgpr_read_b32 v7, a129
    v_accvgpr_read_b32 v8, a130
    v_accvgpr_read_b32 v9, a131
    v_mul_f32 v6, v6, v5
    v_mul_f32 v7, v7, v5
    v_mul_f32 v8, v8, v5
    v_mul_f32 v9, v9, v5
    v_accvgpr_write_b32 a128, v6
    v_accvgpr_write_b32 a129, v7
    v_accvgpr_write_b32 a130, v8
    v_accvgpr_write_b32 a131, v9
    v_accvgpr_read_b32 v6, a132
    v_accvgpr_read_b32 v7, a133
    v_accvgpr_read_b32 v8, a134
    v_accvgpr_read_b32 v9, a135
    v_mul_f32 v6, v6, v5
    v_mul_f32 v7, v7, v5
    v_mul_f32 v8, v8, v5
    v_mul_f32 v9, v9, v5
    v_accvgpr_write_b32 a132, v6
    v_accvgpr_write_b32 a133, v7
    v_accvgpr_write_b32 a134, v8
    v_accvgpr_write_b32 a135, v9
    v_accvgpr_read_b32 v6, a136
    v_accvgpr_read_b32 v7, a137
    v_accvgpr_read_b32 v8, a138
    v_accvgpr_read_b32 v9, a139
    v_mul_f32 v6, v6, v5
    v_mul_f32 v7, v7, v5
    v_mul_f32 v8, v8, v5
    v_mul_f32 v9, v9, v5
    v_accvgpr_write_b32 a136, v6
    v_accvgpr_write_b32 a137, v7
    v_accvgpr_write_b32 a138, v8
    v_accvgpr_write_b32 a139, v9
    v_accvgpr_read_b32 v6, a140
    v_accvgpr_read_b32 v7, a141
    v_accvgpr_read_b32 v8, a142
    v_accvgpr_read_b32 v9, a143
    v_mul_f32 v6, v6, v5
    v_mul_f32 v7, v7, v5
    v_mul_f32 v8, v8, v5
    v_mul_f32 v9, v9, v5
    v_accvgpr_write_b32 a140, v6
    v_accvgpr_write_b32 a141, v7
    v_accvgpr_write_b32 a142, v8
    v_accvgpr_write_b32 a143, v9
    v_accvgpr_read_b32 v6, a144
    v_accvgpr_read_b32 v7, a145
    v_accvgpr_read_b32 v8, a146
    v_accvgpr_read_b32 v9, a147
    v_mul_f32 v6, v6, v5
    v_mul_f32 v7, v7, v5
    v_mul_f32 v8, v8, v5
    v_mul_f32 v9, v9, v5
    v_accvgpr_write_b32 a144, v6
    v_accvgpr_write_b32 a145, v7
    v_accvgpr_write_b32 a146, v8
    v_accvgpr_write_b32 a147, v9
    v_accvgpr_read_b32 v6, a148
    v_accvgpr_read_b32 v7, a149
    v_accvgpr_read_b32 v8, a150
    v_accvgpr_read_b32 v9, a151
    v_mul_f32 v6, v6, v5
    v_mul_f32 v7, v7, v5
    v_mul_f32 v8, v8, v5
    v_mul_f32 v9, v9, v5
    v_accvgpr_write_b32 a148, v6
    v_accvgpr_write_b32 a149, v7
    v_accvgpr_write_b32 a150, v8
    v_accvgpr_write_b32 a151, v9
    v_accvgpr_read_b32 v6, a152
    v_accvgpr_read_b32 v7, a153
    v_accvgpr_read_b32 v8, a154
    v_accvgpr_read_b32 v9, a155
    v_mul_f32 v6, v6, v5
    v_mul_f32 v7, v7, v5
    v_mul_f32 v8, v8, v5
    v_mul_f32 v9, v9, v5
    v_accvgpr_write_b32 a152, v6
    v_accvgpr_write_b32 a153, v7
    v_accvgpr_write_b32 a154, v8
    v_accvgpr_write_b32 a155, v9
    v_accvgpr_read_b32 v6, a156
    v_accvgpr_read_b32 v7, a157
    v_accvgpr_read_b32 v8, a158
    v_accvgpr_read_b32 v9, a159
    v_mul_f32 v6, v6, v5
    v_mul_f32 v7, v7, v5
    v_mul_f32 v8, v8, v5
    v_mul_f32 v9, v9, v5
    v_accvgpr_write_b32 a156, v6
    v_accvgpr_write_b32 a157, v7
    v_accvgpr_write_b32 a158, v8
    v_accvgpr_write_b32 a159, v9
    v_exp_f32 v6, v64
    v_exp_f32 v7, v65
    s_nop 0
    v_cvt_pk_bf16_f32 v136, v6, v7
    v_exp_f32 v6, v66
    v_exp_f32 v7, v67
    s_nop 0
    v_cvt_pk_bf16_f32 v137, v6, v7
    v_exp_f32 v6, v68
    v_exp_f32 v7, v69
    s_nop 0
    v_cvt_pk_bf16_f32 v138, v6, v7
    v_exp_f32 v6, v70
    v_exp_f32 v7, v71
    s_nop 0
    v_cvt_pk_bf16_f32 v139, v6, v7
    v_exp_f32 v6, v72
    v_exp_f32 v7, v73
    s_nop 0
    v_cvt_pk_bf16_f32 v140, v6, v7
    v_exp_f32 v6, v74
    v_exp_f32 v7, v75
    s_nop 0
    v_cvt_pk_bf16_f32 v141, v6, v7
    v_exp_f32 v6, v76
    v_exp_f32 v7, v77
    s_nop 0
    v_cvt_pk_bf16_f32 v142, v6, v7
    v_exp_f32 v6, v78
    v_exp_f32 v7, v79
    s_nop 0
    v_cvt_pk_bf16_f32 v143, v6, v7
    s_nop 7
    s_branch L_k2_ret1
L_k2_rare2:
    s_nop 15
    v_max3_f32 v4, v16, v17, v18
    v_max3_f32 v4, v4, v19, v20
    v_max3_f32 v4, v4, v21, v22
    v_max3_f32 v4, v4, v23, v24
    v_max3_f32 v4, v4, v25, v26
    v_max3_f32 v4, v4, v27, v28
    v_max3_f32 v4, v4, v29, v30
    v_max_f32 v4, v4, v31
    v_mov_b32 v5, v4
    s_nop 1
    v_permlane32_swap_b32 v4, v5
    s_nop 1
    v_max_f32 v4, v4, v5
    v_add_f32 v4, 0x42200000, v4
    v_max_f32 v4, 0, v4
    v_sub_f32 v5, 0, v4
    v_exp_f32 v5, v5
    v_sub_f32 v16, v16, v4
    v_sub_f32 v48, v48, v4
    v_sub_f32 v80, v80, v4
    v_sub_f32 v17, v17, v4
    v_sub_f32 v49, v49, v4
    v_sub_f32 v81, v81, v4
    v_sub_f32 v18, v18, v4
    v_sub_f32 v50, v50, v4
    v_sub_f32 v82, v82, v4
    v_sub_f32 v19, v19, v4
    v_sub_f32 v51, v51, v4
    v_sub_f32 v83, v83, v4
    v_sub_f32 v20, v20, v4
    v_sub_f32 v52, v52, v4
    v_sub_f32 v84, v84, v4
    v_sub_f32 v21, v21, v4
    v_sub_f32 v53, v53, v4
    v_sub_f32 v85, v85, v4
    v_sub_f32 v22, v22, v4
    v_sub_f32 v54, v54, v4
    v_sub_f32 v86, v86, v4
    v_sub_f32 v23, v23, v4
    v_sub_f32 v55, v55, v4
    v_sub_f32 v87, v87, v4
    v_sub_f32 v24, v24, v4
    v_sub_f32 v56, v56, v4
    v_sub_f32 v88, v88, v4
    v_sub_f32 v25, v25, v4
    v_sub_f32 v57, v57, v4
    v_sub_f32 v89, v89, v4
    v_sub_f32 v26, v26, v4
    v_sub_f32 v58, v58, v4
    v_sub_f32 v90, v90, v4
    v_sub_f32 v27, v27, v4
    v_sub_f32 v59, v59, v4
    v_sub_f32 v91, v91, v4
    v_sub_f32 v28, v28, v4
    v_sub_f32 v60, v60, v4
    v_sub_f32 v92, v92, v4
    v_sub_f32 v29, v29, v4
    v_sub_f32 v61, v61, v4
    v_sub_f32 v93, v93, v4
    v_sub_f32 v30, v30, v4
    v_sub_f32 v62, v62, v4
    v_sub_f32 v94, v94, v4
    v_sub_f32 v31, v31, v4
    v_sub_f32 v63, v63, v4
    v_sub_f32 v95, v95, v4
    v_accvgpr_read_b32 v6, a0
    v_accvgpr_read_b32 v7, a1
    v_accvgpr_read_b32 v8, a2
    v_accvgpr_read_b32 v9, a3
    v_mul_f32 v6, v6, v5
    v_mul_f32 v7, v7, v5
    v_mul_f32 v8, v8, v5
    v_mul_f32 v9, v9, v5
    v_accvgpr_write_b32 a0, v6
    v_accvgpr_write_b32 a1, v7
    v_accvgpr_write_b32 a2, v8
    v_accvgpr_write_b32 a3, v9
    v_accvgpr_read_b32 v6, a4
    v_accvgpr_read_b32 v7, a5
    v_accvgpr_read_b32 v8, a6
    v_accvgpr_read_b32 v9, a7
    v_mul_f32 v6, v6, v5
    v_mul_f32 v7, v7, v5
    v_mul_f32 v8, v8, v5
    v_mul_f32 v9, v9, v5
    v_accvgpr_write_b32 a4, v6
    v_accvgpr_write_b32 a5, v7
    v_accvgpr_write_b32 a6, v8
    v_accvgpr_write_b32 a7, v9
    v_accvgpr_read_b32 v6, a8
    v_accvgpr_read_b32 v7, a9
    v_accvgpr_read_b32 v8, a10
    v_accvgpr_read_b32 v9, a11
    v_mul_f32 v6, v6, v5
    v_mul_f32 v7, v7, v5
    v_mul_f32 v8, v8, v5
    v_mul_f32 v9, v9, v5
    v_accvgpr_write_b32 a8, v6
    v_accvgpr_write_b32 a9, v7
    v_accvgpr_write_b32 a10, v8
    v_accvgpr_write_b32 a11, v9
    v_accvgpr_read_b32 v6, a12
    v_accvgpr_read_b32 v7, a13
    v_accvgpr_read_b32 v8, a14
    v_accvgpr_read_b32 v9, a15
    v_mul_f32 v6, v6, v5
    v_mul_f32 v7, v7, v5
    v_mul_f32 v8, v8, v5
    v_mul_f32 v9, v9, v5
    v_accvgpr_write_b32 a12, v6
    v_accvgpr_write_b32 a13, v7
    v_accvgpr_write_b32 a14, v8
    v_accvgpr_write_b32 a15, v9
    v_accvgpr_read_b32 v6, a16
    v_accvgpr_read_b32 v7, a17
    v_accvgpr_read_b32 v8, a18
    v_accvgpr_read_b32 v9, a19
    v_mul_f32 v6, v6, v5
    v_mul_f32 v7, v7, v5
    v_mul_f32 v8, v8, v5
    v_mul_f32 v9, v9, v5
    v_accvgpr_write_b32 a16, v6
    v_accvgpr_write_b32 a17, v7
    v_accvgpr_write_b32 a18, v8
    v_accvgpr_write_b32 a19, v9
    v_accvgpr_read_b32 v6, a20
    v_accvgpr_read_b32 v7, a21
    v_accvgpr_read_b32 v8, a22
    v_accvgpr_read_b32 v9, a23
    v_mul_f32 v6, v6, v5
    v_mul_f32 v7, v7, v5
    v_mul_f32 v8, v8, v5
    v_mul_f32 v9, v9, v5
    v_accvgpr_write_b32 a20, v6
    v_accvgpr_write_b32 a21, v7
    v_accvgpr_write_b32 a22, v8
    v_accvgpr_write_b32 a23, v9
    v_accvgpr_read_b32 v6, a24
    v_accvgpr_read_b32 v7, a25
    v_accvgpr_read_b32 v8, a26
    v_accvgpr_read_b32 v9, a27
    v_mul_f32 v6, v6, v5
    v_mul_f32 v7, v7, v5
    v_mul_f32 v8, v8, v5
    v_mul_f32 v9, v9, v5
    v_accvgpr_write_b32 a24, v6
    v_accvgpr_write_b32 a25, v7
    v_accvgpr_write_b32 a26, v8
    v_accvgpr_write_b32 a27, v9
    v_accvgpr_read_b32 v6, a28
    v_accvgpr_read_b32 v7, a29
    v_accvgpr_read_b32 v8, a30
    v_accvgpr_read_b32 v9, a31
    v_mul_f32 v6, v6, v5
    v_mul_f32 v7, v7, v5
    v_mul_f32 v8, v8, v5
    v_mul_f32 v9, v9, v5
    v_accvgpr_write_b32 a28, v6
    v_accvgpr_write_b32 a29, v7
    v_accvgpr_write_b32 a30, v8
    v_accvgpr_write_b32 a31, v9
    v_accvgpr_read_b32 v6, a32
    v_accvgpr_read_b32 v7, a33
    v_accvgpr_read_b32 v8, a34
    v_accvgpr_read_b32 v9, a35
    v_mul_f32 v6, v6, v5
    v_mul_f32 v7, v7, v5
    v_mul_f32 v8, v8, v5
    v_mul_f32 v9, v9, v5
    v_accvgpr_write_b32 a32, v6
    v_accvgpr_write_b32 a33, v7
    v_accvgpr_write_b32 a34, v8
    v_accvgpr_write_b32 a35, v9
    v_accvgpr_read_b32 v6, a36
    v_accvgpr_read_b32 v7, a37
    v_accvgpr_read_b32 v8, a38
    v_accvgpr_read_b32 v9, a39
    v_mul_f32 v6, v6, v5
    v_mul_f32 v7, v7, v5
    v_mul_f32 v8, v8, v5
    v_mul_f32 v9, v9, v5
    v_accvgpr_write_b32 a36, v6
    v_accvgpr_write_b32 a37, v7
    v_accvgpr_write_b32 a38, v8
    v_accvgpr_write_b32 a39, v9
    v_accvgpr_read_b32 v6, a40
    v_accvgpr_read_b32 v7, a41
    v_accvgpr_read_b32 v8, a42
    v_accvgpr_read_b32 v9, a43
    v_mul_f32 v6, v6, v5
    v_mul_f32 v7, v7, v5
    v_mul_f32 v8, v8, v5
    v_mul_f32 v9, v9, v5
    v_accvgpr_write_b32 a40, v6
    v_accvgpr_write_b32 a41, v7
    v_accvgpr_write_b32 a42, v8
    v_accvgpr_write_b32 a43, v9
    v_accvgpr_read_b32 v6, a44
    v_accvgpr_read_b32 v7, a45
    v_accvgpr_read_b32 v8, a46
    v_accvgpr_read_b32 v9, a47
    v_mul_f32 v6, v6, v5
    v_mul_f32 v7, v7, v5
    v_mul_f32 v8, v8, v5
    v_mul_f32 v9, v9, v5
    v_accvgpr_write_b32 a44, v6
    v_accvgpr_write_b32 a45, v7
    v_accvgpr_write_b32 a46, v8
    v_accvgpr_write_b32 a47, v9
    v_accvgpr_read_b32 v6, a48
    v_accvgpr_read_b32 v7, a49
    v_accvgpr_read_b32 v8, a50
    v_accvgpr_read_b32 v9, a51
    v_mul_f32 v6, v6, v5
    v_mul_f32 v7, v7, v5
    v_mul_f32 v8, v8, v5
    v_mul_f32 v9, v9, v5
    v_accvgpr_write_b32 a48, v6
    v_accvgpr_write_b32 a49, v7
    v_accvgpr_write_b32 a50, v8
    v_accvgpr_write_b32 a51, v9
    v_accvgpr_read_b32 v6, a52
    v_accvgpr_read_b32 v7, a53
    v_accvgpr_read_b32 v8, a54
    v_accvgpr_read_b32 v9, a55
    v_mul_f32 v6, v6, v5
    v_mul_f32 v7, v7, v5
    v_mul_f32 v8, v8, v5
    v_mul_f32 v9, v9, v5
    v_accvgpr_write_b32 a52, v6
    v_accvgpr_write_b32 a53, v7
    v_accvgpr_write_b32 a54, v8
    v_accvgpr_write_b32 a55, v9
    v_accvgpr_read_b32 v6, a56
    v_accvgpr_read_b32 v7, a57
    v_accvgpr_read_b32 v8, a58
    v_accvgpr_read_b32 v9, a59
    v_mul_f32 v6, v6, v5
    v_mul_f32 v7, v7, v5
    v_mul_f32 v8, v8, v5
    v_mul_f32 v9, v9, v5
    v_accvgpr_write_b32 a56, v6
    v_accvgpr_write_b32 a57, v7
    v_accvgpr_write_b32 a58, v8
    v_accvgpr_write_b32 a59, v9
    v_accvgpr_read_b32 v6, a60
    v_accvgpr_read_b32 v7, a61
    v_accvgpr_read_b32 v8, a62
    v_accvgpr_read_b32 v9, a63
    v_mul_f32 v6, v6, v5
    v_mul_f32 v7, v7, v5
    v_mul_f32 v8, v8, v5
    v_mul_f32 v9, v9, v5
    v_accvgpr_write_b32 a60, v6
    v_accvgpr_write_b32 a61, v7
    v_accvgpr_write_b32 a62, v8
    v_accvgpr_write_b32 a63, v9
    v_accvgpr_read_b32 v6, a64
    v_accvgpr_read_b32 v7, a65
    v_accvgpr_read_b32 v8, a66
    v_accvgpr_read_b32 v9, a67
    v_mul_f32 v6, v6, v5
    v_mul_f32 v7, v7, v5
    v_mul_f32 v8, v8, v5
    v_mul_f32 v9, v9, v5
    v_accvgpr_write_b32 a64, v6
    v_accvgpr_write_b32 a65, v7
    v_accvgpr_write_b32 a66, v8
    v_accvgpr_write_b32 a67, v9
    v_accvgpr_read_b32 v6, a68
    v_accvgpr_read_b32 v7, a69
    v_accvgpr_read_b32 v8, a70
    v_accvgpr_read_b32 v9, a71
    v_mul_f32 v6, v6, v5
    v_mul_f32 v7, v7, v5
    v_mul_f32 v8, v8, v5
    v_mul_f32 v9, v9, v5
    v_accvgpr_write_b32 a68, v6
    v_accvgpr_write_b32 a69, v7
    v_accvgpr_write_b32 a70, v8
    v_accvgpr_write_b32 a71, v9
    v_accvgpr_read_b32 v6, a72
    v_accvgpr_read_b32 v7, a73
    v_accvgpr_read_b32 v8, a74
    v_accvgpr_read_b32 v9, a75
    v_mul_f32 v6, v6, v5
    v_mul_f32 v7, v7, v5
    v_mul_f32 v8, v8, v5
    v_mul_f32 v9, v9, v5
    v_accvgpr_write_b32 a72, v6
    v_accvgpr_write_b32 a73, v7
    v_accvgpr_write_b32 a74, v8
    v_accvgpr_write_b32 a75, v9
    v_accvgpr_read_b32 v6, a76
    v_accvgpr_read_b32 v7, a77
    v_accvgpr_read_b32 v8, a78
    v_accvgpr_read_b32 v9, a79
    v_mul_f32 v6, v6, v5
    v_mul_f32 v7, v7, v5
    v_mul_f32 v8, v8, v5
    v_mul_f32 v9, v9, v5
    v_accvgpr_write_b32 a76, v6
    v_accvgpr_write_b32 a77, v7
    v_accvgpr_write_b32 a78, v8
    v_accvgpr_write_b32 a79, v9
    v_exp_f32 v6, v16
    v_exp_f32 v7, v17
    s_nop 0
    v_cvt_pk_bf16_f32 v112, v6, v7
    v_exp_f32 v6, v18
    v_exp_f32 v7, v19
    s_nop 0
    v_cvt_pk_bf16_f32 v113, v6, v7
    v_exp_f32 v6, v20
    v_exp_f32 v7, v21
    s_nop 0
    v_cvt_pk_bf16_f32 v114, v6, v7
    v_exp_f32 v6, v22
    v_exp_f32 v7, v23
    s_nop 0
    v_cvt_pk_bf16_f32 v115, v6, v7
    v_exp_f32 v6, v24
    v_exp_f32 v7, v25
    s_nop 0
    v_cvt_pk_bf16_f32 v116, v6, v7
    v_exp_f32 v6, v26
    v_exp_f32 v7, v27
    s_nop 0
    v_cvt_pk_bf16_f32 v117, v6, v7
    v_exp_f32 v6, v28
    v_exp_f32 v7, v29
    s_nop 0
    v_cvt_pk_bf16_f32 v118, v6, v7
    v_exp_f32 v6, v30
    v_exp_f32 v7, v31
    s_nop 0
    v_cvt_pk_bf16_f32 v119, v6, v7
    v_max3_f32 v4, v32, v33, v34
    v_max3_f32 v4, v4, v35, v36
    v_max3_f32 v4, v4, v37, v38
    v_max3_f32 v4, v4, v39, v40
    v_max3_f32 v4, v4, v41, v42
    v_max3_f32 v4, v4, v43, v44
    v_max3_f32 v4, v4, v45, v46
    v_max_f32 v4, v4, v47
    v_mov_b32 v5, v4
    s_nop 1
    v_permlane32_swap_b32 v4, v5
    s_nop 1
    v_max_f32 v4, v4, v5
    v_add_f32 v4, 0x42200000, v4
    v_max_f32 v4, 0, v4
    v_sub_f32 v5, 0, v4
    v_exp_f32 v5, v5
    v_sub_f32 v32, v32, v4
    v_sub_f32 v64, v64, v4
    v_sub_f32 v96, v96, v4
    v_sub_f32 v33, v33, v4
    v_sub_f32 v65, v65, v4
    v_sub_f32 v97, v97, v4
    v_sub_f32 v34, v34, v4
    v_sub_f32 v66, v66, v4
    v_sub_f32 v98, v98, v4
    v_sub_f32 v35, v35, v4
    v_sub_f32 v67, v67, v4
    v_sub_f32 v99, v99, v4
    v_sub_f32 v36, v36, v4
    v_sub_f32 v68, v68, v4
    v_sub_f32 v100, v100, v4
    v_sub_f32 v37, v37, v4
    v_sub_f32 v69, v69, v4
    v_sub_f32 v101, v101, v4
    v_sub_f32 v38, v38, v4
    v_sub_f32 v70, v70, v4
    v_sub_f32 v102, v102, v4
    v_sub_f32 v39, v39, v4
    v_sub_f32 v71, v71, v4
    v_sub_f32 v103, v103, v4
    v_sub_f32 v40, v40, v4
    v_sub_f32 v72, v72, v4
    v_sub_f32 v104, v104, v4
    v_sub_f32 v41, v41, v4
    v_sub_f32 v73, v73, v4
    v_sub_f32 v105, v105, v4
    v_sub_f32 v42, v42, v4
    v_sub_f32 v74, v74, v4
    v_sub_f32 v106, v106, v4
    v_sub_f32 v43, v43, v4
    v_sub_f32 v75, v75, v4
    v_sub_f32 v107, v107, v4
    v_sub_f32 v44, v44, v4
    v_sub_f32 v76, v76, v4
    v_sub_f32 v108, v108, v4
    v_sub_f32 v45, v45, v4
    v_sub_f32 v77, v77, v4
    v_sub_f32 v109, v109, v4
    v_sub_f32 v46, v46, v4
    v_sub_f32 v78, v78, v4
    v_sub_f32 v110, v110, v4
    v_sub_f32 v47, v47, v4
    v_sub_f32 v79, v79, v4
    v_sub_f32 v111, v111, v4
    v_accvgpr_read_b32 v6, a80
    v_accvgpr_read_b32 v7, a81
    v_accvgpr_read_b32 v8, a82
    v_accvgpr_read_b32 v9, a83
    v_mul_f32 v6, v6, v5
    v_mul_f32 v7, v7, v5
    v_mul_f32 v8, v8, v5
    v_mul_f32 v9, v9, v5
    v_accvgpr_write_b32 a80, v6
    v_accvgpr_write_b32 a81, v7
    v_accvgpr_write_b32 a82, v8
    v_accvgpr_write_b32 a83, v9
    v_accvgpr_read_b32 v6, a84
    v_accvgpr_read_b32 v7, a85
    v_accvgpr_read_b32 v8, a86
    v_accvgpr_read_b32 v9, a87
    v_mul_f32 v6, v6, v5
    v_mul_f32 v7, v7, v5
    v_mul_f32 v8, v8, v5
    v_mul_f32 v9, v9, v5
    v_accvgpr_write_b32 a84, v6
    v_accvgpr_write_b32 a85, v7
    v_accvgpr_write_b32 a86, v8
    v_accvgpr_write_b32 a87, v9
    v_accvgpr_read_b32 v6, a88
    v_accvgpr_read_b32 v7, a89
    v_accvgpr_read_b32 v8, a90
    v_accvgpr_read_b32 v9, a91
    v_mul_f32 v6, v6, v5
    v_mul_f32 v7, v7, v5
    v_mul_f32 v8, v8, v5
    v_mul_f32 v9, v9, v5
    v_accvgpr_write_b32 a88, v6
    v_accvgpr_write_b32 a89, v7
    v_accvgpr_write_b32 a90, v8
    v_accvgpr_write_b32 a91, v9
    v_accvgpr_read_b32 v6, a92
    v_accvgpr_read_b32 v7, a93
    v_accvgpr_read_b32 v8, a94
    v_accvgpr_read_b32 v9, a95
    v_mul_f32 v6, v6, v5
    v_mul_f32 v7, v7, v5
    v_mul_f32 v8, v8, v5
    v_mul_f32 v9, v9, v5
    v_accvgpr_write_b32 a92, v6
    v_accvgpr_write_b32 a93, v7
    v_accvgpr_write_b32 a94, v8
    v_accvgpr_write_b32 a95, v9
    v_accvgpr_read_b32 v6, a96
    v_accvgpr_read_b32 v7, a97
    v_accvgpr_read_b32 v8, a98
    v_accvgpr_read_b32 v9, a99
    v_mul_f32 v6, v6, v5
    v_mul_f32 v7, v7, v5
    v_mul_f32 v8, v8, v5
    v_mul_f32 v9, v9, v5
    v_accvgpr_write_b32 a96, v6
    v_accvgpr_write_b32 a97, v7
    v_accvgpr_write_b32 a98, v8
    v_accvgpr_write_b32 a99, v9
    v_accvgpr_read_b32 v6, a100
    v_accvgpr_read_b32 v7, a101
    v_accvgpr_read_b32 v8, a102
    v_accvgpr_read_b32 v9, a103
    v_mul_f32 v6, v6, v5
    v_mul_f32 v7, v7, v5
    v_mul_f32 v8, v8, v5
    v_mul_f32 v9, v9, v5
    v_accvgpr_write_b32 a100, v6
    v_accvgpr_write_b32 a101, v7
    v_accvgpr_write_b32 a102, v8
    v_accvgpr_write_b32 a103, v9
    v_accvgpr_read_b32 v6, a104
    v_accvgpr_read_b32 v7, a105
    v_accvgpr_read_b32 v8, a106
    v_accvgpr_read_b32 v9, a107
    v_mul_f32 v6, v6, v5
    v_mul_f32 v7, v7, v5
    v_mul_f32 v8, v8, v5
    v_mul_f32 v9, v9, v5
    v_accvgpr_write_b32 a104, v6
    v_accvgpr_write_b32 a105, v7
    v_accvgpr_write_b32 a106, v8
    v_accvgpr_write_b32 a107, v9
    v_accvgpr_read_b32 v6, a108
    v_accvgpr_read_b32 v7, a109
    v_accvgpr_read_b32 v8, a110
    v_accvgpr_read_b32 v9, a111
    v_mul_f32 v6, v6, v5
    v_mul_f32 v7, v7, v5
    v_mul_f32 v8, v8, v5
    v_mul_f32 v9, v9, v5
    v_accvgpr_write_b32 a108, v6
    v_accvgpr_write_b32 a109, v7
    v_accvgpr_write_b32 a110, v8
    v_accvgpr_write_b32 a111, v9
    v_accvgpr_read_b32 v6, a112
    v_accvgpr_read_b32 v7, a113
    v_accvgpr_read_b32 v8, a114
    v_accvgpr_read_b32 v9, a115
    v_mul_f32 v6, v6, v5
    v_mul_f32 v7, v7, v5
    v_mul_f32 v8, v8, v5
    v_mul_f32 v9, v9, v5
    v_accvgpr_write_b32 a112, v6
    v_accvgpr_write_b32 a113, v7
    v_accvgpr_write_b32 a114, v8
    v_accvgpr_write_b32 a115, v9
    v_accvgpr_read_b32 v6, a116
    v_accvgpr_read_b32 v7, a117
    v_accvgpr_read_b32 v8, a118
    v_accvgpr_read_b32 v9, a119
    v_mul_f32 v6, v6, v5
    v_mul_f32 v7, v7, v5
    v_mul_f32 v8, v8, v5
    v_mul_f32 v9, v9, v5
    v_accvgpr_write_b32 a116, v6
    v_accvgpr_write_b32 a117, v7
    v_accvgpr_write_b32 a118, v8
    v_accvgpr_write_b32 a119, v9
    v_accvgpr_read_b32 v6, a120
    v_accvgpr_read_b32 v7, a121
    v_accvgpr_read_b32 v8, a122
    v_accvgpr_read_b32 v9, a123
    v_mul_f32 v6, v6, v5
    v_mul_f32 v7, v7, v5
    v_mul_f32 v8, v8, v5
    v_mul_f32 v9, v9, v5
    v_accvgpr_write_b32 a120, v6
    v_accvgpr_write_b32 a121, v7
    v_accvgpr_write_b32 a122, v8
    v_accvgpr_write_b32 a123, v9
    v_accvgpr_read_b32 v6, a124
    v_accvgpr_read_b32 v7, a125
    v_accvgpr_read_b32 v8, a126
    v_accvgpr_read_b32 v9, a127
    v_mul_f32 v6, v6, v5
    v_mul_f32 v7, v7, v5
    v_mul_f32 v8, v8, v5
    v_mul_f32 v9, v9, v5
    v_accvgpr_write_b32 a124, v6
    v_accvgpr_write_b32 a125, v7
    v_accvgpr_write_b32 a126, v8
    v_accvgpr_write_b32 a127, v9
    v_accvgpr_read_b32 v6, a128
    v_accvgpr_read_b32 v7, a129
    v_accvgpr_read_b32 v8, a130
    v_accvgpr_read_b32 v9, a131
    v_mul_f32 v6, v6, v5
    v_mul_f32 v7, v7, v5
    v_mul_f32 v8, v8, v5
    v_mul_f32 v9, v9, v5
    v_accvgpr_write_b32 a128, v6
    v_accvgpr_write_b32 a129, v7
    v_accvgpr_write_b32 a130, v8
    v_accvgpr_write_b32 a131, v9
    v_accvgpr_read_b32 v6, a132
    v_accvgpr_read_b32 v7, a133
    v_accvgpr_read_b32 v8, a134
    v_accvgpr_read_b32 v9, a135
    v_mul_f32 v6, v6, v5
    v_mul_f32 v7, v7, v5
    v_mul_f32 v8, v8, v5
    v_mul_f32 v9, v9, v5
    v_accvgpr_write_b32 a132, v6
    v_accvgpr_write_b32 a133, v7
    v_accvgpr_write_b32 a134, v8
    v_accvgpr_write_b32 a135, v9
    v_accvgpr_read_b32 v6, a136
    v_accvgpr_read_b32 v7, a137
    v_accvgpr_read_b32 v8, a138
    v_accvgpr_read_b32 v9, a139
    v_mul_f32 v6, v6, v5
    v_mul_f32 v7, v7, v5
    v_mul_f32 v8, v8, v5
    v_mul_f32 v9, v9, v5
    v_accvgpr_write_b32 a136, v6
    v_accvgpr_write_b32 a137, v7
    v_accvgpr_write_b32 a138, v8
    v_accvgpr_write_b32 a139, v9
    v_accvgpr_read_b32 v6, a140
    v_accvgpr_read_b32 v7, a141
    v_accvgpr_read_b32 v8, a142
    v_accvgpr_read_b32 v9, a143
    v_mul_f32 v6, v6, v5
    v_mul_f32 v7, v7, v5
    v_mul_f32 v8, v8, v5
    v_mul_f32 v9, v9, v5
    v_accvgpr_write_b32 a140, v6
    v_accvgpr_write_b32 a141, v7
    v_accvgpr_write_b32 a142, v8
    v_accvgpr_write_b32 a143, v9
    v_accvgpr_read_b32 v6, a144
    v_accvgpr_read_b32 v7, a145
    v_accvgpr_read_b32 v8, a146
    v_accvgpr_read_b32 v9, a147
    v_mul_f32 v6, v6, v5
    v_mul_f32 v7, v7, v5
    v_mul_f32 v8, v8, v5
    v_mul_f32 v9, v9, v5
    v_accvgpr_write_b32 a144, v6
    v_accvgpr_write_b32 a145, v7
    v_accvgpr_write_b32 a146, v8
    v_accvgpr_write_b32 a147, v9
    v_accvgpr_read_b32 v6, a148
    v_accvgpr_read_b32 v7, a149
    v_accvgpr_read_b32 v8, a150
    v_accvgpr_read_b32 v9, a151
    v_mul_f32 v6, v6, v5
    v_mul_f32 v7, v7, v5
    v_mul_f32 v8, v8, v5
    v_mul_f32 v9, v9, v5
    v_accvgpr_write_b32 a148, v6
    v_accvgpr_write_b32 a149, v7
    v_accvgpr_write_b32 a150, v8
    v_accvgpr_write_b32 a151, v9
    v_accvgpr_read_b32 v6, a152
    v_accvgpr_read_b32 v7, a153
    v_accvgpr_read_b32 v8, a154
    v_accvgpr_read_b32 v9, a155
    v_mul_f32 v6, v6, v5
    v_mul_f32 v7, v7, v5
    v_mul_f32 v8, v8, v5
    v_mul_f32 v9, v9, v5
    v_accvgpr_write_b32 a152, v6
    v_accvgpr_write_b32 a153, v7
    v_accvgpr_write_b32 a154, v8
    v_accvgpr_write_b32 a155, v9
    v_accvgpr_read_b32 v6, a156
    v_accvgpr_read_b32 v7, a157
    v_accvgpr_read_b32 v8, a158
    v_accvgpr_read_b32 v9, a159
    v_mul_f32 v6, v6, v5
    v_mul_f32 v7, v7, v5
    v_mul_f32 v8, v8, v5
    v_mul_f32 v9, v9, v5
    v_accvgpr_write_b32 a156, v6
    v_accvgpr_write_b32 a157, v7
    v_accvgpr_write_b32 a158, v8
    v_accvgpr_write_b32 a159, v9
    v_exp_f32 v6, v32
    v_exp_f32 v7, v33
    s_nop 0
    v_cvt_pk_bf16_f32 v120, v6, v7
    v_exp_f32 v6, v34
    v_exp_f32 v7, v35
    s_nop 0
    v_cvt_pk_bf16_f32 v121, v6, v7
    v_exp_f32 v6, v36
    v_exp_f32 v7, v37
    s_nop 0
    v_cvt_pk_bf16_f32 v122, v6, v7
    v_exp_f32 v6, v38
    v_exp_f32 v7, v39
    s_nop 0
    v_cvt_pk_bf16_f32 v123, v6, v7
    v_exp_f32 v6, v40
    v_exp_f32 v7, v41
    s_nop 0
    v_cvt_pk_bf16_f32 v124, v6, v7
    v_exp_f32 v6, v42
    v_exp_f32 v7, v43
    s_nop 0
    v_cvt_pk_bf16_f32 v125, v6, v7
    v_exp_f32 v6, v44
    v_exp_f32 v7, v45
    s_nop 0
    v_cvt_pk_bf16_f32 v126, v6, v7
    v_exp_f32 v6, v46
    v_exp_f32 v7, v47
    s_nop 0
    v_cvt_pk_bf16_f32 v127, v6, v7
    s_nop 7
    s_branch L_k2_ret2
L_k2_rare3:
    s_nop 15
    v_max3_f32 v4, v48, v49, v50
    v_max3_f32 v4, v4, v51, v52
    v_max3_f32 v4, v4, v53, v54
    v_max3_f32 v4, v4, v55, v56
    v_max3_f32 v4, v4, v57, v58
    v_max3_f32 v4, v4, v59, v60
    v_max3_f32 v4, v4, v61, v62
    v_max_f32 v4, v4, v63
    v_mov_b32 v5, v4
    s_nop 1
    v_permlane32_swap_b32 v4, v5
    s_nop 1
    v_max_f32 v4, v4, v5
    v_add_f32 v4, 0x42200000, v4
    v_max_f32 v4, 0, v4
    v_sub_f32 v5, 0, v4
    v_exp_f32 v5, v5
    v_sub_f32 v48, v48, v4
    v_sub_f32 v16, v16, v4
    v_sub_f32 v80, v80, v4
    v_sub_f32 v49, v49, v4
    v_sub_f32 v17, v17, v4
    v_sub_f32 v81, v81, v4
    v_sub_f32 v50, v50, v4
    v_sub_f32 v18, v18, v4
    v_sub_f32 v82, v82, v4
    v_sub_f32 v51, v51, v4
    v_sub_f32 v19, v19, v4
    v_sub_f32 v83, v83, v4
    v_sub_f32 v52, v52, v4
    v_sub_f32 v20, v20, v4
    v_sub_f32 v84, v84, v4
    v_sub_f32 v53, v53, v4
    v_sub_f32 v21, v21, v4
    v_sub_f32 v85, v85, v4
    v_sub_f32 v54, v54, v4
    v_sub_f32 v22, v22, v4
    v_sub_f32 v86, v86, v4
    v_sub_f32 v55, v55, v4
    v_sub_f32 v23, v23, v4
    v_sub_f32 v87, v87, v4
    v_sub_f32 v56, v56, v4
    v_sub_f32 v24, v24, v4
    v_sub_f32 v88, v88, v4
    v_sub_f32 v57, v57, v4
    v_sub_f32 v25, v25, v4
    v_sub_f32 v89, v89, v4
    v_sub_f32 v58, v58, v4
    v_sub_f32 v26, v26, v4
    v_sub_f32 v90, v90, v4
    v_sub_f32 v59, v59, v4
    v_sub_f32 v27, v27, v4
    v_sub_f32 v91, v91, v4
    v_sub_f32 v60, v60, v4
    v_sub_f32 v28, v28, v4
    v_sub_f32 v92, v92, v4
    v_sub_f32 v61, v61, v4
    v_sub_f32 v29, v29, v4
    v_sub_f32 v93, v93, v4
    v_sub_f32 v62, v62, v4
    v_sub_f32 v30, v30, v4
    v_sub_f32 v94, v94, v4
    v_sub_f32 v63, v63, v4
    v_sub_f32 v31, v31, v4
    v_sub_f32 v95, v95, v4
    v_accvgpr_read_b32 v6, a0
    v_accvgpr_read_b32 v7, a1
    v_accvgpr_read_b32 v8, a2
    v_accvgpr_read_b32 v9, a3
    v_mul_f32 v6, v6, v5
    v_mul_f32 v7, v7, v5
    v_mul_f32 v8, v8, v5
    v_mul_f32 v9, v9, v5
    v_accvgpr_write_b32 a0, v6
    v_accvgpr_write_b32 a1, v7
    v_accvgpr_write_b32 a2, v8
    v_accvgpr_write_b32 a3, v9
    v_accvgpr_read_b32 v6, a4
    v_accvgpr_read_b32 v7, a5
    v_accvgpr_read_b32 v8, a6
    v_accvgpr_read_b32 v9, a7
    v_mul_f32 v6, v6, v5
    v_mul_f32 v7, v7, v5
    v_mul_f32 v8, v8, v5
    v_mul_f32 v9, v9, v5
    v_accvgpr_write_b32 a4, v6
    v_accvgpr_write_b32 a5, v7
    v_accvgpr_write_b32 a6, v8
    v_accvgpr_write_b32 a7, v9
    v_accvgpr_read_b32 v6, a8
    v_accvgpr_read_b32 v7, a9
    v_accvgpr_read_b32 v8, a10
    v_accvgpr_read_b32 v9, a11
    v_mul_f32 v6, v6, v5
    v_mul_f32 v7, v7, v5
    v_mul_f32 v8, v8, v5
    v_mul_f32 v9, v9, v5
    v_accvgpr_write_b32 a8, v6
    v_accvgpr_write_b32 a9, v7
    v_accvgpr_write_b32 a10, v8
    v_accvgpr_write_b32 a11, v9
    v_accvgpr_read_b32 v6, a12
    v_accvgpr_read_b32 v7, a13
    v_accvgpr_read_b32 v8, a14
    v_accvgpr_read_b32 v9, a15
    v_mul_f32 v6, v6, v5
    v_mul_f32 v7, v7, v5
    v_mul_f32 v8, v8, v5
    v_mul_f32 v9, v9, v5
    v_accvgpr_write_b32 a12, v6
    v_accvgpr_write_b32 a13, v7
    v_accvgpr_write_b32 a14, v8
    v_accvgpr_write_b32 a15, v9
    v_accvgpr_read_b32 v6, a16
    v_accvgpr_read_b32 v7, a17
    v_accvgpr_read_b32 v8, a18
    v_accvgpr_read_b32 v9, a19
    v_mul_f32 v6, v6, v5
    v_mul_f32 v7, v7, v5
    v_mul_f32 v8, v8, v5
    v_mul_f32 v9, v9, v5
    v_accvgpr_write_b32 a16, v6
    v_accvgpr_write_b32 a17, v7
    v_accvgpr_write_b32 a18, v8
    v_accvgpr_write_b32 a19, v9
    v_accvgpr_read_b32 v6, a20
    v_accvgpr_read_b32 v7, a21
    v_accvgpr_read_b32 v8, a22
    v_accvgpr_read_b32 v9, a23
    v_mul_f32 v6, v6, v5
    v_mul_f32 v7, v7, v5
    v_mul_f32 v8, v8, v5
    v_mul_f32 v9, v9, v5
    v_accvgpr_write_b32 a20, v6
    v_accvgpr_write_b32 a21, v7
    v_accvgpr_write_b32 a22, v8
    v_accvgpr_write_b32 a23, v9
    v_accvgpr_read_b32 v6, a24
    v_accvgpr_read_b32 v7, a25
    v_accvgpr_read_b32 v8, a26
    v_accvgpr_read_b32 v9, a27
    v_mul_f32 v6, v6, v5
    v_mul_f32 v7, v7, v5
    v_mul_f32 v8, v8, v5
    v_mul_f32 v9, v9, v5
    v_accvgpr_write_b32 a24, v6
    v_accvgpr_write_b32 a25, v7
    v_accvgpr_write_b32 a26, v8
    v_accvgpr_write_b32 a27, v9
    v_accvgpr_read_b32 v6, a28
    v_accvgpr_read_b32 v7, a29
    v_accvgpr_read_b32 v8, a30
    v_accvgpr_read_b32 v9, a31
    v_mul_f32 v6, v6, v5
    v_mul_f32 v7, v7, v5
    v_mul_f32 v8, v8, v5
    v_mul_f32 v9, v9, v5
    v_accvgpr_write_b32 a28, v6
    v_accvgpr_write_b32 a29, v7
    v_accvgpr_write_b32 a30, v8
    v_accvgpr_write_b32 a31, v9
    v_accvgpr_read_b32 v6, a32
    v_accvgpr_read_b32 v7, a33
    v_accvgpr_read_b32 v8, a34
    v_accvgpr_read_b32 v9, a35
    v_mul_f32 v6, v6, v5
    v_mul_f32 v7, v7, v5
    v_mul_f32 v8, v8, v5
    v_mul_f32 v9, v9, v5
    v_accvgpr_write_b32 a32, v6
    v_accvgpr_write_b32 a33, v7
    v_accvgpr_write_b32 a34, v8
    v_accvgpr_write_b32 a35, v9
    v_accvgpr_read_b32 v6, a36
    v_accvgpr_read_b32 v7, a37
    v_accvgpr_read_b32 v8, a38
    v_accvgpr_read_b32 v9, a39
    v_mul_f32 v6, v6, v5
    v_mul_f32 v7, v7, v5
    v_mul_f32 v8, v8, v5
    v_mul_f32 v9, v9, v5
    v_accvgpr_write_b32 a36, v6
    v_accvgpr_write_b32 a37, v7
    v_accvgpr_write_b32 a38, v8
    v_accvgpr_write_b32 a39, v9
    v_accvgpr_read_b32 v6, a40
    v_accvgpr_read_b32 v7, a41
    v_accvgpr_read_b32 v8, a42
    v_accvgpr_read_b32 v9, a43
    v_mul_f32 v6, v6, v5
    v_mul_f32 v7, v7, v5
    v_mul_f32 v8, v8, v5
    v_mul_f32 v9, v9, v5
    v_accvgpr_write_b32 a40, v6
    v_accvgpr_write_b32 a41, v7
    v_accvgpr_write_b32 a42, v8
    v_accvgpr_write_b32 a43, v9
    v_accvgpr_read_b32 v6, a44
    v_accvgpr_read_b32 v7, a45
    v_accvgpr_read_b32 v8, a46
    v_accvgpr_read_b32 v9, a47
    v_mul_f32 v6, v6, v5
    v_mul_f32 v7, v7, v5
    v_mul_f32 v8, v8, v5
    v_mul_f32 v9, v9, v5
    v_accvgpr_write_b32 a44, v6
    v_accvgpr_write_b32 a45, v7
    v_accvgpr_write_b32 a46, v8
    v_accvgpr_write_b32 a47, v9
    v_accvgpr_read_b32 v6, a48
    v_accvgpr_read_b32 v7, a49
    v_accvgpr_read_b32 v8, a50
    v_accvgpr_read_b32 v9, a51
    v_mul_f32 v6, v6, v5
    v_mul_f32 v7, v7, v5
    v_mul_f32 v8, v8, v5
    v_mul_f32 v9, v9, v5
    v_accvgpr_write_b32 a48, v6
    v_accvgpr_write_b32 a49, v7
    v_accvgpr_write_b32 a50, v8
    v_accvgpr_write_b32 a51, v9
    v_accvgpr_read_b32 v6, a52
    v_accvgpr_read_b32 v7, a53
    v_accvgpr_read_b32 v8, a54
    v_accvgpr_read_b32 v9, a55
    v_mul_f32 v6, v6, v5
    v_mul_f32 v7, v7, v5
    v_mul_f32 v8, v8, v5
    v_mul_f32 v9, v9, v5
    v_accvgpr_write_b32 a52, v6
    v_accvgpr_write_b32 a53, v7
    v_accvgpr_write_b32 a54, v8
    v_accvgpr_write_b32 a55, v9
    v_accvgpr_read_b32 v6, a56
    v_accvgpr_read_b32 v7, a57
    v_accvgpr_read_b32 v8, a58
    v_accvgpr_read_b32 v9, a59
    v_mul_f32 v6, v6, v5
    v_mul_f32 v7, v7, v5
    v_mul_f32 v8, v8, v5
    v_mul_f32 v9, v9, v5
    v_accvgpr_write_b32 a56, v6
    v_accvgpr_write_b32 a57, v7
    v_accvgpr_write_b32 a58, v8
    v_accvgpr_write_b32 a59, v9
    v_accvgpr_read_b32 v6, a60
    v_accvgpr_read_b32 v7, a61
    v_accvgpr_read_b32 v8, a62
    v_accvgpr_read_b32 v9, a63
    v_mul_f32 v6, v6, v5
    v_mul_f32 v7, v7, v5
    v_mul_f32 v8, v8, v5
    v_mul_f32 v9, v9, v5
    v_accvgpr_write_b32 a60, v6
    v_accvgpr_write_b32 a61, v7
    v_accvgpr_write_b32 a62, v8
    v_accvgpr_write_b32 a63, v9
    v_accvgpr_read_b32 v6, a64
    v_accvgpr_read_b32 v7, a65
    v_accvgpr_read_b32 v8, a66
    v_accvgpr_read_b32 v9, a67
    v_mul_f32 v6, v6, v5
    v_mul_f32 v7, v7, v5
    v_mul_f32 v8, v8, v5
    v_mul_f32 v9, v9, v5
    v_accvgpr_write_b32 a64, v6
    v_accvgpr_write_b32 a65, v7
    v_accvgpr_write_b32 a66, v8
    v_accvgpr_write_b32 a67, v9
    v_accvgpr_read_b32 v6, a68
    v_accvgpr_read_b32 v7, a69
    v_accvgpr_read_b32 v8, a70
    v_accvgpr_read_b32 v9, a71
    v_mul_f32 v6, v6, v5
    v_mul_f32 v7, v7, v5
    v_mul_f32 v8, v8, v5
    v_mul_f32 v9, v9, v5
    v_accvgpr_write_b32 a68, v6
    v_accvgpr_write_b32 a69, v7
    v_accvgpr_write_b32 a70, v8
    v_accvgpr_write_b32 a71, v9
    v_accvgpr_read_b32 v6, a72
    v_accvgpr_read_b32 v7, a73
    v_accvgpr_read_b32 v8, a74
    v_accvgpr_read_b32 v9, a75
    v_mul_f32 v6, v6, v5
    v_mul_f32 v7, v7, v5
    v_mul_f32 v8, v8, v5
    v_mul_f32 v9, v9, v5
    v_accvgpr_write_b32 a72, v6
    v_accvgpr_write_b32 a73, v7
    v_accvgpr_write_b32 a74, v8
    v_accvgpr_write_b32 a75, v9
    v_accvgpr_read_b32 v6, a76
    v_accvgpr_read_b32 v7, a77
    v_accvgpr_read_b32 v8, a78
    v_accvgpr_read_b32 v9, a79
    v_mul_f32 v6, v6, v5
    v_mul_f32 v7, v7, v5
    v_mul_f32 v8, v8, v5
    v_mul_f32 v9, v9, v5
    v_accvgpr_write_b32 a76, v6
    v_accvgpr_write_b32 a77, v7
    v_accvgpr_write_b32 a78, v8
    v_accvgpr_write_b32 a79, v9
    v_exp_f32 v6, v48
    v_exp_f32 v7, v49
    s_nop 0
    v_cvt_pk_bf16_f32 v128, v6, v7
    v_exp_f32 v6, v50
    v_exp_f32 v7, v51
    s_nop 0
    v_cvt_pk_bf16_f32 v129, v6, v7
    v_exp_f32 v6, v52
    v_exp_f32 v7, v53
    s_nop 0
    v_cvt_pk_bf16_f32 v130, v6, v7
    v_exp_f32 v6, v54
    v_exp_f32 v7, v55
    s_nop 0
    v_cvt_pk_bf16_f32 v131, v6, v7
    v_exp_f32 v6, v56
    v_exp_f32 v7, v57
    s_nop 0
    v_cvt_pk_bf16_f32 v132, v6, v7
    v_exp_f32 v6, v58
    v_exp_f32 v7, v59
    s_nop 0
    v_cvt_pk_bf16_f32 v133, v6, v7
    v_exp_f32 v6, v60
    v_exp_f32 v7, v61
    s_nop 0
    v_cvt_pk_bf16_f32 v134, v6, v7
    v_exp_f32 v6, v62
    v_exp_f32 v7, v63
    s_nop 0
    v_cvt_pk_bf16_f32 v135, v6, v7
    v_max3_f32 v4, v64, v65, v66
    v_max3_f32 v4, v4, v67, v68
    v_max3_f32 v4, v4, v69, v70
    v_max3_f32 v4, v4, v71, v72
    v_max3_f32 v4, v4, v73, v74
    v_max3_f32 v4, v4, v75, v76
    v_max3_f32 v4, v4, v77, v78
    v_max_f32 v4, v4, v79
    v_mov_b32 v5, v4
    s_nop 1
    v_permlane32_swap_b32 v4, v5
    s_nop 1
    v_max_f32 v4, v4, v5
    v_add_f32 v4, 0x42200000, v4
    v_max_f32 v4, 0, v4
    v_sub_f32 v5, 0, v4
    v_exp_f32 v5, v5
    v_sub_f32 v64, v64, v4
    v_sub_f32 v32, v32, v4
    v_sub_f32 v96, v96, v4
    v_sub_f32 v65, v65, v4
    v_sub_f32 v33, v33, v4
    v_sub_f32 v97, v97, v4
    v_sub_f32 v66, v66, v4
    v_sub_f32 v34, v34, v4
    v_sub_f32 v98, v98, v4
    v_sub_f32 v67, v67, v4
    v_sub_f32 v35, v35, v4
    v_sub_f32 v99, v99, v4
    v_sub_f32 v68, v68, v4
    v_sub_f32 v36, v36, v4
    v_sub_f32 v100, v100, v4
    v_sub_f32 v69, v69, v4
    v_sub_f32 v37, v37, v4
    v_sub_f32 v101, v101, v4
    v_sub_f32 v70, v70, v4
    v_sub_f32 v38, v38, v4
    v_sub_f32 v102, v102, v4
    v_sub_f32 v71, v71, v4
    v_sub_f32 v39, v39, v4
    v_sub_f32 v103, v103, v4
    v_sub_f32 v72, v72, v4
    v_sub_f32 v40, v40, v4
    v_sub_f32 v104, v104, v4
    v_sub_f32 v73, v73, v4
    v_sub_f32 v41, v41, v4
    v_sub_f32 v105, v105, v4
    v_sub_f32 v74, v74, v4
    v_sub_f32 v42, v42, v4
    v_sub_f32 v106, v106, v4
    v_sub_f32 v75, v75, v4
    v_sub_f32 v43, v43, v4
    v_sub_f32 v107, v107, v4
    v_sub_f32 v76, v76, v4
    v_sub_f32 v44, v44, v4
    v_sub_f32 v108, v108, v4
    v_sub_f32 v77, v77, v4
    v_sub_f32 v45, v45, v4
    v_sub_f32 v109, v109, v4
    v_sub_f32 v78, v78, v4
    v_sub_f32 v46, v46, v4
    v_sub_f32 v110, v110, v4
    v_sub_f32 v79, v79, v4
    v_sub_f32 v47, v47, v4
    v_sub_f32 v111, v111, v4
    v_accvgpr_read_b32 v6, a80
    v_accvgpr_read_b32 v7, a81
    v_accvgpr_read_b32 v8, a82
    v_accvgpr_read_b32 v9, a83
    v_mul_f32 v6, v6, v5
    v_mul_f32 v7, v7, v5
    v_mul_f32 v8, v8, v5
    v_mul_f32 v9, v9, v5
    v_accvgpr_write_b32 a80, v6
    v_accvgpr_write_b32 a81, v7
    v_accvgpr_write_b32 a82, v8
    v_accvgpr_write_b32 a83, v9
    v_accvgpr_read_b32 v6, a84
    v_accvgpr_read_b32 v7, a85
    v_accvgpr_read_b32 v8, a86
    v_accvgpr_read_b32 v9, a87
    v_mul_f32 v6, v6, v5
    v_mul_f32 v7, v7, v5
    v_mul_f32 v8, v8, v5
    v_mul_f32 v9, v9, v5
    v_accvgpr_write_b32 a84, v6
    v_accvgpr_write_b32 a85, v7
    v_accvgpr_write_b32 a86, v8
    v_accvgpr_write_b32 a87, v9
    v_accvgpr_read_b32 v6, a88
    v_accvgpr_read_b32 v7, a89
    v_accvgpr_read_b32 v8, a90
    v_accvgpr_read_b32 v9, a91
    v_mul_f32 v6, v6, v5
    v_mul_f32 v7, v7, v5
    v_mul_f32 v8, v8, v5
    v_mul_f32 v9, v9, v5
    v_accvgpr_write_b32 a88, v6
    v_accvgpr_write_b32 a89, v7
    v_accvgpr_write_b32 a90, v8
    v_accvgpr_write_b32 a91, v9
    v_accvgpr_read_b32 v6, a92
    v_accvgpr_read_b32 v7, a93
    v_accvgpr_read_b32 v8, a94
    v_accvgpr_read_b32 v9, a95
    v_mul_f32 v6, v6, v5
    v_mul_f32 v7, v7, v5
    v_mul_f32 v8, v8, v5
    v_mul_f32 v9, v9, v5
    v_accvgpr_write_b32 a92, v6
    v_accvgpr_write_b32 a93, v7
    v_accvgpr_write_b32 a94, v8
    v_accvgpr_write_b32 a95, v9
    v_accvgpr_read_b32 v6, a96
    v_accvgpr_read_b32 v7, a97
    v_accvgpr_read_b32 v8, a98
    v_accvgpr_read_b32 v9, a99
    v_mul_f32 v6, v6, v5
    v_mul_f32 v7, v7, v5
    v_mul_f32 v8, v8, v5
    v_mul_f32 v9, v9, v5
    v_accvgpr_write_b32 a96, v6
    v_accvgpr_write_b32 a97, v7
    v_accvgpr_write_b32 a98, v8
    v_accvgpr_write_b32 a99, v9
    v_accvgpr_read_b32 v6, a100
    v_accvgpr_read_b32 v7, a101
    v_accvgpr_read_b32 v8, a102
    v_accvgpr_read_b32 v9, a103
    v_mul_f32 v6, v6, v5
    v_mul_f32 v7, v7, v5
    v_mul_f32 v8, v8, v5
    v_mul_f32 v9, v9, v5
    v_accvgpr_write_b32 a100, v6
    v_accvgpr_write_b32 a101, v7
    v_accvgpr_write_b32 a102, v8
    v_accvgpr_write_b32 a103, v9
    v_accvgpr_read_b32 v6, a104
    v_accvgpr_read_b32 v7, a105
    v_accvgpr_read_b32 v8, a106
    v_accvgpr_read_b32 v9, a107
    v_mul_f32 v6, v6, v5
    v_mul_f32 v7, v7, v5
    v_mul_f32 v8, v8, v5
    v_mul_f32 v9, v9, v5
    v_accvgpr_write_b32 a104, v6
    v_accvgpr_write_b32 a105, v7
    v_accvgpr_write_b32 a106, v8
    v_accvgpr_write_b32 a107, v9
    v_accvgpr_read_b32 v6, a108
    v_accvgpr_read_b32 v7, a109
    v_accvgpr_read_b32 v8, a110
    v_accvgpr_read_b32 v9, a111
    v_mul_f32 v6, v6, v5
    v_mul_f32 v7, v7, v5
    v_mul_f32 v8, v8, v5
    v_mul_f32 v9, v9, v5
    v_accvgpr_write_b32 a108, v6
    v_accvgpr_write_b32 a109, v7
    v_accvgpr_write_b32 a110, v8
    v_accvgpr_write_b32 a111, v9
    v_accvgpr_read_b32 v6, a112
    v_accvgpr_read_b32 v7, a113
    v_accvgpr_read_b32 v8, a114
    v_accvgpr_read_b32 v9, a115
    v_mul_f32 v6, v6, v5
    v_mul_f32 v7, v7, v5
    v_mul_f32 v8, v8, v5
    v_mul_f32 v9, v9, v5
    v_accvgpr_write_b32 a112, v6
    v_accvgpr_write_b32 a113, v7
    v_accvgpr_write_b32 a114, v8
    v_accvgpr_write_b32 a115, v9
    v_accvgpr_read_b32 v6, a116
    v_accvgpr_read_b32 v7, a117
    v_accvgpr_read_b32 v8, a118
    v_accvgpr_read_b32 v9, a119
    v_mul_f32 v6, v6, v5
    v_mul_f32 v7, v7, v5
    v_mul_f32 v8, v8, v5
    v_mul_f32 v9, v9, v5
    v_accvgpr_write_b32 a116, v6
    v_accvgpr_write_b32 a117, v7
    v_accvgpr_write_b32 a118, v8
    v_accvgpr_write_b32 a119, v9
    v_accvgpr_read_b32 v6, a120
    v_accvgpr_read_b32 v7, a121
    v_accvgpr_read_b32 v8, a122
    v_accvgpr_read_b32 v9, a123
    v_mul_f32 v6, v6, v5
    v_mul_f32 v7, v7, v5
    v_mul_f32 v8, v8, v5
    v_mul_f32 v9, v9, v5
    v_accvgpr_write_b32 a120, v6
    v_accvgpr_write_b32 a121, v7
    v_accvgpr_write_b32 a122, v8
    v_accvgpr_write_b32 a123, v9
    v_accvgpr_read_b32 v6, a124
    v_accvgpr_read_b32 v7, a125
    v_accvgpr_read_b32 v8, a126
    v_accvgpr_read_b32 v9, a127
    v_mul_f32 v6, v6, v5
    v_mul_f32 v7, v7, v5
    v_mul_f32 v8, v8, v5
    v_mul_f32 v9, v9, v5
    v_accvgpr_write_b32 a124, v6
    v_accvgpr_write_b32 a125, v7
    v_accvgpr_write_b32 a126, v8
    v_accvgpr_write_b32 a127, v9
    v_accvgpr_read_b32 v6, a128
    v_accvgpr_read_b32 v7, a129
    v_accvgpr_read_b32 v8, a130
    v_accvgpr_read_b32 v9, a131
    v_mul_f32 v6, v6, v5
    v_mul_f32 v7, v7, v5
    v_mul_f32 v8, v8, v5
    v_mul_f32 v9, v9, v5
    v_accvgpr_write_b32 a128, v6
    v_accvgpr_write_b32 a129, v7
    v_accvgpr_write_b32 a130, v8
    v_accvgpr_write_b32 a131, v9
    v_accvgpr_read_b32 v6, a132
    v_accvgpr_read_b32 v7, a133
    v_accvgpr_read_b32 v8, a134
    v_accvgpr_read_b32 v9, a135
    v_mul_f32 v6, v6, v5
    v_mul_f32 v7, v7, v5
    v_mul_f32 v8, v8, v5
    v_mul_f32 v9, v9, v5
    v_accvgpr_write_b32 a132, v6
    v_accvgpr_write_b32 a133, v7
    v_accvgpr_write_b32 a134, v8
    v_accvgpr_write_b32 a135, v9
    v_accvgpr_read_b32 v6, a136
    v_accvgpr_read_b32 v7, a137
    v_accvgpr_read_b32 v8, a138
    v_accvgpr_read_b32 v9, a139
    v_mul_f32 v6, v6, v5
    v_mul_f32 v7, v7, v5
    v_mul_f32 v8, v8, v5
    v_mul_f32 v9, v9, v5
    v_accvgpr_write_b32 a136, v6
    v_accvgpr_write_b32 a137, v7
    v_accvgpr_write_b32 a138, v8
    v_accvgpr_write_b32 a139, v9
    v_accvgpr_read_b32 v6, a140
    v_accvgpr_read_b32 v7, a141
    v_accvgpr_read_b32 v8, a142
    v_accvgpr_read_b32 v9, a143
    v_mul_f32 v6, v6, v5
    v_mul_f32 v7, v7, v5
    v_mul_f32 v8, v8, v5
    v_mul_f32 v9, v9, v5
    v_accvgpr_write_b32 a140, v6
    v_accvgpr_write_b32 a141, v7
    v_accvgpr_write_b32 a142, v8
    v_accvgpr_write_b32 a143, v9
    v_accvgpr_read_b32 v6, a144
    v_accvgpr_read_b32 v7, a145
    v_accvgpr_read_b32 v8, a146
    v_accvgpr_read_b32 v9, a147
    v_mul_f32 v6, v6, v5
    v_mul_f32 v7, v7, v5
    v_mul_f32 v8, v8, v5
    v_mul_f32 v9, v9, v5
    v_accvgpr_write_b32 a144, v6
    v_accvgpr_write_b32 a145, v7
    v_accvgpr_write_b32 a146, v8
    v_accvgpr_write_b32 a147, v9
    v_accvgpr_read_b32 v6, a148
    v_accvgpr_read_b32 v7, a149
    v_accvgpr_read_b32 v8, a150
    v_accvgpr_read_b32 v9, a151
    v_mul_f32 v6, v6, v5
    v_mul_f32 v7, v7, v5
    v_mul_f32 v8, v8, v5
    v_mul_f32 v9, v9, v5
    v_accvgpr_write_b32 a148, v6
    v_accvgpr_write_b32 a149, v7
    v_accvgpr_write_b32 a150, v8
    v_accvgpr_write_b32 a151, v9
    v_accvgpr_read_b32 v6, a152
    v_accvgpr_read_b32 v7, a153
    v_accvgpr_read_b32 v8, a154
    v_accvgpr_read_b32 v9, a155
    v_mul_f32 v6, v6, v5
    v_mul_f32 v7, v7, v5
    v_mul_f32 v8, v8, v5
    v_mul_f32 v9, v9, v5
    v_accvgpr_write_b32 a152, v6
    v_accvgpr_write_b32 a153, v7
    v_accvgpr_write_b32 a154, v8
    v_accvgpr_write_b32 a155, v9
    v_accvgpr_read_b32 v6, a156
    v_accvgpr_read_b32 v7, a157
    v_accvgpr_read_b32 v8, a158
    v_accvgpr_read_b32 v9, a159
    v_mul_f32 v6, v6, v5
    v_mul_f32 v7, v7, v5
    v_mul_f32 v8, v8, v5
    v_mul_f32 v9, v9, v5
    v_accvgpr_write_b32 a156, v6
    v_accvgpr_write_b32 a157, v7
    v_accvgpr_write_b32 a158, v8
    v_accvgpr_write_b32 a159, v9
    v_exp_f32 v6, v64
    v_exp_f32 v7, v65
    s_nop 0
    v_cvt_pk_bf16_f32 v136, v6, v7
    v_exp_f32 v6, v66
    v_exp_f32 v7, v67
    s_nop 0
    v_cvt_pk_bf16_f32 v137, v6, v7
    v_exp_f32 v6, v68
    v_exp_f32 v7, v69
    s_nop 0
    v_cvt_pk_bf16_f32 v138, v6, v7
    v_exp_f32 v6, v70
    v_exp_f32 v7, v71
    s_nop 0
    v_cvt_pk_bf16_f32 v139, v6, v7
    v_exp_f32 v6, v72
    v_exp_f32 v7, v73
    s_nop 0
    v_cvt_pk_bf16_f32 v140, v6, v7
    v_exp_f32 v6, v74
    v_exp_f32 v7, v75
    s_nop 0
    v_cvt_pk_bf16_f32 v141, v6, v7
    v_exp_f32 v6, v76
    v_exp_f32 v7, v77
    s_nop 0
    v_cvt_pk_bf16_f32 v142, v6, v7
    v_exp_f32 v6, v78
    v_exp_f32 v7, v79
    s_nop 0
    v_cvt_pk_bf16_f32 v143, v6, v7
    s_nop 7
    s_branch L_k2_ret3
L_k2_last:
    s_cmp_eq_u32 s20, 1
    s_cbranch_scc1 L_k2_last1
    s_cmp_eq_u32 s20, 2
    s_cbranch_scc1 L_k2_last2
    s_cmp_eq_u32 s20, 3
    s_cbranch_scc1 L_k2_last3
L_k2_last0:
    s_waitcnt vmcnt(0) lgkmcnt(0)
    ds_read_b64_tr_b16 v[180:181], v163 offset:30720
    ds_read_b64_tr_b16 v[182:183], v164 offset:30720
    ds_read_b64_tr_b16 v[184:185], v163 offset:34816
    ds_read_b64_tr_b16 v[186:187], v164 offset:34816
    ds_read_b64_tr_b16 v[188:189], v165 offset:30720
    ds_read_b64_tr_b16 v[190:191], v166 offset:30720
    v_exp_f32 v145, v57
    s_nop 0
    v_cvt_pk_bf16_f32 v132, v144, v145
    v_exp_f32 v146, v72
    v_exp_f32 v147, v73
    s_nop 0
    v_cvt_pk_bf16_f32 v140, v146, v147
    v_or3_b32 v152, v132, v140, v152
    v_exp_f32 v148, v58
    v_exp_f32 v149, v59
    s_nop 0
    v_cvt_pk_bf16_f32 v133, v148, v149
    v_exp_f32 v150, v74
    v_exp_f32 v151, v75
    s_nop 0
    v_cvt_pk_bf16_f32 v141, v150, v151
    v_or3_b32 v152, v133, v141, v152
    v_exp_f32 v144, v60
    v_exp_f32 v145, v61
    s_nop 0
    v_cvt_pk_bf16_f32 v134, v144, v145
    v_exp_f32 v146, v76
    v_exp_f32 v147, v77
    s_nop 0
    v_cvt_pk_bf16_f32 v142, v146, v147
    v_or3_b32 v152, v134, v142, v152
    v_exp_f32 v148, v62
    v_exp_f32 v149, v63
    s_nop 0
    v_cvt_pk_bf16_f32 v135, v148, v149
    v_exp_f32 v150, v78
    v_exp_f32 v151, v79
    s_nop 0
    v_cvt_pk_bf16_f32 v143, v150, v151
    v_or3_b32 v152, v135, v143, v152
    v_lshl_or_b32 v153, v152, 16, v152
    v_cmp_le_u32 vcc, 0x40000000, v153
    s_cbranch_vccnz L_k2_rareL0
L_k2_retL0:
    s_waitcnt lgkmcnt(4)
    v_mfma_f32_32x32x16_bf16 a[0:15], v[180:183], v[128:131], a[0:15]
    v_mfma_f32_32x32x16_bf16 a[80:95], v[180:183], v[136:139], a[80:95]
    ds_read_b64_tr_b16 v[192:193], v165 offset:34816
    ds_read_b64_tr_b16 v[194:195], v166 offset:34816
    s_waitcnt lgkmcnt(4)
    v_mfma_f32_32x32x16_bf16 a[0:15], v[184:187], v[132:135], a[0:15]
    v_mfma_f32_32x32x16_bf16 a[80:95], v[184:187], v[140:143], a[80:95]
    ds_read_b64_tr_b16 v[196:197], v167 offset:30720
    ds_read_b64_tr_b16 v[198:199], v168 offset:30720
    s_waitcnt lgkmcnt(4)
    v_mfma_f32_32x32x16_bf16 a[16:31], v[188:191], v[128:131], a[16:31]
    v_mfma_f32_32x32x16_bf16 a[96:111], v[188:191], v[136:139], a[96:111]
    ds_read_b64_tr_b16 v[200:201], v167 offset:34816
    ds_read_b64_tr_b16 v[202:203], v168 offset:34816
    s_waitcnt lgkmcnt(4)
    v_mfma_f32_32x32x16_bf16 a[16:31], v[192:195], v[132:135], a[16:31]
    ds_write_b128 v14, a[80:83] offset:8192
    ds_write_b128 v14, a[84:87] offset:9216
    v_mfma_f32_32x32x16_bf16 a[96:111], v[192:195], v[140:143], a[96:111]
    ds_read_b64_tr_b16 v[204:205], v169 offset:30720
    ds_read_b64_tr_b16 v[206:207], v170 offset:30720
    ds_write_b128 v14, a[88:91] offset:10240
    ds_write_b128 v14, a[92:95] offset:11264
    s_waitcnt lgkmcnt(8)
    v_mfma_f32_32x32x16_bf16 a[32:47], v[196:199], v[128:131], a[32:47]
    v_mfma_f32_32x32x16_bf16 a[112:127], v[196:199], v[136:139], a[112:127]
    ds_read_b64_tr_b16 v[208:209], v169 offset:34816
    ds_read_b64_tr_b16 v[210:211], v170 offset:34816
    s_waitcnt lgkmcnt(8)
    v_mfma_f32_32x32x16_bf16 a[32:47], v[200:203], v[132:135], a[32:47]
    ds_write_b128 v14, a[96:99] offset:12288
    ds_write_b128 v14, a[100:103] offset:13312
    v_mfma_f32_32x32x16_bf16 a[112:127], v[200:203], v[140:143], a[112:127]
    ds_read_b64_tr_b16 v[212:213], v171 offset:30720
    ds_read_b64_tr_b16 v[214:215], v172 offset:30720
    ds_write_b128 v14, a[104:107] offset:14336
    ds_write_b128 v14, a[108:111] offset:15360
    s_waitcnt lgkmcnt(10)
    v_mfma_f32_32x32x16_bf16 a[48:63], v[204:207], v[128:131], a[48:63]
    v_mfma_f32_32x32x16_bf16 a[128:143], v[204:207], v[136:139], a[128:143]
    ds_read_b64_tr_b16 v[216:217], v171 offset:31232
    ds_read_b64_tr_b16 v[218:219], v172 offset:31232
    ds_write_b128 v14, a[40:43] offset:0
    ds_write_b128 v14, a[44:47] offset:1024
    s_waitcnt lgkmcnt(10)
    v_mfma_f32_32x32x16_bf16 a[48:63], v[208:211], v[132:135], a[48:63]
    ds_write_b128 v14, a[112:115] offset:16384
    ds_write_b128 v14, a[116:119] offset:17408
    v_mfma_f32_32x32x16_bf16 a[128:143], v[208:211], v[140:143], a[128:143]
    ds_write_b128 v14, a[120:123] offset:18432
    ds_write_b128 v14, a[124:127] offset:19456
    s_waitcnt lgkmcnt(10)
    v_mfma_f32_32x32x16_bf16 a[64:79], v[212:215], v[128:131], a[64:79]
    v_mfma_f32_32x32x16_bf16 a[144:159], v[212:215], v[136:139], a[144:159]
    ds_write_b128 v14, a[48:51] offset:2048
    ds_write_b128 v14, a[52:55] offset:3072
    s_waitcnt lgkmcnt(8)
    v_mfma_f32_32x32x16_bf16 a[64:79], v[216:219], v[132:135], a[64:79]
    ds_write_b128 v14, a[56:59] offset:4096
    ds_write_b128 v14, a[60:63] offset:5120
    v_mfma_f32_32x32x16_bf16 a[144:159], v[216:219], v[140:143], a[144:159]
    ds_write_b128 v14, a[128:131] offset:20480
    ds_write_b128 v14, a[132:135] offset:21504
    v_lshlrev_b32 v2, 2, v13
    v_add_u32 v3, s26, v2
    s_lshl_b32 s46, s42, 1
    s_add_u32 s46, s46, s41
    s_mul_i32 s47, s46, 1152000
    s_add_u32 s47, s47, 4718592
    s_add_u32 s12, s4, s47
    s_addc_u32 s13, s5, 0
    s_mul_i32 s47, s46, 16000
    s_add_u32 s47, s47, 9437184
    s_add_u32 s16, s4, s47
    s_addc_u32 s17, s5, 0
    s_mov_b32 s18, 16000
    s_mov_b32 s19, 0x20000
    ds_write_b128 v14, a[136:139] offset:22528
    ds_write_b128 v14, a[140:143] offset:23552
    s_nop 7
    ds_write_b128 v14, a[64:67] offset:6144
    ds_write_b128 v14, a[68:71] offset:7168
    ds_write_b128 v14, a[144:147] offset:24576
    ds_write_b128 v14, a[148:151] offset:25600
    ds_write_b32 v3, v80 offset:28672
    ds_write_b32 v3, a72 offset:29184
    ds_write_b32 v3, v96 offset:28928
    ds_write_b32 v3, a152 offset:29440
    v_accvgpr_read_b32 v16, a0
    v_accvgpr_read_b32 v17, a1
    v_accvgpr_read_b32 v18, a2
    v_accvgpr_read_b32 v19, a3
    v_accvgpr_read_b32 v20, a4
    v_accvgpr_read_b32 v21, a5
    v_accvgpr_read_b32 v22, a6
    v_accvgpr_read_b32 v23, a7
    v_accvgpr_read_b32 v24, a8
    v_accvgpr_read_b32 v25, a9
    v_accvgpr_read_b32 v26, a10
    v_accvgpr_read_b32 v27, a11
    v_accvgpr_read_b32 v28, a12
    v_accvgpr_read_b32 v29, a13
    v_accvgpr_read_b32 v30, a14
    v_accvgpr_read_b32 v31, a15
    v_accvgpr_read_b32 v32, a16
    v_accvgpr_read_b32 v33, a17
    v_accvgpr_read_b32 v34, a18
    v_accvgpr_read_b32 v35, a19
    v_accvgpr_read_b32 v36, a20
    v_accvgpr_read_b32 v37, a21
    v_accvgpr_read_b32 v38, a22
    v_accvgpr_read_b32 v39, a23
    v_accvgpr_read_b32 v40, a24
    v_accvgpr_read_b32 v41, a25
    v_accvgpr_read_b32 v42, a26
    v_accvgpr_read_b32 v43, a27
    v_accvgpr_read_b32 v44, a28
    v_accvgpr_read_b32 v45, a29
    v_accvgpr_read_b32 v46, a30
    v_accvgpr_read_b32 v47, a31
    v_accvgpr_read_b32 v48, a32
    v_accvgpr_read_b32 v49, a33
    v_accvgpr_read_b32 v50, a34
    v_accvgpr_read_b32 v51, a35
    v_accvgpr_read_b32 v52, a36
    v_accvgpr_read_b32 v53, a37
    v_accvgpr_read_b32 v54, a38
    v_accvgpr_read_b32 v55, a39
    v_add_u32 v208, 40960, v12
    v_add_u32 v209, 81920, v12
    v_add_u32 v210, 122880, v12
    v_add_u32 v213, 40960, v2
    v_add_u32 v214, 81920, v2
    v_add_u32 v215, 122880, v2
    s_lshl_b32 s44, s40, 1
    s_add_u32 s44, s44, 0
    s_mul_i32 s45, s44, 9216
    s_add_u32 s45, s45, 0
    s_lshl_b32 s44, s44, 7
    v_and_b32 v197, 31, v13
    v_lshlrev_b32 v197, 2, v197
    s_waitcnt lgkmcnt(0)
    s_barrier
    ds_read_b32 v4, v2 offset:28672
    ds_read_b32 v5, v2 offset:29184
    ds_read_b32 v6, v213 offset:28672
    ds_read_b32 v7, v213 offset:29184
    ds_read_b32 v8, v214 offset:28672
    ds_read_b32 v9, v214 offset:29184
    ds_read_b32 v10, v215 offset:28672
    ds_read_b32 v11, v215 offset:29184
    ds_read_b128 v[56:59], v208 offset:0
    ds_read_b128 v[60:63], v209 offset:0
    ds_read_b128 v[64:67], v210 offset:0
    ds_read_b128 v[68:71], v208 offset:1024
    ds_read_b128 v[72:75], v209 offset:1024
    ds_read_b128 v[76:79], v210 offset:1024
    s_waitcnt lgkmcnt(6)
    v_min3_f32 v192, v4, v6, v8
    v_min_f32 v192, v192, v10
    v_sub_f32 v4, v192, v4
    v_sub_f32 v6, v192, v6
    v_sub_f32 v8, v192, v8
    v_sub_f32 v10, v192, v10
    v_exp_f32 v4, v4
    v_exp_f32 v6, v6
    v_exp_f32 v8, v8
    v_exp_f32 v10, v10
    ds_read_b128 v[80:83], v208 offset:2048
    ds_read_b128 v[84:87], v209 offset:2048
    ds_read_b128 v[88:91], v210 offset:2048
    ds_read_b128 v[92:95], v208 offset:3072
    ds_read_b128 v[96:99], v209 offset:3072
    ds_read_b128 v[100:103], v210 offset:3072
    v_mul_f32 v193, v4, v5
    v_fmac_f32 v193, v6, v7
    v_fmac_f32 v193, v8, v9
    v_fmac_f32 v193, v10, v11
    v_rcp_f32 v194, v193
    v_log_f32 v195, v193
    s_nop 0
    v_mul_f32 v4, v4, v194
    v_mul_f32 v6, v6, v194
    v_mul_f32 v8, v8, v194
    v_mul_f32 v10, v10, v194
    v_sub_f32 v195, v195, v192
    buffer_store_dword v195, v197, s[16:19], s44 offen sc1
    v_pk_mul_f32 v[16:17], v[16:17], v[4:5] op_sel_hi:[1,0]
    v_pk_mul_f32 v[18:19], v[18:19], v[4:5] op_sel_hi:[1,0]
    v_pk_mul_f32 v[20:21], v[20:21], v[4:5] op_sel_hi:[1,0]
    v_pk_mul_f32 v[22:23], v[22:23], v[4:5] op_sel_hi:[1,0]
    v_pk_mul_f32 v[24:25], v[24:25], v[4:5] op_sel_hi:[1,0]
    v_pk_mul_f32 v[26:27], v[26:27], v[4:5] op_sel_hi:[1,0]
    v_pk_mul_f32 v[28:29], v[28:29], v[4:5] op_sel_hi:[1,0]
    v_pk_mul_f32 v[30:31], v[30:31], v[4:5] op_sel_hi:[1,0]
    v_pk_mul_f32 v[32:33], v[32:33], v[4:5] op_sel_hi:[1,0]
    v_pk_mul_f32 v[34:35], v[34:35], v[4:5] op_sel_hi:[1,0]
    v_pk_mul_f32 v[36:37], v[36:37], v[4:5] op_sel_hi:[1,0]
    v_pk_mul_f32 v[38:39], v[38:39], v[4:5] op_sel_hi:[1,0]
    v_pk_mul_f32 v[40:41], v[40:41], v[4:5] op_sel_hi:[1,0]
    v_pk_mul_f32 v[42:43], v[42:43], v[4:5] op_sel_hi:[1,0]
    v_pk_mul_f32 v[44:45], v[44:45], v[4:5] op_sel_hi:[1,0]
    v_pk_mul_f32 v[46:47], v[46:47], v[4:5] op_sel_hi:[1,0]
    v_pk_mul_f32 v[48:49], v[48:49], v[4:5] op_sel_hi:[1,0]
    v_pk_mul_f32 v[50:51], v[50:51], v[4:5] op_sel_hi:[1,0]
    v_pk_mul_f32 v[52:53], v[52:53], v[4:5] op_sel_hi:[1,0]
    v_pk_mul_f32 v[54:55], v[54:55], v[4:5] op_sel_hi:[1,0]
    s_waitcnt lgkmcnt(9)
    v_pk_fma_f32 v[16:17], v[56:57], v[6:7], v[16:17] op_sel_hi:[1,0,1]
    v_pk_fma_f32 v[18:19], v[58:59], v[6:7], v[18:19] op_sel_hi:[1,0,1]
    v_pk_fma_f32 v[16:17], v[60:61], v[8:9], v[16:17] op_sel_hi:[1,0,1]
    v_pk_fma_f32 v[18:19], v[62:63], v[8:9], v[18:19] op_sel_hi:[1,0,1]
    v_pk_fma_f32 v[16:17], v[64:65], v[10:11], v[16:17] op_sel_hi:[1,0,1]
    v_pk_fma_f32 v[18:19], v[66:67], v[10:11], v[18:19] op_sel_hi:[1,0,1]
    v_cvt_pk_bf16_f32 v216, v16, v17
    v_cvt_pk_bf16_f32 v217, v18, v19
    ds_read_b128 v[104:107], v208 offset:4096
    ds_read_b128 v[108:111], v209 offset:4096
    ds_read_b128 v[112:115], v210 offset:4096
    s_waitcnt lgkmcnt(9)
    v_pk_fma_f32 v[20:21], v[68:69], v[6:7], v[20:21] op_sel_hi:[1,0,1]
    v_pk_fma_f32 v[22:23], v[70:71], v[6:7], v[22:23] op_sel_hi:[1,0,1]
    v_pk_fma_f32 v[20:21], v[72:73], v[8:9], v[20:21] op_sel_hi:[1,0,1]
    v_pk_fma_f32 v[22:23], v[74:75], v[8:9], v[22:23] op_sel_hi:[1,0,1]
    v_pk_fma_f32 v[20:21], v[76:77], v[10:11], v[20:21] op_sel_hi:[1,0,1]
    v_pk_fma_f32 v[22:23], v[78:79], v[10:11], v[22:23] op_sel_hi:[1,0,1]
    v_cvt_pk_bf16_f32 v218, v20, v21
    v_cvt_pk_bf16_f32 v219, v22, v23
    buffer_store_dwordx4 v[216:219], v12, s[12:15], s45 offen offset:0 sc1
    ds_read_b128 v[116:119], v208 offset:5120
    ds_read_b128 v[120:123], v209 offset:5120
    ds_read_b128 v[124:127], v210 offset:5120
    s_waitcnt lgkmcnt(9)
    v_pk_fma_f32 v[24:25], v[80:81], v[6:7], v[24:25] op_sel_hi:[1,0,1]
    v_pk_fma_f32 v[26:27], v[82:83], v[6:7], v[26:27] op_sel_hi:[1,0,1]
    v_pk_fma_f32 v[24:25], v[84:85], v[8:9], v[24:25] op_sel_hi:[1,0,1]
    v_pk_fma_f32 v[26:27], v[86:87], v[8:9], v[26:27] op_sel_hi:[1,0,1]
    v_pk_fma_f32 v[24:25], v[88:89], v[10:11], v[24:25] op_sel_hi:[1,0,1]
    v_pk_fma_f32 v[26:27], v[90:91], v[10:11], v[26:27] op_sel_hi:[1,0,1]
    v_cvt_pk_bf16_f32 v220, v24, v25
    v_cvt_pk_bf16_f32 v221, v26, v27
    ds_read_b128 v[128:131], v208 offset:6144
    ds_read_b128 v[132:135], v209 offset:6144
    ds_read_b128 v[136:139], v210 offset:6144
    s_waitcnt lgkmcnt(9)
    v_pk_fma_f32 v[28:29], v[92:93], v[6:7], v[28:29] op_sel_hi:[1,0,1]
    v_pk_fma_f32 v[30:31], v[94:95], v[6:7], v[30:31] op_sel_hi:[1,0,1]
    v_pk_fma_f32 v[28:29], v[96:97], v[8:9], v[28:29] op_sel_hi:[1,0,1]
    v_pk_fma_f32 v[30:31], v[98:99], v[8:9], v[30:31] op_sel_hi:[1,0,1]
    v_pk_fma_f32 v[28:29], v[100:101], v[10:11], v[28:29] op_sel_hi:[1,0,1]
    v_pk_fma_f32 v[30:31], v[102:103], v[10:11], v[30:31] op_sel_hi:[1,0,1]
    v_cvt_pk_bf16_f32 v222, v28, v29
    v_cvt_pk_bf16_f32 v223, v30, v31
    buffer_store_dwordx4 v[220:223], v12, s[12:15], s45 offen offset:1024 sc1
    ds_read_b128 v[140:143], v208 offset:7168
    ds_read_b128 v[144:147], v209 offset:7168
    ds_read_b128 v[148:151], v210 offset:7168
    s_waitcnt lgkmcnt(9)
    v_pk_fma_f32 v[32:33], v[104:105], v[6:7], v[32:33] op_sel_hi:[1,0,1]
    v_pk_fma_f32 v[34:35], v[106:107], v[6:7], v[34:35] op_sel_hi:[1,0,1]
    v_pk_fma_f32 v[32:33], v[108:109], v[8:9], v[32:33] op_sel_hi:[1,0,1]
    v_pk_fma_f32 v[34:35], v[110:111], v[8:9], v[34:35] op_sel_hi:[1,0,1]
    v_pk_fma_f32 v[32:33], v[112:113], v[10:11], v[32:33] op_sel_hi:[1,0,1]
    v_pk_fma_f32 v[34:35], v[114:115], v[10:11], v[34:35] op_sel_hi:[1,0,1]
    v_cvt_pk_bf16_f32 v224, v32, v33
    v_cvt_pk_bf16_f32 v225, v34, v35
    ds_read_b128 v[152:155], v208 offset:8192
    ds_read_b128 v[156:159], v209 offset:8192
    ds_read_b128 v[160:163], v210 offset:8192
    s_waitcnt lgkmcnt(9)
    v_pk_fma_f32 v[36:37], v[116:117], v[6:7], v[36:37] op_sel_hi:[1,0,1]
    v_pk_fma_f32 v[38:39], v[118:119], v[6:7], v[38:39] op_sel_hi:[1,0,1]
    v_pk_fma_f32 v[36:37], v[120:121], v[8:9], v[36:37] op_sel_hi:[1,0,1]
    v_pk_fma_f32 v[38:39], v[122:123], v[8:9], v[38:39] op_sel_hi:[1,0,1]
    v_pk_fma_f32 v[36:37], v[124:125], v[10:11], v[36:37] op_sel_hi:[1,0,1]
    v_pk_fma_f32 v[38:39], v[126:127], v[10:11], v[38:39] op_sel_hi:[1,0,1]
    v_cvt_pk_bf16_f32 v226, v36, v37
    v_cvt_pk_bf16_f32 v227, v38, v39
    buffer_store_dwordx4 v[224:227], v12, s[12:15], s45 offen offset:2048 sc1
    ds_read_b128 v[164:167], v208 offset:9216
    ds_read_b128 v[168:171], v209 offset:9216
    ds_read_b128 v[172:175], v210 offset:9216
    s_waitcnt lgkmcnt(9)
    v_pk_fma_f32 v[40:41], v[128:129], v[6:7], v[40:41] op_sel_hi:[1,0,1]
    v_pk_fma_f32 v[42:43], v[130:131], v[6:7], v[42:43] op_sel_hi:[1,0,1]
    v_pk_fma_f32 v[40:41], v[132:133], v[8:9], v[40:41] op_sel_hi:[1,0,1]
    v_pk_fma_f32 v[42:43], v[134:135], v[8:9], v[42:43] op_sel_hi:[1,0,1]
    v_pk_fma_f32 v[40:41], v[136:137], v[10:11], v[40:41] op_sel_hi:[1,0,1]
    v_pk_fma_f32 v[42:43], v[138:139], v[10:11], v[42:43] op_sel_hi:[1,0,1]
    v_cvt_pk_bf16_f32 v228, v40, v41
    v_cvt_pk_bf16_f32 v229, v42, v43
    s_waitcnt lgkmcnt(6)
    v_pk_fma_f32 v[44:45], v[140:141], v[6:7], v[44:45] op_sel_hi:[1,0,1]
    v_pk_fma_f32 v[46:47], v[142:143], v[6:7], v[46:47] op_sel_hi:[1,0,1]
    v_pk_fma_f32 v[44:45], v[144:145], v[8:9], v[44:45] op_sel_hi:[1,0,1]
    v_pk_fma_f32 v[46:47], v[146:147], v[8:9], v[46:47] op_sel_hi:[1,0,1]
    v_pk_fma_f32 v[44:45], v[148:149], v[10:11], v[44:45] op_sel_hi:[1,0,1]
    v_pk_fma_f32 v[46:47], v[150:151], v[10:11], v[46:47] op_sel_hi:[1,0,1]
    v_cvt_pk_bf16_f32 v230, v44, v45
    v_cvt_pk_bf16_f32 v231, v46, v47
    buffer_store_dwordx4 v[228:231], v12, s[12:15], s45 offen offset:3072 sc1
    s_waitcnt lgkmcnt(3)
    v_pk_fma_f32 v[48:49], v[152:153], v[6:7], v[48:49] op_sel_hi:[1,0,1]
    v_pk_fma_f32 v[50:51], v[154:155], v[6:7], v[50:51] op_sel_hi:[1,0,1]
    v_pk_fma_f32 v[48:49], v[156:157], v[8:9], v[48:49] op_sel_hi:[1,0,1]
    v_pk_fma_f32 v[50:51], v[158:159], v[8:9], v[50:51] op_sel_hi:[1,0,1]
    v_pk_fma_f32 v[48:49], v[160:161], v[10:11], v[48:49] op_sel_hi:[1,0,1]
    v_pk_fma_f32 v[50:51], v[162:163], v[10:11], v[50:51] op_sel_hi:[1,0,1]
    v_cvt_pk_bf16_f32 v232, v48, v49
    v_cvt_pk_bf16_f32 v233, v50, v51
    s_waitcnt lgkmcnt(0)
    v_pk_fma_f32 v[52:53], v[164:165], v[6:7], v[52:53] op_sel_hi:[1,0,1]
    v_pk_fma_f32 v[54:55], v[166:167], v[6:7], v[54:55] op_sel_hi:[1,0,1]
    v_pk_fma_f32 v[52:53], v[168:169], v[8:9], v[52:53] op_sel_hi:[1,0,1]
    v_pk_fma_f32 v[54:55], v[170:171], v[8:9], v[54:55] op_sel_hi:[1,0,1]
    v_pk_fma_f32 v[52:53], v[172:173], v[10:11], v[52:53] op_sel_hi:[1,0,1]
    v_pk_fma_f32 v[54:55], v[174:175], v[10:11], v[54:55] op_sel_hi:[1,0,1]
    v_cvt_pk_bf16_f32 v234, v52, v53
    v_cvt_pk_bf16_f32 v235, v54, v55
    s_add_u32 s45, s45, 4096
    buffer_store_dwordx4 v[232:235], v12, s[12:15], s45 offen offset:0 sc1
    s_endpgm
L_k2_last1:
    s_waitcnt vmcnt(0) lgkmcnt(0)
    ds_read_b64_tr_b16 v[180:181], v163 offset:30720
    ds_read_b64_tr_b16 v[182:183], v164 offset:30720
    ds_read_b64_tr_b16 v[184:185], v163 offset:34816
    ds_read_b64_tr_b16 v[186:187], v164 offset:34816
    ds_read_b64_tr_b16 v[188:189], v165 offset:30720
    ds_read_b64_tr_b16 v[190:191], v166 offset:30720
    v_exp_f32 v145, v57
    s_nop 0
    v_cvt_pk_bf16_f32 v132, v144, v145
    v_exp_f32 v146, v72
    v_exp_f32 v147, v73
    s_nop 0
    v_cvt_pk_bf16_f32 v140, v146, v147
    v_or3_b32 v152, v132, v140, v152
    v_exp_f32 v148, v58
    v_exp_f32 v149, v59
    s_nop 0
    v_cvt_pk_bf16_f32 v133, v148, v149
    v_exp_f32 v150, v74
    v_exp_f32 v151, v75
    s_nop 0
    v_cvt_pk_bf16_f32 v141, v150, v151
    v_or3_b32 v152, v133, v141, v152
    v_exp_f32 v144, v60
    v_exp_f32 v145, v61
    s_nop 0
    v_cvt_pk_bf16_f32 v134, v144, v145
    v_exp_f32 v146, v76
    v_exp_f32 v147, v77
    s_nop 0
    v_cvt_pk_bf16_f32 v142, v146, v147
    v_or3_b32 v152, v134, v142, v152
    v_exp_f32 v148, v62
    v_exp_f32 v149, v63
    s_nop 0
    v_cvt_pk_bf16_f32 v135, v148, v149
    v_exp_f32 v150, v78
    v_exp_f32 v151, v79
    s_nop 0
    v_cvt_pk_bf16_f32 v143, v150, v151
    v_or3_b32 v152, v135, v143, v152
    v_lshl_or_b32 v153, v152, 16, v152
    v_cmp_le_u32 vcc, 0x40000000, v153
    s_cbranch_vccnz L_k2_rareL1
L_k2_retL1:
    s_waitcnt lgkmcnt(4)
    v_mfma_f32_32x32x16_bf16 a[0:15], v[180:183], v[128:131], a[0:15]
    v_mfma_f32_32x32x16_bf16 a[80:95], v[180:183], v[136:139], a[80:95]
    ds_read_b64_tr_b16 v[192:193], v165 offset:34816
    ds_read_b64_tr_b16 v[194:195], v166 offset:34816
    s_waitcnt lgkmcnt(4)
    v_mfma_f32_32x32x16_bf16 a[0:15], v[184:187], v[132:135], a[0:15]
    v_mfma_f32_32x32x16_bf16 a[80:95], v[184:187], v[140:143], a[80:95]
    ds_read_b64_tr_b16 v[196:197], v167 offset:30720
    ds_read_b64_tr_b16 v[198:199], v168 offset:30720
    s_waitcnt lgkmcnt(4)
    v_mfma_f32_32x32x16_bf16 a[16:31], v[188:191], v[128:131], a[16:31]
    v_mfma_f32_32x32x16_bf16 a[96:111], v[188:191], v[136:139], a[96:111]
    ds_read_b64_tr_b16 v[200:201], v167 offset:34816
    ds_read_b64_tr_b16 v[202:203], v168 offset:34816
    ds_write_b128 v14, a[0:3] offset:0
    ds_write_b128 v14, a[4:7] offset:1024
    s_waitcnt lgkmcnt(6)
    v_mfma_f32_32x32x16_bf16 a[16:31], v[192:195], v[132:135], a[16:31]
    ds_write_b128 v14, a[8:11] offset:2048
    ds_write_b128 v14, a[12:15] offset:3072
    v_mfma_f32_32x32x16_bf16 a[96:111], v[192:195], v[140:143], a[96:111]
    ds_read_b64_tr_b16 v[204:205], v169 offset:30720
    ds_read_b64_tr_b16 v[206:207], v170 offset:30720
    ds_write_b128 v14, a[80:83] offset:10240
    ds_write_b128 v14, a[84:87] offset:11264
    s_waitcnt lgkmcnt(10)
    v_mfma_f32_32x32x16_bf16 a[32:47], v[196:199], v[128:131], a[32:47]
    ds_write_b128 v14, a[88:91] offset:12288
    ds_write_b128 v14, a[92:95] offset:13312
    v_mfma_f32_32x32x16_bf16 a[112:127], v[196:199], v[136:139], a[112:127]
    ds_read_b64_tr_b16 v[208:209], v169 offset:34816
    ds_read_b64_tr_b16 v[210:211], v170 offset:34816
    ds_write_b128 v14, a[16:19] offset:4096
    ds_write_b128 v14, a[20:23] offset:5120
    s_waitcnt lgkmcnt(14)
    v_mfma_f32_32x32x16_bf16 a[32:47], v[200:203], v[132:135], a[32:47]
    ds_write_b128 v14, a[24:27] offset:6144
    ds_write_b128 v14, a[28:31] offset:7168
    v_mfma_f32_32x32x16_bf16 a[112:127], v[200:203], v[140:143], a[112:127]
    ds_read_b64_tr_b16 v[212:213], v171 offset:30720
    ds_read_b64_tr_b16 v[214:215], v172 offset:30720
    ds_write_b128 v14, a[96:99] offset:14336
    ds_write_b128 v14, a[100:103] offset:15360
    s_waitcnt lgkmcnt(14)
    v_mfma_f32_32x32x16_bf16 a[48:63], v[204:207], v[128:131], a[48:63]
    ds_write_b128 v14, a[104:107] offset:16384
    ds_write_b128 v14, a[108:111] offset:17408
    v_mfma_f32_32x32x16_bf16 a[128:143], v[204:207], v[136:139], a[128:143]
    ds_read_b64_tr_b16 v[216:217], v171 offset:31232
    ds_read_b64_tr_b16 v[218:219], v172 offset:31232
    ds_write_b128 v14, a[32:35] offset:8192
    ds_write_b128 v14, a[36:39] offset:9216
    s_waitcnt lgkmcnt(14)
    v_mfma_f32_32x32x16_bf16 a[48:63], v[208:211], v[132:135], a[48:63]
    ds_write_b128 v14, a[112:115] offset:18432
    ds_write_b128 v14, a[116:119] offset:19456
    v_mfma_f32_32x32x16_bf16 a[128:143], v[208:211], v[140:143], a[128:143]
    ds_write_b128 v14, a[120:123] offset:20480
    ds_write_b128 v14, a[124:127] offset:21504
    s_waitcnt lgkmcnt(12)
    v_mfma_f32_32x32x16_bf16 a[64:79], v[212:215], v[128:131], a[64:79]
    v_mfma_f32_32x32x16_bf16 a[144:159], v[212:215], v[136:139], a[144:159]
    s_waitcnt lgkmcnt(6)
    v_mfma_f32_32x32x16_bf16 a[64:79], v[216:219], v[132:135], a[64:79]
    ds_write_b128 v14, a[128:131] offset:22528
    ds_write_b128 v14, a[132:135] offset:23552
    v_mfma_f32_32x32x16_bf16 a[144:159], v[216:219], v[140:143], a[144:159]
    ds_write_b128 v14, a[136:139] offset:24576
    ds_write_b128 v14, a[140:143] offset:25600
    v_lshlrev_b32 v2, 2, v13
    v_add_u32 v3, s26, v2
    s_lshl_b32 s46, s42, 1
    s_add_u32 s46, s46, s41
    s_mul_i32 s47, s46, 1152000
    s_add_u32 s47, s47, 4718592
    s_add_u32 s12, s4, s47
    s_addc_u32 s13, s5, 0
    s_mul_i32 s47, s46, 16000
    s_add_u32 s47, s47, 9437184
    s_add_u32 s16, s4, s47
    s_addc_u32 s17, s5, 0
    s_mov_b32 s18, 16000
    s_mov_b32 s19, 0x20000
    s_nop 7
    ds_write_b128 v14, a[144:147] offset:26624
    ds_write_b128 v14, a[148:151] offset:27648
    ds_write_b32 v3, v80 offset:28672
    ds_write_b32 v3, a72 offset:29184
    ds_write_b32 v3, v96 offset:28928
    ds_write_b32 v3, a152 offset:29440
    v_accvgpr_read_b32 v16, a40
    v_accvgpr_read_b32 v17, a41
    v_accvgpr_read_b32 v18, a42
    v_accvgpr_read_b32 v19, a43
    v_accvgpr_read_b32 v20, a44
    v_accvgpr_read_b32 v21, a45
    v_accvgpr_read_b32 v22, a46
    v_accvgpr_read_b32 v23, a47
    v_accvgpr_read_b32 v24, a48
    v_accvgpr_read_b32 v25, a49
    v_accvgpr_read_b32 v26, a50
    v_accvgpr_read_b32 v27, a51
    v_accvgpr_read_b32 v28, a52
    v_accvgpr_read_b32 v29, a53
    v_accvgpr_read_b32 v30, a54
    v_accvgpr_read_b32 v31, a55
    v_accvgpr_read_b32 v32, a56
    v_accvgpr_read_b32 v33, a57
    v_accvgpr_read_b32 v34, a58
    v_accvgpr_read_b32 v35, a59
    v_accvgpr_read_b32 v36, a60
    v_accvgpr_read_b32 v37, a61
    v_accvgpr_read_b32 v38, a62
    v_accvgpr_read_b32 v39, a63
    v_accvgpr_read_b32 v40, a64
    v_accvgpr_read_b32 v41, a65
    v_accvgpr_read_b32 v42, a66
    v_accvgpr_read_b32 v43, a67
    v_accvgpr_read_b32 v44, a68
    v_accvgpr_read_b32 v45, a69
    v_accvgpr_read_b32 v46, a70
    v_accvgpr_read_b32 v47, a71
    v_add_u32 v208, 0, v12
    v_add_u32 v209, 81920, v12
    v_add_u32 v210, 122880, v12
    v_add_u32 v213, 40960, v2
    v_add_u32 v214, 81920, v2
    v_add_u32 v215, 122880, v2
    s_lshl_b32 s44, s40, 1
    s_add_u32 s44, s44, 0
    s_mul_i32 s45, s44, 9216
    s_add_u32 s45, s45, 5120
    s_lshl_b32 s44, s44, 7
    v_and_b32 v197, 31, v13
    v_lshlrev_b32 v197, 2, v197
    s_waitcnt lgkmcnt(0)
    s_barrier
    ds_read_b32 v4, v2 offset:28672
    ds_read_b32 v5, v2 offset:29184
    ds_read_b32 v6, v213 offset:28672
    ds_read_b32 v7, v213 offset:29184
    ds_read_b32 v8, v214 offset:28672
    ds_read_b32 v9, v214 offset:29184
    ds_read_b32 v10, v215 offset:28672
    ds_read_b32 v11, v215 offset:29184
    ds_read_b128 v[56:59], v208 offset:0
    ds_read_b128 v[60:63], v209 offset:10240
    ds_read_b128 v[64:67], v210 offset:10240
    ds_read_b128 v[68:71], v208 offset:1024
    ds_read_b128 v[72:75], v209 offset:11264
    ds_read_b128 v[76:79], v210 offset:11264
    s_waitcnt lgkmcnt(6)
    v_min3_f32 v192, v4, v6, v8
    v_min_f32 v192, v192, v10
    v_sub_f32 v4, v192, v4
    v_sub_f32 v6, v192, v6
    v_sub_f32 v8, v192, v8
    v_sub_f32 v10, v192, v10
    v_exp_f32 v4, v4
    v_exp_f32 v6, v6
    v_exp_f32 v8, v8
    v_exp_f32 v10, v10
    ds_read_b128 v[80:83], v208 offset:2048
    ds_read_b128 v[84:87], v209 offset:12288
    ds_read_b128 v[88:91], v210 offset:12288
    ds_read_b128 v[92:95], v208 offset:3072
    ds_read_b128 v[96:99], v209 offset:13312
    ds_read_b128 v[100:103], v210 offset:13312
    v_mul_f32 v193, v4, v5
    v_fmac_f32 v193, v6, v7
    v_fmac_f32 v193, v8, v9
    v_fmac_f32 v193, v10, v11
    v_rcp_f32 v194, v193
    v_log_f32 v195, v193
    s_nop 0
    v_mul_f32 v4, v4, v194
    v_mul_f32 v6, v6, v194
    v_mul_f32 v8, v8, v194
    v_mul_f32 v10, v10, v194
    v_sub_f32 v195, v195, v192
    v_pk_mul_f32 v[16:17], v[16:17], v[6:7] op_sel_hi:[1,0]
    v_pk_mul_f32 v[18:19], v[18:19], v[6:7] op_sel_hi:[1,0]
    v_pk_mul_f32 v[20:21], v[20:21], v[6:7] op_sel_hi:[1,0]
    v_pk_mul_f32 v[22:23], v[22:23], v[6:7] op_sel_hi:[1,0]
    v_pk_mul_f32 v[24:25], v[24:25], v[6:7] op_sel_hi:[1,0]
    v_pk_mul_f32 v[26:27], v[26:27], v[6:7] op_sel_hi:[1,0]
    v_pk_mul_f32 v[28:29], v[28:29], v[6:7] op_sel_hi:[1,0]
    v_pk_mul_f32 v[30:31], v[30:31], v[6:7] op_sel_hi:[1,0]
    v_pk_mul_f32 v[32:33], v[32:33], v[6:7] op_sel_hi:[1,0]
    v_pk_mul_f32 v[34:35], v[34:35], v[6:7] op_sel_hi:[1,0]
    v_pk_mul_f32 v[36:37], v[36:37], v[6:7] op_sel_hi:[1,0]
    v_pk_mul_f32 v[38:39], v[38:39], v[6:7] op_sel_hi:[1,0]
    v_pk_mul_f32 v[40:41], v[40:41], v[6:7] op_sel_hi:[1,0]
    v_pk_mul_f32 v[42:43], v[42:43], v[6:7] op_sel_hi:[1,0]
    v_pk_mul_f32 v[44:45], v[44:45], v[6:7] op_sel_hi:[1,0]
    v_pk_mul_f32 v[46:47], v[46:47], v[6:7] op_sel_hi:[1,0]
    s_waitcnt lgkmcnt(9)
    v_pk_fma_f32 v[16:17], v[56:57], v[4:5], v[16:17] op_sel_hi:[1,0,1]
    v_pk_fma_f32 v[18:19], v[58:59], v[4:5], v[18:19] op_sel_hi:[1,0,1]
    v_pk_fma_f32 v[16:17], v[60:61], v[8:9], v[16:17] op_sel_hi:[1,0,1]
    v_pk_fma_f32 v[18:19], v[62:63], v[8:9], v[18:19] op_sel_hi:[1,0,1]
    v_pk_fma_f32 v[16:17], v[64:65], v[10:11], v[16:17] op_sel_hi:[1,0,1]
    v_pk_fma_f32 v[18:19], v[66:67], v[10:11], v[18:19] op_sel_hi:[1,0,1]
    v_cvt_pk_bf16_f32 v216, v16, v17
    v_cvt_pk_bf16_f32 v217, v18, v19
    ds_read_b128 v[104:107], v208 offset:4096
    ds_read_b128 v[108:111], v209 offset:14336
    ds_read_b128 v[112:115], v210 offset:14336
    s_waitcnt lgkmcnt(9)
    v_pk_fma_f32 v[20:21], v[68:69], v[4:5], v[20:21] op_sel_hi:[1,0,1]
    v_pk_fma_f32 v[22:23], v[70:71], v[4:5], v[22:23] op_sel_hi:[1,0,1]
    v_pk_fma_f32 v[20:21], v[72:73], v[8:9], v[20:21] op_sel_hi:[1,0,1]
    v_pk_fma_f32 v[22:23], v[74:75], v[8:9], v[22:23] op_sel_hi:[1,0,1]
    v_pk_fma_f32 v[20:21], v[76:77], v[10:11], v[20:21] op_sel_hi:[1,0,1]
    v_pk_fma_f32 v[22:23], v[78:79], v[10:11], v[22:23] op_sel_hi:[1,0,1]
    v_cvt_pk_bf16_f32 v218, v20, v21
    v_cvt_pk_bf16_f32 v219, v22, v23
    buffer_store_dwordx4 v[216:219], v12, s[12:15], s45 offen offset:0 sc1
    ds_read_b128 v[116:119], v208 offset:5120
    ds_read_b128 v[120:123], v209 offset:15360
    ds_read_b128 v[124:127], v210 offset:15360
    s_waitcnt lgkmcnt(9)
    v_pk_fma_f32 v[24:25], v[80:81], v[4:5], v[24:25] op_sel_hi:[1,0,1]
    v_pk_fma_f32 v[26:27], v[82:83], v[4:5], v[26:27] op_sel_hi:[1,0,1]
    v_pk_fma_f32 v[24:25], v[84:85], v[8:9], v[24:25] op_sel_hi:[1,0,1]
    v_pk_fma_f32 v[26:27], v[86:87], v[8:9], v[26:27] op_sel_hi:[1,0,1]
    v_pk_fma_f32 v[24:25], v[88:89], v[10:11], v[24:25] op_sel_hi:[1,0,1]
    v_pk_fma_f32 v[26:27], v[90:91], v[10:11], v[26:27] op_sel_hi:[1,0,1]
    v_cvt_pk_bf16_f32 v220, v24, v25
    v_cvt_pk_bf16_f32 v221, v26, v27
    ds_read_b128 v[128:131], v208 offset:6144
    ds_read_b128 v[132:135], v209 offset:16384
    ds_read_b128 v[136:139], v210 offset:16384
    s_waitcnt lgkmcnt(9)
    v_pk_fma_f32 v[28:29], v[92:93], v[4:5], v[28:29] op_sel_hi:[1,0,1]
    v_pk_fma_f32 v[30:31], v[94:95], v[4:5], v[30:31] op_sel_hi:[1,0,1]
    v_pk_fma_f32 v[28:29], v[96:97], v[8:9], v[28:29] op_sel_hi:[1,0,1]
    v_pk_fma_f32 v[30:31], v[98:99], v[8:9], v[30:31] op_sel_hi:[1,0,1]
    v_pk_fma_f32 v[28:29], v[100:101], v[10:11], v[28:29] op_sel_hi:[1,0,1]
    v_pk_fma_f32 v[30:31], v[102:103], v[10:11], v[30:31] op_sel_hi:[1,0,1]
    v_cvt_pk_bf16_f32 v222, v28, v29
    v_cvt_pk_bf16_f32 v223, v30, v31
    buffer_store_dwordx4 v[220:223], v12, s[12:15], s45 offen offset:1024 sc1
    ds_read_b128 v[140:143], v208 offset:7168
    ds_read_b128 v[144:147], v209 offset:17408
    ds_read_b128 v[148:151], v210 offset:17408
    s_waitcnt lgkmcnt(9)
    v_pk_fma_f32 v[32:33], v[104:105], v[4:5], v[32:33] op_sel_hi:[1,0,1]
    v_pk_fma_f32 v[34:35], v[106:107], v[4:5], v[34:35] op_sel_hi:[1,0,1]
    v_pk_fma_f32 v[32:33], v[108:109], v[8:9], v[32:33] op_sel_hi:[1,0,1]
    v_pk_fma_f32 v[34:35], v[110:111], v[8:9], v[34:35] op_sel_hi:[1,0,1]
    v_pk_fma_f32 v[32:33], v[112:113], v[10:11], v[32:33] op_sel_hi:[1,0,1]
    v_pk_fma_f32 v[34:35], v[114:115], v[10:11], v[34:35] op_sel_hi:[1,0,1]
    v_cvt_pk_bf16_f32 v224, v32, v33
    v_cvt_pk_bf16_f32 v225, v34, v35
    s_waitcnt lgkmcnt(6)
    v_pk_fma_f32 v[36:37], v[116:117], v[4:5], v[36:37] op_sel_hi:[1,0,1]
    v_pk_fma_f32 v[38:39], v[118:119], v[4:5], v[38:39] op_sel_hi:[1,0,1]
    v_pk_fma_f32 v[36:37], v[120:121], v[8:9], v[36:37] op_sel_hi:[1,0,1]
    v_pk_fma_f32 v[38:39], v[122:123], v[8:9], v[38:39] op_sel_hi:[1,0,1]
    v_pk_fma_f32 v[36:37], v[124:125], v[10:11], v[36:37] op_sel_hi:[1,0,1]
    v_pk_fma_f32 v[38:39], v[126:127], v[10:11], v[38:39] op_sel_hi:[1,0,1]
    v_cvt_pk_bf16_f32 v226, v36, v37
    v_cvt_pk_bf16_f32 v227, v38, v39
    buffer_store_dwordx4 v[224:227], v12, s[12:15], s45 offen offset:2048 sc1
    s_waitcnt lgkmcnt(3)
    v_pk_fma_f32 v[40:41], v[128:129], v[4:5], v[40:41] op_sel_hi:[1,0,1]
    v_pk_fma_f32 v[42:43], v[130:131], v[4:5], v[42:43] op_sel_hi:[1,0,1]
    v_pk_fma_f32 v[40:41], v[132:133], v[8:9], v[40:41] op_sel_hi:[1,0,1]
    v_pk_fma_f32 v[42:43], v[134:135], v[8:9], v[42:43] op_sel_hi:[1,0,1]
    v_pk_fma_f32 v[40:41], v[136:137], v[10:11], v[40:41] op_sel_hi:[1,0,1]
    v_pk_fma_f32 v[42:43], v[138:139], v[10:11], v[42:43] op_sel_hi:[1,0,1]
    v_cvt_pk_bf16_f32 v228, v40, v41
    v_cvt_pk_bf16_f32 v229, v42, v43
    s_waitcnt lgkmcnt(0)
    v_pk_fma_f32 v[44:45], v[140:141], v[4:5], v[44:45] op_sel_hi:[1,0,1]
    v_pk_fma_f32 v[46:47], v[142:143], v[4:5], v[46:47] op_sel_hi:[1,0,1]
    v_pk_fma_f32 v[44:45], v[144:145], v[8:9], v[44:45] op_sel_hi:[1,0,1]
    v_pk_fma_f32 v[46:47], v[146:147], v[8:9], v[46:47] op_sel_hi:[1,0,1]
    v_pk_fma_f32 v[44:45], v[148:149], v[10:11], v[44:45] op_sel_hi:[1,0,1]
    v_pk_fma_f32 v[46:47], v[150:151], v[10:11], v[46:47] op_sel_hi:[1,0,1]
    v_cvt_pk_bf16_f32 v230, v44, v45
    v_cvt_pk_bf16_f32 v231, v46, v47
    buffer_store_dwordx4 v[228:231], v12, s[12:15], s45 offen offset:3072 sc1
    s_endpgm
L_k2_last2:
    s_waitcnt vmcnt(0) lgkmcnt(0)
    ds_read_b64_tr_b16 v[180:181], v163 offset:30720
    ds_read_b64_tr_b16 v[182:183], v164 offset:30720
    ds_read_b64_tr_b16 v[184:185], v163 offset:34816
    ds_read_b64_tr_b16 v[186:187], v164 offset:34816
    ds_read_b64_tr_b16 v[188:189], v165 offset:30720
    ds_read_b64_tr_b16 v[190:191], v166 offset:30720
    v_exp_f32 v145, v57
    s_nop 0
    v_cvt_pk_bf16_f32 v132, v144, v145
    v_exp_f32 v146, v72
    v_exp_f32 v147, v73
    s_nop 0
    v_cvt_pk_bf16_f32 v140, v146, v147
    v_or3_b32 v152, v132, v140, v152
    v_exp_f32 v148, v58
    v_exp_f32 v149, v59
    s_nop 0
    v_cvt_pk_bf16_f32 v133, v148, v149
    v_exp_f32 v150, v74
    v_exp_f32 v151, v75
    s_nop 0
    v_cvt_pk_bf16_f32 v141, v150, v151
    v_or3_b32 v152, v133, v141, v152
    v_exp_f32 v144, v60
    v_exp_f32 v145, v61
    s_nop 0
    v_cvt_pk_bf16_f32 v134, v144, v145
    v_exp_f32 v146, v76
    v_exp_f32 v147, v77
    s_nop 0
    v_cvt_pk_bf16_f32 v142, v146, v147
    v_or3_b32 v152, v134, v142, v152
    v_exp_f32 v148, v62
    v_exp_f32 v149, v63
    s_nop 0
    v_cvt_pk_bf16_f32 v135, v148, v149
    v_exp_f32 v150, v78
    v_exp_f32 v151, v79
    s_nop 0
    v_cvt_pk_bf16_f32 v143, v150, v151
    v_or3_b32 v152, v135, v143, v152
    v_lshl_or_b32 v153, v152, 16, v152
    v_cmp_le_u32 vcc, 0x40000000, v153
    s_cbranch_vccnz L_k2_rareL2
L_k2_retL2:
    s_waitcnt lgkmcnt(4)
    v_mfma_f32_32x32x16_bf16 a[0:15], v[180:183], v[128:131], a[0:15]
    v_mfma_f32_32x32x16_bf16 a[80:95], v[180:183], v[136:139], a[80:95]
    ds_read_b64_tr_b16 v[192:193], v165 offset:34816
    ds_read_b64_tr_b16 v[194:195], v166 offset:34816
    s_waitcnt lgkmcnt(4)
    v_mfma_f32_32x32x16_bf16 a[0:15], v[184:187], v[132:135], a[0:15]
    v_mfma_f32_32x32x16_bf16 a[80:95], v[184:187], v[140:143], a[80:95]
    ds_read_b64_tr_b16 v[196:197], v167 offset:30720
    ds_read_b64_tr_b16 v[198:199], v168 offset:30720
    s_waitcnt lgkmcnt(4)
    v_mfma_f32_32x32x16_bf16 a[16:31], v[188:191], v[128:131], a[16:31]
    v_mfma_f32_32x32x16_bf16 a[96:111], v[188:191], v[136:139], a[96:111]
    ds_read_b64_tr_b16 v[200:201], v167 offset:34816
    ds_read_b64_tr_b16 v[202:203], v168 offset:34816
    ds_write_b128 v14, a[0:3] offset:0
    ds_write_b128 v14, a[4:7] offset:1024
    s_waitcnt lgkmcnt(6)
    v_mfma_f32_32x32x16_bf16 a[16:31], v[192:195], v[132:135], a[16:31]
    ds_write_b128 v14, a[8:11] offset:2048
    ds_write_b128 v14, a[12:15] offset:3072
    v_mfma_f32_32x32x16_bf16 a[96:111], v[192:195], v[140:143], a[96:111]
    ds_read_b64_tr_b16 v[204:205], v169 offset:30720
    ds_read_b64_tr_b16 v[206:207], v170 offset:30720
    s_waitcnt lgkmcnt(8)
    v_mfma_f32_32x32x16_bf16 a[32:47], v[196:199], v[128:131], a[32:47]
    v_mfma_f32_32x32x16_bf16 a[112:127], v[196:199], v[136:139], a[112:127]
    ds_read_b64_tr_b16 v[208:209], v169 offset:34816
    ds_read_b64_tr_b16 v[210:211], v170 offset:34816
    ds_write_b128 v14, a[16:19] offset:4096
    ds_write_b128 v14, a[20:23] offset:5120
    s_waitcnt lgkmcnt(10)
    v_mfma_f32_32x32x16_bf16 a[32:47], v[200:203], v[132:135], a[32:47]
    ds_write_b128 v14, a[24:27] offset:6144
    ds_write_b128 v14, a[28:31] offset:7168
    v_mfma_f32_32x32x16_bf16 a[112:127], v[200:203], v[140:143], a[112:127]
    ds_read_b64_tr_b16 v[212:213], v171 offset:30720
    ds_read_b64_tr_b16 v[214:215], v172 offset:30720
    s_waitcnt lgkmcnt(8)
    v_mfma_f32_32x32x16_bf16 a[48:63], v[204:207], v[128:131], a[48:63]
    v_mfma_f32_32x32x16_bf16 a[128:143], v[204:207], v[136:139], a[128:143]
    ds_read_b64_tr_b16 v[216:217], v171 offset:31232
    ds_read_b64_tr_b16 v[218:219], v172 offset:31232
    ds_write_b128 v14, a[32:35] offset:8192
    ds_write_b128 v14, a[36:39] offset:9216
    s_waitcnt lgkmcnt(10)
    v_mfma_f32_32x32x16_bf16 a[48:63], v[208:211], v[132:135], a[48:63]
    ds_write_b128 v14, a[40:43] offset:10240
    ds_write_b128 v14, a[44:47] offset:11264
    v_mfma_f32_32x32x16_bf16 a[128:143], v[208:211], v[140:143], a[128:143]
    ds_write_b128 v14, a[120:123] offset:18432
    ds_write_b128 v14, a[124:127] offset:19456
    s_waitcnt lgkmcnt(8)
    v_mfma_f32_32x32x16_bf16 a[64:79], v[212:215], v[128:131], a[64:79]
    v_mfma_f32_32x32x16_bf16 a[144:159], v[212:215], v[136:139], a[144:159]
    ds_write_b128 v14, a[48:51] offset:12288
    ds_write_b128 v14, a[52:55] offset:13312
    s_waitcnt lgkmcnt(8)
    v_mfma_f32_32x32x16_bf16 a[64:79], v[216:219], v[132:135], a[64:79]
    ds_write_b128 v14, a[56:59] offset:14336
    ds_write_b128 v14, a[60:63] offset:15360
    v_mfma_f32_32x32x16_bf16 a[144:159], v[216:219], v[140:143], a[144:159]
    ds_write_b128 v14, a[128:131] offset:20480
    ds_write_b128 v14, a[132:135] offset:21504
    v_lshlrev_b32 v2, 2, v13
    v_add_u32 v3, s26, v2
    s_lshl_b32 s46, s42, 1
    s_add_u32 s46, s46, s41
    s_mul_i32 s47, s46, 1152000
    s_add_u32 s47, s47, 4718592
    s_add_u32 s12, s4, s47
    s_addc_u32 s13, s5, 0
    s_mul_i32 s47, s46, 16000
    s_add_u32 s47, s47, 9437184
    s_add_u32 s16, s4, s47
    s_addc_u32 s17, s5, 0
    s_mov_b32 s18, 16000
    s_mov_b32 s19, 0x20000
    ds_write_b128 v14, a[136:139] offset:22528
    ds_write_b128 v14, a[140:143] offset:23552
    s_nop 7
    ds_write_b128 v14, a[64:67] offset:16384
    ds_write_b128 v14, a[68:71] offset:17408
    ds_write_b128 v14, a[144:147] offset:24576
    ds_write_b128 v14, a[148:151] offset:25600
    ds_write_b32 v3, v80 offset:28672
    ds_write_b32 v3, a72 offset:29184
    ds_write_b32 v3, v96 offset:28928
    ds_write_b32 v3, a152 offset:29440
    v_accvgpr_read_b32 v16, a80
    v_accvgpr_read_b32 v17, a81
    v_accvgpr_read_b32 v18, a82
    v_accvgpr_read_b32 v19, a83
    v_accvgpr_read_b32 v20, a84
    v_accvgpr_read_b32 v21, a85
    v_accvgpr_read_b32 v22, a86
    v_accvgpr_read_b32 v23, a87
    v_accvgpr_read_b32 v24, a88
    v_accvgpr_read_b32 v25, a89
    v_accvgpr_read_b32 v26, a90
    v_accvgpr_read_b32 v27, a91
    v_accvgpr_read_b32 v28, a92
    v_accvgpr_read_b32 v29, a93
    v_accvgpr_read_b32 v30, a94
    v_accvgpr_read_b32 v31, a95
    v_accvgpr_read_b32 v32, a96
    v_accvgpr_read_b32 v33, a97
    v_accvgpr_read_b32 v34, a98
    v_accvgpr_read_b32 v35, a99
    v_accvgpr_read_b32 v36, a100
    v_accvgpr_read_b32 v37, a101
    v_accvgpr_read_b32 v38, a102
    v_accvgpr_read_b32 v39, a103
    v_accvgpr_read_b32 v40, a104
    v_accvgpr_read_b32 v41, a105
    v_accvgpr_read_b32 v42, a106
    v_accvgpr_read_b32 v43, a107
    v_accvgpr_read_b32 v44, a108
    v_accvgpr_read_b32 v45, a109
    v_accvgpr_read_b32 v46, a110
    v_accvgpr_read_b32 v47, a111
    v_accvgpr_read_b32 v48, a112
    v_accvgpr_read_b32 v49, a113
    v_accvgpr_read_b32 v50, a114
    v_accvgpr_read_b32 v51, a115
    v_accvgpr_read_b32 v52, a116
    v_accvgpr_read_b32 v53, a117
    v_accvgpr_read_b32 v54, a118
    v_accvgpr_read_b32 v55, a119
    v_add_u32 v208, 0, v12
    v_add_u32 v209, 40960, v12
    v_add_u32 v210, 122880, v12
    v_add_u32 v213, 40960, v2
    v_add_u32 v214, 81920, v2
    v_add_u32 v215, 122880, v2
    s_lshl_b32 s44, s40, 1
    s_add_u32 s44, s44, 1
    s_mul_i32 s45, s44, 9216
    s_add_u32 s45, s45, 0
    s_lshl_b32 s44, s44, 7
    v_and_b32 v197, 31, v13
    v_lshlrev_b32 v197, 2, v197
    s_waitcnt lgkmcnt(0)
    s_barrier
    ds_read_b32 v4, v2 offset:28928
    ds_read_b32 v5, v2 offset:29440
    ds_read_b32 v6, v213 offset:28928
    ds_read_b32 v7, v213 offset:29440
    ds_read_b32 v8, v214 offset:28928
    ds_read_b32 v9, v214 offset:29440
    ds_read_b32 v10, v215 offset:28928
    ds_read_b32 v11, v215 offset:29440
    ds_read_b128 v[56:59], v208 offset:8192
    ds_read_b128 v[60:63], v209 offset:10240
    ds_read_b128 v[64:67], v210 offset:18432
    ds_read_b128 v[68:71], v208 offset:9216
    ds_read_b128 v[72:75], v209 offset:11264
    ds_read_b128 v[76:79], v210 offset:19456
    s_waitcnt lgkmcnt(6)
    v_min3_f32 v192, v4, v6, v8
    v_min_f32 v192, v192, v10
    v_sub_f32 v4, v192, v4
    v_sub_f32 v6, v192, v6
    v_sub_f32 v8, v192, v8
    v_sub_f32 v10, v192, v10
    v_exp_f32 v4, v4
    v_exp_f32 v6, v6
    v_exp_f32 v8, v8
    v_exp_f32 v10, v10
    ds_read_b128 v[80:83], v208 offset:10240
    ds_read_b128 v[84:87], v209 offset:12288
    ds_read_b128 v[88:91], v210 offset:20480
    ds_read_b128 v[92:95], v208 offset:11264
    ds_read_b128 v[96:99], v209 offset:13312
    ds_read_b128 v[100:103], v210 offset:21504
    v_mul_f32 v193, v4, v5
    v_fmac_f32 v193, v6, v7
    v_fmac_f32 v193, v8, v9
    v_fmac_f32 v193, v10, v11
    v_rcp_f32 v194, v193
    v_log_f32 v195, v193
    s_nop 0
    v_mul_f32 v4, v4, v194
    v_mul_f32 v6, v6, v194
    v_mul_f32 v8, v8, v194
    v_mul_f32 v10, v10, v194
    v_sub_f32 v195, v195, v192
    buffer_store_dword v195, v197, s[16:19], s44 offen sc1
    v_pk_mul_f32 v[16:17], v[16:17], v[8:9] op_sel_hi:[1,0]
    v_pk_mul_f32 v[18:19], v[18:19], v[8:9] op_sel_hi:[1,0]
    v_pk_mul_f32 v[20:21], v[20:21], v[8:9] op_sel_hi:[1,0]
    v_pk_mul_f32 v[22:23], v[22:23], v[8:9] op_sel_hi:[1,0]
    v_pk_mul_f32 v[24:25], v[24:25], v[8:9] op_sel_hi:[1,0]
    v_pk_mul_f32 v[26:27], v[26:27], v[8:9] op_sel_hi:[1,0]
    v_pk_mul_f32 v[28:29], v[28:29], v[8:9] op_sel_hi:[1,0]
    v_pk_mul_f32 v[30:31], v[30:31], v[8:9] op_sel_hi:[1,0]
    v_pk_mul_f32 v[32:33], v[32:33], v[8:9] op_sel_hi:[1,0]
    v_pk_mul_f32 v[34:35], v[34:35], v[8:9] op_sel_hi:[1,0]
    v_pk_mul_f32 v[36:37], v[36:37], v[8:9] op_sel_hi:[1,0]
    v_pk_mul_f32 v[38:39], v[38:39], v[8:9] op_sel_hi:[1,0]
    v_pk_mul_f32 v[40:41], v[40:41], v[8:9] op_sel_hi:[1,0]
    v_pk_mul_f32 v[42:43], v[42:43], v[8:9] op_sel_hi:[1,0]
    v_pk_mul_f32 v[44:45], v[44:45], v[8:9] op_sel_hi:[1,0]
    v_pk_mul_f32 v[46:47], v[46:47], v[8:9] op_sel_hi:[1,0]
    v_pk_mul_f32 v[48:49], v[48:49], v[8:9] op_sel_hi:[1,0]
    v_pk_mul_f32 v[50:51], v[50:51], v[8:9] op_sel_hi:[1,0]
    v_pk_mul_f32 v[52:53], v[52:53], v[8:9] op_sel_hi:[1,0]
    v_pk_mul_f32 v[54:55], v[54:55], v[8:9] op_sel_hi:[1,0]
    s_waitcnt lgkmcnt(9)
    v_pk_fma_f32 v[16:17], v[56:57], v[4:5], v[16:17] op_sel_hi:[1,0,1]
    v_pk_fma_f32 v[18:19], v[58:59], v[4:5], v[18:19] op_sel_hi:[1,0,1]
    v_pk_fma_f32 v[16:17], v[60:61], v[6:7], v[16:17] op_sel_hi:[1,0,1]
    v_pk_fma_f32 v[18:19], v[62:63], v[6:7], v[18:19] op_sel_hi:[1,0,1]
    v_pk_fma_f32 v[16:17], v[64:65], v[10:11], v[16:17] op_sel_hi:[1,0,1]
    v_pk_fma_f32 v[18:19], v[66:67], v[10:11], v[18:19] op_sel_hi:[1,0,1]
    v_cvt_pk_bf16_f32 v216, v16, v17
    v_cvt_pk_bf16_f32 v217, v18, v19
    ds_read_b128 v[104:107], v208 offset:12288
    ds_read_b128 v[108:111], v209 offset:14336
    ds_read_b128 v[112:115], v210 offset:22528
    s_waitcnt lgkmcnt(9)
    v_pk_fma_f32 v[20:21], v[68:69], v[4:5], v[20:21] op_sel_hi:[1,0,1]
    v_pk_fma_f32 v[22:23], v[70:71], v[4:5], v[22:23] op_sel_hi:[1,0,1]
    v_pk_fma_f32 v[20:21], v[72:73], v[6:7], v[20:21] op_sel_hi:[1,0,1]
    v_pk_fma_f32 v[22:23], v[74:75], v[6:7], v[22:23] op_sel_hi:[1,0,1]
    v_pk_fma_f32 v[20:21], v[76:77], v[10:11], v[20:21] op_sel_hi:[1,0,1]
    v_pk_fma_f32 v[22:23], v[78:79], v[10:11], v[22:23] op_sel_hi:[1,0,1]
    v_cvt_pk_bf16_f32 v218, v20, v21
    v_cvt_pk_bf16_f32 v219, v22, v23
    buffer_store_dwordx4 v[216:219], v12, s[12:15], s45 offen offset:0 sc1
    ds_read_b128 v[116:119], v208 offset:13312
    ds_read_b128 v[120:123], v209 offset:15360
    ds_read_b128 v[124:127], v210 offset:23552
    s_waitcnt lgkmcnt(9)
    v_pk_fma_f32 v[24:25], v[80:81], v[4:5], v[24:25] op_sel_hi:[1,0,1]
    v_pk_fma_f32 v[26:27], v[82:83], v[4:5], v[26:27] op_sel_hi:[1,0,1]
    v_pk_fma_f32 v[24:25], v[84:85], v[6:7], v[24:25] op_sel_hi:[1,0,1]
    v_pk_fma_f32 v[26:27], v[86:87], v[6:7], v[26:27] op_sel_hi:[1,0,1]
    v_pk_fma_f32 v[24:25], v[88:89], v[10:11], v[24:25] op_sel_hi:[1,0,1]
    v_pk_fma_f32 v[26:27], v[90:91], v[10:11], v[26:27] op_sel_hi:[1,0,1]
    v_cvt_pk_bf16_f32 v220, v24, v25
    v_cvt_pk_bf16_f32 v221, v26, v27
    ds_read_b128 v[128:131], v208 offset:14336
    ds_read_b128 v[132:135], v209 offset:16384
    ds_read_b128 v[136:139], v210 offset:24576
    s_waitcnt lgkmcnt(9)
    v_pk_fma_f32 v[28:29], v[92:93], v[4:5], v[28:29] op_sel_hi:[1,0,1]
    v_pk_fma_f32 v[30:31], v[94:95], v[4:5], v[30:31] op_sel_hi:[1,0,1]
    v_pk_fma_f32 v[28:29], v[96:97], v[6:7], v[28:29] op_sel_hi:[1,0,1]
    v_pk_fma_f32 v[30:31], v[98:99], v[6:7], v[30:31] op_sel_hi:[1,0,1]
    v_pk_fma_f32 v[28:29], v[100:101], v[10:11], v[28:29] op_sel_hi:[1,0,1]
    v_pk_fma_f32 v[30:31], v[102:103], v[10:11], v[30:31] op_sel_hi:[1,0,1]
    v_cvt_pk_bf16_f32 v222, v28, v29
    v_cvt_pk_bf16_f32 v223, v30, v31
    buffer_store_dwordx4 v[220:223], v12, s[12:15], s45 offen offset:1024 sc1
    ds_read_b128 v[140:143], v208 offset:15360
    ds_read_b128 v[144:147], v209 offset:17408
    ds_read_b128 v[148:151], v210 offset:25600
    s_waitcnt lgkmcnt(9)
    v_pk_fma_f32 v[32:33], v[104:105], v[4:5], v[32:33] op_sel_hi:[1,0,1]
    v_pk_fma_f32 v[34:35], v[106:107], v[4:5], v[34:35] op_sel_hi:[1,0,1]
    v_pk_fma_f32 v[32:33], v[108:109], v[6:7], v[32:33] op_sel_hi:[1,0,1]
    v_pk_fma_f32 v[34:35], v[110:111], v[6:7], v[34:35] op_sel_hi:[1,0,1]
    v_pk_fma_f32 v[32:33], v[112:113], v[10:11], v[32:33] op_sel_hi:[1,0,1]
    v_pk_fma_f32 v[34:35], v[114:115], v[10:11], v[34:35] op_sel_hi:[1,0,1]
    v_cvt_pk_bf16_f32 v224, v32, v33
    v_cvt_pk_bf16_f32 v225, v34, v35
    ds_read_b128 v[152:155], v208 offset:16384
    ds_read_b128 v[156:159], v209 offset:18432
    ds_read_b128 v[160:163], v210 offset:26624
    s_waitcnt lgkmcnt(9)
    v_pk_fma_f32 v[36:37], v[116:117], v[4:5], v[36:37] op_sel_hi:[1,0,1]
    v_pk_fma_f32 v[38:39], v[118:119], v[4:5], v[38:39] op_sel_hi:[1,0,1]
    v_pk_fma_f32 v[36:37], v[120:121], v[6:7], v[36:37] op_sel_hi:[1,0,1]
    v_pk_fma_f32 v[38:39], v[122:123], v[6:7], v[38:39] op_sel_hi:[1,0,1]
    v_pk_fma_f32 v[36:37], v[124:125], v[10:11], v[36:37] op_sel_hi:[1,0,1]
    v_pk_fma_f32 v[38:39], v[126:127], v[10:11], v[38:39] op_sel_hi:[1,0,1]
    v_cvt_pk_bf16_f32 v226, v36, v37
    v_cvt_pk_bf16_f32 v227, v38, v39
    buffer_store_dwordx4 v[224:227], v12, s[12:15], s45 offen offset:2048 sc1
    ds_read_b128 v[164:167], v208 offset:17408
    ds_read_b128 v[168:171], v209 offset:19456
    ds_read_b128 v[172:175], v210 offset:27648
    s_waitcnt lgkmcnt(9)
    v_pk_fma_f32 v[40:41], v[128:129], v[4:5], v[40:41] op_sel_hi:[1,0,1]
    v_pk_fma_f32 v[42:43], v[130:131], v[4:5], v[42:43] op_sel_hi:[1,0,1]
    v_pk_fma_f32 v[40:41], v[132:133], v[6:7], v[40:41] op_sel_hi:[1,0,1]
    v_pk_fma_f32 v[42:43], v[134:135], v[6:7], v[42:43] op_sel_hi:[1,0,1]
    v_pk_fma_f32 v[40:41], v[136:137], v[10:11], v[40:41] op_sel_hi:[1,0,1]
    v_pk_fma_f32 v[42:43], v[138:139], v[10:11], v[42:43] op_sel_hi:[1,0,1]
    v_cvt_pk_bf16_f32 v228, v40, v41
    v_cvt_pk_bf16_f32 v229, v42, v43
    s_waitcnt lgkmcnt(6)
    v_pk_fma_f32 v[44:45], v[140:141], v[4:5], v[44:45] op_sel_hi:[1,0,1]
    v_pk_fma_f32 v[46:47], v[142:143], v[4:5], v[46:47] op_sel_hi:[1,0,1]
    v_pk_fma_f32 v[44:45], v[144:145], v[6:7], v[44:45] op_sel_hi:[1,0,1]
    v_pk_fma_f32 v[46:47], v[146:147], v[6:7], v[46:47] op_sel_hi:[1,0,1]
    v_pk_fma_f32 v[44:45], v[148:149], v[10:11], v[44:45] op_sel_hi:[1,0,1]
    v_pk_fma_f32 v[46:47], v[150:151], v[10:11], v[46:47] op_sel_hi:[1,0,1]
    v_cvt_pk_bf16_f32 v230, v44, v45
    v_cvt_pk_bf16_f32 v231, v46, v47
    buffer_store_dwordx4 v[228:231], v12, s[12:15], s45 offen offset:3072 sc1
    s_waitcnt lgkmcnt(3)
    v_pk_fma_f32 v[48:49], v[152:153], v[4:5], v[48:49] op_sel_hi:[1,0,1]
    v_pk_fma_f32 v[50:51], v[154:155], v[4:5], v[50:51] op_sel_hi:[1,0,1]
    v_pk_fma_f32 v[48:49], v[156:157], v[6:7], v[48:49] op_sel_hi:[1,0,1]
    v_pk_fma_f32 v[50:51], v[158:159], v[6:7], v[50:51] op_sel_hi:[1,0,1]
    v_pk_fma_f32 v[48:49], v[160:161], v[10:11], v[48:49] op_sel_hi:[1,0,1]
    v_pk_fma_f32 v[50:51], v[162:163], v[10:11], v[50:51] op_sel_hi:[1,0,1]
    v_cvt_pk_bf16_f32 v232, v48, v49
    v_cvt_pk_bf16_f32 v233, v50, v51
    s_waitcnt lgkmcnt(0)
    v_pk_fma_f32 v[52:53], v[164:165], v[4:5], v[52:53] op_sel_hi:[1,0,1]
    v_pk_fma_f32 v[54:55], v[166:167], v[4:5], v[54:55] op_sel_hi:[1,0,1]
    v_pk_fma_f32 v[52:53], v[168:169], v[6:7], v[52:53] op_sel_hi:[1,0,1]
    v_pk_fma_f32 v[54:55], v[170:171], v[6:7], v[54:55] op_sel_hi:[1,0,1]
    v_pk_fma_f32 v[52:53], v[172:173], v[10:11], v[52:53] op_sel_hi:[1,0,1]
    v_pk_fma_f32 v[54:55], v[174:175], v[10:11], v[54:55] op_sel_hi:[1,0,1]
    v_cvt_pk_bf16_f32 v234, v52, v53
    v_cvt_pk_bf16_f32 v235, v54, v55
    s_add_u32 s45, s45, 4096
    buffer_store_dwordx4 v[232:235], v12, s[12:15], s45 offen offset:0 sc1
    s_endpgm
L_k2_last3:
    s_waitcnt vmcnt(0) lgkmcnt(0)
    ds_read_b64_tr_b16 v[180:181], v163 offset:30720
    ds_read_b64_tr_b16 v[182:183], v164 offset:30720
    ds_read_b64_tr_b16 v[184:185], v163 offset:34816
    ds_read_b64_tr_b16 v[186:187], v164 offset:34816
    ds_read_b64_tr_b16 v[188:189], v165 offset:30720
    ds_read_b64_tr_b16 v[190:191], v166 offset:30720
    v_exp_f32 v145, v57
    s_nop 0
    v_cvt_pk_bf16_f32 v132, v144, v145
    v_exp_f32 v146, v72
    v_exp_f32 v147, v73
    s_nop 0
    v_cvt_pk_bf16_f32 v140, v146, v147
    v_or3_b32 v152, v132, v140, v152
    v_exp_f32 v148, v58
    v_exp_f32 v149, v59
    s_nop 0
    v_cvt_pk_bf16_f32 v133, v148, v149
    v_exp_f32 v150, v74
    v_exp_f32 v151, v75
    s_nop 0
    v_cvt_pk_bf16_f32 v141, v150, v151
    v_or3_b32 v152, v133, v141, v152
    v_exp_f32 v144, v60
    v_exp_f32 v145, v61
    s_nop 0
    v_cvt_pk_bf16_f32 v134, v144, v145
    v_exp_f32 v146, v76
    v_exp_f32 v147, v77
    s_nop 0
    v_cvt_pk_bf16_f32 v142, v146, v147
    v_or3_b32 v152, v134, v142, v152
    v_exp_f32 v148, v62
    v_exp_f32 v149, v63
    s_nop 0
    v_cvt_pk_bf16_f32 v135, v148, v149
    v_exp_f32 v150, v78
    v_exp_f32 v151, v79
    s_nop 0
    v_cvt_pk_bf16_f32 v143, v150, v151
    v_or3_b32 v152, v135, v143, v152
    v_lshl_or_b32 v153, v152, 16, v152
    v_cmp_le_u32 vcc, 0x40000000, v153
    s_cbranch_vccnz L_k2_rareL3
L_k2_retL3:
    s_waitcnt lgkmcnt(4)
    v_mfma_f32_32x32x16_bf16 a[0:15], v[180:183], v[128:131], a[0:15]
    v_mfma_f32_32x32x16_bf16 a[80:95], v[180:183], v[136:139], a[80:95]
    ds_read_b64_tr_b16 v[192:193], v165 offset:34816
    ds_read_b64_tr_b16 v[194:195], v166 offset:34816
    s_waitcnt lgkmcnt(4)
    v_mfma_f32_32x32x16_bf16 a[0:15], v[184:187], v[132:135], a[0:15]
    v_mfma_f32_32x32x16_bf16 a[80:95], v[184:187], v[140:143], a[80:95]
    ds_read_b64_tr_b16 v[196:197], v167 offset:30720
    ds_read_b64_tr_b16 v[198:199], v168 offset:30720
    s_waitcnt lgkmcnt(4)
    v_mfma_f32_32x32x16_bf16 a[16:31], v[188:191], v[128:131], a[16:31]
    v_mfma_f32_32x32x16_bf16 a[96:111], v[188:191], v[136:139], a[96:111]
    ds_read_b64_tr_b16 v[200:201], v167 offset:34816
    ds_read_b64_tr_b16 v[202:203], v168 offset:34816
    ds_write_b128 v14, a[0:3] offset:0
    ds_write_b128 v14, a[4:7] offset:1024
    s_waitcnt lgkmcnt(6)
    v_mfma_f32_32x32x16_bf16 a[16:31], v[192:195], v[132:135], a[16:31]
    ds_write_b128 v14, a[8:11] offset:2048
    ds_write_b128 v14, a[12:15] offset:3072
    v_mfma_f32_32x32x16_bf16 a[96:111], v[192:195], v[140:143], a[96:111]
    ds_read_b64_tr_b16 v[204:205], v169 offset:30720
    ds_read_b64_tr_b16 v[206:207], v170 offset:30720
    ds_write_b128 v14, a[80:83] offset:18432
    ds_write_b128 v14, a[84:87] offset:19456
    s_waitcnt lgkmcnt(10)
    v_mfma_f32_32x32x16_bf16 a[32:47], v[196:199], v[128:131], a[32:47]
    ds_write_b128 v14, a[88:91] offset:20480
    ds_write_b128 v14, a[92:95] offset:21504
    v_mfma_f32_32x32x16_bf16 a[112:127], v[196:199], v[136:139], a[112:127]
    ds_read_b64_tr_b16 v[208:209], v169 offset:34816
    ds_read_b64_tr_b16 v[210:211], v170 offset:34816
    ds_write_b128 v14, a[16:19] offset:4096
    ds_write_b128 v14, a[20:23] offset:5120
    s_waitcnt lgkmcnt(14)
    v_mfma_f32_32x32x16_bf16 a[32:47], v[200:203], v[132:135], a[32:47]
    ds_write_b128 v14, a[24:27] offset:6144
    ds_write_b128 v14, a[28:31] offset:7168
    v_mfma_f32_32x32x16_bf16 a[112:127], v[200:203], v[140:143], a[112:127]
    ds_read_b64_tr_b16 v[212:213], v171 offset:30720
    ds_read_b64_tr_b16 v[214:215], v172 offset:30720
    ds_write_b128 v14, a[96:99] offset:22528
    ds_write_b128 v14, a[100:103] offset:23552
    s_waitcnt lgkmcnt(14)
    v_mfma_f32_32x32x16_bf16 a[48:63], v[204:207], v[128:131], a[48:63]
    ds_write_b128 v14, a[104:107] offset:24576
    ds_write_b128 v14, a[108:111] offset:25600
    v_mfma_f32_32x32x16_bf16 a[128:143], v[204:207], v[136:139], a[128:143]
    ds_read_b64_tr_b16 v[216:217], v171 offset:31232
    ds_read_b64_tr_b16 v[218:219], v172 offset:31232
    ds_write_b128 v14, a[32:35] offset:8192
    ds_write_b128 v14, a[36:39] offset:9216
    s_waitcnt lgkmcnt(14)
    v_mfma_f32_32x32x16_bf16 a[48:63], v[208:211], v[132:135], a[48:63]
    ds_write_b128 v14, a[40:43] offset:10240
    ds_write_b128 v14, a[44:47] offset:11264
    v_mfma_f32_32x32x16_bf16 a[128:143], v[208:211], v[140:143], a[128:143]
    ds_write_b128 v14, a[112:115] offset:26624
    ds_write_b128 v14, a[116:119] offset:27648
    s_waitcnt lgkmcnt(12)
    v_mfma_f32_32x32x16_bf16 a[64:79], v[212:215], v[128:131], a[64:79]
    v_mfma_f32_32x32x16_bf16 a[144:159], v[212:215], v[136:139], a[144:159]
    ds_write_b128 v14, a[48:51] offset:12288
    ds_write_b128 v14, a[52:55] offset:13312
    s_waitcnt lgkmcnt(8)
    v_mfma_f32_32x32x16_bf16 a[64:79], v[216:219], v[132:135], a[64:79]
    ds_write_b128 v14, a[56:59] offset:14336
    ds_write_b128 v14, a[60:63] offset:15360
    v_mfma_f32_32x32x16_bf16 a[144:159], v[216:219], v[140:143], a[144:159]
    v_lshlrev_b32 v2, 2, v13
    v_add_u32 v3, s26, v2
    s_lshl_b32 s46, s42, 1
    s_add_u32 s46, s46, s41
    s_mul_i32 s47, s46, 1152000
    s_add_u32 s47, s47, 4718592
    s_add_u32 s12, s4, s47
    s_addc_u32 s13, s5, 0
    s_mul_i32 s47, s46, 16000
    s_add_u32 s47, s47, 9437184
    s_add_u32 s16, s4, s47
    s_addc_u32 s17, s5, 0
    s_mov_b32 s18, 16000
    s_mov_b32 s19, 0x20000
    s_nop 7
    ds_write_b128 v14, a[64:67] offset:16384
    ds_write_b128 v14, a[68:71] offset:17408
    ds_write_b32 v3, v80 offset:28672
    ds_write_b32 v3, a72 offset:29184
    ds_write_b32 v3, v96 offset:28928
    ds_write_b32 v3, a152 offset:29440
    v_accvgpr_read_b32 v16, a120
    v_accvgpr_read_b32 v17, a121
    v_accvgpr_read_b32 v18, a122
    v_accvgpr_read_b32 v19, a123
    v_accvgpr_read_b32 v20, a124
    v_accvgpr_read_b32 v21, a125
    v_accvgpr_read_b32 v22, a126
    v_accvgpr_read_b32 v23, a127
    v_accvgpr_read_b32 v24, a128
    v_accvgpr_read_b32 v25, a129
    v_accvgpr_read_b32 v26, a130
    v_accvgpr_read_b32 v27, a131
    v_accvgpr_read_b32 v28, a132
    v_accvgpr_read_b32 v29, a133
    v_accvgpr_read_b32 v30, a134
    v_accvgpr_read_b32 v31, a135
    v_accvgpr_read_b32 v32, a136
    v_accvgpr_read_b32 v33, a137
    v_accvgpr_read_b32 v34, a138
    v_accvgpr_read_b32 v35, a139
    v_accvgpr_read_b32 v36, a140
    v_accvgpr_read_b32 v37, a141
    v_accvgpr_read_b32 v38, a142
    v_accvgpr_read_b32 v39, a143
    v_accvgpr_read_b32 v40, a144
    v_accvgpr_read_b32 v41, a145
    v_accvgpr_read_b32 v42, a146
    v_accvgpr_read_b32 v43, a147
    v_accvgpr_read_b32 v44, a148
    v_accvgpr_read_b32 v45, a149
    v_accvgpr_read_b32 v46, a150
    v_accvgpr_read_b32 v47, a151
    v_add_u32 v208, 0, v12
    v_add_u32 v209, 40960, v12
    v_add_u32 v210, 81920, v12
    v_add_u32 v213, 40960, v2
    v_add_u32 v214, 81920, v2
    v_add_u32 v215, 122880, v2
    s_lshl_b32 s44, s40, 1
    s_add_u32 s44, s44, 1
    s_mul_i32 s45, s44, 9216
    s_add_u32 s45, s45, 5120
    s_lshl_b32 s44, s44, 7
    v_and_b32 v197, 31, v13
    v_lshlrev_b32 v197, 2, v197
    s_waitcnt lgkmcnt(0)
    s_barrier
    ds_read_b32 v4, v2 offset:28928
    ds_read_b32 v5, v2 offset:29440
    ds_read_b32 v6, v213 offset:28928
    ds_read_b32 v7, v213 offset:29440
    ds_read_b32 v8, v214 offset:28928
    ds_read_b32 v9, v214 offset:29440
    ds_read_b32 v10, v215 offset:28928
    ds_read_b32 v11, v215 offset:29440
    ds_read_b128 v[56:59], v208 offset:18432
    ds_read_b128 v[60:63], v209 offset:20480
    ds_read_b128 v[64:67], v210 offset:18432
    ds_read_b128 v[68:71], v208 offset:19456
    ds_read_b128 v[72:75], v209 offset:21504
    ds_read_b128 v[76:79], v210 offset:19456
    s_waitcnt lgkmcnt(6)
    v_min3_f32 v192, v4, v6, v8
    v_min_f32 v192, v192, v10
    v_sub_f32 v4, v192, v4
    v_sub_f32 v6, v192, v6
    v_sub_f32 v8, v192, v8
    v_sub_f32 v10, v192, v10
    v_exp_f32 v4, v4
    v_exp_f32 v6, v6
    v_exp_f32 v8, v8
    v_exp_f32 v10, v10
    ds_read_b128 v[80:83], v208 offset:20480
    ds_read_b128 v[84:87], v209 offset:22528
    ds_read_b128 v[88:91], v210 offset:20480
    ds_read_b128 v[92:95], v208 offset:21504
    ds_read_b128 v[96:99], v209 offset:23552
    ds_read_b128 v[100:103], v210 offset:21504
    v_mul_f32 v193, v4, v5
    v_fmac_f32 v193, v6, v7
    v_fmac_f32 v193, v8, v9
    v_fmac_f32 v193, v10, v11
    v_rcp_f32 v194, v193
    v_log_f32 v195, v193
    s_nop 0
    v_mul_f32 v4, v4, v194
    v_mul_f32 v6, v6, v194
    v_mul_f32 v8, v8, v194
    v_mul_f32 v10, v10, v194
    v_sub_f32 v195, v195, v192
    v_pk_mul_f32 v[16:17], v[16:17], v[10:11] op_sel_hi:[1,0]
    v_pk_mul_f32 v[18:19], v[18:19], v[10:11] op_sel_hi:[1,0]
    v_pk_mul_f32 v[20:21], v[20:21], v[10:11] op_sel_hi:[1,0]
    v_pk_mul_f32 v[22:23], v[22:23], v[10:11] op_sel_hi:[1,0]
    v_pk_mul_f32 v[24:25], v[24:25], v[10:11] op_sel_hi:[1,0]
    v_pk_mul_f32 v[26:27], v[26:27], v[10:11] op_sel_hi:[1,0]
    v_pk_mul_f32 v[28:29], v[28:29], v[10:11] op_sel_hi:[1,0]
    v_pk_mul_f32 v[30:31], v[30:31], v[10:11] op_sel_hi:[1,0]
    v_pk_mul_f32 v[32:33], v[32:33], v[10:11] op_sel_hi:[1,0]
    v_pk_mul_f32 v[34:35], v[34:35], v[10:11] op_sel_hi:[1,0]
    v_pk_mul_f32 v[36:37], v[36:37], v[10:11] op_sel_hi:[1,0]
    v_pk_mul_f32 v[38:39], v[38:39], v[10:11] op_sel_hi:[1,0]
    v_pk_mul_f32 v[40:41], v[40:41], v[10:11] op_sel_hi:[1,0]
    v_pk_mul_f32 v[42:43], v[42:43], v[10:11] op_sel_hi:[1,0]
    v_pk_mul_f32 v[44:45], v[44:45], v[10:11] op_sel_hi:[1,0]
    v_pk_mul_f32 v[46:47], v[46:47], v[10:11] op_sel_hi:[1,0]
    s_waitcnt lgkmcnt(9)
    v_pk_fma_f32 v[16:17], v[56:57], v[4:5], v[16:17] op_sel_hi:[1,0,1]
    v_pk_fma_f32 v[18:19], v[58:59], v[4:5], v[18:19] op_sel_hi:[1,0,1]
    v_pk_fma_f32 v[16:17], v[60:61], v[6:7], v[16:17] op_sel_hi:[1,0,1]
    v_pk_fma_f32 v[18:19], v[62:63], v[6:7], v[18:19] op_sel_hi:[1,0,1]
    v_pk_fma_f32 v[16:17], v[64:65], v[8:9], v[16:17] op_sel_hi:[1,0,1]
    v_pk_fma_f32 v[18:19], v[66:67], v[8:9], v[18:19] op_sel_hi:[1,0,1]
    v_cvt_pk_bf16_f32 v216, v16, v17
    v_cvt_pk_bf16_f32 v217, v18, v19
    ds_read_b128 v[104:107], v208 offset:22528
    ds_read_b128 v[108:111], v209 offset:24576
    ds_read_b128 v[112:115], v210 offset:22528
    s_waitcnt lgkmcnt(9)
    v_pk_fma_f32 v[20:21], v[68:69], v[4:5], v[20:21] op_sel_hi:[1,0,1]
    v_pk_fma_f32 v[22:23], v[70:71], v[4:5], v[22:23] op_sel_hi:[1,0,1]
    v_pk_fma_f32 v[20:21], v[72:73], v[6:7], v[20:21] op_sel_hi:[1,0,1]
    v_pk_fma_f32 v[22:23], v[74:75], v[6:7], v[22:23] op_sel_hi:[1,0,1]
    v_pk_fma_f32 v[20:21], v[76:77], v[8:9], v[20:21] op_sel_hi:[1,0,1]
    v_pk_fma_f32 v[22:23], v[78:79], v[8:9], v[22:23] op_sel_hi:[1,0,1]
    v_cvt_pk_bf16_f32 v218, v20, v21
    v_cvt_pk_bf16_f32 v219, v22, v23
    buffer_store_dwordx4 v[216:219], v12, s[12:15], s45 offen offset:0 sc1
    ds_read_b128 v[116:119], v208 offset:23552
    ds_read_b128 v[120:123], v209 offset:25600
    ds_read_b128 v[124:127], v210 offset:23552
    s_waitcnt lgkmcnt(9)
    v_pk_fma_f32 v[24:25], v[80:81], v[4:5], v[24:25] op_sel_hi:[1,0,1]
    v_pk_fma_f32 v[26:27], v[82:83], v[4:5], v[26:27] op_sel_hi:[1,0,1]
    v_pk_fma_f32 v[24:25], v[84:85], v[6:7], v[24:25] op_sel_hi:[1,0,1]
    v_pk_fma_f32 v[26:27], v[86:87], v[6:7], v[26:27] op_sel_hi:[1,0,1]
    v_pk_fma_f32 v[24:25], v[88:89], v[8:9], v[24:25] op_sel_hi:[1,0,1]
    v_pk_fma_f32 v[26:27], v[90:91], v[8:9], v[26:27] op_sel_hi:[1,0,1]
    v_cvt_pk_bf16_f32 v220, v24, v25
    v_cvt_pk_bf16_f32 v221, v26, v27
    ds_read_b128 v[128:131], v208 offset:24576
    ds_read_b128 v[132:135], v209 offset:26624
    ds_read_b128 v[136:139], v210 offset:24576
    s_waitcnt lgkmcnt(9)
    v_pk_fma_f32 v[28:29], v[92:93], v[4:5], v[28:29] op_sel_hi:[1,0,1]
    v_pk_fma_f32 v[30:31], v[94:95], v[4:5], v[30:31] op_sel_hi:[1,0,1]
    v_pk_fma_f32 v[28:29], v[96:97], v[6:7], v[28:29] op_sel_hi:[1,0,1]
    v_pk_fma_f32 v[30:31], v[98:99], v[6:7], v[30:31] op_sel_hi:[1,0,1]
    v_pk_fma_f32 v[28:29], v[100:101], v[8:9], v[28:29] op_sel_hi:[1,0,1]
    v_pk_fma_f32 v[30:31], v[102:103], v[8:9], v[30:31] op_sel_hi:[1,0,1]
    v_cvt_pk_bf16_f32 v222, v28, v29
    v_cvt_pk_bf16_f32 v223, v30, v31
    buffer_store_dwordx4 v[220:223], v12, s[12:15], s45 offen offset:1024 sc1
    ds_read_b128 v[140:143], v208 offset:25600
    ds_read_b128 v[144:147], v209 offset:27648
    ds_read_b128 v[148:151], v210 offset:25600
    s_waitcnt lgkmcnt(9)
    v_pk_fma_f32 v[32:33], v[104:105], v[4:5], v[32:33] op_sel_hi:[1,0,1]
    v_pk_fma_f32 v[34:35], v[106:107], v[4:5], v[34:35] op_sel_hi:[1,0,1]
    v_pk_fma_f32 v[32:33], v[108:109], v[6:7], v[32:33] op_sel_hi:[1,0,1]
    v_pk_fma_f32 v[34:35], v[110:111], v[6:7], v[34:35] op_sel_hi:[1,0,1]
    v_pk_fma_f32 v[32:33], v[112:113], v[8:9], v[32:33] op_sel_hi:[1,0,1]
    v_pk_fma_f32 v[34:35], v[114:115], v[8:9], v[34:35] op_sel_hi:[1,0,1]
    v_cvt_pk_bf16_f32 v224, v32, v33
    v_cvt_pk_bf16_f32 v225, v34, v35
    s_waitcnt lgkmcnt(6)
    v_pk_fma_f32 v[36:37], v[116:117], v[4:5], v[36:37] op_sel_hi:[1,0,1]
    v_pk_fma_f32 v[38:39], v[118:119], v[4:5], v[38:39] op_sel_hi:[1,0,1]
    v_pk_fma_f32 v[36:37], v[120:121], v[6:7], v[36:37] op_sel_hi:[1,0,1]
    v_pk_fma_f32 v[38:39], v[122:123], v[6:7], v[38:39] op_sel_hi:[1,0,1]
    v_pk_fma_f32 v[36:37], v[124:125], v[8:9], v[36:37] op_sel_hi:[1,0,1]
    v_pk_fma_f32 v[38:39], v[126:127], v[8:9], v[38:39] op_sel_hi:[1,0,1]
    v_cvt_pk_bf16_f32 v226, v36, v37
    v_cvt_pk_bf16_f32 v227, v38, v39
    buffer_store_dwordx4 v[224:227], v12, s[12:15], s45 offen offset:2048 sc1
    s_waitcnt lgkmcnt(3)
    v_pk_fma_f32 v[40:41], v[128:129], v[4:5], v[40:41] op_sel_hi:[1,0,1]
    v_pk_fma_f32 v[42:43], v[130:131], v[4:5], v[42:43] op_sel_hi:[1,0,1]
    v_pk_fma_f32 v[40:41], v[132:133], v[6:7], v[40:41] op_sel_hi:[1,0,1]
    v_pk_fma_f32 v[42:43], v[134:135], v[6:7], v[42:43] op_sel_hi:[1,0,1]
    v_pk_fma_f32 v[40:41], v[136:137], v[8:9], v[40:41] op_sel_hi:[1,0,1]
    v_pk_fma_f32 v[42:43], v[138:139], v[8:9], v[42:43] op_sel_hi:[1,0,1]
    v_cvt_pk_bf16_f32 v228, v40, v41
    v_cvt_pk_bf16_f32 v229, v42, v43
    s_waitcnt lgkmcnt(0)
    v_pk_fma_f32 v[44:45], v[140:141], v[4:5], v[44:45] op_sel_hi:[1,0,1]
    v_pk_fma_f32 v[46:47], v[142:143], v[4:5], v[46:47] op_sel_hi:[1,0,1]
    v_pk_fma_f32 v[44:45], v[144:145], v[6:7], v[44:45] op_sel_hi:[1,0,1]
    v_pk_fma_f32 v[46:47], v[146:147], v[6:7], v[46:47] op_sel_hi:[1,0,1]
    v_pk_fma_f32 v[44:45], v[148:149], v[8:9], v[44:45] op_sel_hi:[1,0,1]
    v_pk_fma_f32 v[46:47], v[150:151], v[8:9], v[46:47] op_sel_hi:[1,0,1]
    v_cvt_pk_bf16_f32 v230, v44, v45
    v_cvt_pk_bf16_f32 v231, v46, v47
    buffer_store_dwordx4 v[228:231], v12, s[12:15], s45 offen offset:3072 sc1
    s_endpgm
L_k2_rareL0:
    s_nop 15
    v_max3_f32 v4, v48, v49, v50
    v_max3_f32 v4, v4, v51, v52
    v_max3_f32 v4, v4, v53, v54
    v_max3_f32 v4, v4, v55, v56
    v_max3_f32 v4, v4, v57, v58
    v_max3_f32 v4, v4, v59, v60
    v_max3_f32 v4, v4, v61, v62
    v_max_f32 v4, v4, v63
    v_mov_b32 v5, v4
    s_nop 1
    v_permlane32_swap_b32 v4, v5
    s_nop 1
    v_max_f32 v4, v4, v5
    v_add_f32 v4, 0x42200000, v4
    v_max_f32 v4, 0, v4
    v_sub_f32 v5, 0, v4
    v_exp_f32 v5, v5
    v_sub_f32 v48, v48, v4
    v_sub_f32 v80, v80, v4
    v_sub_f32 v49, v49, v4
    v_sub_f32 v81, v81, v4
    v_sub_f32 v50, v50, v4
    v_sub_f32 v82, v82, v4
    v_sub_f32 v51, v51, v4
    v_sub_f32 v83, v83, v4
    v_sub_f32 v52, v52, v4
    v_sub_f32 v84, v84, v4
    v_sub_f32 v53, v53, v4
    v_sub_f32 v85, v85, v4
    v_sub_f32 v54, v54, v4
    v_sub_f32 v86, v86, v4
    v_sub_f32 v55, v55, v4
    v_sub_f32 v87, v87, v4
    v_sub_f32 v56, v56, v4
    v_sub_f32 v88, v88, v4
    v_sub_f32 v57, v57, v4
    v_sub_f32 v89, v89, v4
    v_sub_f32 v58, v58, v4
    v_sub_f32 v90, v90, v4
    v_sub_f32 v59, v59, v4
    v_sub_f32 v91, v91, v4
    v_sub_f32 v60, v60, v4
    v_sub_f32 v92, v92, v4
    v_sub_f32 v61, v61, v4
    v_sub_f32 v93, v93, v4
    v_sub_f32 v62, v62, v4
    v_sub_f32 v94, v94, v4
    v_sub_f32 v63, v63, v4
    v_sub_f32 v95, v95, v4
    v_accvgpr_read_b32 v6, a0
    v_accvgpr_read_b32 v7, a1
    v_accvgpr_read_b32 v8, a2
    v_accvgpr_read_b32 v9, a3
    v_mul_f32 v6, v6, v5
    v_mul_f32 v7, v7, v5
    v_mul_f32 v8, v8, v5
    v_mul_f32 v9, v9, v5
    v_accvgpr_write_b32 a0, v6
    v_accvgpr_write_b32 a1, v7
    v_accvgpr_write_b32 a2, v8
    v_accvgpr_write_b32 a3, v9
    v_accvgpr_read_b32 v6, a4
    v_accvgpr_read_b32 v7, a5
    v_accvgpr_read_b32 v8, a6
    v_accvgpr_read_b32 v9, a7
    v_mul_f32 v6, v6, v5
    v_mul_f32 v7, v7, v5
    v_mul_f32 v8, v8, v5
    v_mul_f32 v9, v9, v5
    v_accvgpr_write_b32 a4, v6
    v_accvgpr_write_b32 a5, v7
    v_accvgpr_write_b32 a6, v8
    v_accvgpr_write_b32 a7, v9
    v_accvgpr_read_b32 v6, a8
    v_accvgpr_read_b32 v7, a9
    v_accvgpr_read_b32 v8, a10
    v_accvgpr_read_b32 v9, a11
    v_mul_f32 v6, v6, v5
    v_mul_f32 v7, v7, v5
    v_mul_f32 v8, v8, v5
    v_mul_f32 v9, v9, v5
    v_accvgpr_write_b32 a8, v6
    v_accvgpr_write_b32 a9, v7
    v_accvgpr_write_b32 a10, v8
    v_accvgpr_write_b32 a11, v9
    v_accvgpr_read_b32 v6, a12
    v_accvgpr_read_b32 v7, a13
    v_accvgpr_read_b32 v8, a14
    v_accvgpr_read_b32 v9, a15
    v_mul_f32 v6, v6, v5
    v_mul_f32 v7, v7, v5
    v_mul_f32 v8, v8, v5
    v_mul_f32 v9, v9, v5
    v_accvgpr_write_b32 a12, v6
    v_accvgpr_write_b32 a13, v7
    v_accvgpr_write_b32 a14, v8
    v_accvgpr_write_b32 a15, v9
    v_accvgpr_read_b32 v6, a16
    v_accvgpr_read_b32 v7, a17
    v_accvgpr_read_b32 v8, a18
    v_accvgpr_read_b32 v9, a19
    v_mul_f32 v6, v6, v5
    v_mul_f32 v7, v7, v5
    v_mul_f32 v8, v8, v5
    v_mul_f32 v9, v9, v5
    v_accvgpr_write_b32 a16, v6
    v_accvgpr_write_b32 a17, v7
    v_accvgpr_write_b32 a18, v8
    v_accvgpr_write_b32 a19, v9
    v_accvgpr_read_b32 v6, a20
    v_accvgpr_read_b32 v7, a21
    v_accvgpr_read_b32 v8, a22
    v_accvgpr_read_b32 v9, a23
    v_mul_f32 v6, v6, v5
    v_mul_f32 v7, v7, v5
    v_mul_f32 v8, v8, v5
    v_mul_f32 v9, v9, v5
    v_accvgpr_write_b32 a20, v6
    v_accvgpr_write_b32 a21, v7
    v_accvgpr_write_b32 a22, v8
    v_accvgpr_write_b32 a23, v9
    v_accvgpr_read_b32 v6, a24
    v_accvgpr_read_b32 v7, a25
    v_accvgpr_read_b32 v8, a26
    v_accvgpr_read_b32 v9, a27
    v_mul_f32 v6, v6, v5
    v_mul_f32 v7, v7, v5
    v_mul_f32 v8, v8, v5
    v_mul_f32 v9, v9, v5
    v_accvgpr_write_b32 a24, v6
    v_accvgpr_write_b32 a25, v7
    v_accvgpr_write_b32 a26, v8
    v_accvgpr_write_b32 a27, v9
    v_accvgpr_read_b32 v6, a28
    v_accvgpr_read_b32 v7, a29
    v_accvgpr_read_b32 v8, a30
    v_accvgpr_read_b32 v9, a31
    v_mul_f32 v6, v6, v5
    v_mul_f32 v7, v7, v5
    v_mul_f32 v8, v8, v5
    v_mul_f32 v9, v9, v5
    v_accvgpr_write_b32 a28, v6
    v_accvgpr_write_b32 a29, v7
    v_accvgpr_write_b32 a30, v8
    v_accvgpr_write_b32 a31, v9
    v_accvgpr_read_b32 v6, a32
    v_accvgpr_read_b32 v7, a33
    v_accvgpr_read_b32 v8, a34
    v_accvgpr_read_b32 v9, a35
    v_mul_f32 v6, v6, v5
    v_mul_f32 v7, v7, v5
    v_mul_f32 v8, v8, v5
    v_mul_f32 v9, v9, v5
    v_accvgpr_write_b32 a32, v6
    v_accvgpr_write_b32 a33, v7
    v_accvgpr_write_b32 a34, v8
    v_accvgpr_write_b32 a35, v9
    v_accvgpr_read_b32 v6, a36
    v_accvgpr_read_b32 v7, a37
    v_accvgpr_read_b32 v8, a38
    v_accvgpr_read_b32 v9, a39
    v_mul_f32 v6, v6, v5
    v_mul_f32 v7, v7, v5
    v_mul_f32 v8, v8, v5
    v_mul_f32 v9, v9, v5
    v_accvgpr_write_b32 a36, v6
    v_accvgpr_write_b32 a37, v7
    v_accvgpr_write_b32 a38, v8
    v_accvgpr_write_b32 a39, v9
    v_accvgpr_read_b32 v6, a40
    v_accvgpr_read_b32 v7, a41
    v_accvgpr_read_b32 v8, a42
    v_accvgpr_read_b32 v9, a43
    v_mul_f32 v6, v6, v5
    v_mul_f32 v7, v7, v5
    v_mul_f32 v8, v8, v5
    v_mul_f32 v9, v9, v5
    v_accvgpr_write_b32 a40, v6
    v_accvgpr_write_b32 a41, v7
    v_accvgpr_write_b32 a42, v8
    v_accvgpr_write_b32 a43, v9
    v_accvgpr_read_b32 v6, a44
    v_accvgpr_read_b32 v7, a45
    v_accvgpr_read_b32 v8, a46
    v_accvgpr_read_b32 v9, a47
    v_mul_f32 v6, v6, v5
    v_mul_f32 v7, v7, v5
    v_mul_f32 v8, v8, v5
    v_mul_f32 v9, v9, v5
    v_accvgpr_write_b32 a44, v6
    v_accvgpr_write_b32 a45, v7
    v_accvgpr_write_b32 a46, v8
    v_accvgpr_write_b32 a47, v9
    v_accvgpr_read_b32 v6, a48
    v_accvgpr_read_b32 v7, a49
    v_accvgpr_read_b32 v8, a50
    v_accvgpr_read_b32 v9, a51
    v_mul_f32 v6, v6, v5
    v_mul_f32 v7, v7, v5
    v_mul_f32 v8, v8, v5
    v_mul_f32 v9, v9, v5
    v_accvgpr_write_b32 a48, v6
    v_accvgpr_write_b32 a49, v7
    v_accvgpr_write_b32 a50, v8
    v_accvgpr_write_b32 a51, v9
    v_accvgpr_read_b32 v6, a52
    v_accvgpr_read_b32 v7, a53
    v_accvgpr_read_b32 v8, a54
    v_accvgpr_read_b32 v9, a55
    v_mul_f32 v6, v6, v5
    v_mul_f32 v7, v7, v5
    v_mul_f32 v8, v8, v5
    v_mul_f32 v9, v9, v5
    v_accvgpr_write_b32 a52, v6
    v_accvgpr_write_b32 a53, v7
    v_accvgpr_write_b32 a54, v8
    v_accvgpr_write_b32 a55, v9
    v_accvgpr_read_b32 v6, a56
    v_accvgpr_read_b32 v7, a57
    v_accvgpr_read_b32 v8, a58
    v_accvgpr_read_b32 v9, a59
    v_mul_f32 v6, v6, v5
    v_mul_f32 v7, v7, v5
    v_mul_f32 v8, v8, v5
    v_mul_f32 v9, v9, v5
    v_accvgpr_write_b32 a56, v6
    v_accvgpr_write_b32 a57, v7
    v_accvgpr_write_b32 a58, v8
    v_accvgpr_write_b32 a59, v9
    v_accvgpr_read_b32 v6, a60
    v_accvgpr_read_b32 v7, a61
    v_accvgpr_read_b32 v8, a62
    v_accvgpr_read_b32 v9, a63
    v_mul_f32 v6, v6, v5
    v_mul_f32 v7, v7, v5
    v_mul_f32 v8, v8, v5
    v_mul_f32 v9, v9, v5
    v_accvgpr_write_b32 a60, v6
    v_accvgpr_write_b32 a61, v7
    v_accvgpr_write_b32 a62, v8
    v_accvgpr_write_b32 a63, v9
    v_accvgpr_read_b32 v6, a64
    v_accvgpr_read_b32 v7, a65
    v_accvgpr_read_b32 v8, a66
    v_accvgpr_read_b32 v9, a67
    v_mul_f32 v6, v6, v5
    v_mul_f32 v7, v7, v5
    v_mul_f32 v8, v8, v5
    v_mul_f32 v9, v9, v5
    v_accvgpr_write_b32 a64, v6
    v_accvgpr_write_b32 a65, v7
    v_accvgpr_write_b32 a66, v8
    v_accvgpr_write_b32 a67, v9
    v_accvgpr_read_b32 v6, a68
    v_accvgpr_read_b32 v7, a69
    v_accvgpr_read_b32 v8, a70
    v_accvgpr_read_b32 v9, a71
    v_mul_f32 v6, v6, v5
    v_mul_f32 v7, v7, v5
    v_mul_f32 v8, v8, v5
    v_mul_f32 v9, v9, v5
    v_accvgpr_write_b32 a68, v6
    v_accvgpr_write_b32 a69, v7
    v_accvgpr_write_b32 a70, v8
    v_accvgpr_write_b32 a71, v9
    v_accvgpr_read_b32 v6, a72
    v_accvgpr_read_b32 v7, a73
    v_accvgpr_read_b32 v8, a74
    v_accvgpr_read_b32 v9, a75
    v_mul_f32 v6, v6, v5
    v_mul_f32 v7, v7, v5
    v_mul_f32 v8, v8, v5
    v_mul_f32 v9, v9, v5
    v_accvgpr_write_b32 a72, v6
    v_accvgpr_write_b32 a73, v7
    v_accvgpr_write_b32 a74, v8
    v_accvgpr_write_b32 a75, v9
    v_accvgpr_read_b32 v6, a76
    v_accvgpr_read_b32 v7, a77
    v_accvgpr_read_b32 v8, a78
    v_accvgpr_read_b32 v9, a79
    v_mul_f32 v6, v6, v5
    v_mul_f32 v7, v7, v5
    v_mul_f32 v8, v8, v5
    v_mul_f32 v9, v9, v5
    v_accvgpr_write_b32 a76, v6
    v_accvgpr_write_b32 a77, v7
    v_accvgpr_write_b32 a78, v8
    v_accvgpr_write_b32 a79, v9
    v_exp_f32 v6, v48
    v_exp_f32 v7, v49
    s_nop 0
    v_cvt_pk_bf16_f32 v128, v6, v7
    v_exp_f32 v6, v50
    v_exp_f32 v7, v51
    s_nop 0
    v_cvt_pk_bf16_f32 v129, v6, v7
    v_exp_f32 v6, v52
    v_exp_f32 v7, v53
    s_nop 0
    v_cvt_pk_bf16_f32 v130, v6, v7
    v_exp_f32 v6, v54
    v_exp_f32 v7, v55
    s_nop 0
    v_cvt_pk_bf16_f32 v131, v6, v7
    v_exp_f32 v6, v56
    v_exp_f32 v7, v57
    s_nop 0
    v_cvt_pk_bf16_f32 v132, v6, v7
    v_exp_f32 v6, v58
    v_exp_f32 v7, v59
    s_nop 0
    v_cvt_pk_bf16_f32 v133, v6, v7
    v_exp_f32 v6, v60
    v_exp_f32 v7, v61
    s_nop 0
    v_cvt_pk_bf16_f32 v134, v6, v7
    v_exp_f32 v6, v62
    v_exp_f32 v7, v63
    s_nop 0
    v_cvt_pk_bf16_f32 v135, v6, v7
    v_max3_f32 v4, v64, v65, v66
    v_max3_f32 v4, v4, v67, v68
    v_max3_f32 v4, v4, v69, v70
    v_max3_f32 v4, v4, v71, v72
    v_max3_f32 v4, v4, v73, v74
    v_max3_f32 v4, v4, v75, v76
    v_max3_f32 v4, v4, v77, v78
    v_max_f32 v4, v4, v79
    v_mov_b32 v5, v4
    s_nop 1
    v_permlane32_swap_b32 v4, v5
    s_nop 1
    v_max_f32 v4, v4, v5
    v_add_f32 v4, 0x42200000, v4
    v_max_f32 v4, 0, v4
    v_sub_f32 v5, 0, v4
    v_exp_f32 v5, v5
    v_sub_f32 v64, v64, v4
    v_sub_f32 v96, v96, v4
    v_sub_f32 v65, v65, v4
    v_sub_f32 v97, v97, v4
    v_sub_f32 v66, v66, v4
    v_sub_f32 v98, v98, v4
    v_sub_f32 v67, v67, v4
    v_sub_f32 v99, v99, v4
    v_sub_f32 v68, v68, v4
    v_sub_f32 v100, v100, v4
    v_sub_f32 v69, v69, v4
    v_sub_f32 v101, v101, v4
    v_sub_f32 v70, v70, v4
    v_sub_f32 v102, v102, v4
    v_sub_f32 v71, v71, v4
    v_sub_f32 v103, v103, v4
    v_sub_f32 v72, v72, v4
    v_sub_f32 v104, v104, v4
    v_sub_f32 v73, v73, v4
    v_sub_f32 v105, v105, v4
    v_sub_f32 v74, v74, v4
    v_sub_f32 v106, v106, v4
    v_sub_f32 v75, v75, v4
    v_sub_f32 v107, v107, v4
    v_sub_f32 v76, v76, v4
    v_sub_f32 v108, v108, v4
    v_sub_f32 v77, v77, v4
    v_sub_f32 v109, v109, v4
    v_sub_f32 v78, v78, v4
    v_sub_f32 v110, v110, v4
    v_sub_f32 v79, v79, v4
    v_sub_f32 v111, v111, v4
    v_accvgpr_read_b32 v6, a80
    v_accvgpr_read_b32 v7, a81
    v_accvgpr_read_b32 v8, a82
    v_accvgpr_read_b32 v9, a83
    v_mul_f32 v6, v6, v5
    v_mul_f32 v7, v7, v5
    v_mul_f32 v8, v8, v5
    v_mul_f32 v9, v9, v5
    v_accvgpr_write_b32 a80, v6
    v_accvgpr_write_b32 a81, v7
    v_accvgpr_write_b32 a82, v8
    v_accvgpr_write_b32 a83, v9
    v_accvgpr_read_b32 v6, a84
    v_accvgpr_read_b32 v7, a85
    v_accvgpr_read_b32 v8, a86
    v_accvgpr_read_b32 v9, a87
    v_mul_f32 v6, v6, v5
    v_mul_f32 v7, v7, v5
    v_mul_f32 v8, v8, v5
    v_mul_f32 v9, v9, v5
    v_accvgpr_write_b32 a84, v6
    v_accvgpr_write_b32 a85, v7
    v_accvgpr_write_b32 a86, v8
    v_accvgpr_write_b32 a87, v9
    v_accvgpr_read_b32 v6, a88
    v_accvgpr_read_b32 v7, a89
    v_accvgpr_read_b32 v8, a90
    v_accvgpr_read_b32 v9, a91
    v_mul_f32 v6, v6, v5
    v_mul_f32 v7, v7, v5
    v_mul_f32 v8, v8, v5
    v_mul_f32 v9, v9, v5
    v_accvgpr_write_b32 a88, v6
    v_accvgpr_write_b32 a89, v7
    v_accvgpr_write_b32 a90, v8
    v_accvgpr_write_b32 a91, v9
    v_accvgpr_read_b32 v6, a92
    v_accvgpr_read_b32 v7, a93
    v_accvgpr_read_b32 v8, a94
    v_accvgpr_read_b32 v9, a95
    v_mul_f32 v6, v6, v5
    v_mul_f32 v7, v7, v5
    v_mul_f32 v8, v8, v5
    v_mul_f32 v9, v9, v5
    v_accvgpr_write_b32 a92, v6
    v_accvgpr_write_b32 a93, v7
    v_accvgpr_write_b32 a94, v8
    v_accvgpr_write_b32 a95, v9
    v_accvgpr_read_b32 v6, a96
    v_accvgpr_read_b32 v7, a97
    v_accvgpr_read_b32 v8, a98
    v_accvgpr_read_b32 v9, a99
    v_mul_f32 v6, v6, v5
    v_mul_f32 v7, v7, v5
    v_mul_f32 v8, v8, v5
    v_mul_f32 v9, v9, v5
    v_accvgpr_write_b32 a96, v6
    v_accvgpr_write_b32 a97, v7
    v_accvgpr_write_b32 a98, v8
    v_accvgpr_write_b32 a99, v9
    v_accvgpr_read_b32 v6, a100
    v_accvgpr_read_b32 v7, a101
    v_accvgpr_read_b32 v8, a102
    v_accvgpr_read_b32 v9, a103
    v_mul_f32 v6, v6, v5
    v_mul_f32 v7, v7, v5
    v_mul_f32 v8, v8, v5
    v_mul_f32 v9, v9, v5
    v_accvgpr_write_b32 a100, v6
    v_accvgpr_write_b32 a101, v7
    v_accvgpr_write_b32 a102, v8
    v_accvgpr_write_b32 a103, v9
    v_accvgpr_read_b32 v6, a104
    v_accvgpr_read_b32 v7, a105
    v_accvgpr_read_b32 v8, a106
    v_accvgpr_read_b32 v9, a107
    v_mul_f32 v6, v6, v5
    v_mul_f32 v7, v7, v5
    v_mul_f32 v8, v8, v5
    v_mul_f32 v9, v9, v5
    v_accvgpr_write_b32 a104, v6
    v_accvgpr_write_b32 a105, v7
    v_accvgpr_write_b32 a106, v8
    v_accvgpr_write_b32 a107, v9
    v_accvgpr_read_b32 v6, a108
    v_accvgpr_read_b32 v7, a109
    v_accvgpr_read_b32 v8, a110
    v_accvgpr_read_b32 v9, a111
    v_mul_f32 v6, v6, v5
    v_mul_f32 v7, v7, v5
    v_mul_f32 v8, v8, v5
    v_mul_f32 v9, v9, v5
    v_accvgpr_write_b32 a108, v6
    v_accvgpr_write_b32 a109, v7
    v_accvgpr_write_b32 a110, v8
    v_accvgpr_write_b32 a111, v9
    v_accvgpr_read_b32 v6, a112
    v_accvgpr_read_b32 v7, a113
    v_accvgpr_read_b32 v8, a114
    v_accvgpr_read_b32 v9, a115
    v_mul_f32 v6, v6, v5
    v_mul_f32 v7, v7, v5
    v_mul_f32 v8, v8, v5
    v_mul_f32 v9, v9, v5
    v_accvgpr_write_b32 a112, v6
    v_accvgpr_write_b32 a113, v7
    v_accvgpr_write_b32 a114, v8
    v_accvgpr_write_b32 a115, v9
    v_accvgpr_read_b32 v6, a116
    v_accvgpr_read_b32 v7, a117
    v_accvgpr_read_b32 v8, a118
    v_accvgpr_read_b32 v9, a119
    v_mul_f32 v6, v6, v5
    v_mul_f32 v7, v7, v5
    v_mul_f32 v8, v8, v5
    v_mul_f32 v9, v9, v5
    v_accvgpr_write_b32 a116, v6
    v_accvgpr_write_b32 a117, v7
    v_accvgpr_write_b32 a118, v8
    v_accvgpr_write_b32 a119, v9
    v_accvgpr_read_b32 v6, a120
    v_accvgpr_read_b32 v7, a121
    v_accvgpr_read_b32 v8, a122
    v_accvgpr_read_b32 v9, a123
    v_mul_f32 v6, v6, v5
    v_mul_f32 v7, v7, v5
    v_mul_f32 v8, v8, v5
    v_mul_f32 v9, v9, v5
    v_accvgpr_write_b32 a120, v6
    v_accvgpr_write_b32 a121, v7
    v_accvgpr_write_b32 a122, v8
    v_accvgpr_write_b32 a123, v9
    v_accvgpr_read_b32 v6, a124
    v_accvgpr_read_b32 v7, a125
    v_accvgpr_read_b32 v8, a126
    v_accvgpr_read_b32 v9, a127
    v_mul_f32 v6, v6, v5
    v_mul_f32 v7, v7, v5
    v_mul_f32 v8, v8, v5
    v_mul_f32 v9, v9, v5
    v_accvgpr_write_b32 a124, v6
    v_accvgpr_write_b32 a125, v7
    v_accvgpr_write_b32 a126, v8
    v_accvgpr_write_b32 a127, v9
    v_accvgpr_read_b32 v6, a128
    v_accvgpr_read_b32 v7, a129
    v_accvgpr_read_b32 v8, a130
    v_accvgpr_read_b32 v9, a131
    v_mul_f32 v6, v6, v5
    v_mul_f32 v7, v7, v5
    v_mul_f32 v8, v8, v5
    v_mul_f32 v9, v9, v5
    v_accvgpr_write_b32 a128, v6
    v_accvgpr_write_b32 a129, v7
    v_accvgpr_write_b32 a130, v8
    v_accvgpr_write_b32 a131, v9
    v_accvgpr_read_b32 v6, a132
    v_accvgpr_read_b32 v7, a133
    v_accvgpr_read_b32 v8, a134
    v_accvgpr_read_b32 v9, a135
    v_mul_f32 v6, v6, v5
    v_mul_f32 v7, v7, v5
    v_mul_f32 v8, v8, v5
    v_mul_f32 v9, v9, v5
    v_accvgpr_write_b32 a132, v6
    v_accvgpr_write_b32 a133, v7
    v_accvgpr_write_b32 a134, v8
    v_accvgpr_write_b32 a135, v9
    v_accvgpr_read_b32 v6, a136
    v_accvgpr_read_b32 v7, a137
    v_accvgpr_read_b32 v8, a138
    v_accvgpr_read_b32 v9, a139
    v_mul_f32 v6, v6, v5
    v_mul_f32 v7, v7, v5
    v_mul_f32 v8, v8, v5
    v_mul_f32 v9, v9, v5
    v_accvgpr_write_b32 a136, v6
    v_accvgpr_write_b32 a137, v7
    v_accvgpr_write_b32 a138, v8
    v_accvgpr_write_b32 a139, v9
    v_accvgpr_read_b32 v6, a140
    v_accvgpr_read_b32 v7, a141
    v_accvgpr_read_b32 v8, a142
    v_accvgpr_read_b32 v9, a143
    v_mul_f32 v6, v6, v5
    v_mul_f32 v7, v7, v5
    v_mul_f32 v8, v8, v5
    v_mul_f32 v9, v9, v5
    v_accvgpr_write_b32 a140, v6
    v_accvgpr_write_b32 a141, v7
    v_accvgpr_write_b32 a142, v8
    v_accvgpr_write_b32 a143, v9
    v_accvgpr_read_b32 v6, a144
    v_accvgpr_read_b32 v7, a145
    v_accvgpr_read_b32 v8, a146
    v_accvgpr_read_b32 v9, a147
    v_mul_f32 v6, v6, v5
    v_mul_f32 v7, v7, v5
    v_mul_f32 v8, v8, v5
    v_mul_f32 v9, v9, v5
    v_accvgpr_write_b32 a144, v6
    v_accvgpr_write_b32 a145, v7
    v_accvgpr_write_b32 a146, v8
    v_accvgpr_write_b32 a147, v9
    v_accvgpr_read_b32 v6, a148
    v_accvgpr_read_b32 v7, a149
    v_accvgpr_read_b32 v8, a150
    v_accvgpr_read_b32 v9, a151
    v_mul_f32 v6, v6, v5
    v_mul_f32 v7, v7, v5
    v_mul_f32 v8, v8, v5
    v_mul_f32 v9, v9, v5
    v_accvgpr_write_b32 a148, v6
    v_accvgpr_write_b32 a149, v7
    v_accvgpr_write_b32 a150, v8
    v_accvgpr_write_b32 a151, v9
    v_accvgpr_read_b32 v6, a152
    v_accvgpr_read_b32 v7, a153
    v_accvgpr_read_b32 v8, a154
    v_accvgpr_read_b32 v9, a155
    v_mul_f32 v6, v6, v5
    v_mul_f32 v7, v7, v5
    v_mul_f32 v8, v8, v5
    v_mul_f32 v9, v9, v5
    v_accvgpr_write_b32 a152, v6
    v_accvgpr_write_b32 a153, v7
    v_accvgpr_write_b32 a154, v8
    v_accvgpr_write_b32 a155, v9
    v_accvgpr_read_b32 v6, a156
    v_accvgpr_read_b32 v7, a157
    v_accvgpr_read_b32 v8, a158
    v_accvgpr_read_b32 v9, a159
    v_mul_f32 v6, v6, v5
    v_mul_f32 v7, v7, v5
    v_mul_f32 v8, v8, v5
    v_mul_f32 v9, v9, v5
    v_accvgpr_write_b32 a156, v6
    v_accvgpr_write_b32 a157, v7
    v_accvgpr_write_b32 a158, v8
    v_accvgpr_write_b32 a159, v9
    v_exp_f32 v6, v64
    v_exp_f32 v7, v65
    s_nop 0
    v_cvt_pk_bf16_f32 v136, v6, v7
    v_exp_f32 v6, v66
    v_exp_f32 v7, v67
    s_nop 0
    v_cvt_pk_bf16_f32 v137, v6, v7
    v_exp_f32 v6, v68
    v_exp_f32 v7, v69
    s_nop 0
    v_cvt_pk_bf16_f32 v138, v6, v7
    v_exp_f32 v6, v70
    v_exp_f32 v7, v71
    s_nop 0
    v_cvt_pk_bf16_f32 v139, v6, v7
    v_exp_f32 v6, v72
    v_exp_f32 v7, v73
    s_nop 0
    v_cvt_pk_bf16_f32 v140, v6, v7
    v_exp_f32 v6, v74
    v_exp_f32 v7, v75
    s_nop 0
    v_cvt_pk_bf16_f32 v141, v6, v7
    v_exp_f32 v6, v76
    v_exp_f32 v7, v77
    s_nop 0
    v_cvt_pk_bf16_f32 v142, v6, v7
    v_exp_f32 v6, v78
    v_exp_f32 v7, v79
    s_nop 0
    v_cvt_pk_bf16_f32 v143, v6, v7
    s_nop 7
    s_branch L_k2_retL0
L_k2_rareL1:
    s_nop 15
    v_max3_f32 v4, v48, v49, v50
    v_max3_f32 v4, v4, v51, v52
    v_max3_f32 v4, v4, v53, v54
    v_max3_f32 v4, v4, v55, v56
    v_max3_f32 v4, v4, v57, v58
    v_max3_f32 v4, v4, v59, v60
    v_max3_f32 v4, v4, v61, v62
    v_max_f32 v4, v4, v63
    v_mov_b32 v5, v4
    s_nop 1
    v_permlane32_swap_b32 v4, v5
    s_nop 1
    v_max_f32 v4, v4, v5
    v_add_f32 v4, 0x42200000, v4
    v_max_f32 v4, 0, v4
    v_sub_f32 v5, 0, v4
    v_exp_f32 v5, v5
    v_sub_f32 v48, v48, v4
    v_sub_f32 v80, v80, v4
    v_sub_f32 v49, v49, v4
    v_sub_f32 v81, v81, v4
    v_sub_f32 v50, v50, v4
    v_sub_f32 v82, v82, v4
    v_sub_f32 v51, v51, v4
    v_sub_f32 v83, v83, v4
    v_sub_f32 v52, v52, v4
    v_sub_f32 v84, v84, v4
    v_sub_f32 v53, v53, v4
    v_sub_f32 v85, v85, v4
    v_sub_f32 v54, v54, v4
    v_sub_f32 v86, v86, v4
    v_sub_f32 v55, v55, v4
    v_sub_f32 v87, v87, v4
    v_sub_f32 v56, v56, v4
    v_sub_f32 v88, v88, v4
    v_sub_f32 v57, v57, v4
    v_sub_f32 v89, v89, v4
    v_sub_f32 v58, v58, v4
    v_sub_f32 v90, v90, v4
    v_sub_f32 v59, v59, v4
    v_sub_f32 v91, v91, v4
    v_sub_f32 v60, v60, v4
    v_sub_f32 v92, v92, v4
    v_sub_f32 v61, v61, v4
    v_sub_f32 v93, v93, v4
    v_sub_f32 v62, v62, v4
    v_sub_f32 v94, v94, v4
    v_sub_f32 v63, v63, v4
    v_sub_f32 v95, v95, v4
    v_accvgpr_read_b32 v6, a0
    v_accvgpr_read_b32 v7, a1
    v_accvgpr_read_b32 v8, a2
    v_accvgpr_read_b32 v9, a3
    v_mul_f32 v6, v6, v5
    v_mul_f32 v7, v7, v5
    v_mul_f32 v8, v8, v5
    v_mul_f32 v9, v9, v5
    v_accvgpr_write_b32 a0, v6
    v_accvgpr_write_b32 a1, v7
    v_accvgpr_write_b32 a2, v8
    v_accvgpr_write_b32 a3, v9
    v_accvgpr_read_b32 v6, a4
    v_accvgpr_read_b32 v7, a5
    v_accvgpr_read_b32 v8, a6
    v_accvgpr_read_b32 v9, a7
    v_mul_f32 v6, v6, v5
    v_mul_f32 v7, v7, v5
    v_mul_f32 v8, v8, v5
    v_mul_f32 v9, v9, v5
    v_accvgpr_write_b32 a4, v6
    v_accvgpr_write_b32 a5, v7
    v_accvgpr_write_b32 a6, v8
    v_accvgpr_write_b32 a7, v9
    v_accvgpr_read_b32 v6, a8
    v_accvgpr_read_b32 v7, a9
    v_accvgpr_read_b32 v8, a10
    v_accvgpr_read_b32 v9, a11
    v_mul_f32 v6, v6, v5
    v_mul_f32 v7, v7, v5
    v_mul_f32 v8, v8, v5
    v_mul_f32 v9, v9, v5
    v_accvgpr_write_b32 a8, v6
    v_accvgpr_write_b32 a9, v7
    v_accvgpr_write_b32 a10, v8
    v_accvgpr_write_b32 a11, v9
    v_accvgpr_read_b32 v6, a12
    v_accvgpr_read_b32 v7, a13
    v_accvgpr_read_b32 v8, a14
    v_accvgpr_read_b32 v9, a15
    v_mul_f32 v6, v6, v5
    v_mul_f32 v7, v7, v5
    v_mul_f32 v8, v8, v5
    v_mul_f32 v9, v9, v5
    v_accvgpr_write_b32 a12, v6
    v_accvgpr_write_b32 a13, v7
    v_accvgpr_write_b32 a14, v8
    v_accvgpr_write_b32 a15, v9
    v_accvgpr_read_b32 v6, a16
    v_accvgpr_read_b32 v7, a17
    v_accvgpr_read_b32 v8, a18
    v_accvgpr_read_b32 v9, a19
    v_mul_f32 v6, v6, v5
    v_mul_f32 v7, v7, v5
    v_mul_f32 v8, v8, v5
    v_mul_f32 v9, v9, v5
    v_accvgpr_write_b32 a16, v6
    v_accvgpr_write_b32 a17, v7
    v_accvgpr_write_b32 a18, v8
    v_accvgpr_write_b32 a19, v9
    v_accvgpr_read_b32 v6, a20
    v_accvgpr_read_b32 v7, a21
    v_accvgpr_read_b32 v8, a22
    v_accvgpr_read_b32 v9, a23
    v_mul_f32 v6, v6, v5
    v_mul_f32 v7, v7, v5
    v_mul_f32 v8, v8, v5
    v_mul_f32 v9, v9, v5
    v_accvgpr_write_b32 a20, v6
    v_accvgpr_write_b32 a21, v7
    v_accvgpr_write_b32 a22, v8
    v_accvgpr_write_b32 a23, v9
    v_accvgpr_read_b32 v6, a24
    v_accvgpr_read_b32 v7, a25
    v_accvgpr_read_b32 v8, a26
    v_accvgpr_read_b32 v9, a27
    v_mul_f32 v6, v6, v5
    v_mul_f32 v7, v7, v5
    v_mul_f32 v8, v8, v5
    v_mul_f32 v9, v9, v5
    v_accvgpr_write_b32 a24, v6
    v_accvgpr_write_b32 a25, v7
    v_accvgpr_write_b32 a26, v8
    v_accvgpr_write_b32 a27, v9
    v_accvgpr_read_b32 v6, a28
    v_accvgpr_read_b32 v7, a29
    v_accvgpr_read_b32 v8, a30
    v_accvgpr_read_b32 v9, a31
    v_mul_f32 v6, v6, v5
    v_mul_f32 v7, v7, v5
    v_mul_f32 v8, v8, v5
    v_mul_f32 v9, v9, v5
    v_accvgpr_write_b32 a28, v6
    v_accvgpr_write_b32 a29, v7
    v_accvgpr_write_b32 a30, v8
    v_accvgpr_write_b32 a31, v9
    v_accvgpr_read_b32 v6, a32
    v_accvgpr_read_b32 v7, a33
    v_accvgpr_read_b32 v8, a34
    v_accvgpr_read_b32 v9, a35
    v_mul_f32 v6, v6, v5
    v_mul_f32 v7, v7, v5
    v_mul_f32 v8, v8, v5
    v_mul_f32 v9, v9, v5
    v_accvgpr_write_b32 a32, v6
    v_accvgpr_write_b32 a33, v7
    v_accvgpr_write_b32 a34, v8
    v_accvgpr_write_b32 a35, v9
    v_accvgpr_read_b32 v6, a36
    v_accvgpr_read_b32 v7, a37
    v_accvgpr_read_b32 v8, a38
    v_accvgpr_read_b32 v9, a39
    v_mul_f32 v6, v6, v5
    v_mul_f32 v7, v7, v5
    v_mul_f32 v8, v8, v5
    v_mul_f32 v9, v9, v5
    v_accvgpr_write_b32 a36, v6
    v_accvgpr_write_b32 a37, v7
    v_accvgpr_write_b32 a38, v8
    v_accvgpr_write_b32 a39, v9
    v_accvgpr_read_b32 v6, a40
    v_accvgpr_read_b32 v7, a41
    v_accvgpr_read_b32 v8, a42
    v_accvgpr_read_b32 v9, a43
    v_mul_f32 v6, v6, v5
    v_mul_f32 v7, v7, v5
    v_mul_f32 v8, v8, v5
    v_mul_f32 v9, v9, v5
    v_accvgpr_write_b32 a40, v6
    v_accvgpr_write_b32 a41, v7
    v_accvgpr_write_b32 a42, v8
    v_accvgpr_write_b32 a43, v9
    v_accvgpr_read_b32 v6, a44
    v_accvgpr_read_b32 v7, a45
    v_accvgpr_read_b32 v8, a46
    v_accvgpr_read_b32 v9, a47
    v_mul_f32 v6, v6, v5
    v_mul_f32 v7, v7, v5
    v_mul_f32 v8, v8, v5
    v_mul_f32 v9, v9, v5
    v_accvgpr_write_b32 a44, v6
    v_accvgpr_write_b32 a45, v7
    v_accvgpr_write_b32 a46, v8
    v_accvgpr_write_b32 a47, v9
    v_accvgpr_read_b32 v6, a48
    v_accvgpr_read_b32 v7, a49
    v_accvgpr_read_b32 v8, a50
    v_accvgpr_read_b32 v9, a51
    v_mul_f32 v6, v6, v5
    v_mul_f32 v7, v7, v5
    v_mul_f32 v8, v8, v5
    v_mul_f32 v9, v9, v5
    v_accvgpr_write_b32 a48, v6
    v_accvgpr_write_b32 a49, v7
    v_accvgpr_write_b32 a50, v8
    v_accvgpr_write_b32 a51, v9
    v_accvgpr_read_b32 v6, a52
    v_accvgpr_read_b32 v7, a53
    v_accvgpr_read_b32 v8, a54
    v_accvgpr_read_b32 v9, a55
    v_mul_f32 v6, v6, v5
    v_mul_f32 v7, v7, v5
    v_mul_f32 v8, v8, v5
    v_mul_f32 v9, v9, v5
    v_accvgpr_write_b32 a52, v6
    v_accvgpr_write_b32 a53, v7
    v_accvgpr_write_b32 a54, v8
    v_accvgpr_write_b32 a55, v9
    v_accvgpr_read_b32 v6, a56
    v_accvgpr_read_b32 v7, a57
    v_accvgpr_read_b32 v8, a58
    v_accvgpr_read_b32 v9, a59
    v_mul_f32 v6, v6, v5
    v_mul_f32 v7, v7, v5
    v_mul_f32 v8, v8, v5
    v_mul_f32 v9, v9, v5
    v_accvgpr_write_b32 a56, v6
    v_accvgpr_write_b32 a57, v7
    v_accvgpr_write_b32 a58, v8
    v_accvgpr_write_b32 a59, v9
    v_accvgpr_read_b32 v6, a60
    v_accvgpr_read_b32 v7, a61
    v_accvgpr_read_b32 v8, a62
    v_accvgpr_read_b32 v9, a63
    v_mul_f32 v6, v6, v5
    v_mul_f32 v7, v7, v5
    v_mul_f32 v8, v8, v5
    v_mul_f32 v9, v9, v5
    v_accvgpr_write_b32 a60, v6
    v_accvgpr_write_b32 a61, v7
    v_accvgpr_write_b32 a62, v8
    v_accvgpr_write_b32 a63, v9
    v_accvgpr_read_b32 v6, a64
    v_accvgpr_read_b32 v7, a65
    v_accvgpr_read_b32 v8, a66
    v_accvgpr_read_b32 v9, a67
    v_mul_f32 v6, v6, v5
    v_mul_f32 v7, v7, v5
    v_mul_f32 v8, v8, v5
    v_mul_f32 v9, v9, v5
    v_accvgpr_write_b32 a64, v6
    v_accvgpr_write_b32 a65, v7
    v_accvgpr_write_b32 a66, v8
    v_accvgpr_write_b32 a67, v9
    v_accvgpr_read_b32 v6, a68
    v_accvgpr_read_b32 v7, a69
    v_accvgpr_read_b32 v8, a70
    v_accvgpr_read_b32 v9, a71
    v_mul_f32 v6, v6, v5
    v_mul_f32 v7, v7, v5
    v_mul_f32 v8, v8, v5
    v_mul_f32 v9, v9, v5
    v_accvgpr_write_b32 a68, v6
    v_accvgpr_write_b32 a69, v7
    v_accvgpr_write_b32 a70, v8
    v_accvgpr_write_b32 a71, v9
    v_accvgpr_read_b32 v6, a72
    v_accvgpr_read_b32 v7, a73
    v_accvgpr_read_b32 v8, a74
    v_accvgpr_read_b32 v9, a75
    v_mul_f32 v6, v6, v5
    v_mul_f32 v7, v7, v5
    v_mul_f32 v8, v8, v5
    v_mul_f32 v9, v9, v5
    v_accvgpr_write_b32 a72, v6
    v_accvgpr_write_b32 a73, v7
    v_accvgpr_write_b32 a74, v8
    v_accvgpr_write_b32 a75, v9
    v_accvgpr_read_b32 v6, a76
    v_accvgpr_read_b32 v7, a77
    v_accvgpr_read_b32 v8, a78
    v_accvgpr_read_b32 v9, a79
    v_mul_f32 v6, v6, v5
    v_mul_f32 v7, v7, v5
    v_mul_f32 v8, v8, v5
    v_mul_f32 v9, v9, v5
    v_accvgpr_write_b32 a76, v6
    v_accvgpr_write_b32 a77, v7
    v_accvgpr_write_b32 a78, v8
    v_accvgpr_write_b32 a79, v9
    v_exp_f32 v6, v48
    v_exp_f32 v7, v49
    s_nop 0
    v_cvt_pk_bf16_f32 v128, v6, v7
    v_exp_f32 v6, v50
    v_exp_f32 v7, v51
    s_nop 0
    v_cvt_pk_bf16_f32 v129, v6, v7
    v_exp_f32 v6, v52
    v_exp_f32 v7, v53
    s_nop 0
    v_cvt_pk_bf16_f32 v130, v6, v7
    v_exp_f32 v6, v54
    v_exp_f32 v7, v55
    s_nop 0
    v_cvt_pk_bf16_f32 v131, v6, v7
    v_exp_f32 v6, v56
    v_exp_f32 v7, v57
    s_nop 0
    v_cvt_pk_bf16_f32 v132, v6, v7
    v_exp_f32 v6, v58
    v_exp_f32 v7, v59
    s_nop 0
    v_cvt_pk_bf16_f32 v133, v6, v7
    v_exp_f32 v6, v60
    v_exp_f32 v7, v61
    s_nop 0
    v_cvt_pk_bf16_f32 v134, v6, v7
    v_exp_f32 v6, v62
    v_exp_f32 v7, v63
    s_nop 0
    v_cvt_pk_bf16_f32 v135, v6, v7
    v_max3_f32 v4, v64, v65, v66
    v_max3_f32 v4, v4, v67, v68
    v_max3_f32 v4, v4, v69, v70
    v_max3_f32 v4, v4, v71, v72
    v_max3_f32 v4, v4, v73, v74
    v_max3_f32 v4, v4, v75, v76
    v_max3_f32 v4, v4, v77, v78
    v_max_f32 v4, v4, v79
    v_mov_b32 v5, v4
    s_nop 1
    v_permlane32_swap_b32 v4, v5
    s_nop 1
    v_max_f32 v4, v4, v5
    v_add_f32 v4, 0x42200000, v4
    v_max_f32 v4, 0, v4
    v_sub_f32 v5, 0, v4
    v_exp_f32 v5, v5
    v_sub_f32 v64, v64, v4
    v_sub_f32 v96, v96, v4
    v_sub_f32 v65, v65, v4
    v_sub_f32 v97, v97, v4
    v_sub_f32 v66, v66, v4
    v_sub_f32 v98, v98, v4
    v_sub_f32 v67, v67, v4
    v_sub_f32 v99, v99, v4
    v_sub_f32 v68, v68, v4
    v_sub_f32 v100, v100, v4
    v_sub_f32 v69, v69, v4
    v_sub_f32 v101, v101, v4
    v_sub_f32 v70, v70, v4
    v_sub_f32 v102, v102, v4
    v_sub_f32 v71, v71, v4
    v_sub_f32 v103, v103, v4
    v_sub_f32 v72, v72, v4
    v_sub_f32 v104, v104, v4
    v_sub_f32 v73, v73, v4
    v_sub_f32 v105, v105, v4
    v_sub_f32 v74, v74, v4
    v_sub_f32 v106, v106, v4
    v_sub_f32 v75, v75, v4
    v_sub_f32 v107, v107, v4
    v_sub_f32 v76, v76, v4
    v_sub_f32 v108, v108, v4
    v_sub_f32 v77, v77, v4
    v_sub_f32 v109, v109, v4
    v_sub_f32 v78, v78, v4
    v_sub_f32 v110, v110, v4
    v_sub_f32 v79, v79, v4
    v_sub_f32 v111, v111, v4
    v_accvgpr_read_b32 v6, a80
    v_accvgpr_read_b32 v7, a81
    v_accvgpr_read_b32 v8, a82
    v_accvgpr_read_b32 v9, a83
    v_mul_f32 v6, v6, v5
    v_mul_f32 v7, v7, v5
    v_mul_f32 v8, v8, v5
    v_mul_f32 v9, v9, v5
    v_accvgpr_write_b32 a80, v6
    v_accvgpr_write_b32 a81, v7
    v_accvgpr_write_b32 a82, v8
    v_accvgpr_write_b32 a83, v9
    v_accvgpr_read_b32 v6, a84
    v_accvgpr_read_b32 v7, a85
    v_accvgpr_read_b32 v8, a86
    v_accvgpr_read_b32 v9, a87
    v_mul_f32 v6, v6, v5
    v_mul_f32 v7, v7, v5
    v_mul_f32 v8, v8, v5
    v_mul_f32 v9, v9, v5
    v_accvgpr_write_b32 a84, v6
    v_accvgpr_write_b32 a85, v7
    v_accvgpr_write_b32 a86, v8
    v_accvgpr_write_b32 a87, v9
    v_accvgpr_read_b32 v6, a88
    v_accvgpr_read_b32 v7, a89
    v_accvgpr_read_b32 v8, a90
    v_accvgpr_read_b32 v9, a91
    v_mul_f32 v6, v6, v5
    v_mul_f32 v7, v7, v5
    v_mul_f32 v8, v8, v5
    v_mul_f32 v9, v9, v5
    v_accvgpr_write_b32 a88, v6
    v_accvgpr_write_b32 a89, v7
    v_accvgpr_write_b32 a90, v8
    v_accvgpr_write_b32 a91, v9
    v_accvgpr_read_b32 v6, a92
    v_accvgpr_read_b32 v7, a93
    v_accvgpr_read_b32 v8, a94
    v_accvgpr_read_b32 v9, a95
    v_mul_f32 v6, v6, v5
    v_mul_f32 v7, v7, v5
    v_mul_f32 v8, v8, v5
    v_mul_f32 v9, v9, v5
    v_accvgpr_write_b32 a92, v6
    v_accvgpr_write_b32 a93, v7
    v_accvgpr_write_b32 a94, v8
    v_accvgpr_write_b32 a95, v9
    v_accvgpr_read_b32 v6, a96
    v_accvgpr_read_b32 v7, a97
    v_accvgpr_read_b32 v8, a98
    v_accvgpr_read_b32 v9, a99
    v_mul_f32 v6, v6, v5
    v_mul_f32 v7, v7, v5
    v_mul_f32 v8, v8, v5
    v_mul_f32 v9, v9, v5
    v_accvgpr_write_b32 a96, v6
    v_accvgpr_write_b32 a97, v7
    v_accvgpr_write_b32 a98, v8
    v_accvgpr_write_b32 a99, v9
    v_accvgpr_read_b32 v6, a100
    v_accvgpr_read_b32 v7, a101
    v_accvgpr_read_b32 v8, a102
    v_accvgpr_read_b32 v9, a103
    v_mul_f32 v6, v6, v5
    v_mul_f32 v7, v7, v5
    v_mul_f32 v8, v8, v5
    v_mul_f32 v9, v9, v5
    v_accvgpr_write_b32 a100, v6
    v_accvgpr_write_b32 a101, v7
    v_accvgpr_write_b32 a102, v8
    v_accvgpr_write_b32 a103, v9
    v_accvgpr_read_b32 v6, a104
    v_accvgpr_read_b32 v7, a105
    v_accvgpr_read_b32 v8, a106
    v_accvgpr_read_b32 v9, a107
    v_mul_f32 v6, v6, v5
    v_mul_f32 v7, v7, v5
    v_mul_f32 v8, v8, v5
    v_mul_f32 v9, v9, v5
    v_accvgpr_write_b32 a104, v6
    v_accvgpr_write_b32 a105, v7
    v_accvgpr_write_b32 a106, v8
    v_accvgpr_write_b32 a107, v9
    v_accvgpr_read_b32 v6, a108
    v_accvgpr_read_b32 v7, a109
    v_accvgpr_read_b32 v8, a110
    v_accvgpr_read_b32 v9, a111
    v_mul_f32 v6, v6, v5
    v_mul_f32 v7, v7, v5
    v_mul_f32 v8, v8, v5
    v_mul_f32 v9, v9, v5
    v_accvgpr_write_b32 a108, v6
    v_accvgpr_write_b32 a109, v7
    v_accvgpr_write_b32 a110, v8
    v_accvgpr_write_b32 a111, v9
    v_accvgpr_read_b32 v6, a112
    v_accvgpr_read_b32 v7, a113
    v_accvgpr_read_b32 v8, a114
    v_accvgpr_read_b32 v9, a115
    v_mul_f32 v6, v6, v5
    v_mul_f32 v7, v7, v5
    v_mul_f32 v8, v8, v5
    v_mul_f32 v9, v9, v5
    v_accvgpr_write_b32 a112, v6
    v_accvgpr_write_b32 a113, v7
    v_accvgpr_write_b32 a114, v8
    v_accvgpr_write_b32 a115, v9
    v_accvgpr_read_b32 v6, a116
    v_accvgpr_read_b32 v7, a117
    v_accvgpr_read_b32 v8, a118
    v_accvgpr_read_b32 v9, a119
    v_mul_f32 v6, v6, v5
    v_mul_f32 v7, v7, v5
    v_mul_f32 v8, v8, v5
    v_mul_f32 v9, v9, v5
    v_accvgpr_write_b32 a116, v6
    v_accvgpr_write_b32 a117, v7
    v_accvgpr_write_b32 a118, v8
    v_accvgpr_write_b32 a119, v9
    v_accvgpr_read_b32 v6, a120
    v_accvgpr_read_b32 v7, a121
    v_accvgpr_read_b32 v8, a122
    v_accvgpr_read_b32 v9, a123
    v_mul_f32 v6, v6, v5
    v_mul_f32 v7, v7, v5
    v_mul_f32 v8, v8, v5
    v_mul_f32 v9, v9, v5
    v_accvgpr_write_b32 a120, v6
    v_accvgpr_write_b32 a121, v7
    v_accvgpr_write_b32 a122, v8
    v_accvgpr_write_b32 a123, v9
    v_accvgpr_read_b32 v6, a124
    v_accvgpr_read_b32 v7, a125
    v_accvgpr_read_b32 v8, a126
    v_accvgpr_read_b32 v9, a127
    v_mul_f32 v6, v6, v5
    v_mul_f32 v7, v7, v5
    v_mul_f32 v8, v8, v5
    v_mul_f32 v9, v9, v5
    v_accvgpr_write_b32 a124, v6
    v_accvgpr_write_b32 a125, v7
    v_accvgpr_write_b32 a126, v8
    v_accvgpr_write_b32 a127, v9
    v_accvgpr_read_b32 v6, a128
    v_accvgpr_read_b32 v7, a129
    v_accvgpr_read_b32 v8, a130
    v_accvgpr_read_b32 v9, a131
    v_mul_f32 v6, v6, v5
    v_mul_f32 v7, v7, v5
    v_mul_f32 v8, v8, v5
    v_mul_f32 v9, v9, v5
    v_accvgpr_write_b32 a128, v6
    v_accvgpr_write_b32 a129, v7
    v_accvgpr_write_b32 a130, v8
    v_accvgpr_write_b32 a131, v9
    v_accvgpr_read_b32 v6, a132
    v_accvgpr_read_b32 v7, a133
    v_accvgpr_read_b32 v8, a134
    v_accvgpr_read_b32 v9, a135
    v_mul_f32 v6, v6, v5
    v_mul_f32 v7, v7, v5
    v_mul_f32 v8, v8, v5
    v_mul_f32 v9, v9, v5
    v_accvgpr_write_b32 a132, v6
    v_accvgpr_write_b32 a133, v7
    v_accvgpr_write_b32 a134, v8
    v_accvgpr_write_b32 a135, v9
    v_accvgpr_read_b32 v6, a136
    v_accvgpr_read_b32 v7, a137
    v_accvgpr_read_b32 v8, a138
    v_accvgpr_read_b32 v9, a139
    v_mul_f32 v6, v6, v5
    v_mul_f32 v7, v7, v5
    v_mul_f32 v8, v8, v5
    v_mul_f32 v9, v9, v5
    v_accvgpr_write_b32 a136, v6
    v_accvgpr_write_b32 a137, v7
    v_accvgpr_write_b32 a138, v8
    v_accvgpr_write_b32 a139, v9
    v_accvgpr_read_b32 v6, a140
    v_accvgpr_read_b32 v7, a141
    v_accvgpr_read_b32 v8, a142
    v_accvgpr_read_b32 v9, a143
    v_mul_f32 v6, v6, v5
    v_mul_f32 v7, v7, v5
    v_mul_f32 v8, v8, v5
    v_mul_f32 v9, v9, v5
    v_accvgpr_write_b32 a140, v6
    v_accvgpr_write_b32 a141, v7
    v_accvgpr_write_b32 a142, v8
    v_accvgpr_write_b32 a143, v9
    v_accvgpr_read_b32 v6, a144
    v_accvgpr_read_b32 v7, a145
    v_accvgpr_read_b32 v8, a146
    v_accvgpr_read_b32 v9, a147
    v_mul_f32 v6, v6, v5
    v_mul_f32 v7, v7, v5
    v_mul_f32 v8, v8, v5
    v_mul_f32 v9, v9, v5
    v_accvgpr_write_b32 a144, v6
    v_accvgpr_write_b32 a145, v7
    v_accvgpr_write_b32 a146, v8
    v_accvgpr_write_b32 a147, v9
    v_accvgpr_read_b32 v6, a148
    v_accvgpr_read_b32 v7, a149
    v_accvgpr_read_b32 v8, a150
    v_accvgpr_read_b32 v9, a151
    v_mul_f32 v6, v6, v5
    v_mul_f32 v7, v7, v5
    v_mul_f32 v8, v8, v5
    v_mul_f32 v9, v9, v5
    v_accvgpr_write_b32 a148, v6
    v_accvgpr_write_b32 a149, v7
    v_accvgpr_write_b32 a150, v8
    v_accvgpr_write_b32 a151, v9
    v_accvgpr_read_b32 v6, a152
    v_accvgpr_read_b32 v7, a153
    v_accvgpr_read_b32 v8, a154
    v_accvgpr_read_b32 v9, a155
    v_mul_f32 v6, v6, v5
    v_mul_f32 v7, v7, v5
    v_mul_f32 v8, v8, v5
    v_mul_f32 v9, v9, v5
    v_accvgpr_write_b32 a152, v6
    v_accvgpr_write_b32 a153, v7
    v_accvgpr_write_b32 a154, v8
    v_accvgpr_write_b32 a155, v9
    v_accvgpr_read_b32 v6, a156
    v_accvgpr_read_b32 v7, a157
    v_accvgpr_read_b32 v8, a158
    v_accvgpr_read_b32 v9, a159
    v_mul_f32 v6, v6, v5
    v_mul_f32 v7, v7, v5
    v_mul_f32 v8, v8, v5
    v_mul_f32 v9, v9, v5
    v_accvgpr_write_b32 a156, v6
    v_accvgpr_write_b32 a157, v7
    v_accvgpr_write_b32 a158, v8
    v_accvgpr_write_b32 a159, v9
    v_exp_f32 v6, v64
    v_exp_f32 v7, v65
    s_nop 0
    v_cvt_pk_bf16_f32 v136, v6, v7
    v_exp_f32 v6, v66
    v_exp_f32 v7, v67
    s_nop 0
    v_cvt_pk_bf16_f32 v137, v6, v7
    v_exp_f32 v6, v68
    v_exp_f32 v7, v69
    s_nop 0
    v_cvt_pk_bf16_f32 v138, v6, v7
    v_exp_f32 v6, v70
    v_exp_f32 v7, v71
    s_nop 0
    v_cvt_pk_bf16_f32 v139, v6, v7
    v_exp_f32 v6, v72
    v_exp_f32 v7, v73
    s_nop 0
    v_cvt_pk_bf16_f32 v140, v6, v7
    v_exp_f32 v6, v74
    v_exp_f32 v7, v75
    s_nop 0
    v_cvt_pk_bf16_f32 v141, v6, v7
    v_exp_f32 v6, v76
    v_exp_f32 v7, v77
    s_nop 0
    v_cvt_pk_bf16_f32 v142, v6, v7
    v_exp_f32 v6, v78
    v_exp_f32 v7, v79
    s_nop 0
    v_cvt_pk_bf16_f32 v143, v6, v7
    s_nop 7
    s_branch L_k2_retL1
L_k2_rareL2:
    s_nop 15
    v_max3_f32 v4, v48, v49, v50
    v_max3_f32 v4, v4, v51, v52
    v_max3_f32 v4, v4, v53, v54
    v_max3_f32 v4, v4, v55, v56
    v_max3_f32 v4, v4, v57, v58
    v_max3_f32 v4, v4, v59, v60
    v_max3_f32 v4, v4, v61, v62
    v_max_f32 v4, v4, v63
    v_mov_b32 v5, v4
    s_nop 1
    v_permlane32_swap_b32 v4, v5
    s_nop 1
    v_max_f32 v4, v4, v5
    v_add_f32 v4, 0x42200000, v4
    v_max_f32 v4, 0, v4
    v_sub_f32 v5, 0, v4
    v_exp_f32 v5, v5
    v_sub_f32 v48, v48, v4
    v_sub_f32 v80, v80, v4
    v_sub_f32 v49, v49, v4
    v_sub_f32 v81, v81, v4
    v_sub_f32 v50, v50, v4
    v_sub_f32 v82, v82, v4
    v_sub_f32 v51, v51, v4
    v_sub_f32 v83, v83, v4
    v_sub_f32 v52, v52, v4
    v_sub_f32 v84, v84, v4
    v_sub_f32 v53, v53, v4
    v_sub_f32 v85, v85, v4
    v_sub_f32 v54, v54, v4
    v_sub_f32 v86, v86, v4
    v_sub_f32 v55, v55, v4
    v_sub_f32 v87, v87, v4
    v_sub_f32 v56, v56, v4
    v_sub_f32 v88, v88, v4
    v_sub_f32 v57, v57, v4
    v_sub_f32 v89, v89, v4
    v_sub_f32 v58, v58, v4
    v_sub_f32 v90, v90, v4
    v_sub_f32 v59, v59, v4
    v_sub_f32 v91, v91, v4
    v_sub_f32 v60, v60, v4
    v_sub_f32 v92, v92, v4
    v_sub_f32 v61, v61, v4
    v_sub_f32 v93, v93, v4
    v_sub_f32 v62, v62, v4
    v_sub_f32 v94, v94, v4
    v_sub_f32 v63, v63, v4
    v_sub_f32 v95, v95, v4
    v_accvgpr_read_b32 v6, a0
    v_accvgpr_read_b32 v7, a1
    v_accvgpr_read_b32 v8, a2
    v_accvgpr_read_b32 v9, a3
    v_mul_f32 v6, v6, v5
    v_mul_f32 v7, v7, v5
    v_mul_f32 v8, v8, v5
    v_mul_f32 v9, v9, v5
    v_accvgpr_write_b32 a0, v6
    v_accvgpr_write_b32 a1, v7
    v_accvgpr_write_b32 a2, v8
    v_accvgpr_write_b32 a3, v9
    v_accvgpr_read_b32 v6, a4
    v_accvgpr_read_b32 v7, a5
    v_accvgpr_read_b32 v8, a6
    v_accvgpr_read_b32 v9, a7
    v_mul_f32 v6, v6, v5
    v_mul_f32 v7, v7, v5
    v_mul_f32 v8, v8, v5
    v_mul_f32 v9, v9, v5
    v_accvgpr_write_b32 a4, v6
    v_accvgpr_write_b32 a5, v7
    v_accvgpr_write_b32 a6, v8
    v_accvgpr_write_b32 a7, v9
    v_accvgpr_read_b32 v6, a8
    v_accvgpr_read_b32 v7, a9
    v_accvgpr_read_b32 v8, a10
    v_accvgpr_read_b32 v9, a11
    v_mul_f32 v6, v6, v5
    v_mul_f32 v7, v7, v5
    v_mul_f32 v8, v8, v5
    v_mul_f32 v9, v9, v5
    v_accvgpr_write_b32 a8, v6
    v_accvgpr_write_b32 a9, v7
    v_accvgpr_write_b32 a10, v8
    v_accvgpr_write_b32 a11, v9
    v_accvgpr_read_b32 v6, a12
    v_accvgpr_read_b32 v7, a13
    v_accvgpr_read_b32 v8, a14
    v_accvgpr_read_b32 v9, a15
    v_mul_f32 v6, v6, v5
    v_mul_f32 v7, v7, v5
    v_mul_f32 v8, v8, v5
    v_mul_f32 v9, v9, v5
    v_accvgpr_write_b32 a12, v6
    v_accvgpr_write_b32 a13, v7
    v_accvgpr_write_b32 a14, v8
    v_accvgpr_write_b32 a15, v9
    v_accvgpr_read_b32 v6, a16
    v_accvgpr_read_b32 v7, a17
    v_accvgpr_read_b32 v8, a18
    v_accvgpr_read_b32 v9, a19
    v_mul_f32 v6, v6, v5
    v_mul_f32 v7, v7, v5
    v_mul_f32 v8, v8, v5
    v_mul_f32 v9, v9, v5
    v_accvgpr_write_b32 a16, v6
    v_accvgpr_write_b32 a17, v7
    v_accvgpr_write_b32 a18, v8
    v_accvgpr_write_b32 a19, v9
    v_accvgpr_read_b32 v6, a20
    v_accvgpr_read_b32 v7, a21
    v_accvgpr_read_b32 v8, a22
    v_accvgpr_read_b32 v9, a23
    v_mul_f32 v6, v6, v5
    v_mul_f32 v7, v7, v5
    v_mul_f32 v8, v8, v5
    v_mul_f32 v9, v9, v5
    v_accvgpr_write_b32 a20, v6
    v_accvgpr_write_b32 a21, v7
    v_accvgpr_write_b32 a22, v8
    v_accvgpr_write_b32 a23, v9
    v_accvgpr_read_b32 v6, a24
    v_accvgpr_read_b32 v7, a25
    v_accvgpr_read_b32 v8, a26
    v_accvgpr_read_b32 v9, a27
    v_mul_f32 v6, v6, v5
    v_mul_f32 v7, v7, v5
    v_mul_f32 v8, v8, v5
    v_mul_f32 v9, v9, v5
    v_accvgpr_write_b32 a24, v6
    v_accvgpr_write_b32 a25, v7
    v_accvgpr_write_b32 a26, v8
    v_accvgpr_write_b32 a27, v9
    v_accvgpr_read_b32 v6, a28
    v_accvgpr_read_b32 v7, a29
    v_accvgpr_read_b32 v8, a30
    v_accvgpr_read_b32 v9, a31
    v_mul_f32 v6, v6, v5
    v_mul_f32 v7, v7, v5
    v_mul_f32 v8, v8, v5
    v_mul_f32 v9, v9, v5
    v_accvgpr_write_b32 a28, v6
    v_accvgpr_write_b32 a29, v7
    v_accvgpr_write_b32 a30, v8
    v_accvgpr_write_b32 a31, v9
    v_accvgpr_read_b32 v6, a32
    v_accvgpr_read_b32 v7, a33
    v_accvgpr_read_b32 v8, a34
    v_accvgpr_read_b32 v9, a35
    v_mul_f32 v6, v6, v5
    v_mul_f32 v7, v7, v5
    v_mul_f32 v8, v8, v5
    v_mul_f32 v9, v9, v5
    v_accvgpr_write_b32 a32, v6
    v_accvgpr_write_b32 a33, v7
    v_accvgpr_write_b32 a34, v8
    v_accvgpr_write_b32 a35, v9
    v_accvgpr_read_b32 v6, a36
    v_accvgpr_read_b32 v7, a37
    v_accvgpr_read_b32 v8, a38
    v_accvgpr_read_b32 v9, a39
    v_mul_f32 v6, v6, v5
    v_mul_f32 v7, v7, v5
    v_mul_f32 v8, v8, v5
    v_mul_f32 v9, v9, v5
    v_accvgpr_write_b32 a36, v6
    v_accvgpr_write_b32 a37, v7
    v_accvgpr_write_b32 a38, v8
    v_accvgpr_write_b32 a39, v9
    v_accvgpr_read_b32 v6, a40
    v_accvgpr_read_b32 v7, a41
    v_accvgpr_read_b32 v8, a42
    v_accvgpr_read_b32 v9, a43
    v_mul_f32 v6, v6, v5
    v_mul_f32 v7, v7, v5
    v_mul_f32 v8, v8, v5
    v_mul_f32 v9, v9, v5
    v_accvgpr_write_b32 a40, v6
    v_accvgpr_write_b32 a41, v7
    v_accvgpr_write_b32 a42, v8
    v_accvgpr_write_b32 a43, v9
    v_accvgpr_read_b32 v6, a44
    v_accvgpr_read_b32 v7, a45
    v_accvgpr_read_b32 v8, a46
    v_accvgpr_read_b32 v9, a47
    v_mul_f32 v6, v6, v5
    v_mul_f32 v7, v7, v5
    v_mul_f32 v8, v8, v5
    v_mul_f32 v9, v9, v5
    v_accvgpr_write_b32 a44, v6
    v_accvgpr_write_b32 a45, v7
    v_accvgpr_write_b32 a46, v8
    v_accvgpr_write_b32 a47, v9
    v_accvgpr_read_b32 v6, a48
    v_accvgpr_read_b32 v7, a49
    v_accvgpr_read_b32 v8, a50
    v_accvgpr_read_b32 v9, a51
    v_mul_f32 v6, v6, v5
    v_mul_f32 v7, v7, v5
    v_mul_f32 v8, v8, v5
    v_mul_f32 v9, v9, v5
    v_accvgpr_write_b32 a48, v6
    v_accvgpr_write_b32 a49, v7
    v_accvgpr_write_b32 a50, v8
    v_accvgpr_write_b32 a51, v9
    v_accvgpr_read_b32 v6, a52
    v_accvgpr_read_b32 v7, a53
    v_accvgpr_read_b32 v8, a54
    v_accvgpr_read_b32 v9, a55
    v_mul_f32 v6, v6, v5
    v_mul_f32 v7, v7, v5
    v_mul_f32 v8, v8, v5
    v_mul_f32 v9, v9, v5
    v_accvgpr_write_b32 a52, v6
    v_accvgpr_write_b32 a53, v7
    v_accvgpr_write_b32 a54, v8
    v_accvgpr_write_b32 a55, v9
    v_accvgpr_read_b32 v6, a56
    v_accvgpr_read_b32 v7, a57
    v_accvgpr_read_b32 v8, a58
    v_accvgpr_read_b32 v9, a59
    v_mul_f32 v6, v6, v5
    v_mul_f32 v7, v7, v5
    v_mul_f32 v8, v8, v5
    v_mul_f32 v9, v9, v5
    v_accvgpr_write_b32 a56, v6
    v_accvgpr_write_b32 a57, v7
    v_accvgpr_write_b32 a58, v8
    v_accvgpr_write_b32 a59, v9
    v_accvgpr_read_b32 v6, a60
    v_accvgpr_read_b32 v7, a61
    v_accvgpr_read_b32 v8, a62
    v_accvgpr_read_b32 v9, a63
    v_mul_f32 v6, v6, v5
    v_mul_f32 v7, v7, v5
    v_mul_f32 v8, v8, v5
    v_mul_f32 v9, v9, v5
    v_accvgpr_write_b32 a60, v6
    v_accvgpr_write_b32 a61, v7
    v_accvgpr_write_b32 a62, v8
    v_accvgpr_write_b32 a63, v9
    v_accvgpr_read_b32 v6, a64
    v_accvgpr_read_b32 v7, a65
    v_accvgpr_read_b32 v8, a66
    v_accvgpr_read_b32 v9, a67
    v_mul_f32 v6, v6, v5
    v_mul_f32 v7, v7, v5
    v_mul_f32 v8, v8, v5
    v_mul_f32 v9, v9, v5
    v_accvgpr_write_b32 a64, v6
    v_accvgpr_write_b32 a65, v7
    v_accvgpr_write_b32 a66, v8
    v_accvgpr_write_b32 a67, v9
    v_accvgpr_read_b32 v6, a68
    v_accvgpr_read_b32 v7, a69
    v_accvgpr_read_b32 v8, a70
    v_accvgpr_read_b32 v9, a71
    v_mul_f32 v6, v6, v5
    v_mul_f32 v7, v7, v5
    v_mul_f32 v8, v8, v5
    v_mul_f32 v9, v9, v5
    v_accvgpr_write_b32 a68, v6
    v_accvgpr_write_b32 a69, v7
    v_accvgpr_write_b32 a70, v8
    v_accvgpr_write_b32 a71, v9
    v_accvgpr_read_b32 v6, a72
    v_accvgpr_read_b32 v7, a73
    v_accvgpr_read_b32 v8, a74
    v_accvgpr_read_b32 v9, a75
    v_mul_f32 v6, v6, v5
    v_mul_f32 v7, v7, v5
    v_mul_f32 v8, v8, v5
    v_mul_f32 v9, v9, v5
    v_accvgpr_write_b32 a72, v6
    v_accvgpr_write_b32 a73, v7
    v_accvgpr_write_b32 a74, v8
    v_accvgpr_write_b32 a75, v9
    v_accvgpr_read_b32 v6, a76
    v_accvgpr_read_b32 v7, a77
    v_accvgpr_read_b32 v8, a78
    v_accvgpr_read_b32 v9, a79
    v_mul_f32 v6, v6, v5
    v_mul_f32 v7, v7, v5
    v_mul_f32 v8, v8, v5
    v_mul_f32 v9, v9, v5
    v_accvgpr_write_b32 a76, v6
    v_accvgpr_write_b32 a77, v7
    v_accvgpr_write_b32 a78, v8
    v_accvgpr_write_b32 a79, v9
    v_exp_f32 v6, v48
    v_exp_f32 v7, v49
    s_nop 0
    v_cvt_pk_bf16_f32 v128, v6, v7
    v_exp_f32 v6, v50
    v_exp_f32 v7, v51
    s_nop 0
    v_cvt_pk_bf16_f32 v129, v6, v7
    v_exp_f32 v6, v52
    v_exp_f32 v7, v53
    s_nop 0
    v_cvt_pk_bf16_f32 v130, v6, v7
    v_exp_f32 v6, v54
    v_exp_f32 v7, v55
    s_nop 0
    v_cvt_pk_bf16_f32 v131, v6, v7
    v_exp_f32 v6, v56
    v_exp_f32 v7, v57
    s_nop 0
    v_cvt_pk_bf16_f32 v132, v6, v7
    v_exp_f32 v6, v58
    v_exp_f32 v7, v59
    s_nop 0
    v_cvt_pk_bf16_f32 v133, v6, v7
    v_exp_f32 v6, v60
    v_exp_f32 v7, v61
    s_nop 0
    v_cvt_pk_bf16_f32 v134, v6, v7
    v_exp_f32 v6, v62
    v_exp_f32 v7, v63
    s_nop 0
    v_cvt_pk_bf16_f32 v135, v6, v7
    v_max3_f32 v4, v64, v65, v66
    v_max3_f32 v4, v4, v67, v68
    v_max3_f32 v4, v4, v69, v70
    v_max3_f32 v4, v4, v71, v72
    v_max3_f32 v4, v4, v73, v74
    v_max3_f32 v4, v4, v75, v76
    v_max3_f32 v4, v4, v77, v78
    v_max_f32 v4, v4, v79
    v_mov_b32 v5, v4
    s_nop 1
    v_permlane32_swap_b32 v4, v5
    s_nop 1
    v_max_f32 v4, v4, v5
    v_add_f32 v4, 0x42200000, v4
    v_max_f32 v4, 0, v4
    v_sub_f32 v5, 0, v4
    v_exp_f32 v5, v5
    v_sub_f32 v64, v64, v4
    v_sub_f32 v96, v96, v4
    v_sub_f32 v65, v65, v4
    v_sub_f32 v97, v97, v4
    v_sub_f32 v66, v66, v4
    v_sub_f32 v98, v98, v4
    v_sub_f32 v67, v67, v4
    v_sub_f32 v99, v99, v4
    v_sub_f32 v68, v68, v4
    v_sub_f32 v100, v100, v4
    v_sub_f32 v69, v69, v4
    v_sub_f32 v101, v101, v4
    v_sub_f32 v70, v70, v4
    v_sub_f32 v102, v102, v4
    v_sub_f32 v71, v71, v4
    v_sub_f32 v103, v103, v4
    v_sub_f32 v72, v72, v4
    v_sub_f32 v104, v104, v4
    v_sub_f32 v73, v73, v4
    v_sub_f32 v105, v105, v4
    v_sub_f32 v74, v74, v4
    v_sub_f32 v106, v106, v4
    v_sub_f32 v75, v75, v4
    v_sub_f32 v107, v107, v4
    v_sub_f32 v76, v76, v4
    v_sub_f32 v108, v108, v4
    v_sub_f32 v77, v77, v4
    v_sub_f32 v109, v109, v4
    v_sub_f32 v78, v78, v4
    v_sub_f32 v110, v110, v4
    v_sub_f32 v79, v79, v4
    v_sub_f32 v111, v111, v4
    v_accvgpr_read_b32 v6, a80
    v_accvgpr_read_b32 v7, a81
    v_accvgpr_read_b32 v8, a82
    v_accvgpr_read_b32 v9, a83
    v_mul_f32 v6, v6, v5
    v_mul_f32 v7, v7, v5
    v_mul_f32 v8, v8, v5
    v_mul_f32 v9, v9, v5
    v_accvgpr_write_b32 a80, v6
    v_accvgpr_write_b32 a81, v7
    v_accvgpr_write_b32 a82, v8
    v_accvgpr_write_b32 a83, v9
    v_accvgpr_read_b32 v6, a84
    v_accvgpr_read_b32 v7, a85
    v_accvgpr_read_b32 v8, a86
    v_accvgpr_read_b32 v9, a87
    v_mul_f32 v6, v6, v5
    v_mul_f32 v7, v7, v5
    v_mul_f32 v8, v8, v5
    v_mul_f32 v9, v9, v5
    v_accvgpr_write_b32 a84, v6
    v_accvgpr_write_b32 a85, v7
    v_accvgpr_write_b32 a86, v8
    v_accvgpr_write_b32 a87, v9
    v_accvgpr_read_b32 v6, a88
    v_accvgpr_read_b32 v7, a89
    v_accvgpr_read_b32 v8, a90
    v_accvgpr_read_b32 v9, a91
    v_mul_f32 v6, v6, v5
    v_mul_f32 v7, v7, v5
    v_mul_f32 v8, v8, v5
    v_mul_f32 v9, v9, v5
    v_accvgpr_write_b32 a88, v6
    v_accvgpr_write_b32 a89, v7
    v_accvgpr_write_b32 a90, v8
    v_accvgpr_write_b32 a91, v9
    v_accvgpr_read_b32 v6, a92
    v_accvgpr_read_b32 v7, a93
    v_accvgpr_read_b32 v8, a94
    v_accvgpr_read_b32 v9, a95
    v_mul_f32 v6, v6, v5
    v_mul_f32 v7, v7, v5
    v_mul_f32 v8, v8, v5
    v_mul_f32 v9, v9, v5
    v_accvgpr_write_b32 a92, v6
    v_accvgpr_write_b32 a93, v7
    v_accvgpr_write_b32 a94, v8
    v_accvgpr_write_b32 a95, v9
    v_accvgpr_read_b32 v6, a96
    v_accvgpr_read_b32 v7, a97
    v_accvgpr_read_b32 v8, a98
    v_accvgpr_read_b32 v9, a99
    v_mul_f32 v6, v6, v5
    v_mul_f32 v7, v7, v5
    v_mul_f32 v8, v8, v5
    v_mul_f32 v9, v9, v5
    v_accvgpr_write_b32 a96, v6
    v_accvgpr_write_b32 a97, v7
    v_accvgpr_write_b32 a98, v8
    v_accvgpr_write_b32 a99, v9
    v_accvgpr_read_b32 v6, a100
    v_accvgpr_read_b32 v7, a101
    v_accvgpr_read_b32 v8, a102
    v_accvgpr_read_b32 v9, a103
    v_mul_f32 v6, v6, v5
    v_mul_f32 v7, v7, v5
    v_mul_f32 v8, v8, v5
    v_mul_f32 v9, v9, v5
    v_accvgpr_write_b32 a100, v6
    v_accvgpr_write_b32 a101, v7
    v_accvgpr_write_b32 a102, v8
    v_accvgpr_write_b32 a103, v9
    v_accvgpr_read_b32 v6, a104
    v_accvgpr_read_b32 v7, a105
    v_accvgpr_read_b32 v8, a106
    v_accvgpr_read_b32 v9, a107
    v_mul_f32 v6, v6, v5
    v_mul_f32 v7, v7, v5
    v_mul_f32 v8, v8, v5
    v_mul_f32 v9, v9, v5
    v_accvgpr_write_b32 a104, v6
    v_accvgpr_write_b32 a105, v7
    v_accvgpr_write_b32 a106, v8
    v_accvgpr_write_b32 a107, v9
    v_accvgpr_read_b32 v6, a108
    v_accvgpr_read_b32 v7, a109
    v_accvgpr_read_b32 v8, a110
    v_accvgpr_read_b32 v9, a111
    v_mul_f32 v6, v6, v5
    v_mul_f32 v7, v7, v5
    v_mul_f32 v8, v8, v5
    v_mul_f32 v9, v9, v5
    v_accvgpr_write_b32 a108, v6
    v_accvgpr_write_b32 a109, v7
    v_accvgpr_write_b32 a110, v8
    v_accvgpr_write_b32 a111, v9
    v_accvgpr_read_b32 v6, a112
    v_accvgpr_read_b32 v7, a113
    v_accvgpr_read_b32 v8, a114
    v_accvgpr_read_b32 v9, a115
    v_mul_f32 v6, v6, v5
    v_mul_f32 v7, v7, v5
    v_mul_f32 v8, v8, v5
    v_mul_f32 v9, v9, v5
    v_accvgpr_write_b32 a112, v6
    v_accvgpr_write_b32 a113, v7
    v_accvgpr_write_b32 a114, v8
    v_accvgpr_write_b32 a115, v9
    v_accvgpr_read_b32 v6, a116
    v_accvgpr_read_b32 v7, a117
    v_accvgpr_read_b32 v8, a118
    v_accvgpr_read_b32 v9, a119
    v_mul_f32 v6, v6, v5
    v_mul_f32 v7, v7, v5
    v_mul_f32 v8, v8, v5
    v_mul_f32 v9, v9, v5
    v_accvgpr_write_b32 a116, v6
    v_accvgpr_write_b32 a117, v7
    v_accvgpr_write_b32 a118, v8
    v_accvgpr_write_b32 a119, v9
    v_accvgpr_read_b32 v6, a120
    v_accvgpr_read_b32 v7, a121
    v_accvgpr_read_b32 v8, a122
    v_accvgpr_read_b32 v9, a123
    v_mul_f32 v6, v6, v5
    v_mul_f32 v7, v7, v5
    v_mul_f32 v8, v8, v5
    v_mul_f32 v9, v9, v5
    v_accvgpr_write_b32 a120, v6
    v_accvgpr_write_b32 a121, v7
    v_accvgpr_write_b32 a122, v8
    v_accvgpr_write_b32 a123, v9
    v_accvgpr_read_b32 v6, a124
    v_accvgpr_read_b32 v7, a125
    v_accvgpr_read_b32 v8, a126
    v_accvgpr_read_b32 v9, a127
    v_mul_f32 v6, v6, v5
    v_mul_f32 v7, v7, v5
    v_mul_f32 v8, v8, v5
    v_mul_f32 v9, v9, v5
    v_accvgpr_write_b32 a124, v6
    v_accvgpr_write_b32 a125, v7
    v_accvgpr_write_b32 a126, v8
    v_accvgpr_write_b32 a127, v9
    v_accvgpr_read_b32 v6, a128
    v_accvgpr_read_b32 v7, a129
    v_accvgpr_read_b32 v8, a130
    v_accvgpr_read_b32 v9, a131
    v_mul_f32 v6, v6, v5
    v_mul_f32 v7, v7, v5
    v_mul_f32 v8, v8, v5
    v_mul_f32 v9, v9, v5
    v_accvgpr_write_b32 a128, v6
    v_accvgpr_write_b32 a129, v7
    v_accvgpr_write_b32 a130, v8
    v_accvgpr_write_b32 a131, v9
    v_accvgpr_read_b32 v6, a132
    v_accvgpr_read_b32 v7, a133
    v_accvgpr_read_b32 v8, a134
    v_accvgpr_read_b32 v9, a135
    v_mul_f32 v6, v6, v5
    v_mul_f32 v7, v7, v5
    v_mul_f32 v8, v8, v5
    v_mul_f32 v9, v9, v5
    v_accvgpr_write_b32 a132, v6
    v_accvgpr_write_b32 a133, v7
    v_accvgpr_write_b32 a134, v8
    v_accvgpr_write_b32 a135, v9
    v_accvgpr_read_b32 v6, a136
    v_accvgpr_read_b32 v7, a137
    v_accvgpr_read_b32 v8, a138
    v_accvgpr_read_b32 v9, a139
    v_mul_f32 v6, v6, v5
    v_mul_f32 v7, v7, v5
    v_mul_f32 v8, v8, v5
    v_mul_f32 v9, v9, v5
    v_accvgpr_write_b32 a136, v6
    v_accvgpr_write_b32 a137, v7
    v_accvgpr_write_b32 a138, v8
    v_accvgpr_write_b32 a139, v9
    v_accvgpr_read_b32 v6, a140
    v_accvgpr_read_b32 v7, a141
    v_accvgpr_read_b32 v8, a142
    v_accvgpr_read_b32 v9, a143
    v_mul_f32 v6, v6, v5
    v_mul_f32 v7, v7, v5
    v_mul_f32 v8, v8, v5
    v_mul_f32 v9, v9, v5
    v_accvgpr_write_b32 a140, v6
    v_accvgpr_write_b32 a141, v7
    v_accvgpr_write_b32 a142, v8
    v_accvgpr_write_b32 a143, v9
    v_accvgpr_read_b32 v6, a144
    v_accvgpr_read_b32 v7, a145
    v_accvgpr_read_b32 v8, a146
    v_accvgpr_read_b32 v9, a147
    v_mul_f32 v6, v6, v5
    v_mul_f32 v7, v7, v5
    v_mul_f32 v8, v8, v5
    v_mul_f32 v9, v9, v5
    v_accvgpr_write_b32 a144, v6
    v_accvgpr_write_b32 a145, v7
    v_accvgpr_write_b32 a146, v8
    v_accvgpr_write_b32 a147, v9
    v_accvgpr_read_b32 v6, a148
    v_accvgpr_read_b32 v7, a149
    v_accvgpr_read_b32 v8, a150
    v_accvgpr_read_b32 v9, a151
    v_mul_f32 v6, v6, v5
    v_mul_f32 v7, v7, v5
    v_mul_f32 v8, v8, v5
    v_mul_f32 v9, v9, v5
    v_accvgpr_write_b32 a148, v6
    v_accvgpr_write_b32 a149, v7
    v_accvgpr_write_b32 a150, v8
    v_accvgpr_write_b32 a151, v9
    v_accvgpr_read_b32 v6, a152
    v_accvgpr_read_b32 v7, a153
    v_accvgpr_read_b32 v8, a154
    v_accvgpr_read_b32 v9, a155
    v_mul_f32 v6, v6, v5
    v_mul_f32 v7, v7, v5
    v_mul_f32 v8, v8, v5
    v_mul_f32 v9, v9, v5
    v_accvgpr_write_b32 a152, v6
    v_accvgpr_write_b32 a153, v7
    v_accvgpr_write_b32 a154, v8
    v_accvgpr_write_b32 a155, v9
    v_accvgpr_read_b32 v6, a156
    v_accvgpr_read_b32 v7, a157
    v_accvgpr_read_b32 v8, a158
    v_accvgpr_read_b32 v9, a159
    v_mul_f32 v6, v6, v5
    v_mul_f32 v7, v7, v5
    v_mul_f32 v8, v8, v5
    v_mul_f32 v9, v9, v5
    v_accvgpr_write_b32 a156, v6
    v_accvgpr_write_b32 a157, v7
    v_accvgpr_write_b32 a158, v8
    v_accvgpr_write_b32 a159, v9
    v_exp_f32 v6, v64
    v_exp_f32 v7, v65
    s_nop 0
    v_cvt_pk_bf16_f32 v136, v6, v7
    v_exp_f32 v6, v66
    v_exp_f32 v7, v67
    s_nop 0
    v_cvt_pk_bf16_f32 v137, v6, v7
    v_exp_f32 v6, v68
    v_exp_f32 v7, v69
    s_nop 0
    v_cvt_pk_bf16_f32 v138, v6, v7
    v_exp_f32 v6, v70
    v_exp_f32 v7, v71
    s_nop 0
    v_cvt_pk_bf16_f32 v139, v6, v7
    v_exp_f32 v6, v72
    v_exp_f32 v7, v73
    s_nop 0
    v_cvt_pk_bf16_f32 v140, v6, v7
    v_exp_f32 v6, v74
    v_exp_f32 v7, v75
    s_nop 0
    v_cvt_pk_bf16_f32 v141, v6, v7
    v_exp_f32 v6, v76
    v_exp_f32 v7, v77
    s_nop 0
    v_cvt_pk_bf16_f32 v142, v6, v7
    v_exp_f32 v6, v78
    v_exp_f32 v7, v79
    s_nop 0
    v_cvt_pk_bf16_f32 v143, v6, v7
    s_nop 7
    s_branch L_k2_retL2
L_k2_rareL3:
    s_nop 15
    v_max3_f32 v4, v48, v49, v50
    v_max3_f32 v4, v4, v51, v52
    v_max3_f32 v4, v4, v53, v54
    v_max3_f32 v4, v4, v55, v56
    v_max3_f32 v4, v4, v57, v58
    v_max3_f32 v4, v4, v59, v60
    v_max3_f32 v4, v4, v61, v62
    v_max_f32 v4, v4, v63
    v_mov_b32 v5, v4
    s_nop 1
    v_permlane32_swap_b32 v4, v5
    s_nop 1
    v_max_f32 v4, v4, v5
    v_add_f32 v4, 0x42200000, v4
    v_max_f32 v4, 0, v4
    v_sub_f32 v5, 0, v4
    v_exp_f32 v5, v5
    v_sub_f32 v48, v48, v4
    v_sub_f32 v80, v80, v4
    v_sub_f32 v49, v49, v4
    v_sub_f32 v81, v81, v4
    v_sub_f32 v50, v50, v4
    v_sub_f32 v82, v82, v4
    v_sub_f32 v51, v51, v4
    v_sub_f32 v83, v83, v4
    v_sub_f32 v52, v52, v4
    v_sub_f32 v84, v84, v4
    v_sub_f32 v53, v53, v4
    v_sub_f32 v85, v85, v4
    v_sub_f32 v54, v54, v4
    v_sub_f32 v86, v86, v4
    v_sub_f32 v55, v55, v4
    v_sub_f32 v87, v87, v4
    v_sub_f32 v56, v56, v4
    v_sub_f32 v88, v88, v4
    v_sub_f32 v57, v57, v4
    v_sub_f32 v89, v89, v4
    v_sub_f32 v58, v58, v4
    v_sub_f32 v90, v90, v4
    v_sub_f32 v59, v59, v4
    v_sub_f32 v91, v91, v4
    v_sub_f32 v60, v60, v4
    v_sub_f32 v92, v92, v4
    v_sub_f32 v61, v61, v4
    v_sub_f32 v93, v93, v4
    v_sub_f32 v62, v62, v4
    v_sub_f32 v94, v94, v4
    v_sub_f32 v63, v63, v4
    v_sub_f32 v95, v95, v4
    v_accvgpr_read_b32 v6, a0
    v_accvgpr_read_b32 v7, a1
    v_accvgpr_read_b32 v8, a2
    v_accvgpr_read_b32 v9, a3
    v_mul_f32 v6, v6, v5
    v_mul_f32 v7, v7, v5
    v_mul_f32 v8, v8, v5
    v_mul_f32 v9, v9, v5
    v_accvgpr_write_b32 a0, v6
    v_accvgpr_write_b32 a1, v7
    v_accvgpr_write_b32 a2, v8
    v_accvgpr_write_b32 a3, v9
    v_accvgpr_read_b32 v6, a4
    v_accvgpr_read_b32 v7, a5
    v_accvgpr_read_b32 v8, a6
    v_accvgpr_read_b32 v9, a7
    v_mul_f32 v6, v6, v5
    v_mul_f32 v7, v7, v5
    v_mul_f32 v8, v8, v5
    v_mul_f32 v9, v9, v5
    v_accvgpr_write_b32 a4, v6
    v_accvgpr_write_b32 a5, v7
    v_accvgpr_write_b32 a6, v8
    v_accvgpr_write_b32 a7, v9
    v_accvgpr_read_b32 v6, a8
    v_accvgpr_read_b32 v7, a9
    v_accvgpr_read_b32 v8, a10
    v_accvgpr_read_b32 v9, a11
    v_mul_f32 v6, v6, v5
    v_mul_f32 v7, v7, v5
    v_mul_f32 v8, v8, v5
    v_mul_f32 v9, v9, v5
    v_accvgpr_write_b32 a8, v6
    v_accvgpr_write_b32 a9, v7
    v_accvgpr_write_b32 a10, v8
    v_accvgpr_write_b32 a11, v9
    v_accvgpr_read_b32 v6, a12
    v_accvgpr_read_b32 v7, a13
    v_accvgpr_read_b32 v8, a14
    v_accvgpr_read_b32 v9, a15
    v_mul_f32 v6, v6, v5
    v_mul_f32 v7, v7, v5
    v_mul_f32 v8, v8, v5
    v_mul_f32 v9, v9, v5
    v_accvgpr_write_b32 a12, v6
    v_accvgpr_write_b32 a13, v7
    v_accvgpr_write_b32 a14, v8
    v_accvgpr_write_b32 a15, v9
    v_accvgpr_read_b32 v6, a16
    v_accvgpr_read_b32 v7, a17
    v_accvgpr_read_b32 v8, a18
    v_accvgpr_read_b32 v9, a19
    v_mul_f32 v6, v6, v5
    v_mul_f32 v7, v7, v5
    v_mul_f32 v8, v8, v5
    v_mul_f32 v9, v9, v5
    v_accvgpr_write_b32 a16, v6
    v_accvgpr_write_b32 a17, v7
    v_accvgpr_write_b32 a18, v8
    v_accvgpr_write_b32 a19, v9
    v_accvgpr_read_b32 v6, a20
    v_accvgpr_read_b32 v7, a21
    v_accvgpr_read_b32 v8, a22
    v_accvgpr_read_b32 v9, a23
    v_mul_f32 v6, v6, v5
    v_mul_f32 v7, v7, v5
    v_mul_f32 v8, v8, v5
    v_mul_f32 v9, v9, v5
    v_accvgpr_write_b32 a20, v6
    v_accvgpr_write_b32 a21, v7
    v_accvgpr_write_b32 a22, v8
    v_accvgpr_write_b32 a23, v9
    v_accvgpr_read_b32 v6, a24
    v_accvgpr_read_b32 v7, a25
    v_accvgpr_read_b32 v8, a26
    v_accvgpr_read_b32 v9, a27
    v_mul_f32 v6, v6, v5
    v_mul_f32 v7, v7, v5
    v_mul_f32 v8, v8, v5
    v_mul_f32 v9, v9, v5
    v_accvgpr_write_b32 a24, v6
    v_accvgpr_write_b32 a25, v7
    v_accvgpr_write_b32 a26, v8
    v_accvgpr_write_b32 a27, v9
    v_accvgpr_read_b32 v6, a28
    v_accvgpr_read_b32 v7, a29
    v_accvgpr_read_b32 v8, a30
    v_accvgpr_read_b32 v9, a31
    v_mul_f32 v6, v6, v5
    v_mul_f32 v7, v7, v5
    v_mul_f32 v8, v8, v5
    v_mul_f32 v9, v9, v5
    v_accvgpr_write_b32 a28, v6
    v_accvgpr_write_b32 a29, v7
    v_accvgpr_write_b32 a30, v8
    v_accvgpr_write_b32 a31, v9
    v_accvgpr_read_b32 v6, a32
    v_accvgpr_read_b32 v7, a33
    v_accvgpr_read_b32 v8, a34
    v_accvgpr_read_b32 v9, a35
    v_mul_f32 v6, v6, v5
    v_mul_f32 v7, v7, v5
    v_mul_f32 v8, v8, v5
    v_mul_f32 v9, v9, v5
    v_accvgpr_write_b32 a32, v6
    v_accvgpr_write_b32 a33, v7
    v_accvgpr_write_b32 a34, v8
    v_accvgpr_write_b32 a35, v9
    v_accvgpr_read_b32 v6, a36
    v_accvgpr_read_b32 v7, a37
    v_accvgpr_read_b32 v8, a38
    v_accvgpr_read_b32 v9, a39
    v_mul_f32 v6, v6, v5
    v_mul_f32 v7, v7, v5
    v_mul_f32 v8, v8, v5
    v_mul_f32 v9, v9, v5
    v_accvgpr_write_b32 a36, v6
    v_accvgpr_write_b32 a37, v7
    v_accvgpr_write_b32 a38, v8
    v_accvgpr_write_b32 a39, v9
    v_accvgpr_read_b32 v6, a40
    v_accvgpr_read_b32 v7, a41
    v_accvgpr_read_b32 v8, a42
    v_accvgpr_read_b32 v9, a43
    v_mul_f32 v6, v6, v5
    v_mul_f32 v7, v7, v5
    v_mul_f32 v8, v8, v5
    v_mul_f32 v9, v9, v5
    v_accvgpr_write_b32 a40, v6
    v_accvgpr_write_b32 a41, v7
    v_accvgpr_write_b32 a42, v8
    v_accvgpr_write_b32 a43, v9
    v_accvgpr_read_b32 v6, a44
    v_accvgpr_read_b32 v7, a45
    v_accvgpr_read_b32 v8, a46
    v_accvgpr_read_b32 v9, a47
    v_mul_f32 v6, v6, v5
    v_mul_f32 v7, v7, v5
    v_mul_f32 v8, v8, v5
    v_mul_f32 v9, v9, v5
    v_accvgpr_write_b32 a44, v6
    v_accvgpr_write_b32 a45, v7
    v_accvgpr_write_b32 a46, v8
    v_accvgpr_write_b32 a47, v9
    v_accvgpr_read_b32 v6, a48
    v_accvgpr_read_b32 v7, a49
    v_accvgpr_read_b32 v8, a50
    v_accvgpr_read_b32 v9, a51
    v_mul_f32 v6, v6, v5
    v_mul_f32 v7, v7, v5
    v_mul_f32 v8, v8, v5
    v_mul_f32 v9, v9, v5
    v_accvgpr_write_b32 a48, v6
    v_accvgpr_write_b32 a49, v7
    v_accvgpr_write_b32 a50, v8
    v_accvgpr_write_b32 a51, v9
    v_accvgpr_read_b32 v6, a52
    v_accvgpr_read_b32 v7, a53
    v_accvgpr_read_b32 v8, a54
    v_accvgpr_read_b32 v9, a55
    v_mul_f32 v6, v6, v5
    v_mul_f32 v7, v7, v5
    v_mul_f32 v8, v8, v5
    v_mul_f32 v9, v9, v5
    v_accvgpr_write_b32 a52, v6
    v_accvgpr_write_b32 a53, v7
    v_accvgpr_write_b32 a54, v8
    v_accvgpr_write_b32 a55, v9
    v_accvgpr_read_b32 v6, a56
    v_accvgpr_read_b32 v7, a57
    v_accvgpr_read_b32 v8, a58
    v_accvgpr_read_b32 v9, a59
    v_mul_f32 v6, v6, v5
    v_mul_f32 v7, v7, v5
    v_mul_f32 v8, v8, v5
    v_mul_f32 v9, v9, v5
    v_accvgpr_write_b32 a56, v6
    v_accvgpr_write_b32 a57, v7
    v_accvgpr_write_b32 a58, v8
    v_accvgpr_write_b32 a59, v9
    v_accvgpr_read_b32 v6, a60
    v_accvgpr_read_b32 v7, a61
    v_accvgpr_read_b32 v8, a62
    v_accvgpr_read_b32 v9, a63
    v_mul_f32 v6, v6, v5
    v_mul_f32 v7, v7, v5
    v_mul_f32 v8, v8, v5
    v_mul_f32 v9, v9, v5
    v_accvgpr_write_b32 a60, v6
    v_accvgpr_write_b32 a61, v7
    v_accvgpr_write_b32 a62, v8
    v_accvgpr_write_b32 a63, v9
    v_accvgpr_read_b32 v6, a64
    v_accvgpr_read_b32 v7, a65
    v_accvgpr_read_b32 v8, a66
    v_accvgpr_read_b32 v9, a67
    v_mul_f32 v6, v6, v5
    v_mul_f32 v7, v7, v5
    v_mul_f32 v8, v8, v5
    v_mul_f32 v9, v9, v5
    v_accvgpr_write_b32 a64, v6
    v_accvgpr_write_b32 a65, v7
    v_accvgpr_write_b32 a66, v8
    v_accvgpr_write_b32 a67, v9
    v_accvgpr_read_b32 v6, a68
    v_accvgpr_read_b32 v7, a69
    v_accvgpr_read_b32 v8, a70
    v_accvgpr_read_b32 v9, a71
    v_mul_f32 v6, v6, v5
    v_mul_f32 v7, v7, v5
    v_mul_f32 v8, v8, v5
    v_mul_f32 v9, v9, v5
    v_accvgpr_write_b32 a68, v6
    v_accvgpr_write_b32 a69, v7
    v_accvgpr_write_b32 a70, v8
    v_accvgpr_write_b32 a71, v9
    v_accvgpr_read_b32 v6, a72
    v_accvgpr_read_b32 v7, a73
    v_accvgpr_read_b32 v8, a74
    v_accvgpr_read_b32 v9, a75
    v_mul_f32 v6, v6, v5
    v_mul_f32 v7, v7, v5
    v_mul_f32 v8, v8, v5
    v_mul_f32 v9, v9, v5
    v_accvgpr_write_b32 a72, v6
    v_accvgpr_write_b32 a73, v7
    v_accvgpr_write_b32 a74, v8
    v_accvgpr_write_b32 a75, v9
    v_accvgpr_read_b32 v6, a76
    v_accvgpr_read_b32 v7, a77
    v_accvgpr_read_b32 v8, a78
    v_accvgpr_read_b32 v9, a79
    v_mul_f32 v6, v6, v5
    v_mul_f32 v7, v7, v5
    v_mul_f32 v8, v8, v5
    v_mul_f32 v9, v9, v5
    v_accvgpr_write_b32 a76, v6
    v_accvgpr_write_b32 a77, v7
    v_accvgpr_write_b32 a78, v8
    v_accvgpr_write_b32 a79, v9
    v_exp_f32 v6, v48
    v_exp_f32 v7, v49
    s_nop 0
    v_cvt_pk_bf16_f32 v128, v6, v7
    v_exp_f32 v6, v50
    v_exp_f32 v7, v51
    s_nop 0
    v_cvt_pk_bf16_f32 v129, v6, v7
    v_exp_f32 v6, v52
    v_exp_f32 v7, v53
    s_nop 0
    v_cvt_pk_bf16_f32 v130, v6, v7
    v_exp_f32 v6, v54
    v_exp_f32 v7, v55
    s_nop 0
    v_cvt_pk_bf16_f32 v131, v6, v7
    v_exp_f32 v6, v56
    v_exp_f32 v7, v57
    s_nop 0
    v_cvt_pk_bf16_f32 v132, v6, v7
    v_exp_f32 v6, v58
    v_exp_f32 v7, v59
    s_nop 0
    v_cvt_pk_bf16_f32 v133, v6, v7
    v_exp_f32 v6, v60
    v_exp_f32 v7, v61
    s_nop 0
    v_cvt_pk_bf16_f32 v134, v6, v7
    v_exp_f32 v6, v62
    v_exp_f32 v7, v63
    s_nop 0
    v_cvt_pk_bf16_f32 v135, v6, v7
    v_max3_f32 v4, v64, v65, v66
    v_max3_f32 v4, v4, v67, v68
    v_max3_f32 v4, v4, v69, v70
    v_max3_f32 v4, v4, v71, v72
    v_max3_f32 v4, v4, v73, v74
    v_max3_f32 v4, v4, v75, v76
    v_max3_f32 v4, v4, v77, v78
    v_max_f32 v4, v4, v79
    v_mov_b32 v5, v4
    s_nop 1
    v_permlane32_swap_b32 v4, v5
    s_nop 1
    v_max_f32 v4, v4, v5
    v_add_f32 v4, 0x42200000, v4
    v_max_f32 v4, 0, v4
    v_sub_f32 v5, 0, v4
    v_exp_f32 v5, v5
    v_sub_f32 v64, v64, v4
    v_sub_f32 v96, v96, v4
    v_sub_f32 v65, v65, v4
    v_sub_f32 v97, v97, v4
    v_sub_f32 v66, v66, v4
    v_sub_f32 v98, v98, v4
    v_sub_f32 v67, v67, v4
    v_sub_f32 v99, v99, v4
    v_sub_f32 v68, v68, v4
    v_sub_f32 v100, v100, v4
    v_sub_f32 v69, v69, v4
    v_sub_f32 v101, v101, v4
    v_sub_f32 v70, v70, v4
    v_sub_f32 v102, v102, v4
    v_sub_f32 v71, v71, v4
    v_sub_f32 v103, v103, v4
    v_sub_f32 v72, v72, v4
    v_sub_f32 v104, v104, v4
    v_sub_f32 v73, v73, v4
    v_sub_f32 v105, v105, v4
    v_sub_f32 v74, v74, v4
    v_sub_f32 v106, v106, v4
    v_sub_f32 v75, v75, v4
    v_sub_f32 v107, v107, v4
    v_sub_f32 v76, v76, v4
    v_sub_f32 v108, v108, v4
    v_sub_f32 v77, v77, v4
    v_sub_f32 v109, v109, v4
    v_sub_f32 v78, v78, v4
    v_sub_f32 v110, v110, v4
    v_sub_f32 v79, v79, v4
    v_sub_f32 v111, v111, v4
    v_accvgpr_read_b32 v6, a80
    v_accvgpr_read_b32 v7, a81
    v_accvgpr_read_b32 v8, a82
    v_accvgpr_read_b32 v9, a83
    v_mul_f32 v6, v6, v5
    v_mul_f32 v7, v7, v5
    v_mul_f32 v8, v8, v5
    v_mul_f32 v9, v9, v5
    v_accvgpr_write_b32 a80, v6
    v_accvgpr_write_b32 a81, v7
    v_accvgpr_write_b32 a82, v8
    v_accvgpr_write_b32 a83, v9
    v_accvgpr_read_b32 v6, a84
    v_accvgpr_read_b32 v7, a85
    v_accvgpr_read_b32 v8, a86
    v_accvgpr_read_b32 v9, a87
    v_mul_f32 v6, v6, v5
    v_mul_f32 v7, v7, v5
    v_mul_f32 v8, v8, v5
    v_mul_f32 v9, v9, v5
    v_accvgpr_write_b32 a84, v6
    v_accvgpr_write_b32 a85, v7
    v_accvgpr_write_b32 a86, v8
    v_accvgpr_write_b32 a87, v9
    v_accvgpr_read_b32 v6, a88
    v_accvgpr_read_b32 v7, a89
    v_accvgpr_read_b32 v8, a90
    v_accvgpr_read_b32 v9, a91
    v_mul_f32 v6, v6, v5
    v_mul_f32 v7, v7, v5
    v_mul_f32 v8, v8, v5
    v_mul_f32 v9, v9, v5
    v_accvgpr_write_b32 a88, v6
    v_accvgpr_write_b32 a89, v7
    v_accvgpr_write_b32 a90, v8
    v_accvgpr_write_b32 a91, v9
    v_accvgpr_read_b32 v6, a92
    v_accvgpr_read_b32 v7, a93
    v_accvgpr_read_b32 v8, a94
    v_accvgpr_read_b32 v9, a95
    v_mul_f32 v6, v6, v5
    v_mul_f32 v7, v7, v5
    v_mul_f32 v8, v8, v5
    v_mul_f32 v9, v9, v5
    v_accvgpr_write_b32 a92, v6
    v_accvgpr_write_b32 a93, v7
    v_accvgpr_write_b32 a94, v8
    v_accvgpr_write_b32 a95, v9
    v_accvgpr_read_b32 v6, a96
    v_accvgpr_read_b32 v7, a97
    v_accvgpr_read_b32 v8, a98
    v_accvgpr_read_b32 v9, a99
    v_mul_f32 v6, v6, v5
    v_mul_f32 v7, v7, v5
    v_mul_f32 v8, v8, v5
    v_mul_f32 v9, v9, v5
    v_accvgpr_write_b32 a96, v6
    v_accvgpr_write_b32 a97, v7
    v_accvgpr_write_b32 a98, v8
    v_accvgpr_write_b32 a99, v9
    v_accvgpr_read_b32 v6, a100
    v_accvgpr_read_b32 v7, a101
    v_accvgpr_read_b32 v8, a102
    v_accvgpr_read_b32 v9, a103
    v_mul_f32 v6, v6, v5
    v_mul_f32 v7, v7, v5
    v_mul_f32 v8, v8, v5
    v_mul_f32 v9, v9, v5
    v_accvgpr_write_b32 a100, v6
    v_accvgpr_write_b32 a101, v7
    v_accvgpr_write_b32 a102, v8
    v_accvgpr_write_b32 a103, v9
    v_accvgpr_read_b32 v6, a104
    v_accvgpr_read_b32 v7, a105
    v_accvgpr_read_b32 v8, a106
    v_accvgpr_read_b32 v9, a107
    v_mul_f32 v6, v6, v5
    v_mul_f32 v7, v7, v5
    v_mul_f32 v8, v8, v5
    v_mul_f32 v9, v9, v5
    v_accvgpr_write_b32 a104, v6
    v_accvgpr_write_b32 a105, v7
    v_accvgpr_write_b32 a106, v8
    v_accvgpr_write_b32 a107, v9
    v_accvgpr_read_b32 v6, a108
    v_accvgpr_read_b32 v7, a109
    v_accvgpr_read_b32 v8, a110
    v_accvgpr_read_b32 v9, a111
    v_mul_f32 v6, v6, v5
    v_mul_f32 v7, v7, v5
    v_mul_f32 v8, v8, v5
    v_mul_f32 v9, v9, v5
    v_accvgpr_write_b32 a108, v6
    v_accvgpr_write_b32 a109, v7
    v_accvgpr_write_b32 a110, v8
    v_accvgpr_write_b32 a111, v9
    v_accvgpr_read_b32 v6, a112
    v_accvgpr_read_b32 v7, a113
    v_accvgpr_read_b32 v8, a114
    v_accvgpr_read_b32 v9, a115
    v_mul_f32 v6, v6, v5
    v_mul_f32 v7, v7, v5
    v_mul_f32 v8, v8, v5
    v_mul_f32 v9, v9, v5
    v_accvgpr_write_b32 a112, v6
    v_accvgpr_write_b32 a113, v7
    v_accvgpr_write_b32 a114, v8
    v_accvgpr_write_b32 a115, v9
    v_accvgpr_read_b32 v6, a116
    v_accvgpr_read_b32 v7, a117
    v_accvgpr_read_b32 v8, a118
    v_accvgpr_read_b32 v9, a119
    v_mul_f32 v6, v6, v5
    v_mul_f32 v7, v7, v5
    v_mul_f32 v8, v8, v5
    v_mul_f32 v9, v9, v5
    v_accvgpr_write_b32 a116, v6
    v_accvgpr_write_b32 a117, v7
    v_accvgpr_write_b32 a118, v8
    v_accvgpr_write_b32 a119, v9
    v_accvgpr_read_b32 v6, a120
    v_accvgpr_read_b32 v7, a121
    v_accvgpr_read_b32 v8, a122
    v_accvgpr_read_b32 v9, a123
    v_mul_f32 v6, v6, v5
    v_mul_f32 v7, v7, v5
    v_mul_f32 v8, v8, v5
    v_mul_f32 v9, v9, v5
    v_accvgpr_write_b32 a120, v6
    v_accvgpr_write_b32 a121, v7
    v_accvgpr_write_b32 a122, v8
    v_accvgpr_write_b32 a123, v9
    v_accvgpr_read_b32 v6, a124
    v_accvgpr_read_b32 v7, a125
    v_accvgpr_read_b32 v8, a126
    v_accvgpr_read_b32 v9, a127
    v_mul_f32 v6, v6, v5
    v_mul_f32 v7, v7, v5
    v_mul_f32 v8, v8, v5
    v_mul_f32 v9, v9, v5
    v_accvgpr_write_b32 a124, v6
    v_accvgpr_write_b32 a125, v7
    v_accvgpr_write_b32 a126, v8
    v_accvgpr_write_b32 a127, v9
    v_accvgpr_read_b32 v6, a128
    v_accvgpr_read_b32 v7, a129
    v_accvgpr_read_b32 v8, a130
    v_accvgpr_read_b32 v9, a131
    v_mul_f32 v6, v6, v5
    v_mul_f32 v7, v7, v5
    v_mul_f32 v8, v8, v5
    v_mul_f32 v9, v9, v5
    v_accvgpr_write_b32 a128, v6
    v_accvgpr_write_b32 a129, v7
    v_accvgpr_write_b32 a130, v8
    v_accvgpr_write_b32 a131, v9
    v_accvgpr_read_b32 v6, a132
    v_accvgpr_read_b32 v7, a133
    v_accvgpr_read_b32 v8, a134
    v_accvgpr_read_b32 v9, a135
    v_mul_f32 v6, v6, v5
    v_mul_f32 v7, v7, v5
    v_mul_f32 v8, v8, v5
    v_mul_f32 v9, v9, v5
    v_accvgpr_write_b32 a132, v6
    v_accvgpr_write_b32 a133, v7
    v_accvgpr_write_b32 a134, v8
    v_accvgpr_write_b32 a135, v9
    v_accvgpr_read_b32 v6, a136
    v_accvgpr_read_b32 v7, a137
    v_accvgpr_read_b32 v8, a138
    v_accvgpr_read_b32 v9, a139
    v_mul_f32 v6, v6, v5
    v_mul_f32 v7, v7, v5
    v_mul_f32 v8, v8, v5
    v_mul_f32 v9, v9, v5
    v_accvgpr_write_b32 a136, v6
    v_accvgpr_write_b32 a137, v7
    v_accvgpr_write_b32 a138, v8
    v_accvgpr_write_b32 a139, v9
    v_accvgpr_read_b32 v6, a140
    v_accvgpr_read_b32 v7, a141
    v_accvgpr_read_b32 v8, a142
    v_accvgpr_read_b32 v9, a143
    v_mul_f32 v6, v6, v5
    v_mul_f32 v7, v7, v5
    v_mul_f32 v8, v8, v5
    v_mul_f32 v9, v9, v5
    v_accvgpr_write_b32 a140, v6
    v_accvgpr_write_b32 a141, v7
    v_accvgpr_write_b32 a142, v8
    v_accvgpr_write_b32 a143, v9
    v_accvgpr_read_b32 v6, a144
    v_accvgpr_read_b32 v7, a145
    v_accvgpr_read_b32 v8, a146
    v_accvgpr_read_b32 v9, a147
    v_mul_f32 v6, v6, v5
    v_mul_f32 v7, v7, v5
    v_mul_f32 v8, v8, v5
    v_mul_f32 v9, v9, v5
    v_accvgpr_write_b32 a144, v6
    v_accvgpr_write_b32 a145, v7
    v_accvgpr_write_b32 a146, v8
    v_accvgpr_write_b32 a147, v9
    v_accvgpr_read_b32 v6, a148
    v_accvgpr_read_b32 v7, a149
    v_accvgpr_read_b32 v8, a150
    v_accvgpr_read_b32 v9, a151
    v_mul_f32 v6, v6, v5
    v_mul_f32 v7, v7, v5
    v_mul_f32 v8, v8, v5
    v_mul_f32 v9, v9, v5
    v_accvgpr_write_b32 a148, v6
    v_accvgpr_write_b32 a149, v7
    v_accvgpr_write_b32 a150, v8
    v_accvgpr_write_b32 a151, v9
    v_accvgpr_read_b32 v6, a152
    v_accvgpr_read_b32 v7, a153
    v_accvgpr_read_b32 v8, a154
    v_accvgpr_read_b32 v9, a155
    v_mul_f32 v6, v6, v5
    v_mul_f32 v7, v7, v5
    v_mul_f32 v8, v8, v5
    v_mul_f32 v9, v9, v5
    v_accvgpr_write_b32 a152, v6
    v_accvgpr_write_b32 a153, v7
    v_accvgpr_write_b32 a154, v8
    v_accvgpr_write_b32 a155, v9
    v_accvgpr_read_b32 v6, a156
    v_accvgpr_read_b32 v7, a157
    v_accvgpr_read_b32 v8, a158
    v_accvgpr_read_b32 v9, a159
    v_mul_f32 v6, v6, v5
    v_mul_f32 v7, v7, v5
    v_mul_f32 v8, v8, v5
    v_mul_f32 v9, v9, v5
    v_accvgpr_write_b32 a156, v6
    v_accvgpr_write_b32 a157, v7
    v_accvgpr_write_b32 a158, v8
    v_accvgpr_write_b32 a159, v9
    v_exp_f32 v6, v64
    v_exp_f32 v7, v65
    s_nop 0
    v_cvt_pk_bf16_f32 v136, v6, v7
    v_exp_f32 v6, v66
    v_exp_f32 v7, v67
    s_nop 0
    v_cvt_pk_bf16_f32 v137, v6, v7
    v_exp_f32 v6, v68
    v_exp_f32 v7, v69
    s_nop 0
    v_cvt_pk_bf16_f32 v138, v6, v7
    v_exp_f32 v6, v70
    v_exp_f32 v7, v71
    s_nop 0
    v_cvt_pk_bf16_f32 v139, v6, v7
    v_exp_f32 v6, v72
    v_exp_f32 v7, v73
    s_nop 0
    v_cvt_pk_bf16_f32 v140, v6, v7
    v_exp_f32 v6, v74
    v_exp_f32 v7, v75
    s_nop 0
    v_cvt_pk_bf16_f32 v141, v6, v7
    v_exp_f32 v6, v76
    v_exp_f32 v7, v77
    s_nop 0
    v_cvt_pk_bf16_f32 v142, v6, v7
    v_exp_f32 v6, v78
    v_exp_f32 v7, v79
    s_nop 0
    v_cvt_pk_bf16_f32 v143, v6, v7
    s_nop 7
    s_branch L_k2_retL3
L_k2_done:
    s_endpgm
.globl k3_kernel
.p2align 8
.type k3_kernel,@function
k3_kernel:
    s_cmp_ge_u32 s2, 256
    s_cbranch_scc1 L_k3_done
    s_and_b32 s46, s2, 7
    s_lshr_b32 s47, s2, 4
    s_lshl_b32 s47, s47, 3
    s_add_u32 s46, s46, s47
    s_cmp_ge_u32 s46, 125
    s_cbranch_scc1 L_k3_done
    s_bfe_u32 s47, s2, 0x10003
    s_lshl_b32 s2, s46, 1
    s_add_u32 s2, s2, s47
    s_load_dwordx2 s[4:5], s[0:1], 88
    s_load_dwordx2 s[6:7], s[0:1], 0
    s_load_dwordx2 s[8:9], s[0:1], 72
    v_lshrrev_b32 v3, 6, v0
    v_and_b32 v1, 63, v0
    v_lshlrev_b32 v2, 4, v1
    v_readfirstlane_b32 s44, v3
    s_mov_b32 s45, s2
    s_mul_i32 s46, s45, 9216
    s_cmp_ge_u32 s45, 125
    s_cselect_b32 s47, 125, 0
    s_sub_u32 s47, s45, s47
    s_cmp_eq_u32 s47, 0
    s_cselect_b64 s[50:51], -1, 0
    s_cmp_eq_u32 s47, 124
    s_cselect_b64 s[52:53], -1, 0
    s_lshl_b32 s48, s45, 7
    s_waitcnt lgkmcnt(0)
    s_add_u32 s12, s4, s46
    s_addc_u32 s13, s5, 0
    s_add_u32 s12, s12, 12049408
    s_addc_u32 s13, s13, 0
    s_mov_b32 s14, 27648
    s_mov_b32 s15, 0x20000
    s_add_u32 s16, s4, 14548992
    s_addc_u32 s17, s5, 0
    s_mov_b32 s18, 23040
    s_mov_b32 s19, 0x20000
    s_add_u32 s20, s4, s46
    s_addc_u32 s21, s5, 0
    s_add_u32 s20, s20, 4718592
    s_addc_u32 s21, s21, 0
    s_mov_b32 s22, 2313216
    s_mov_b32 s23, 0x20000
    s_add_u32 s24, s4, s46
    s_addc_u32 s25, s5, 0
    s_add_u32 s24, s24, 9699328
    s_addc_u32 s25, s25, 0
    s_mov_b32 s26, 9216
    s_mov_b32 s27, 0x20000
    s_add_u32 s28, s4, 14417920
    s_addc_u32 s29, s5, 0
    s_mov_b32 s30, 92160
    s_mov_b32 s31, 0x20000
    s_add_u32 s32, s6, s46
    s_addc_u32 s33, s7, 0
    s_mov_b32 s34, 9216
    s_mov_b32 s35, 0x20000
    s_add_u32 s36, s8, s46
    s_addc_u32 s37, s9, 0
    s_mov_b32 s38, 9216
    s_mov_b32 s39, 0x20000
    s_add_u32 s40, s4, s48
    s_addc_u32 s41, s5, 0
    s_add_u32 s40, s40, 9437184
    s_addc_u32 s41, s41, 0
    s_mov_b32 s42, 32128
    s_mov_b32 s43, 0x20000
    s_cmp_eq_u32 s44, 1
    s_cbranch_scc1 L_k3_w1
    s_cmp_eq_u32 s44, 2
    s_cbranch_scc1 L_k3_w2
    s_cmp_eq_u32 s44, 3
    s_cbranch_scc1 L_k3_w3
L_k3_w0:
    v_mov_b32 v10, 0x80000000
    v_mul_u32_u24 v4, 7282, v1
    v_lshrrev_b32 v4, 16, v4
    v_mul_u32_u24 v5, 9, v4
    v_sub_u32 v5, v1, v5
    v_min_u32 v5, 7, v5
    v_add_u32 v5, 2, v5
    v_lshrrev_b32 v6, 2, v5
    v_and_b32 v5, 3, v5
    v_lshlrev_b32 v5, 4, v5
    v_lshl_add_u32 v5, v4, 6, v5
    v_mul_u32_u24 v7, 9216, v6
    v_add_u32 v5, v5, v7
    v_cmp_eq_u32 vcc, 0, v6
    s_and_b64 vcc, vcc, s[50:51]
    v_cmp_eq_u32 s[46:47], 2, v6
    s_nop 0
    v_cndmask_b32 v5, v5, v10, vcc
    s_and_b64 vcc, s[46:47], s[52:53]
    s_mov_b64 s[46:47], exec
    v_cndmask_b32 v5, v5, v10, vcc
    v_lshrrev_b32 v3, 2, v1
    v_and_b32 v4, 3, v1
    v_lshlrev_b32 v15, 6, v3
    v_lshl_add_u32 v15, v4, 3, v15
    s_bitset0_b64 exec, 63
    s_mov_b32 m0, 0
    s_movk_i32 s48, 0
    buffer_load_dwordx4 v5, s[12:15], s48 offen lds
    s_mov_b32 m0, 1008
    s_movk_i32 s48, 448
    buffer_load_dwordx4 v5, s[12:15], s48 offen lds
    s_mov_b32 m0, 2016
    s_movk_i32 s48, 896
    buffer_load_dwordx4 v5, s[12:15], s48 offen lds
    s_mov_b64 exec, s[46:47]
    s_mov_b32 m0, 3072
    s_movk_i32 s48, 0
    buffer_load_dwordx4 v2, s[16:19], s48 offen offset:0 lds
    buffer_load_dwordx4 v2, s[16:19], s48 offen offset:1024 lds
    buffer_load_dwordx4 v2, s[16:19], s48 offen offset:2048 lds
    s_movk_i32 s48, 0
    buffer_load_dwordx2 v[68:69], v15, s[24:27], s48 offen offset:0
    buffer_load_dwordx2 v[70:71], v15, s[24:27], s48 offen offset:32
    s_bitset0_b64 exec, 63
    s_mov_b32 m0, 6144
    s_movk_i32 s48, 1024
    buffer_load_dwordx4 v5, s[12:15], s48 offen lds
    s_mov_b32 m0, 7152
    s_movk_i32 s48, 1472
    buffer_load_dwordx4 v5, s[12:15], s48 offen lds
    s_mov_b32 m0, 8160
    s_movk_i32 s48, 1920
    buffer_load_dwordx4 v5, s[12:15], s48 offen lds
    s_mov_b64 exec, s[46:47]
    s_mov_b32 m0, 9216
    s_movk_i32 s48, 2560
    buffer_load_dwordx4 v2, s[16:19], s48 offen offset:0 lds
    buffer_load_dwordx4 v2, s[16:19], s48 offen offset:1024 lds
    buffer_load_dwordx4 v2, s[16:19], s48 offen offset:2048 lds
    s_movk_i32 s48, 1024
    buffer_load_dwordx2 v[72:73], v15, s[24:27], s48 offen offset:0
    buffer_load_dwordx2 v[74:75], v15, s[24:27], s48 offen offset:32
    s_bitset0_b64 exec, 63
    s_mov_b32 m0, 12288
    s_movk_i32 s48, 2048
    buffer_load_dwordx4 v5, s[12:15], s48 offen lds
    s_mov_b32 m0, 13296
    s_movk_i32 s48, 2496
    buffer_load_dwordx4 v5, s[12:15], s48 offen lds
    s_mov_b32 m0, 14304
    s_movk_i32 s48, 2944
    buffer_load_dwordx4 v5, s[12:15], s48 offen lds
    s_mov_b64 exec, s[46:47]
    s_mov_b32 m0, 15360
    s_movk_i32 s48, 5120
    buffer_load_dwordx4 v2, s[16:19], s48 offen offset:0 lds
    buffer_load_dwordx4 v2, s[16:19], s48 offen offset:1024 lds
    buffer_load_dwordx4 v2, s[16:19], s48 offen offset:2048 lds
    s_movk_i32 s48, 2048
    buffer_load_dwordx2 v[76:77], v15, s[24:27], s48 offen offset:0
    buffer_load_dwordx2 v[78:79], v15, s[24:27], s48 offen offset:32
    v_and_b32 v6, 31, v1
    v_lshlrev_b32 v7, 2, v6
    v_lshrrev_b32 v8, 5, v1
    v_mul_u32_u24 v9, 288, v6
    v_lshl_add_u32 v9, v8, 4, v9
    v_mul_u32_u24 v11, 80, v3
    v_and_b32 v12, 1, v4
    v_xor_b32 v12, 1, v12
    v_mul_u32_u24 v12, 1280, v12
    v_add_u32 v11, v11, v12
    v_lshrrev_b32 v12, 1, v4
    v_xor_b32 v12, 1, v12
    v_lshl_add_u32 v11, v12, 2, v11
    v_mul_u32_u24 v12, 144, v3
    v_lshl_add_u32 v12, v4, 3, v12
    v_add_u32 v12, 0, v12
    v_add_u32 v13, 73728, v15
    buffer_load_dword v80, v7, s[40:43], 0 offen
    s_movk_i32 s48, 32000
    buffer_load_dword v81, v7, s[40:43], s48 offen
    v_add_u32 v14, 3072, v11
    s_waitcnt vmcnt(20)
    ds_read2_b32 v[16:17], v14 offset0:0 offset1:1
    ds_read2_b32 v[18:19], v14 offset0:2 offset1:3
    ds_read2_b32 v[20:21], v14 offset0:4 offset1:5
    ds_read2_b32 v[22:23], v14 offset0:6 offset1:7
    ds_read2_b32 v[24:25], v14 offset0:8 offset1:9
    ds_read2_b32 v[26:27], v14 offset0:10 offset1:11
    ds_read2_b32 v[28:29], v14 offset0:12 offset1:13
    ds_read2_b32 v[30:31], v14 offset0:14 offset1:15
    ds_read2_b32 v[32:33], v14 offset0:16 offset1:17
    s_waitcnt lgkmcnt(2)
    ds_read_b64 v[34:35], v12 offset:0
    ds_read_b64 v[36:37], v12 offset:8
    ds_read_b64 v[38:39], v12 offset:16
    ds_read_b64 v[40:41], v12 offset:24
    ds_read_b64 v[42:43], v12 offset:32
    ds_read_b64 v[44:45], v12 offset:40
    ds_read_b64 v[46:47], v12 offset:48
    ds_read_b64 v[48:49], v12 offset:56
    ds_read_b64 v[50:51], v12 offset:64
    ds_read_b64 v[52:53], v12 offset:72
    ds_read_b64 v[54:55], v12 offset:80
    ds_read_b64 v[56:57], v12 offset:88
    ds_read_b64 v[58:59], v12 offset:96
    s_waitcnt lgkmcnt(8)
    v_mfma_f32_4x4x4_16b_bf16 v[60:63], v[16:17], v[34:35], 0
    v_mfma_f32_4x4x4_16b_bf16 v[64:67], v[16:17], v[42:43], 0
    s_mov_b32 s48, 0
    buffer_load_dwordx4 v[88:91], v2, s[20:23], s48 offen
    s_waitcnt lgkmcnt(7)
    v_mfma_f32_4x4x4_16b_bf16 v[60:63], v[18:19], v[36:37], v[60:63]
    v_mfma_f32_4x4x4_16b_bf16 v[64:67], v[18:19], v[44:45], v[64:67]
    s_mov_b32 s48, 2304000
    buffer_load_dwordx4 v[92:95], v2, s[20:23], s48 offen
    s_waitcnt lgkmcnt(6)
    v_mfma_f32_4x4x4_16b_bf16 v[60:63], v[20:21], v[38:39], v[60:63]
    v_mfma_f32_4x4x4_16b_bf16 v[64:67], v[20:21], v[46:47], v[64:67]
    s_mov_b32 s48, 1024
    buffer_load_dwordx4 v[96:99], v2, s[20:23], s48 offen
    s_waitcnt lgkmcnt(5)
    v_mfma_f32_4x4x4_16b_bf16 v[60:63], v[22:23], v[40:41], v[60:63]
    v_mfma_f32_4x4x4_16b_bf16 v[64:67], v[22:23], v[48:49], v[64:67]
    s_mov_b32 s48, 2305024
    buffer_load_dwordx4 v[100:103], v2, s[20:23], s48 offen
    s_waitcnt lgkmcnt(4)
    v_mfma_f32_4x4x4_16b_bf16 v[60:63], v[24:25], v[42:43], v[60:63]
    v_mfma_f32_4x4x4_16b_bf16 v[64:67], v[24:25], v[50:51], v[64:67]
    s_mov_b32 s48, 0
    buffer_load_dwordx4 a[0:3], v2, s[28:31], s48 offen
    s_waitcnt lgkmcnt(3)
    v_mfma_f32_4x4x4_16b_bf16 v[60:63], v[26:27], v[44:45], v[60:63]
    v_mfma_f32_4x4x4_16b_bf16 v[64:67], v[26:27], v[52:53], v[64:67]
    s_mov_b32 s48, 5120
    buffer_load_dwordx4 a[4:7], v2, s[28:31], s48 offen
    s_waitcnt lgkmcnt(2)
    v_mfma_f32_4x4x4_16b_bf16 v[60:63], v[28:29], v[46:47], v[60:63]
    v_mfma_f32_4x4x4_16b_bf16 v[64:67], v[28:29], v[54:55], v[64:67]
    s_mov_b32 s48, 10240
    buffer_load_dwordx4 a[8:11], v2, s[28:31], s48 offen
    s_waitcnt lgkmcnt(1)
    v_mfma_f32_4x4x4_16b_bf16 v[60:63], v[30:31], v[48:49], v[60:63]
    v_mfma_f32_4x4x4_16b_bf16 v[64:67], v[30:31], v[56:57], v[64:67]
    s_mov_b32 s48, 15360
    buffer_load_dwordx4 a[12:15], v2, s[28:31], s48 offen
    s_waitcnt lgkmcnt(0)
    v_mfma_f32_4x4x4_16b_bf16 v[60:63], v[32:33], v[50:51], v[60:63]
    v_mfma_f32_4x4x4_16b_bf16 v[64:67], v[32:33], v[58:59], v[64:67]
    s_mov_b32 s48, 20480
    buffer_load_dwordx4 a[16:19], v2, s[28:31], s48 offen
    s_waitcnt vmcnt(27)
    v_lshlrev_b32 v34, 16, v68
    v_and_b32 v35, 0xffff0000, v68
    v_lshlrev_b32 v36, 16, v69
    v_and_b32 v37, 0xffff0000, v69
    v_lshlrev_b32 v38, 16, v70
    v_and_b32 v39, 0xffff0000, v70
    v_lshlrev_b32 v40, 16, v71
    v_and_b32 v41, 0xffff0000, v71
    v_pk_mul_f32 v[60:61], v[60:61], v[34:35]
    v_pk_mul_f32 v[62:63], v[62:63], v[36:37]
    v_cvt_pk_bf16_f32 v42, v60, v61
    v_cvt_pk_bf16_f32 v43, v62, v63
    ds_write_b64 v13, v[42:43] offset:0
    v_pk_mul_f32 v[64:65], v[64:65], v[38:39]
    v_pk_mul_f32 v[66:67], v[66:67], v[40:41]
    v_cvt_pk_bf16_f32 v46, v64, v65
    v_cvt_pk_bf16_f32 v47, v66, v67
    ds_write_b64 v13, v[46:47] offset:32
    v_add_u32 v14, 9216, v11
    s_waitcnt vmcnt(21)
    ds_read2_b32 v[16:17], v14 offset0:0 offset1:1
    ds_read2_b32 v[18:19], v14 offset0:2 offset1:3
    ds_read2_b32 v[20:21], v14 offset0:4 offset1:5
    ds_read2_b32 v[22:23], v14 offset0:6 offset1:7
    ds_read2_b32 v[24:25], v14 offset0:8 offset1:9
    ds_read2_b32 v[26:27], v14 offset0:10 offset1:11
    ds_read2_b32 v[28:29], v14 offset0:12 offset1:13
    ds_read2_b32 v[30:31], v14 offset0:14 offset1:15
    ds_read2_b32 v[32:33], v14 offset0:16 offset1:17
    s_waitcnt lgkmcnt(2)
    ds_read_b64 v[34:35], v12 offset:6144
    ds_read_b64 v[36:37], v12 offset:6152
    ds_read_b64 v[38:39], v12 offset:6160
    ds_read_b64 v[40:41], v12 offset:6168
    ds_read_b64 v[42:43], v12 offset:6176
    ds_read_b64 v[44:45], v12 offset:6184
    ds_read_b64 v[46:47], v12 offset:6192
    ds_read_b64 v[48:49], v12 offset:6200
    ds_read_b64 v[50:51], v12 offset:6208
    ds_read_b64 v[52:53], v12 offset:6216
    ds_read_b64 v[54:55], v12 offset:6224
    ds_read_b64 v[56:57], v12 offset:6232
    ds_read_b64 v[58:59], v12 offset:6240
    s_waitcnt lgkmcnt(8)
    v_mfma_f32_4x4x4_16b_bf16 v[60:63], v[16:17], v[34:35], 0
    v_mfma_f32_4x4x4_16b_bf16 v[64:67], v[16:17], v[42:43], 0
    s_mov_b32 s48, 25600
    buffer_load_dwordx4 a[20:23], v2, s[28:31], s48 offen
    s_waitcnt lgkmcnt(7)
    v_mfma_f32_4x4x4_16b_bf16 v[60:63], v[18:19], v[36:37], v[60:63]
    v_mfma_f32_4x4x4_16b_bf16 v[64:67], v[18:19], v[44:45], v[64:67]
    s_mov_b32 s48, 30720
    buffer_load_dwordx4 a[24:27], v2, s[28:31], s48 offen
    s_waitcnt lgkmcnt(6)
    v_mfma_f32_4x4x4_16b_bf16 v[60:63], v[20:21], v[38:39], v[60:63]
    v_mfma_f32_4x4x4_16b_bf16 v[64:67], v[20:21], v[46:47], v[64:67]
    s_mov_b32 s48, 35840
    buffer_load_dwordx4 a[28:31], v2, s[28:31], s48 offen
    s_waitcnt lgkmcnt(5)
    v_mfma_f32_4x4x4_16b_bf16 v[60:63], v[22:23], v[40:41], v[60:63]
    v_mfma_f32_4x4x4_16b_bf16 v[64:67], v[22:23], v[48:49], v[64:67]
    s_mov_b32 s48, 40960
    buffer_load_dwordx4 a[32:35], v2, s[28:31], s48 offen
    s_waitcnt lgkmcnt(4)
    v_mfma_f32_4x4x4_16b_bf16 v[60:63], v[24:25], v[42:43], v[60:63]
    v_mfma_f32_4x4x4_16b_bf16 v[64:67], v[24:25], v[50:51], v[64:67]
    s_mov_b32 s48, 46080
    buffer_load_dwordx4 a[36:39], v2, s[28:31], s48 offen
    s_waitcnt lgkmcnt(3)
    v_mfma_f32_4x4x4_16b_bf16 v[60:63], v[26:27], v[44:45], v[60:63]
    v_mfma_f32_4x4x4_16b_bf16 v[64:67], v[26:27], v[52:53], v[64:67]
    s_mov_b32 s48, 51200
    buffer_load_dwordx4 a[40:43], v2, s[28:31], s48 offen
    s_waitcnt lgkmcnt(2)
    v_mfma_f32_4x4x4_16b_bf16 v[60:63], v[28:29], v[46:47], v[60:63]
    v_mfma_f32_4x4x4_16b_bf16 v[64:67], v[28:29], v[54:55], v[64:67]
    s_mov_b32 s48, 56320
    buffer_load_dwordx4 a[44:47], v2, s[28:31], s48 offen
    s_waitcnt lgkmcnt(1)
    v_mfma_f32_4x4x4_16b_bf16 v[60:63], v[30:31], v[48:49], v[60:63]
    v_mfma_f32_4x4x4_16b_bf16 v[64:67], v[30:31], v[56:57], v[64:67]
    s_mov_b32 s48, 61440
    buffer_load_dwordx4 a[48:51], v2, s[28:31], s48 offen
    s_waitcnt lgkmcnt(0)
    v_mfma_f32_4x4x4_16b_bf16 v[60:63], v[32:33], v[50:51], v[60:63]
    v_mfma_f32_4x4x4_16b_bf16 v[64:67], v[32:33], v[58:59], v[64:67]
    s_mov_b32 s48, 66560
    buffer_load_dwordx4 a[52:55], v2, s[28:31], s48 offen
    s_waitcnt vmcnt(28)
    v_lshlrev_b32 v34, 16, v72
    v_and_b32 v35, 0xffff0000, v72
    v_lshlrev_b32 v36, 16, v73
    v_and_b32 v37, 0xffff0000, v73
    v_lshlrev_b32 v38, 16, v74
    v_and_b32 v39, 0xffff0000, v74
    v_lshlrev_b32 v40, 16, v75
    v_and_b32 v41, 0xffff0000, v75
    v_pk_mul_f32 v[60:61], v[60:61], v[34:35]
    v_pk_mul_f32 v[62:63], v[62:63], v[36:37]
    v_cvt_pk_bf16_f32 v42, v60, v61
    v_cvt_pk_bf16_f32 v43, v62, v63
    ds_write_b64 v13, v[42:43] offset:1024
    v_pk_mul_f32 v[64:65], v[64:65], v[38:39]
    v_pk_mul_f32 v[66:67], v[66:67], v[40:41]
    v_cvt_pk_bf16_f32 v46, v64, v65
    v_cvt_pk_bf16_f32 v47, v66, v67
    ds_write_b64 v13, v[46:47] offset:1056
    v_add_u32 v14, 15360, v11
    s_waitcnt vmcnt(22)
    ds_read2_b32 v[16:17], v14 offset0:0 offset1:1
    ds_read2_b32 v[18:19], v14 offset0:2 offset1:3
    ds_read2_b32 v[20:21], v14 offset0:4 offset1:5
    ds_read2_b32 v[22:23], v14 offset0:6 offset1:7
    ds_read2_b32 v[24:25], v14 offset0:8 offset1:9
    ds_read2_b32 v[26:27], v14 offset0:10 offset1:11
    ds_read2_b32 v[28:29], v14 offset0:12 offset1:13
    ds_read2_b32 v[30:31], v14 offset0:14 offset1:15
    ds_read2_b32 v[32:33], v14 offset0:16 offset1:17
    s_waitcnt lgkmcnt(2)
    ds_read_b64 v[34:35], v12 offset:12288
    ds_read_b64 v[36:37], v12 offset:12296
    ds_read_b64 v[38:39], v12 offset:12304
    ds_read_b64 v[40:41], v12 offset:12312
    ds_read_b64 v[42:43], v12 offset:12320
    ds_read_b64 v[44:45], v12 offset:12328
    ds_read_b64 v[46:47], v12 offset:12336
    ds_read_b64 v[48:49], v12 offset:12344
    ds_read_b64 v[50:51], v12 offset:12352
    ds_read_b64 v[52:53], v12 offset:12360
    ds_read_b64 v[54:55], v12 offset:12368
    ds_read_b64 v[56:57], v12 offset:12376
    ds_read_b64 v[58:59], v12 offset:12384
    s_waitcnt lgkmcnt(8)
    v_mfma_f32_4x4x4_16b_bf16 v[60:63], v[16:17], v[34:35], 0
    v_mfma_f32_4x4x4_16b_bf16 v[64:67], v[16:17], v[42:43], 0
    s_mov_b32 s48, 71680
    buffer_load_dwordx4 a[56:59], v2, s[28:31], s48 offen
    s_waitcnt lgkmcnt(7)
    v_mfma_f32_4x4x4_16b_bf16 v[60:63], v[18:19], v[36:37], v[60:63]
    v_mfma_f32_4x4x4_16b_bf16 v[64:67], v[18:19], v[44:45], v[64:67]
    s_mov_b32 s48, 76800
    buffer_load_dwordx4 a[60:63], v2, s[28:31], s48 offen
    s_waitcnt lgkmcnt(6)
    v_mfma_f32_4x4x4_16b_bf16 v[60:63], v[20:21], v[38:39], v[60:63]
    v_mfma_f32_4x4x4_16b_bf16 v[64:67], v[20:21], v[46:47], v[64:67]
    s_mov_b32 s48, 81920
    buffer_load_dwordx4 a[64:67], v2, s[28:31], s48 offen
    s_waitcnt lgkmcnt(5)
    v_mfma_f32_4x4x4_16b_bf16 v[60:63], v[22:23], v[40:41], v[60:63]
    v_mfma_f32_4x4x4_16b_bf16 v[64:67], v[22:23], v[48:49], v[64:67]
    s_mov_b32 s48, 87040
    buffer_load_dwordx4 a[68:71], v2, s[28:31], s48 offen
    s_waitcnt lgkmcnt(4)
    v_mfma_f32_4x4x4_16b_bf16 v[60:63], v[24:25], v[42:43], v[60:63]
    v_mfma_f32_4x4x4_16b_bf16 v[64:67], v[24:25], v[50:51], v[64:67]
    buffer_load_dwordx4 v[112:115], v9, s[32:35], 0 offen offset:0
    s_waitcnt lgkmcnt(3)
    v_mfma_f32_4x4x4_16b_bf16 v[60:63], v[26:27], v[44:45], v[60:63]
    v_mfma_f32_4x4x4_16b_bf16 v[64:67], v[26:27], v[52:53], v[64:67]
    buffer_load_dwordx4 v[116:119], v9, s[32:35], 0 offen offset:32
    s_waitcnt lgkmcnt(2)
    v_mfma_f32_4x4x4_16b_bf16 v[60:63], v[28:29], v[46:47], v[60:63]
    v_mfma_f32_4x4x4_16b_bf16 v[64:67], v[28:29], v[54:55], v[64:67]
    s_waitcnt lgkmcnt(1)
    v_mfma_f32_4x4x4_16b_bf16 v[60:63], v[30:31], v[48:49], v[60:63]
    v_mfma_f32_4x4x4_16b_bf16 v[64:67], v[30:31], v[56:57], v[64:67]
    s_waitcnt lgkmcnt(0)
    v_mfma_f32_4x4x4_16b_bf16 v[60:63], v[32:33], v[50:51], v[60:63]
    v_mfma_f32_4x4x4_16b_bf16 v[64:67], v[32:33], v[58:59], v[64:67]
    s_waitcnt vmcnt(26)
    v_lshlrev_b32 v34, 16, v76
    v_and_b32 v35, 0xffff0000, v76
    v_lshlrev_b32 v36, 16, v77
    v_and_b32 v37, 0xffff0000, v77
    v_lshlrev_b32 v38, 16, v78
    v_and_b32 v39, 0xffff0000, v78
    v_lshlrev_b32 v40, 16, v79
    v_and_b32 v41, 0xffff0000, v79
    v_pk_mul_f32 v[60:61], v[60:61], v[34:35]
    v_pk_mul_f32 v[62:63], v[62:63], v[36:37]
    v_cvt_pk_bf16_f32 v42, v60, v61
    v_cvt_pk_bf16_f32 v43, v62, v63
    ds_write_b64 v13, v[42:43] offset:2048
    v_pk_mul_f32 v[64:65], v[64:65], v[38:39]
    v_pk_mul_f32 v[66:67], v[66:67], v[40:41]
    v_cvt_pk_bf16_f32 v46, v64, v65
    v_cvt_pk_bf16_f32 v47, v66, v67
    ds_write_b64 v13, v[46:47] offset:2080
    s_waitcnt vmcnt(20)
    v_sub_f32 v82, v81, v80
    v_exp_f32 v82, v82
    v_sub_f32 v84, v80, v81
    v_exp_f32 v84, v84
    v_add_f32 v82, 1.0, v82
    v_add_f32 v84, 1.0, v84
    v_rcp_f32 v82, v82
    v_rcp_f32 v84, v84
    v_add_u32 v14, 82944, v2
    v_lshlrev_b32 v16, 16, v88
    v_and_b32 v17, 0xffff0000, v88
    v_lshlrev_b32 v18, 16, v92
    v_and_b32 v19, 0xffff0000, v92
    v_pk_mul_f32 v[16:17], v[16:17], v[82:83] op_sel_hi:[1,0]
    v_pk_fma_f32 v[16:17], v[18:19], v[84:85], v[16:17] op_sel_hi:[1,0,1]
    v_cvt_pk_bf16_f32 v88, v16, v17
    v_lshlrev_b32 v20, 16, v89
    v_and_b32 v21, 0xffff0000, v89
    v_lshlrev_b32 v22, 16, v93
    v_and_b32 v23, 0xffff0000, v93
    v_pk_mul_f32 v[20:21], v[20:21], v[82:83] op_sel_hi:[1,0]
    v_pk_fma_f32 v[20:21], v[22:23], v[84:85], v[20:21] op_sel_hi:[1,0,1]
    v_cvt_pk_bf16_f32 v89, v20, v21
    v_lshlrev_b32 v16, 16, v90
    v_and_b32 v17, 0xffff0000, v90
    v_lshlrev_b32 v18, 16, v94
    v_and_b32 v19, 0xffff0000, v94
    v_pk_mul_f32 v[16:17], v[16:17], v[82:83] op_sel_hi:[1,0]
    v_pk_fma_f32 v[16:17], v[18:19], v[84:85], v[16:17] op_sel_hi:[1,0,1]
    v_cvt_pk_bf16_f32 v90, v16, v17
    v_lshlrev_b32 v20, 16, v91
    v_and_b32 v21, 0xffff0000, v91
    v_lshlrev_b32 v22, 16, v95
    v_and_b32 v23, 0xffff0000, v95
    v_pk_mul_f32 v[20:21], v[20:21], v[82:83] op_sel_hi:[1,0]
    v_pk_fma_f32 v[20:21], v[22:23], v[84:85], v[20:21] op_sel_hi:[1,0,1]
    v_cvt_pk_bf16_f32 v91, v20, v21
    ds_write_b128 v14, v[88:91] offset:0
    v_lshlrev_b32 v16, 16, v96
    v_and_b32 v17, 0xffff0000, v96
    v_lshlrev_b32 v18, 16, v100
    v_and_b32 v19, 0xffff0000, v100
    v_pk_mul_f32 v[16:17], v[16:17], v[82:83] op_sel_hi:[1,0]
    v_pk_fma_f32 v[16:17], v[18:19], v[84:85], v[16:17] op_sel_hi:[1,0,1]
    v_cvt_pk_bf16_f32 v96, v16, v17
    v_lshlrev_b32 v20, 16, v97
    v_and_b32 v21, 0xffff0000, v97
    v_lshlrev_b32 v22, 16, v101
    v_and_b32 v23, 0xffff0000, v101
    v_pk_mul_f32 v[20:21], v[20:21], v[82:83] op_sel_hi:[1,0]
    v_pk_fma_f32 v[20:21], v[22:23], v[84:85], v[20:21] op_sel_hi:[1,0,1]
    v_cvt_pk_bf16_f32 v97, v20, v21
    v_lshlrev_b32 v16, 16, v98
    v_and_b32 v17, 0xffff0000, v98
    v_lshlrev_b32 v18, 16, v102
    v_and_b32 v19, 0xffff0000, v102
    v_pk_mul_f32 v[16:17], v[16:17], v[82:83] op_sel_hi:[1,0]
    v_pk_fma_f32 v[16:17], v[18:19], v[84:85], v[16:17] op_sel_hi:[1,0,1]
    v_cvt_pk_bf16_f32 v98, v16, v17
    v_lshlrev_b32 v20, 16, v99
    v_and_b32 v21, 0xffff0000, v99
    v_lshlrev_b32 v22, 16, v103
    v_and_b32 v23, 0xffff0000, v103
    v_pk_mul_f32 v[20:21], v[20:21], v[82:83] op_sel_hi:[1,0]
    v_pk_fma_f32 v[20:21], v[22:23], v[84:85], v[20:21] op_sel_hi:[1,0,1]
    v_cvt_pk_bf16_f32 v99, v20, v21
    ds_write_b128 v14, v[96:99] offset:1024
    v_bfe_u32 v3, v1, 2, 2
    v_lshl_add_u32 v3, v8, 3, v3
    v_lshlrev_b32 v3, 6, v3
    v_bfe_u32 v4, v1, 4, 1
    v_lshl_add_u32 v3, v4, 5, v3
    v_and_b32 v4, 3, v1
    v_lshl_add_u32 v3, v4, 3, v3
    v_add_u32 v3, 73728, v3
    s_waitcnt lgkmcnt(0)
    s_barrier
    ds_read_b128 v[16:19], v14 offset:0
    ds_read_b128 v[20:23], v14 offset:1024
    ds_read_b128 v[24:27], v14 offset:2048
    ds_read_b128 v[28:31], v14 offset:3072
    ds_read_b128 v[32:35], v14 offset:4096
    ds_read_b128 v[36:39], v14 offset:5120
    s_waitcnt vmcnt(2)
    s_waitcnt lgkmcnt(5)
    v_mfma_f32_32x32x16_bf16 v[88:103], a[0:3], v[16:19], 0
    ds_read_b128 v[40:43], v14 offset:6144
    s_waitcnt lgkmcnt(5)
    v_mfma_f32_32x32x16_bf16 v[88:103], a[4:7], v[20:23], v[88:103]
    ds_read_b128 v[44:47], v14 offset:7168
    s_waitcnt lgkmcnt(5)
    v_mfma_f32_32x32x16_bf16 v[88:103], a[8:11], v[24:27], v[88:103]
    ds_read_b128 v[48:51], v14 offset:8192
    s_waitcnt lgkmcnt(5)
    v_mfma_f32_32x32x16_bf16 v[88:103], a[12:15], v[28:31], v[88:103]
    ds_read_b64_tr_b16 v[52:53], v3 offset:0
    ds_read_b64_tr_b16 v[54:55], v3 offset:256
    s_waitcnt lgkmcnt(6)
    v_mfma_f32_32x32x16_bf16 v[88:103], a[16:19], v[32:35], v[88:103]
    ds_read_b64_tr_b16 v[56:57], v3 offset:1024
    ds_read_b64_tr_b16 v[58:59], v3 offset:1280
    s_waitcnt lgkmcnt(7)
    v_mfma_f32_32x32x16_bf16 v[88:103], a[20:23], v[36:39], v[88:103]
    ds_read_b64_tr_b16 v[60:61], v3 offset:2048
    ds_read_b64_tr_b16 v[62:63], v3 offset:2304
    s_waitcnt lgkmcnt(8)
    v_mfma_f32_32x32x16_bf16 v[88:103], a[24:27], v[40:43], v[88:103]
    ds_read_b64_tr_b16 v[64:65], v3 offset:3072
    ds_read_b64_tr_b16 v[66:67], v3 offset:3328
    s_waitcnt lgkmcnt(9)
    v_mfma_f32_32x32x16_bf16 v[88:103], a[28:31], v[44:47], v[88:103]
    ds_read_b64_tr_b16 v[68:69], v3 offset:4096
    ds_read_b64_tr_b16 v[70:71], v3 offset:4352
    s_waitcnt lgkmcnt(10)
    v_mfma_f32_32x32x16_bf16 v[88:103], a[32:35], v[48:51], v[88:103]
    ds_read_b64_tr_b16 v[72:73], v3 offset:5120
    ds_read_b64_tr_b16 v[74:75], v3 offset:5376
    s_waitcnt lgkmcnt(10)
    v_mfma_f32_32x32x16_bf16 v[88:103], a[36:39], v[52:55], v[88:103]
    ds_read_b64_tr_b16 v[76:77], v3 offset:6144
    ds_read_b64_tr_b16 v[78:79], v3 offset:6400
    s_waitcnt lgkmcnt(10)
    v_mfma_f32_32x32x16_bf16 v[88:103], a[40:43], v[56:59], v[88:103]
    ds_read_b64_tr_b16 v[80:81], v3 offset:7168
    ds_read_b64_tr_b16 v[82:83], v3 offset:7424
    s_waitcnt lgkmcnt(10)
    v_mfma_f32_32x32x16_bf16 v[88:103], a[44:47], v[60:63], v[88:103]
    ds_read_b64_tr_b16 v[84:85], v3 offset:8192
    ds_read_b64_tr_b16 v[86:87], v3 offset:8448
    s_waitcnt lgkmcnt(10)
    v_mfma_f32_32x32x16_bf16 v[88:103], a[48:51], v[64:67], v[88:103]
    s_waitcnt lgkmcnt(8)
    v_mfma_f32_32x32x16_bf16 v[88:103], a[52:55], v[68:71], v[88:103]
    s_waitcnt lgkmcnt(6)
    v_mfma_f32_32x32x16_bf16 v[88:103], a[56:59], v[72:75], v[88:103]
    s_waitcnt lgkmcnt(4)
    v_mfma_f32_32x32x16_bf16 v[88:103], a[60:63], v[76:79], v[88:103]
    s_waitcnt lgkmcnt(2)
    v_mfma_f32_32x32x16_bf16 v[88:103], a[64:67], v[80:83], v[88:103]
    s_waitcnt lgkmcnt(0)
    v_mfma_f32_32x32x16_bf16 v[88:103], a[68:71], v[84:87], v[88:103]
    s_waitcnt vmcnt(0)
    s_nop 15
    v_lshlrev_b32 v4, 16, v112
    v_and_b32 v5, 0xffff0000, v112
    v_pk_add_f32 v[88:89], v[88:89], v[4:5]
    v_cvt_pk_bf16_f32 v112, v88, v89
    v_lshlrev_b32 v6, 16, v113
    v_and_b32 v7, 0xffff0000, v113
    v_pk_add_f32 v[90:91], v[90:91], v[6:7]
    v_cvt_pk_bf16_f32 v113, v90, v91
    v_lshlrev_b32 v4, 16, v114
    v_and_b32 v5, 0xffff0000, v114
    v_pk_add_f32 v[92:93], v[92:93], v[4:5]
    v_cvt_pk_bf16_f32 v114, v92, v93
    v_lshlrev_b32 v6, 16, v115
    v_and_b32 v7, 0xffff0000, v115
    v_pk_add_f32 v[94:95], v[94:95], v[6:7]
    v_cvt_pk_bf16_f32 v115, v94, v95
    buffer_store_dwordx4 v[112:115], v9, s[36:39], 0 offen offset:0 sc1
    v_lshlrev_b32 v4, 16, v116
    v_and_b32 v5, 0xffff0000, v116
    v_pk_add_f32 v[96:97], v[96:97], v[4:5]
    v_cvt_pk_bf16_f32 v116, v96, v97
    v_lshlrev_b32 v6, 16, v117
    v_and_b32 v7, 0xffff0000, v117
    v_pk_add_f32 v[98:99], v[98:99], v[6:7]
    v_cvt_pk_bf16_f32 v117, v98, v99
    v_lshlrev_b32 v4, 16, v118
    v_and_b32 v5, 0xffff0000, v118
    v_pk_add_f32 v[100:101], v[100:101], v[4:5]
    v_cvt_pk_bf16_f32 v118, v100, v101
    v_lshlrev_b32 v6, 16, v119
    v_and_b32 v7, 0xffff0000, v119
    v_pk_add_f32 v[102:103], v[102:103], v[6:7]
    v_cvt_pk_bf16_f32 v119, v102, v103
    buffer_store_dwordx4 v[116:119], v9, s[36:39], 0 offen offset:32 sc1
    s_endpgm
L_k3_w1:
    v_mov_b32 v10, 0x80000000
    v_mul_u32_u24 v4, 7282, v1
    v_lshrrev_b32 v4, 16, v4
    v_mul_u32_u24 v5, 9, v4
    v_sub_u32 v5, v1, v5
    v_min_u32 v5, 7, v5
    v_add_u32 v5, 2, v5
    v_lshrrev_b32 v6, 2, v5
    v_and_b32 v5, 3, v5
    v_lshlrev_b32 v5, 4, v5
    v_lshl_add_u32 v5, v4, 6, v5
    v_mul_u32_u24 v7, 9216, v6
    v_add_u32 v5, v5, v7
    v_cmp_eq_u32 vcc, 0, v6
    s_and_b64 vcc, vcc, s[50:51]
    v_cmp_eq_u32 s[46:47], 2, v6
    s_nop 0
    v_cndmask_b32 v5, v5, v10, vcc
    s_and_b64 vcc, s[46:47], s[52:53]
    s_mov_b64 s[46:47], exec
    v_cndmask_b32 v5, v5, v10, vcc
    v_lshrrev_b32 v3, 2, v1
    v_and_b32 v4, 3, v1
    v_lshlrev_b32 v15, 6, v3
    v_lshl_add_u32 v15, v4, 3, v15
    s_bitset0_b64 exec, 63
    s_mov_b32 m0, 18432
    s_movk_i32 s48, 3072
    buffer_load_dwordx4 v5, s[12:15], s48 offen lds
    s_mov_b32 m0, 19440
    s_movk_i32 s48, 3520
    buffer_load_dwordx4 v5, s[12:15], s48 offen lds
    s_mov_b32 m0, 20448
    s_movk_i32 s48, 3968
    buffer_load_dwordx4 v5, s[12:15], s48 offen lds
    s_mov_b64 exec, s[46:47]
    s_mov_b32 m0, 21504
    s_movk_i32 s48, 7680
    buffer_load_dwordx4 v2, s[16:19], s48 offen offset:0 lds
    buffer_load_dwordx4 v2, s[16:19], s48 offen offset:1024 lds
    buffer_load_dwordx4 v2, s[16:19], s48 offen offset:2048 lds
    s_movk_i32 s48, 3072
    buffer_load_dwordx2 v[68:69], v15, s[24:27], s48 offen offset:0
    buffer_load_dwordx2 v[70:71], v15, s[24:27], s48 offen offset:32
    s_bitset0_b64 exec, 63
    s_mov_b32 m0, 24576
    s_movk_i32 s48, 4096
    buffer_load_dwordx4 v5, s[12:15], s48 offen lds
    s_mov_b32 m0, 25584
    s_movk_i32 s48, 4544
    buffer_load_dwordx4 v5, s[12:15], s48 offen lds
    s_mov_b32 m0, 26592
    s_movk_i32 s48, 4992
    buffer_load_dwordx4 v5, s[12:15], s48 offen lds
    s_mov_b64 exec, s[46:47]
    s_mov_b32 m0, 27648
    s_movk_i32 s48, 10240
    buffer_load_dwordx4 v2, s[16:19], s48 offen offset:0 lds
    buffer_load_dwordx4 v2, s[16:19], s48 offen offset:1024 lds
    buffer_load_dwordx4 v2, s[16:19], s48 offen offset:2048 lds
    s_movk_i32 s48, 4096
    buffer_load_dwordx2 v[72:73], v15, s[24:27], s48 offen offset:0
    buffer_load_dwordx2 v[74:75], v15, s[24:27], s48 offen offset:32
    v_and_b32 v6, 31, v1
    v_lshlrev_b32 v7, 2, v6
    v_lshrrev_b32 v8, 5, v1
    v_mul_u32_u24 v9, 288, v6
    v_lshl_add_u32 v9, v8, 4, v9
    v_mul_u32_u24 v11, 80, v3
    v_and_b32 v12, 1, v4
    v_xor_b32 v12, 1, v12
    v_mul_u32_u24 v12, 1280, v12
    v_add_u32 v11, v11, v12
    v_lshrrev_b32 v12, 1, v4
    v_xor_b32 v12, 1, v12
    v_lshl_add_u32 v11, v12, 2, v11
    v_mul_u32_u24 v12, 144, v3
    v_lshl_add_u32 v12, v4, 3, v12
    v_add_u32 v12, 18432, v12
    v_add_u32 v13, 73728, v15
    buffer_load_dword v80, v7, s[40:43], 0 offen
    s_movk_i32 s48, 32000
    buffer_load_dword v81, v7, s[40:43], s48 offen
    v_add_u32 v14, 21504, v11
    s_waitcnt vmcnt(12)
    ds_read2_b32 v[16:17], v14 offset0:0 offset1:1
    ds_read2_b32 v[18:19], v14 offset0:2 offset1:3
    ds_read2_b32 v[20:21], v14 offset0:4 offset1:5
    ds_read2_b32 v[22:23], v14 offset0:6 offset1:7
    ds_read2_b32 v[24:25], v14 offset0:8 offset1:9
    ds_read2_b32 v[26:27], v14 offset0:10 offset1:11
    ds_read2_b32 v[28:29], v14 offset0:12 offset1:13
    ds_read2_b32 v[30:31], v14 offset0:14 offset1:15
    ds_read2_b32 v[32:33], v14 offset0:16 offset1:17
    s_waitcnt lgkmcnt(2)
    ds_read_b64 v[34:35], v12 offset:0
    ds_read_b64 v[36:37], v12 offset:8
    ds_read_b64 v[38:39], v12 offset:16
    ds_read_b64 v[40:41], v12 offset:24
    ds_read_b64 v[42:43], v12 offset:32
    ds_read_b64 v[44:45], v12 offset:40
    ds_read_b64 v[46:47], v12 offset:48
    ds_read_b64 v[48:49], v12 offset:56
    ds_read_b64 v[50:51], v12 offset:64
    ds_read_b64 v[52:53], v12 offset:72
    ds_read_b64 v[54:55], v12 offset:80
    ds_read_b64 v[56:57], v12 offset:88
    ds_read_b64 v[58:59], v12 offset:96
    s_waitcnt lgkmcnt(8)
    v_mfma_f32_4x4x4_16b_bf16 v[60:63], v[16:17], v[34:35], 0
    v_mfma_f32_4x4x4_16b_bf16 v[64:67], v[16:17], v[42:43], 0
    s_mov_b32 s48, 2048
    buffer_load_dwordx4 v[88:91], v2, s[20:23], s48 offen
    s_mov_b32 s48, 2306048
    buffer_load_dwordx4 v[92:95], v2, s[20:23], s48 offen
    s_waitcnt lgkmcnt(7)
    v_mfma_f32_4x4x4_16b_bf16 v[60:63], v[18:19], v[36:37], v[60:63]
    v_mfma_f32_4x4x4_16b_bf16 v[64:67], v[18:19], v[44:45], v[64:67]
    s_mov_b32 s48, 3072
    buffer_load_dwordx4 v[96:99], v2, s[20:23], s48 offen
    s_mov_b32 s48, 2307072
    buffer_load_dwordx4 v[100:103], v2, s[20:23], s48 offen
    s_waitcnt lgkmcnt(6)
    v_mfma_f32_4x4x4_16b_bf16 v[60:63], v[20:21], v[38:39], v[60:63]
    v_mfma_f32_4x4x4_16b_bf16 v[64:67], v[20:21], v[46:47], v[64:67]
    s_mov_b32 s48, 4096
    buffer_load_dwordx4 v[104:107], v2, s[20:23], s48 offen
    s_mov_b32 s48, 2308096
    buffer_load_dwordx4 v[108:111], v2, s[20:23], s48 offen
    s_waitcnt lgkmcnt(5)
    v_mfma_f32_4x4x4_16b_bf16 v[60:63], v[22:23], v[40:41], v[60:63]
    v_mfma_f32_4x4x4_16b_bf16 v[64:67], v[22:23], v[48:49], v[64:67]
    s_mov_b32 s48, 1024
    buffer_load_dwordx4 a[0:3], v2, s[28:31], s48 offen
    s_mov_b32 s48, 6144
    buffer_load_dwordx4 a[4:7], v2, s[28:31], s48 offen
    s_waitcnt lgkmcnt(4)
    v_mfma_f32_4x4x4_16b_bf16 v[60:63], v[24:25], v[42:43], v[60:63]
    v_mfma_f32_4x4x4_16b_bf16 v[64:67], v[24:25], v[50:51], v[64:67]
    s_mov_b32 s48, 11264
    buffer_load_dwordx4 a[8:11], v2, s[28:31], s48 offen
    s_mov_b32 s48, 16384
    buffer_load_dwordx4 a[12:15], v2, s[28:31], s48 offen
    s_waitcnt lgkmcnt(3)
    v_mfma_f32_4x4x4_16b_bf16 v[60:63], v[26:27], v[44:45], v[60:63]
    v_mfma_f32_4x4x4_16b_bf16 v[64:67], v[26:27], v[52:53], v[64:67]
    s_mov_b32 s48, 21504
    buffer_load_dwordx4 a[16:19], v2, s[28:31], s48 offen
    s_mov_b32 s48, 26624
    buffer_load_dwordx4 a[20:23], v2, s[28:31], s48 offen
    s_waitcnt lgkmcnt(2)
    v_mfma_f32_4x4x4_16b_bf16 v[60:63], v[28:29], v[46:47], v[60:63]
    v_mfma_f32_4x4x4_16b_bf16 v[64:67], v[28:29], v[54:55], v[64:67]
    s_mov_b32 s48, 31744
    buffer_load_dwordx4 a[24:27], v2, s[28:31], s48 offen
    s_mov_b32 s48, 36864
    buffer_load_dwordx4 a[28:31], v2, s[28:31], s48 offen
    s_waitcnt lgkmcnt(1)
    v_mfma_f32_4x4x4_16b_bf16 v[60:63], v[30:31], v[48:49], v[60:63]
    v_mfma_f32_4x4x4_16b_bf16 v[64:67], v[30:31], v[56:57], v[64:67]
    s_mov_b32 s48, 41984
    buffer_load_dwordx4 a[32:35], v2, s[28:31], s48 offen
    s_mov_b32 s48, 47104
    buffer_load_dwordx4 a[36:39], v2, s[28:31], s48 offen
    s_waitcnt lgkmcnt(0)
    v_mfma_f32_4x4x4_16b_bf16 v[60:63], v[32:33], v[50:51], v[60:63]
    v_mfma_f32_4x4x4_16b_bf16 v[64:67], v[32:33], v[58:59], v[64:67]
    s_mov_b32 s48, 52224
    buffer_load_dwordx4 a[40:43], v2, s[28:31], s48 offen
    s_mov_b32 s48, 57344
    buffer_load_dwordx4 a[44:47], v2, s[28:31], s48 offen
    s_waitcnt vmcnt(28)
    v_lshlrev_b32 v34, 16, v68
    v_and_b32 v35, 0xffff0000, v68
    v_lshlrev_b32 v36, 16, v69
    v_and_b32 v37, 0xffff0000, v69
    v_lshlrev_b32 v38, 16, v70
    v_and_b32 v39, 0xffff0000, v70
    v_lshlrev_b32 v40, 16, v71
    v_and_b32 v41, 0xffff0000, v71
    v_pk_mul_f32 v[60:61], v[60:61], v[34:35]
    v_pk_mul_f32 v[62:63], v[62:63], v[36:37]
    v_cvt_pk_bf16_f32 v42, v60, v61
    v_cvt_pk_bf16_f32 v43, v62, v63
    ds_write_b64 v13, v[42:43] offset:3072
    v_pk_mul_f32 v[64:65], v[64:65], v[38:39]
    v_pk_mul_f32 v[66:67], v[66:67], v[40:41]
    v_cvt_pk_bf16_f32 v46, v64, v65
    v_cvt_pk_bf16_f32 v47, v66, v67
    ds_write_b64 v13, v[46:47] offset:3104
    v_add_u32 v14, 27648, v11
    s_waitcnt vmcnt(22)
    ds_read2_b32 v[16:17], v14 offset0:0 offset1:1
    ds_read2_b32 v[18:19], v14 offset0:2 offset1:3
    ds_read2_b32 v[20:21], v14 offset0:4 offset1:5
    ds_read2_b32 v[22:23], v14 offset0:6 offset1:7
    ds_read2_b32 v[24:25], v14 offset0:8 offset1:9
    ds_read2_b32 v[26:27], v14 offset0:10 offset1:11
    ds_read2_b32 v[28:29], v14 offset0:12 offset1:13
    ds_read2_b32 v[30:31], v14 offset0:14 offset1:15
    ds_read2_b32 v[32:33], v14 offset0:16 offset1:17
    s_waitcnt lgkmcnt(2)
    ds_read_b64 v[34:35], v12 offset:6144
    ds_read_b64 v[36:37], v12 offset:6152
    ds_read_b64 v[38:39], v12 offset:6160
    ds_read_b64 v[40:41], v12 offset:6168
    ds_read_b64 v[42:43], v12 offset:6176
    ds_read_b64 v[44:45], v12 offset:6184
    ds_read_b64 v[46:47], v12 offset:6192
    ds_read_b64 v[48:49], v12 offset:6200
    ds_read_b64 v[50:51], v12 offset:6208
    ds_read_b64 v[52:53], v12 offset:6216
    ds_read_b64 v[54:55], v12 offset:6224
    ds_read_b64 v[56:57], v12 offset:6232
    ds_read_b64 v[58:59], v12 offset:6240
    s_waitcnt lgkmcnt(8)
    v_mfma_f32_4x4x4_16b_bf16 v[60:63], v[16:17], v[34:35], 0
    v_mfma_f32_4x4x4_16b_bf16 v[64:67], v[16:17], v[42:43], 0
    s_mov_b32 s48, 62464
    buffer_load_dwordx4 a[48:51], v2, s[28:31], s48 offen
    s_mov_b32 s48, 67584
    buffer_load_dwordx4 a[52:55], v2, s[28:31], s48 offen
    s_waitcnt lgkmcnt(7)
    v_mfma_f32_4x4x4_16b_bf16 v[60:63], v[18:19], v[36:37], v[60:63]
    v_mfma_f32_4x4x4_16b_bf16 v[64:67], v[18:19], v[44:45], v[64:67]
    s_mov_b32 s48, 72704
    buffer_load_dwordx4 a[56:59], v2, s[28:31], s48 offen
    s_mov_b32 s48, 77824
    buffer_load_dwordx4 a[60:63], v2, s[28:31], s48 offen
    s_waitcnt lgkmcnt(6)
    v_mfma_f32_4x4x4_16b_bf16 v[60:63], v[20:21], v[38:39], v[60:63]
    v_mfma_f32_4x4x4_16b_bf16 v[64:67], v[20:21], v[46:47], v[64:67]
    s_mov_b32 s48, 82944
    buffer_load_dwordx4 a[64:67], v2, s[28:31], s48 offen
    s_mov_b32 s48, 88064
    buffer_load_dwordx4 a[68:71], v2, s[28:31], s48 offen
    s_waitcnt lgkmcnt(5)
    v_mfma_f32_4x4x4_16b_bf16 v[60:63], v[22:23], v[40:41], v[60:63]
    v_mfma_f32_4x4x4_16b_bf16 v[64:67], v[22:23], v[48:49], v[64:67]
    buffer_load_dwordx4 v[112:115], v9, s[32:35], 0 offen offset:64
    buffer_load_dwordx4 v[116:119], v9, s[32:35], 0 offen offset:96
    s_waitcnt lgkmcnt(4)
    v_mfma_f32_4x4x4_16b_bf16 v[60:63], v[24:25], v[42:43], v[60:63]
    v_mfma_f32_4x4x4_16b_bf16 v[64:67], v[24:25], v[50:51], v[64:67]
    s_waitcnt lgkmcnt(3)
    v_mfma_f32_4x4x4_16b_bf16 v[60:63], v[26:27], v[44:45], v[60:63]
    v_mfma_f32_4x4x4_16b_bf16 v[64:67], v[26:27], v[52:53], v[64:67]
    s_waitcnt lgkmcnt(2)
    v_mfma_f32_4x4x4_16b_bf16 v[60:63], v[28:29], v[46:47], v[60:63]
    v_mfma_f32_4x4x4_16b_bf16 v[64:67], v[28:29], v[54:55], v[64:67]
    s_waitcnt lgkmcnt(1)
    v_mfma_f32_4x4x4_16b_bf16 v[60:63], v[30:31], v[48:49], v[60:63]
    v_mfma_f32_4x4x4_16b_bf16 v[64:67], v[30:31], v[56:57], v[64:67]
    s_waitcnt lgkmcnt(0)
    v_mfma_f32_4x4x4_16b_bf16 v[60:63], v[32:33], v[50:51], v[60:63]
    v_mfma_f32_4x4x4_16b_bf16 v[64:67], v[32:33], v[58:59], v[64:67]
    s_waitcnt vmcnt(28)
    v_lshlrev_b32 v34, 16, v72
    v_and_b32 v35, 0xffff0000, v72
    v_lshlrev_b32 v36, 16, v73
    v_and_b32 v37, 0xffff0000, v73
    v_lshlrev_b32 v38, 16, v74
    v_and_b32 v39, 0xffff0000, v74
    v_lshlrev_b32 v40, 16, v75
    v_and_b32 v41, 0xffff0000, v75
    v_pk_mul_f32 v[60:61], v[60:61], v[34:35]
    v_pk_mul_f32 v[62:63], v[62:63], v[36:37]
    v_cvt_pk_bf16_f32 v42, v60, v61
    v_cvt_pk_bf16_f32 v43, v62, v63
    ds_write_b64 v13, v[42:43] offset:4096
    v_pk_mul_f32 v[64:65], v[64:65], v[38:39]
    v_pk_mul_f32 v[66:67], v[66:67], v[40:41]
    v_cvt_pk_bf16_f32 v46, v64, v65
    v_cvt_pk_bf16_f32 v47, v66, v67
    ds_write_b64 v13, v[46:47] offset:4128
    s_waitcnt vmcnt(20)
    v_sub_f32 v82, v81, v80
    v_exp_f32 v82, v82
    v_sub_f32 v84, v80, v81
    v_exp_f32 v84, v84
    v_add_f32 v82, 1.0, v82
    v_add_f32 v84, 1.0, v84
    v_rcp_f32 v82, v82
    v_rcp_f32 v84, v84
    v_add_u32 v14, 82944, v2
    v_lshlrev_b32 v16, 16, v88
    v_and_b32 v17, 0xffff0000, v88
    v_lshlrev_b32 v18, 16, v92
    v_and_b32 v19, 0xffff0000, v92
    v_pk_mul_f32 v[16:17], v[16:17], v[82:83] op_sel_hi:[1,0]
    v_pk_fma_f32 v[16:17], v[18:19], v[84:85], v[16:17] op_sel_hi:[1,0,1]
    v_cvt_pk_bf16_f32 v88, v16, v17
    v_lshlrev_b32 v20, 16, v89
    v_and_b32 v21, 0xffff0000, v89
    v_lshlrev_b32 v22, 16, v93
    v_and_b32 v23, 0xffff0000, v93
    v_pk_mul_f32 v[20:21], v[20:21], v[82:83] op_sel_hi:[1,0]
    v_pk_fma_f32 v[20:21], v[22:23], v[84:85], v[20:21] op_sel_hi:[1,0,1]
    v_cvt_pk_bf16_f32 v89, v20, v21
    v_lshlrev_b32 v16, 16, v90
    v_and_b32 v17, 0xffff0000, v90
    v_lshlrev_b32 v18, 16, v94
    v_and_b32 v19, 0xffff0000, v94
    v_pk_mul_f32 v[16:17], v[16:17], v[82:83] op_sel_hi:[1,0]
    v_pk_fma_f32 v[16:17], v[18:19], v[84:85], v[16:17] op_sel_hi:[1,0,1]
    v_cvt_pk_bf16_f32 v90, v16, v17
    v_lshlrev_b32 v20, 16, v91
    v_and_b32 v21, 0xffff0000, v91
    v_lshlrev_b32 v22, 16, v95
    v_and_b32 v23, 0xffff0000, v95
    v_pk_mul_f32 v[20:21], v[20:21], v[82:83] op_sel_hi:[1,0]
    v_pk_fma_f32 v[20:21], v[22:23], v[84:85], v[20:21] op_sel_hi:[1,0,1]
    v_cvt_pk_bf16_f32 v91, v20, v21
    ds_write_b128 v14, v[88:91] offset:2048
    v_lshlrev_b32 v16, 16, v96
    v_and_b32 v17, 0xffff0000, v96
    v_lshlrev_b32 v18, 16, v100
    v_and_b32 v19, 0xffff0000, v100
    v_pk_mul_f32 v[16:17], v[16:17], v[82:83] op_sel_hi:[1,0]
    v_pk_fma_f32 v[16:17], v[18:19], v[84:85], v[16:17] op_sel_hi:[1,0,1]
    v_cvt_pk_bf16_f32 v96, v16, v17
    v_lshlrev_b32 v20, 16, v97
    v_and_b32 v21, 0xffff0000, v97
    v_lshlrev_b32 v22, 16, v101
    v_and_b32 v23, 0xffff0000, v101
    v_pk_mul_f32 v[20:21], v[20:21], v[82:83] op_sel_hi:[1,0]
    v_pk_fma_f32 v[20:21], v[22:23], v[84:85], v[20:21] op_sel_hi:[1,0,1]
    v_cvt_pk_bf16_f32 v97, v20, v21
    v_lshlrev_b32 v16, 16, v98
    v_and_b32 v17, 0xffff0000, v98
    v_lshlrev_b32 v18, 16, v102
    v_and_b32 v19, 0xffff0000, v102
    v_pk_mul_f32 v[16:17], v[16:17], v[82:83] op_sel_hi:[1,0]
    v_pk_fma_f32 v[16:17], v[18:19], v[84:85], v[16:17] op_sel_hi:[1,0,1]
    v_cvt_pk_bf16_f32 v98, v16, v17
    v_lshlrev_b32 v20, 16, v99
    v_and_b32 v21, 0xffff0000, v99
    v_lshlrev_b32 v22, 16, v103
    v_and_b32 v23, 0xffff0000, v103
    v_pk_mul_f32 v[20:21], v[20:21], v[82:83] op_sel_hi:[1,0]
    v_pk_fma_f32 v[20:21], v[22:23], v[84:85], v[20:21] op_sel_hi:[1,0,1]
    v_cvt_pk_bf16_f32 v99, v20, v21
    ds_write_b128 v14, v[96:99] offset:3072
    v_lshlrev_b32 v16, 16, v104
    v_and_b32 v17, 0xffff0000, v104
    v_lshlrev_b32 v18, 16, v108
    v_and_b32 v19, 0xffff0000, v108
    v_pk_mul_f32 v[16:17], v[16:17], v[82:83] op_sel_hi:[1,0]
    v_pk_fma_f32 v[16:17], v[18:19], v[84:85], v[16:17] op_sel_hi:[1,0,1]
    v_cvt_pk_bf16_f32 v104, v16, v17
    v_lshlrev_b32 v20, 16, v105
    v_and_b32 v21, 0xffff0000, v105
    v_lshlrev_b32 v22, 16, v109
    v_and_b32 v23, 0xffff0000, v109
    v_pk_mul_f32 v[20:21], v[20:21], v[82:83] op_sel_hi:[1,0]
    v_pk_fma_f32 v[20:21], v[22:23], v[84:85], v[20:21] op_sel_hi:[1,0,1]
    v_cvt_pk_bf16_f32 v105, v20, v21
    v_lshlrev_b32 v16, 16, v106
    v_and_b32 v17, 0xffff0000, v106
    v_lshlrev_b32 v18, 16, v110
    v_and_b32 v19, 0xffff0000, v110
    v_pk_mul_f32 v[16:17], v[16:17], v[82:83] op_sel_hi:[1,0]
    v_pk_fma_f32 v[16:17], v[18:19], v[84:85], v[16:17] op_sel_hi:[1,0,1]
    v_cvt_pk_bf16_f32 v106, v16, v17
    v_lshlrev_b32 v20, 16, v107
    v_and_b32 v21, 0xffff0000, v107
    v_lshlrev_b32 v22, 16, v111
    v_and_b32 v23, 0xffff0000, v111
    v_pk_mul_f32 v[20:21], v[20:21], v[82:83] op_sel_hi:[1,0]
    v_pk_fma_f32 v[20:21], v[22:23], v[84:85], v[20:21] op_sel_hi:[1,0,1]
    v_cvt_pk_bf16_f32 v107, v20, v21
    ds_write_b128 v14, v[104:107] offset:4096
    v_bfe_u32 v3, v1, 2, 2
    v_lshl_add_u32 v3, v8, 3, v3
    v_lshlrev_b32 v3, 6, v3
    v_bfe_u32 v4, v1, 4, 1
    v_lshl_add_u32 v3, v4, 5, v3
    v_and_b32 v4, 3, v1
    v_lshl_add_u32 v3, v4, 3, v3
    v_add_u32 v3, 73728, v3
    s_waitcnt lgkmcnt(0)
    s_barrier
    ds_read_b128 v[16:19], v14 offset:0
    ds_read_b128 v[20:23], v14 offset:1024
    ds_read_b128 v[24:27], v14 offset:2048
    ds_read_b128 v[28:31], v14 offset:3072
    ds_read_b128 v[32:35], v14 offset:4096
    ds_read_b128 v[36:39], v14 offset:5120
    s_waitcnt vmcnt(2)
    s_waitcnt lgkmcnt(5)
    v_mfma_f32_32x32x16_bf16 v[88:103], a[0:3], v[16:19], 0
    ds_read_b128 v[40:43], v14 offset:6144
    s_waitcnt lgkmcnt(5)
    v_mfma_f32_32x32x16_bf16 v[88:103], a[4:7], v[20:23], v[88:103]
    ds_read_b128 v[44:47], v14 offset:7168
    s_waitcnt lgkmcnt(5)
    v_mfma_f32_32x32x16_bf16 v[88:103], a[8:11], v[24:27], v[88:103]
    ds_read_b128 v[48:51], v14 offset:8192
    s_waitcnt lgkmcnt(5)
    v_mfma_f32_32x32x16_bf16 v[88:103], a[12:15], v[28:31], v[88:103]
    ds_read_b64_tr_b16 v[52:53], v3 offset:0
    ds_read_b64_tr_b16 v[54:55], v3 offset:256
    s_waitcnt lgkmcnt(6)
    v_mfma_f32_32x32x16_bf16 v[88:103], a[16:19], v[32:35], v[88:103]
    ds_read_b64_tr_b16 v[56:57], v3 offset:1024
    ds_read_b64_tr_b16 v[58:59], v3 offset:1280
    s_waitcnt lgkmcnt(7)
    v_mfma_f32_32x32x16_bf16 v[88:103], a[20:23], v[36:39], v[88:103]
    ds_read_b64_tr_b16 v[60:61], v3 offset:2048
    ds_read_b64_tr_b16 v[62:63], v3 offset:2304
    s_waitcnt lgkmcnt(8)
    v_mfma_f32_32x32x16_bf16 v[88:103], a[24:27], v[40:43], v[88:103]
    ds_read_b64_tr_b16 v[64:65], v3 offset:3072
    ds_read_b64_tr_b16 v[66:67], v3 offset:3328
    s_waitcnt lgkmcnt(9)
    v_mfma_f32_32x32x16_bf16 v[88:103], a[28:31], v[44:47], v[88:103]
    ds_read_b64_tr_b16 v[68:69], v3 offset:4096
    ds_read_b64_tr_b16 v[70:71], v3 offset:4352
    s_waitcnt lgkmcnt(10)
    v_mfma_f32_32x32x16_bf16 v[88:103], a[32:35], v[48:51], v[88:103]
    ds_read_b64_tr_b16 v[72:73], v3 offset:5120
    ds_read_b64_tr_b16 v[74:75], v3 offset:5376
    s_waitcnt lgkmcnt(10)
    v_mfma_f32_32x32x16_bf16 v[88:103], a[36:39], v[52:55], v[88:103]
    ds_read_b64_tr_b16 v[76:77], v3 offset:6144
    ds_read_b64_tr_b16 v[78:79], v3 offset:6400
    s_waitcnt lgkmcnt(10)
    v_mfma_f32_32x32x16_bf16 v[88:103], a[40:43], v[56:59], v[88:103]
    ds_read_b64_tr_b16 v[80:81], v3 offset:7168
    ds_read_b64_tr_b16 v[82:83], v3 offset:7424
    s_waitcnt lgkmcnt(10)
    v_mfma_f32_32x32x16_bf16 v[88:103], a[44:47], v[60:63], v[88:103]
    ds_read_b64_tr_b16 v[84:85], v3 offset:8192
    ds_read_b64_tr_b16 v[86:87], v3 offset:8448
    s_waitcnt lgkmcnt(10)
    v_mfma_f32_32x32x16_bf16 v[88:103], a[48:51], v[64:67], v[88:103]
    s_waitcnt lgkmcnt(8)
    v_mfma_f32_32x32x16_bf16 v[88:103], a[52:55], v[68:71], v[88:103]
    s_waitcnt lgkmcnt(6)
    v_mfma_f32_32x32x16_bf16 v[88:103], a[56:59], v[72:75], v[88:103]
    s_waitcnt lgkmcnt(4)
    v_mfma_f32_32x32x16_bf16 v[88:103], a[60:63], v[76:79], v[88:103]
    s_waitcnt lgkmcnt(2)
    v_mfma_f32_32x32x16_bf16 v[88:103], a[64:67], v[80:83], v[88:103]
    s_waitcnt lgkmcnt(0)
    v_mfma_f32_32x32x16_bf16 v[88:103], a[68:71], v[84:87], v[88:103]
    s_waitcnt vmcnt(0)
    s_nop 15
    v_lshlrev_b32 v4, 16, v112
    v_and_b32 v5, 0xffff0000, v112
    v_pk_add_f32 v[88:89], v[88:89], v[4:5]
    v_cvt_pk_bf16_f32 v112, v88, v89
    v_lshlrev_b32 v6, 16, v113
    v_and_b32 v7, 0xffff0000, v113
    v_pk_add_f32 v[90:91], v[90:91], v[6:7]
    v_cvt_pk_bf16_f32 v113, v90, v91
    v_lshlrev_b32 v4, 16, v114
    v_and_b32 v5, 0xffff0000, v114
    v_pk_add_f32 v[92:93], v[92:93], v[4:5]
    v_cvt_pk_bf16_f32 v114, v92, v93
    v_lshlrev_b32 v6, 16, v115
    v_and_b32 v7, 0xffff0000, v115
    v_pk_add_f32 v[94:95], v[94:95], v[6:7]
    v_cvt_pk_bf16_f32 v115, v94, v95
    buffer_store_dwordx4 v[112:115], v9, s[36:39], 0 offen offset:64 sc1
    v_lshlrev_b32 v4, 16, v116
    v_and_b32 v5, 0xffff0000, v116
    v_pk_add_f32 v[96:97], v[96:97], v[4:5]
    v_cvt_pk_bf16_f32 v116, v96, v97
    v_lshlrev_b32 v6, 16, v117
    v_and_b32 v7, 0xffff0000, v117
    v_pk_add_f32 v[98:99], v[98:99], v[6:7]
    v_cvt_pk_bf16_f32 v117, v98, v99
    v_lshlrev_b32 v4, 16, v118
    v_and_b32 v5, 0xffff0000, v118
    v_pk_add_f32 v[100:101], v[100:101], v[4:5]
    v_cvt_pk_bf16_f32 v118, v100, v101
    v_lshlrev_b32 v6, 16, v119
    v_and_b32 v7, 0xffff0000, v119
    v_pk_add_f32 v[102:103], v[102:103], v[6:7]
    v_cvt_pk_bf16_f32 v119, v102, v103
    buffer_store_dwordx4 v[116:119], v9, s[36:39], 0 offen offset:96 sc1
    s_endpgm
L_k3_w2:
    v_mov_b32 v10, 0x80000000
    v_mul_u32_u24 v4, 7282, v1
    v_lshrrev_b32 v4, 16, v4
    v_mul_u32_u24 v5, 9, v4
    v_sub_u32 v5, v1, v5
    v_min_u32 v5, 7, v5
    v_add_u32 v5, 2, v5
    v_lshrrev_b32 v6, 2, v5
    v_and_b32 v5, 3, v5
    v_lshlrev_b32 v5, 4, v5
    v_lshl_add_u32 v5, v4, 6, v5
    v_mul_u32_u24 v7, 9216, v6
    v_add_u32 v5, v5, v7
    v_cmp_eq_u32 vcc, 0, v6
    s_and_b64 vcc, vcc, s[50:51]
    v_cmp_eq_u32 s[46:47], 2, v6
    s_nop 0
    v_cndmask_b32 v5, v5, v10, vcc
    s_and_b64 vcc, s[46:47], s[52:53]
    s_mov_b64 s[46:47], exec
    v_cndmask_b32 v5, v5, v10, vcc
    v_lshrrev_b32 v3, 2, v1
    v_and_b32 v4, 3, v1
    v_lshlrev_b32 v15, 6, v3
    v_lshl_add_u32 v15, v4, 3, v15
    s_bitset0_b64 exec, 63
    s_mov_b32 m0, 36864
    s_movk_i32 s48, 5120
    buffer_load_dwordx4 v5, s[12:15], s48 offen lds
    s_mov_b32 m0, 37872
    s_movk_i32 s48, 5568
    buffer_load_dwordx4 v5, s[12:15], s48 offen lds
    s_mov_b32 m0, 38880
    s_movk_i32 s48, 6016
    buffer_load_dwordx4 v5, s[12:15], s48 offen lds
    s_mov_b64 exec, s[46:47]
    s_mov_b32 m0, 39936
    s_movk_i32 s48, 12800
    buffer_load_dwordx4 v2, s[16:19], s48 offen offset:0 lds
    buffer_load_dwordx4 v2, s[16:19], s48 offen offset:1024 lds
    buffer_load_dwordx4 v2, s[16:19], s48 offen offset:2048 lds
    s_movk_i32 s48, 5120
    buffer_load_dwordx2 v[68:69], v15, s[24:27], s48 offen offset:0
    buffer_load_dwordx2 v[70:71], v15, s[24:27], s48 offen offset:32
    s_bitset0_b64 exec, 63
    s_mov_b32 m0, 43008
    s_movk_i32 s48, 6144
    buffer_load_dwordx4 v5, s[12:15], s48 offen lds
    s_mov_b32 m0, 44016
    s_movk_i32 s48, 6592
    buffer_load_dwordx4 v5, s[12:15], s48 offen lds
    s_mov_b32 m0, 45024
    s_movk_i32 s48, 7040
    buffer_load_dwordx4 v5, s[12:15], s48 offen lds
    s_mov_b64 exec, s[46:47]
    s_mov_b32 m0, 46080
    s_movk_i32 s48, 15360
    buffer_load_dwordx4 v2, s[16:19], s48 offen offset:0 lds
    buffer_load_dwordx4 v2, s[16:19], s48 offen offset:1024 lds
    buffer_load_dwordx4 v2, s[16:19], s48 offen offset:2048 lds
    s_movk_i32 s48, 6144
    buffer_load_dwordx2 v[72:73], v15, s[24:27], s48 offen offset:0
    buffer_load_dwordx2 v[74:75], v15, s[24:27], s48 offen offset:32
    v_and_b32 v6, 31, v1
    v_lshlrev_b32 v7, 2, v6
    v_lshrrev_b32 v8, 5, v1
    v_mul_u32_u24 v9, 288, v6
    v_lshl_add_u32 v9, v8, 4, v9
    v_mul_u32_u24 v11, 80, v3
    v_and_b32 v12, 1, v4
    v_xor_b32 v12, 1, v12
    v_mul_u32_u24 v12, 1280, v12
    v_add_u32 v11, v11, v12
    v_lshrrev_b32 v12, 1, v4
    v_xor_b32 v12, 1, v12
    v_lshl_add_u32 v11, v12, 2, v11
    v_mul_u32_u24 v12, 144, v3
    v_lshl_add_u32 v12, v4, 3, v12
    v_add_u32 v12, 36864, v12
    v_add_u32 v13, 73728, v15
    buffer_load_dword v80, v7, s[40:43], 0 offen
    s_movk_i32 s48, 32000
    buffer_load_dword v81, v7, s[40:43], s48 offen
    v_add_u32 v14, 39936, v11
    s_waitcnt vmcnt(12)
    ds_read2_b32 v[16:17], v14 offset0:0 offset1:1
    ds_read2_b32 v[18:19], v14 offset0:2 offset1:3
    ds_read2_b32 v[20:21], v14 offset0:4 offset1:5
    ds_read2_b32 v[22:23], v14 offset0:6 offset1:7
    ds_read2_b32 v[24:25], v14 offset0:8 offset1:9
    ds_read2_b32 v[26:27], v14 offset0:10 offset1:11
    ds_read2_b32 v[28:29], v14 offset0:12 offset1:13
    ds_read2_b32 v[30:31], v14 offset0:14 offset1:15
    ds_read2_b32 v[32:33], v14 offset0:16 offset1:17
    s_waitcnt lgkmcnt(2)
    ds_read_b64 v[34:35], v12 offset:0
    ds_read_b64 v[36:37], v12 offset:8
    ds_read_b64 v[38:39], v12 offset:16
    ds_read_b64 v[40:41], v12 offset:24
    ds_read_b64 v[42:43], v12 offset:32
    ds_read_b64 v[44:45], v12 offset:40
    ds_read_b64 v[46:47], v12 offset:48
    ds_read_b64 v[48:49], v12 offset:56
    ds_read_b64 v[50:51], v12 offset:64
    ds_read_b64 v[52:53], v12 offset:72
    ds_read_b64 v[54:55], v12 offset:80
    ds_read_b64 v[56:57], v12 offset:88
    ds_read_b64 v[58:59], v12 offset:96
    s_waitcnt lgkmcnt(8)
    v_mfma_f32_4x4x4_16b_bf16 v[60:63], v[16:17], v[34:35], 0
    v_mfma_f32_4x4x4_16b_bf16 v[64:67], v[16:17], v[42:43], 0
    s_mov_b32 s48, 5120
    buffer_load_dwordx4 v[88:91], v2, s[20:23], s48 offen
    s_mov_b32 s48, 2309120
    buffer_load_dwordx4 v[92:95], v2, s[20:23], s48 offen
    s_waitcnt lgkmcnt(7)
    v_mfma_f32_4x4x4_16b_bf16 v[60:63], v[18:19], v[36:37], v[60:63]
    v_mfma_f32_4x4x4_16b_bf16 v[64:67], v[18:19], v[44:45], v[64:67]
    s_mov_b32 s48, 6144
    buffer_load_dwordx4 v[96:99], v2, s[20:23], s48 offen
    s_mov_b32 s48, 2310144
    buffer_load_dwordx4 v[100:103], v2, s[20:23], s48 offen
    s_waitcnt lgkmcnt(6)
    v_mfma_f32_4x4x4_16b_bf16 v[60:63], v[20:21], v[38:39], v[60:63]
    v_mfma_f32_4x4x4_16b_bf16 v[64:67], v[20:21], v[46:47], v[64:67]
    s_mov_b32 s48, 2048
    buffer_load_dwordx4 a[0:3], v2, s[28:31], s48 offen
    s_mov_b32 s48, 7168
    buffer_load_dwordx4 a[4:7], v2, s[28:31], s48 offen
    s_waitcnt lgkmcnt(5)
    v_mfma_f32_4x4x4_16b_bf16 v[60:63], v[22:23], v[40:41], v[60:63]
    v_mfma_f32_4x4x4_16b_bf16 v[64:67], v[22:23], v[48:49], v[64:67]
    s_mov_b32 s48, 12288
    buffer_load_dwordx4 a[8:11], v2, s[28:31], s48 offen
    s_mov_b32 s48, 17408
    buffer_load_dwordx4 a[12:15], v2, s[28:31], s48 offen
    s_waitcnt lgkmcnt(4)
    v_mfma_f32_4x4x4_16b_bf16 v[60:63], v[24:25], v[42:43], v[60:63]
    v_mfma_f32_4x4x4_16b_bf16 v[64:67], v[24:25], v[50:51], v[64:67]
    s_mov_b32 s48, 22528
    buffer_load_dwordx4 a[16:19], v2, s[28:31], s48 offen
    s_mov_b32 s48, 27648
    buffer_load_dwordx4 a[20:23], v2, s[28:31], s48 offen
    s_waitcnt lgkmcnt(3)
    v_mfma_f32_4x4x4_16b_bf16 v[60:63], v[26:27], v[44:45], v[60:63]
    v_mfma_f32_4x4x4_16b_bf16 v[64:67], v[26:27], v[52:53], v[64:67]
    s_mov_b32 s48, 32768
    buffer_load_dwordx4 a[24:27], v2, s[28:31], s48 offen
    s_mov_b32 s48, 37888
    buffer_load_dwordx4 a[28:31], v2, s[28:31], s48 offen
    s_waitcnt lgkmcnt(2)
    v_mfma_f32_4x4x4_16b_bf16 v[60:63], v[28:29], v[46:47], v[60:63]
    v_mfma_f32_4x4x4_16b_bf16 v[64:67], v[28:29], v[54:55], v[64:67]
    s_mov_b32 s48, 43008
    buffer_load_dwordx4 a[32:35], v2, s[28:31], s48 offen
    s_mov_b32 s48, 48128
    buffer_load_dwordx4 a[36:39], v2, s[28:31], s48 offen
    s_waitcnt lgkmcnt(1)
    v_mfma_f32_4x4x4_16b_bf16 v[60:63], v[30:31], v[48:49], v[60:63]
    v_mfma_f32_4x4x4_16b_bf16 v[64:67], v[30:31], v[56:57], v[64:67]
    s_mov_b32 s48, 53248
    buffer_load_dwordx4 a[40:43], v2, s[28:31], s48 offen
    s_mov_b32 s48, 58368
    buffer_load_dwordx4 a[44:47], v2, s[28:31], s48 offen
    s_waitcnt lgkmcnt(0)
    v_mfma_f32_4x4x4_16b_bf16 v[60:63], v[32:33], v[50:51], v[60:63]
    v_mfma_f32_4x4x4_16b_bf16 v[64:67], v[32:33], v[58:59], v[64:67]
    s_mov_b32 s48, 63488
    buffer_load_dwordx4 a[48:51], v2, s[28:31], s48 offen
    s_mov_b32 s48, 68608
    buffer_load_dwordx4 a[52:55], v2, s[28:31], s48 offen
    s_waitcnt vmcnt(28)
    v_lshlrev_b32 v34, 16, v68
    v_and_b32 v35, 0xffff0000, v68
    v_lshlrev_b32 v36, 16, v69
    v_and_b32 v37, 0xffff0000, v69
    v_lshlrev_b32 v38, 16, v70
    v_and_b32 v39, 0xffff0000, v70
    v_lshlrev_b32 v40, 16, v71
    v_and_b32 v41, 0xffff0000, v71
    v_pk_mul_f32 v[60:61], v[60:61], v[34:35]
    v_pk_mul_f32 v[62:63], v[62:63], v[36:37]
    v_cvt_pk_bf16_f32 v42, v60, v61
    v_cvt_pk_bf16_f32 v43, v62, v63
    ds_write_b64 v13, v[42:43] offset:5120
    v_pk_mul_f32 v[64:65], v[64:65], v[38:39]
    v_pk_mul_f32 v[66:67], v[66:67], v[40:41]
    v_cvt_pk_bf16_f32 v46, v64, v65
    v_cvt_pk_bf16_f32 v47, v66, v67
    ds_write_b64 v13, v[46:47] offset:5152
    v_add_u32 v14, 46080, v11
    s_waitcnt vmcnt(22)
    ds_read2_b32 v[16:17], v14 offset0:0 offset1:1
    ds_read2_b32 v[18:19], v14 offset0:2 offset1:3
    ds_read2_b32 v[20:21], v14 offset0:4 offset1:5
    ds_read2_b32 v[22:23], v14 offset0:6 offset1:7
    ds_read2_b32 v[24:25], v14 offset0:8 offset1:9
    ds_read2_b32 v[26:27], v14 offset0:10 offset1:11
    ds_read2_b32 v[28:29], v14 offset0:12 offset1:13
    ds_read2_b32 v[30:31], v14 offset0:14 offset1:15
    ds_read2_b32 v[32:33], v14 offset0:16 offset1:17
    s_waitcnt lgkmcnt(2)
    ds_read_b64 v[34:35], v12 offset:6144
    ds_read_b64 v[36:37], v12 offset:6152
    ds_read_b64 v[38:39], v12 offset:6160
    ds_read_b64 v[40:41], v12 offset:6168
    ds_read_b64 v[42:43], v12 offset:6176
    ds_read_b64 v[44:45], v12 offset:6184
    ds_read_b64 v[46:47], v12 offset:6192
    ds_read_b64 v[48:49], v12 offset:6200
    ds_read_b64 v[50:51], v12 offset:6208
    ds_read_b64 v[52:53], v12 offset:6216
    ds_read_b64 v[54:55], v12 offset:6224
    ds_read_b64 v[56:57], v12 offset:6232
    ds_read_b64 v[58:59], v12 offset:6240
    s_waitcnt lgkmcnt(8)
    v_mfma_f32_4x4x4_16b_bf16 v[60:63], v[16:17], v[34:35], 0
    v_mfma_f32_4x4x4_16b_bf16 v[64:67], v[16:17], v[42:43], 0
    s_mov_b32 s48, 73728
    buffer_load_dwordx4 a[56:59], v2, s[28:31], s48 offen
    s_mov_b32 s48, 78848
    buffer_load_dwordx4 a[60:63], v2, s[28:31], s48 offen
    s_waitcnt lgkmcnt(7)
    v_mfma_f32_4x4x4_16b_bf16 v[60:63], v[18:19], v[36:37], v[60:63]
    v_mfma_f32_4x4x4_16b_bf16 v[64:67], v[18:19], v[44:45], v[64:67]
    s_mov_b32 s48, 83968
    buffer_load_dwordx4 a[64:67], v2, s[28:31], s48 offen
    s_mov_b32 s48, 89088
    buffer_load_dwordx4 a[68:71], v2, s[28:31], s48 offen
    s_waitcnt lgkmcnt(6)
    v_mfma_f32_4x4x4_16b_bf16 v[60:63], v[20:21], v[38:39], v[60:63]
    v_mfma_f32_4x4x4_16b_bf16 v[64:67], v[20:21], v[46:47], v[64:67]
    s_mov_b32 s48, 4096
    buffer_load_dwordx4 a[72:75], v2, s[28:31], s48 offen
    s_mov_b32 s48, 9216
    buffer_load_dwordx4 a[76:79], v2, s[28:31], s48 offen
    s_waitcnt lgkmcnt(5)
    v_mfma_f32_4x4x4_16b_bf16 v[60:63], v[22:23], v[40:41], v[60:63]
    v_mfma_f32_4x4x4_16b_bf16 v[64:67], v[22:23], v[48:49], v[64:67]
    s_mov_b32 s48, 14336
    buffer_load_dwordx4 a[80:83], v2, s[28:31], s48 offen
    s_mov_b32 s48, 19456
    buffer_load_dwordx4 a[84:87], v2, s[28:31], s48 offen
    s_waitcnt lgkmcnt(4)
    v_mfma_f32_4x4x4_16b_bf16 v[60:63], v[24:25], v[42:43], v[60:63]
    v_mfma_f32_4x4x4_16b_bf16 v[64:67], v[24:25], v[50:51], v[64:67]
    s_mov_b32 s48, 24576
    buffer_load_dwordx4 a[88:91], v2, s[28:31], s48 offen
    s_mov_b32 s48, 29696
    buffer_load_dwordx4 a[92:95], v2, s[28:31], s48 offen
    s_waitcnt lgkmcnt(3)
    v_mfma_f32_4x4x4_16b_bf16 v[60:63], v[26:27], v[44:45], v[60:63]
    v_mfma_f32_4x4x4_16b_bf16 v[64:67], v[26:27], v[52:53], v[64:67]
    s_mov_b32 s48, 34816
    buffer_load_dwordx4 a[96:99], v2, s[28:31], s48 offen
    s_mov_b32 s48, 39936
    buffer_load_dwordx4 a[100:103], v2, s[28:31], s48 offen
    s_waitcnt lgkmcnt(2)
    v_mfma_f32_4x4x4_16b_bf16 v[60:63], v[28:29], v[46:47], v[60:63]
    v_mfma_f32_4x4x4_16b_bf16 v[64:67], v[28:29], v[54:55], v[64:67]
    s_mov_b32 s48, 45056
    buffer_load_dwordx4 a[104:107], v2, s[28:31], s48 offen
    s_mov_b32 s48, 50176
    buffer_load_dwordx4 a[108:111], v2, s[28:31], s48 offen
    s_waitcnt lgkmcnt(1)
    v_mfma_f32_4x4x4_16b_bf16 v[60:63], v[30:31], v[48:49], v[60:63]
    v_mfma_f32_4x4x4_16b_bf16 v[64:67], v[30:31], v[56:57], v[64:67]
    s_mov_b32 s48, 55296
    buffer_load_dwordx4 a[112:115], v2, s[28:31], s48 offen
    s_mov_b32 s48, 60416
    buffer_load_dwordx4 a[116:119], v2, s[28:31], s48 offen
    s_waitcnt lgkmcnt(0)
    v_mfma_f32_4x4x4_16b_bf16 v[60:63], v[32:33], v[50:51], v[60:63]
    v_mfma_f32_4x4x4_16b_bf16 v[64:67], v[32:33], v[58:59], v[64:67]
    s_mov_b32 s48, 65536
    buffer_load_dwordx4 a[120:123], v2, s[28:31], s48 offen
    s_mov_b32 s48, 70656
    buffer_load_dwordx4 a[124:127], v2, s[28:31], s48 offen
    s_waitcnt vmcnt(38)
    v_lshlrev_b32 v34, 16, v72
    v_and_b32 v35, 0xffff0000, v72
    v_lshlrev_b32 v36, 16, v73
    v_and_b32 v37, 0xffff0000, v73
    v_lshlrev_b32 v38, 16, v74
    v_and_b32 v39, 0xffff0000, v74
    v_lshlrev_b32 v40, 16, v75
    v_and_b32 v41, 0xffff0000, v75
    v_pk_mul_f32 v[60:61], v[60:61], v[34:35]
    v_pk_mul_f32 v[62:63], v[62:63], v[36:37]
    v_cvt_pk_bf16_f32 v42, v60, v61
    v_cvt_pk_bf16_f32 v43, v62, v63
    ds_write_b64 v13, v[42:43] offset:6144
    v_pk_mul_f32 v[64:65], v[64:65], v[38:39]
    v_pk_mul_f32 v[66:67], v[66:67], v[40:41]
    v_cvt_pk_bf16_f32 v46, v64, v65
    v_cvt_pk_bf16_f32 v47, v66, v67
    ds_write_b64 v13, v[46:47] offset:6176
    s_waitcnt vmcnt(32)
    v_sub_f32 v82, v81, v80
    v_exp_f32 v82, v82
    v_sub_f32 v84, v80, v81
    v_exp_f32 v84, v84
    v_add_f32 v82, 1.0, v82
    v_add_f32 v84, 1.0, v84
    v_rcp_f32 v82, v82
    v_rcp_f32 v84, v84
    v_add_u32 v14, 82944, v2
    v_lshlrev_b32 v16, 16, v88
    v_and_b32 v17, 0xffff0000, v88
    v_lshlrev_b32 v18, 16, v92
    v_and_b32 v19, 0xffff0000, v92
    v_pk_mul_f32 v[16:17], v[16:17], v[82:83] op_sel_hi:[1,0]
    v_pk_fma_f32 v[16:17], v[18:19], v[84:85], v[16:17] op_sel_hi:[1,0,1]
    v_cvt_pk_bf16_f32 v88, v16, v17
    s_mov_b32 s48, 75776
    buffer_load_dwordx4 a[128:131], v2, s[28:31], s48 offen
    v_lshlrev_b32 v20, 16, v89
    v_and_b32 v21, 0xffff0000, v89
    v_lshlrev_b32 v22, 16, v93
    v_and_b32 v23, 0xffff0000, v93
    v_pk_mul_f32 v[20:21], v[20:21], v[82:83] op_sel_hi:[1,0]
    v_pk_fma_f32 v[20:21], v[22:23], v[84:85], v[20:21] op_sel_hi:[1,0,1]
    v_cvt_pk_bf16_f32 v89, v20, v21
    s_mov_b32 s48, 80896
    buffer_load_dwordx4 a[132:135], v2, s[28:31], s48 offen
    v_lshlrev_b32 v16, 16, v90
    v_and_b32 v17, 0xffff0000, v90
    v_lshlrev_b32 v18, 16, v94
    v_and_b32 v19, 0xffff0000, v94
    v_pk_mul_f32 v[16:17], v[16:17], v[82:83] op_sel_hi:[1,0]
    v_pk_fma_f32 v[16:17], v[18:19], v[84:85], v[16:17] op_sel_hi:[1,0,1]
    v_cvt_pk_bf16_f32 v90, v16, v17
    s_mov_b32 s48, 86016
    buffer_load_dwordx4 a[136:139], v2, s[28:31], s48 offen
    v_lshlrev_b32 v20, 16, v91
    v_and_b32 v21, 0xffff0000, v91
    v_lshlrev_b32 v22, 16, v95
    v_and_b32 v23, 0xffff0000, v95
    v_pk_mul_f32 v[20:21], v[20:21], v[82:83] op_sel_hi:[1,0]
    v_pk_fma_f32 v[20:21], v[22:23], v[84:85], v[20:21] op_sel_hi:[1,0,1]
    v_cvt_pk_bf16_f32 v91, v20, v21
    s_mov_b32 s48, 91136
    buffer_load_dwordx4 a[140:143], v2, s[28:31], s48 offen
    ds_write_b128 v14, v[88:91] offset:5120
    v_lshlrev_b32 v16, 16, v96
    v_and_b32 v17, 0xffff0000, v96
    v_lshlrev_b32 v18, 16, v100
    v_and_b32 v19, 0xffff0000, v100
    v_pk_mul_f32 v[16:17], v[16:17], v[82:83] op_sel_hi:[1,0]
    v_pk_fma_f32 v[16:17], v[18:19], v[84:85], v[16:17] op_sel_hi:[1,0,1]
    v_cvt_pk_bf16_f32 v96, v16, v17
    buffer_load_dwordx4 v[112:115], v9, s[32:35], 0 offen offset:128
    v_lshlrev_b32 v20, 16, v97
    v_and_b32 v21, 0xffff0000, v97
    v_lshlrev_b32 v22, 16, v101
    v_and_b32 v23, 0xffff0000, v101
    v_pk_mul_f32 v[20:21], v[20:21], v[82:83] op_sel_hi:[1,0]
    v_pk_fma_f32 v[20:21], v[22:23], v[84:85], v[20:21] op_sel_hi:[1,0,1]
    v_cvt_pk_bf16_f32 v97, v20, v21
    buffer_load_dwordx4 v[116:119], v9, s[32:35], 0 offen offset:160
    v_lshlrev_b32 v16, 16, v98
    v_and_b32 v17, 0xffff0000, v98
    v_lshlrev_b32 v18, 16, v102
    v_and_b32 v19, 0xffff0000, v102
    v_pk_mul_f32 v[16:17], v[16:17], v[82:83] op_sel_hi:[1,0]
    v_pk_fma_f32 v[16:17], v[18:19], v[84:85], v[16:17] op_sel_hi:[1,0,1]
    v_cvt_pk_bf16_f32 v98, v16, v17
    buffer_load_dwordx4 v[120:123], v9, s[32:35], 0 offen offset:256
    v_lshlrev_b32 v20, 16, v99
    v_and_b32 v21, 0xffff0000, v99
    v_lshlrev_b32 v22, 16, v103
    v_and_b32 v23, 0xffff0000, v103
    v_pk_mul_f32 v[20:21], v[20:21], v[82:83] op_sel_hi:[1,0]
    v_pk_fma_f32 v[20:21], v[22:23], v[84:85], v[20:21] op_sel_hi:[1,0,1]
    v_cvt_pk_bf16_f32 v99, v20, v21
    ds_write_b128 v14, v[96:99] offset:6144
    v_bfe_u32 v3, v1, 2, 2
    v_lshl_add_u32 v3, v8, 3, v3
    v_lshlrev_b32 v3, 6, v3
    v_bfe_u32 v4, v1, 4, 1
    v_lshl_add_u32 v3, v4, 5, v3
    v_and_b32 v4, 3, v1
    v_lshl_add_u32 v3, v4, 3, v3
    v_add_u32 v3, 73728, v3
    s_waitcnt lgkmcnt(0)
    s_barrier
    ds_read_b128 v[16:19], v14 offset:0
    ds_read_b128 v[20:23], v14 offset:1024
    ds_read_b128 v[24:27], v14 offset:2048
    ds_read_b128 v[28:31], v14 offset:3072
    ds_read_b128 v[32:35], v14 offset:4096
    ds_read_b128 v[36:39], v14 offset:5120
    s_waitcnt vmcnt(21)
    s_waitcnt lgkmcnt(5)
    v_mfma_f32_32x32x16_bf16 v[88:103], a[0:3], v[16:19], 0
    ds_read_b128 v[40:43], v14 offset:6144
    s_waitcnt lgkmcnt(5)
    v_mfma_f32_32x32x16_bf16 v[88:103], a[4:7], v[20:23], v[88:103]
    ds_read_b128 v[44:47], v14 offset:7168
    s_waitcnt lgkmcnt(5)
    v_mfma_f32_32x32x16_bf16 v[88:103], a[8:11], v[24:27], v[88:103]
    ds_read_b128 v[48:51], v14 offset:8192
    s_waitcnt lgkmcnt(5)
    v_mfma_f32_32x32x16_bf16 v[88:103], a[12:15], v[28:31], v[88:103]
    ds_read_b64_tr_b16 v[52:53], v3 offset:0
    ds_read_b64_tr_b16 v[54:55], v3 offset:256
    s_waitcnt lgkmcnt(6)
    v_mfma_f32_32x32x16_bf16 v[88:103], a[16:19], v[32:35], v[88:103]
    ds_read_b64_tr_b16 v[56:57], v3 offset:1024
    ds_read_b64_tr_b16 v[58:59], v3 offset:1280
    s_waitcnt lgkmcnt(7)
    v_mfma_f32_32x32x16_bf16 v[88:103], a[20:23], v[36:39], v[88:103]
    ds_read_b64_tr_b16 v[60:61], v3 offset:2048
    ds_read_b64_tr_b16 v[62:63], v3 offset:2304
    s_waitcnt lgkmcnt(8)
    v_mfma_f32_32x32x16_bf16 v[88:103], a[24:27], v[40:43], v[88:103]
    ds_read_b64_tr_b16 v[64:65], v3 offset:3072
    ds_read_b64_tr_b16 v[66:67], v3 offset:3328
    s_waitcnt lgkmcnt(9)
    v_mfma_f32_32x32x16_bf16 v[88:103], a[28:31], v[44:47], v[88:103]
    ds_read_b64_tr_b16 v[68:69], v3 offset:4096
    ds_read_b64_tr_b16 v[70:71], v3 offset:4352
    s_waitcnt lgkmcnt(10)
    v_mfma_f32_32x32x16_bf16 v[88:103], a[32:35], v[48:51], v[88:103]
    ds_read_b64_tr_b16 v[72:73], v3 offset:5120
    ds_read_b64_tr_b16 v[74:75], v3 offset:5376
    s_waitcnt lgkmcnt(10)
    v_mfma_f32_32x32x16_bf16 v[88:103], a[36:39], v[52:55], v[88:103]
    ds_read_b64_tr_b16 v[76:77], v3 offset:6144
    ds_read_b64_tr_b16 v[78:79], v3 offset:6400
    s_waitcnt lgkmcnt(10)
    v_mfma_f32_32x32x16_bf16 v[88:103], a[40:43], v[56:59], v[88:103]
    ds_read_b64_tr_b16 v[80:81], v3 offset:7168
    ds_read_b64_tr_b16 v[82:83], v3 offset:7424
    s_waitcnt lgkmcnt(10)
    v_mfma_f32_32x32x16_bf16 v[88:103], a[44:47], v[60:63], v[88:103]
    ds_read_b64_tr_b16 v[84:85], v3 offset:8192
    ds_read_b64_tr_b16 v[86:87], v3 offset:8448
    s_waitcnt lgkmcnt(10)
    v_mfma_f32_32x32x16_bf16 v[88:103], a[48:51], v[64:67], v[88:103]
    s_waitcnt lgkmcnt(8)
    v_mfma_f32_32x32x16_bf16 v[88:103], a[52:55], v[68:71], v[88:103]
    s_waitcnt lgkmcnt(6)
    v_mfma_f32_32x32x16_bf16 v[88:103], a[56:59], v[72:75], v[88:103]
    s_waitcnt lgkmcnt(4)
    v_mfma_f32_32x32x16_bf16 v[88:103], a[60:63], v[76:79], v[88:103]
    s_waitcnt lgkmcnt(2)
    v_mfma_f32_32x32x16_bf16 v[88:103], a[64:67], v[80:83], v[88:103]
    s_waitcnt lgkmcnt(0)
    v_mfma_f32_32x32x16_bf16 v[88:103], a[68:71], v[84:87], v[88:103]
    s_waitcnt vmcnt(3)
    v_mfma_f32_32x32x16_bf16 a[144:159], a[72:75], v[16:19], 0
    v_mfma_f32_32x32x16_bf16 a[144:159], a[76:79], v[20:23], a[144:159]
    v_mfma_f32_32x32x16_bf16 a[144:159], a[80:83], v[24:27], a[144:159]
    v_mfma_f32_32x32x16_bf16 a[144:159], a[84:87], v[28:31], a[144:159]
    v_mfma_f32_32x32x16_bf16 a[144:159], a[88:91], v[32:35], a[144:159]
    v_mfma_f32_32x32x16_bf16 a[144:159], a[92:95], v[36:39], a[144:159]
    v_mfma_f32_32x32x16_bf16 a[144:159], a[96:99], v[40:43], a[144:159]
    v_mfma_f32_32x32x16_bf16 a[144:159], a[100:103], v[44:47], a[144:159]
    v_mfma_f32_32x32x16_bf16 a[144:159], a[104:107], v[48:51], a[144:159]
    v_mfma_f32_32x32x16_bf16 a[144:159], a[108:111], v[52:55], a[144:159]
    v_mfma_f32_32x32x16_bf16 a[144:159], a[112:115], v[56:59], a[144:159]
    v_mfma_f32_32x32x16_bf16 a[144:159], a[116:119], v[60:63], a[144:159]
    v_mfma_f32_32x32x16_bf16 a[144:159], a[120:123], v[64:67], a[144:159]
    v_mfma_f32_32x32x16_bf16 a[144:159], a[124:127], v[68:71], a[144:159]
    v_mfma_f32_32x32x16_bf16 a[144:159], a[128:131], v[72:75], a[144:159]
    v_mfma_f32_32x32x16_bf16 a[144:159], a[132:135], v[76:79], a[144:159]
    v_mfma_f32_32x32x16_bf16 a[144:159], a[136:139], v[80:83], a[144:159]
    v_mfma_f32_32x32x16_bf16 a[144:159], a[140:143], v[84:87], a[144:159]
    s_waitcnt vmcnt(0)
    v_lshlrev_b32 v4, 16, v112
    v_and_b32 v5, 0xffff0000, v112
    v_pk_add_f32 v[88:89], v[88:89], v[4:5]
    v_cvt_pk_bf16_f32 v112, v88, v89
    v_lshlrev_b32 v6, 16, v113
    v_and_b32 v7, 0xffff0000, v113
    v_pk_add_f32 v[90:91], v[90:91], v[6:7]
    v_cvt_pk_bf16_f32 v113, v90, v91
    v_lshlrev_b32 v4, 16, v114
    v_and_b32 v5, 0xffff0000, v114
    v_pk_add_f32 v[92:93], v[92:93], v[4:5]
    v_cvt_pk_bf16_f32 v114, v92, v93
    v_lshlrev_b32 v6, 16, v115
    v_and_b32 v7, 0xffff0000, v115
    v_pk_add_f32 v[94:95], v[94:95], v[6:7]
    v_cvt_pk_bf16_f32 v115, v94, v95
    buffer_store_dwordx4 v[112:115], v9, s[36:39], 0 offen offset:128 sc1
    v_lshlrev_b32 v4, 16, v116
    v_and_b32 v5, 0xffff0000, v116
    v_pk_add_f32 v[96:97], v[96:97], v[4:5]
    v_cvt_pk_bf16_f32 v116, v96, v97
    v_lshlrev_b32 v6, 16, v117
    v_and_b32 v7, 0xffff0000, v117
    v_pk_add_f32 v[98:99], v[98:99], v[6:7]
    v_cvt_pk_bf16_f32 v117, v98, v99
    v_lshlrev_b32 v4, 16, v118
    v_and_b32 v5, 0xffff0000, v118
    v_pk_add_f32 v[100:101], v[100:101], v[4:5]
    v_cvt_pk_bf16_f32 v118, v100, v101
    v_lshlrev_b32 v6, 16, v119
    v_and_b32 v7, 0xffff0000, v119
    v_pk_add_f32 v[102:103], v[102:103], v[6:7]
    v_cvt_pk_bf16_f32 v119, v102, v103
    buffer_store_dwordx4 v[116:119], v9, s[36:39], 0 offen offset:160 sc1
    s_nop 7
    v_accvgpr_read_b32 v16, a144
    v_accvgpr_read_b32 v17, a145
    v_accvgpr_read_b32 v18, a146
    v_accvgpr_read_b32 v19, a147
    v_accvgpr_read_b32 v20, a148
    v_accvgpr_read_b32 v21, a149
    v_accvgpr_read_b32 v22, a150
    v_accvgpr_read_b32 v23, a151
    v_lshlrev_b32 v4, 16, v120
    v_and_b32 v5, 0xffff0000, v120
    v_pk_add_f32 v[16:17], v[16:17], v[4:5]
    v_cvt_pk_bf16_f32 v120, v16, v17
    v_lshlrev_b32 v6, 16, v121
    v_and_b32 v7, 0xffff0000, v121
    v_pk_add_f32 v[18:19], v[18:19], v[6:7]
    v_cvt_pk_bf16_f32 v121, v18, v19
    v_lshlrev_b32 v4, 16, v122
    v_and_b32 v5, 0xffff0000, v122
    v_pk_add_f32 v[20:21], v[20:21], v[4:5]
    v_cvt_pk_bf16_f32 v122, v20, v21
    v_lshlrev_b32 v6, 16, v123
    v_and_b32 v7, 0xffff0000, v123
    v_pk_add_f32 v[22:23], v[22:23], v[6:7]
    v_cvt_pk_bf16_f32 v123, v22, v23
    buffer_store_dwordx4 v[120:123], v9, s[36:39], 0 offen offset:256 sc1
    s_endpgm
L_k3_w3:
    v_mov_b32 v10, 0x80000000
    v_mul_u32_u24 v4, 7282, v1
    v_lshrrev_b32 v4, 16, v4
    v_mul_u32_u24 v5, 9, v4
    v_sub_u32 v5, v1, v5
    v_min_u32 v5, 7, v5
    v_add_u32 v5, 2, v5
    v_lshrrev_b32 v6, 2, v5
    v_and_b32 v5, 3, v5
    v_lshlrev_b32 v5, 4, v5
    v_lshl_add_u32 v5, v4, 6, v5
    v_mul_u32_u24 v7, 9216, v6
    v_add_u32 v5, v5, v7
    v_cmp_eq_u32 vcc, 0, v6
    s_and_b64 vcc, vcc, s[50:51]
    v_cmp_eq_u32 s[46:47], 2, v6
    s_nop 0
    v_cndmask_b32 v5, v5, v10, vcc
    s_and_b64 vcc, s[46:47], s[52:53]
    s_mov_b64 s[46:47], exec
    v_cndmask_b32 v5, v5, v10, vcc
    v_lshrrev_b32 v3, 2, v1
    v_and_b32 v4, 3, v1
    v_lshlrev_b32 v15, 6, v3
    v_lshl_add_u32 v15, v4, 3, v15
    s_bitset0_b64 exec, 63
    s_mov_b32 m0, 55296
    s_movk_i32 s48, 7168
    buffer_load_dwordx4 v5, s[12:15], s48 offen lds
    s_mov_b32 m0, 56304
    s_movk_i32 s48, 7616
    buffer_load_dwordx4 v5, s[12:15], s48 offen lds
    s_mov_b32 m0, 57312
    s_movk_i32 s48, 8064
    buffer_load_dwordx4 v5, s[12:15], s48 offen lds
    s_mov_b64 exec, s[46:47]
    s_mov_b32 m0, 58368
    s_movk_i32 s48, 17920
    buffer_load_dwordx4 v2, s[16:19], s48 offen offset:0 lds
    buffer_load_dwordx4 v2, s[16:19], s48 offen offset:1024 lds
    buffer_load_dwordx4 v2, s[16:19], s48 offen offset:2048 lds
    s_movk_i32 s48, 7168
    buffer_load_dwordx2 v[68:69], v15, s[24:27], s48 offen offset:0
    buffer_load_dwordx2 v[70:71], v15, s[24:27], s48 offen offset:32
    s_bitset0_b64 exec, 63
    s_mov_b32 m0, 61440
    s_movk_i32 s48, 8192
    buffer_load_dwordx4 v5, s[12:15], s48 offen lds
    s_mov_b32 m0, 62448
    s_movk_i32 s48, 8640
    buffer_load_dwordx4 v5, s[12:15], s48 offen lds
    s_mov_b32 m0, 63456
    s_movk_i32 s48, 9088
    buffer_load_dwordx4 v5, s[12:15], s48 offen lds
    s_mov_b64 exec, s[46:47]
    s_mov_b32 m0, 64512
    s_movk_i32 s48, 20480
    buffer_load_dwordx4 v2, s[16:19], s48 offen offset:0 lds
    buffer_load_dwordx4 v2, s[16:19], s48 offen offset:1024 lds
    buffer_load_dwordx4 v2, s[16:19], s48 offen offset:2048 lds
    s_movk_i32 s48, 8192
    buffer_load_dwordx2 v[72:73], v15, s[24:27], s48 offen offset:0
    buffer_load_dwordx2 v[74:75], v15, s[24:27], s48 offen offset:32
    v_and_b32 v6, 31, v1
    v_lshlrev_b32 v7, 2, v6
    v_lshrrev_b32 v8, 5, v1
    v_mul_u32_u24 v9, 288, v6
    v_lshl_add_u32 v9, v8, 4, v9
    v_mul_u32_u24 v11, 80, v3
    v_and_b32 v12, 1, v4
    v_xor_b32 v12, 1, v12
    v_mul_u32_u24 v12, 1280, v12
    v_add_u32 v11, v11, v12
    v_lshrrev_b32 v12, 1, v4
    v_xor_b32 v12, 1, v12
    v_lshl_add_u32 v11, v12, 2, v11
    v_mul_u32_u24 v12, 144, v3
    v_lshl_add_u32 v12, v4, 3, v12
    v_add_u32 v12, 55296, v12
    v_add_u32 v13, 73728, v15
    buffer_load_dword v80, v7, s[40:43], 0 offen
    s_movk_i32 s48, 32000
    buffer_load_dword v81, v7, s[40:43], s48 offen
    v_add_u32 v14, 58368, v11
    s_waitcnt vmcnt(12)
    ds_read2_b32 v[16:17], v14 offset0:0 offset1:1
    ds_read2_b32 v[18:19], v14 offset0:2 offset1:3
    ds_read2_b32 v[20:21], v14 offset0:4 offset1:5
    ds_read2_b32 v[22:23], v14 offset0:6 offset1:7
    ds_read2_b32 v[24:25], v14 offset0:8 offset1:9
    ds_read2_b32 v[26:27], v14 offset0:10 offset1:11
    ds_read2_b32 v[28:29], v14 offset0:12 offset1:13
    ds_read2_b32 v[30:31], v14 offset0:14 offset1:15
    ds_read2_b32 v[32:33], v14 offset0:16 offset1:17
    s_waitcnt lgkmcnt(2)
    ds_read_b64 v[34:35], v12 offset:0
    ds_read_b64 v[36:37], v12 offset:8
    ds_read_b64 v[38:39], v12 offset:16
    ds_read_b64 v[40:41], v12 offset:24
    ds_read_b64 v[42:43], v12 offset:32
    ds_read_b64 v[44:45], v12 offset:40
    ds_read_b64 v[46:47], v12 offset:48
    ds_read_b64 v[48:49], v12 offset:56
    ds_read_b64 v[50:51], v12 offset:64
    ds_read_b64 v[52:53], v12 offset:72
    ds_read_b64 v[54:55], v12 offset:80
    ds_read_b64 v[56:57], v12 offset:88
    ds_read_b64 v[58:59], v12 offset:96
    s_waitcnt lgkmcnt(8)
    v_mfma_f32_4x4x4_16b_bf16 v[60:63], v[16:17], v[34:35], 0
    v_mfma_f32_4x4x4_16b_bf16 v[64:67], v[16:17], v[42:43], 0
    s_mov_b32 s48, 7168
    buffer_load_dwordx4 v[88:91], v2, s[20:23], s48 offen
    s_mov_b32 s48, 2311168
    buffer_load_dwordx4 v[92:95], v2, s[20:23], s48 offen
    s_waitcnt lgkmcnt(7)
    v_mfma_f32_4x4x4_16b_bf16 v[60:63], v[18:19], v[36:37], v[60:63]
    v_mfma_f32_4x4x4_16b_bf16 v[64:67], v[18:19], v[44:45], v[64:67]
    s_mov_b32 s48, 8192
    buffer_load_dwordx4 v[96:99], v2, s[20:23], s48 offen
    s_mov_b32 s48, 2312192
    buffer_load_dwordx4 v[100:103], v2, s[20:23], s48 offen
    s_waitcnt lgkmcnt(6)
    v_mfma_f32_4x4x4_16b_bf16 v[60:63], v[20:21], v[38:39], v[60:63]
    v_mfma_f32_4x4x4_16b_bf16 v[64:67], v[20:21], v[46:47], v[64:67]
    s_mov_b32 s48, 3072
    buffer_load_dwordx4 a[0:3], v2, s[28:31], s48 offen
    s_mov_b32 s48, 8192
    buffer_load_dwordx4 a[4:7], v2, s[28:31], s48 offen
    s_waitcnt lgkmcnt(5)
    v_mfma_f32_4x4x4_16b_bf16 v[60:63], v[22:23], v[40:41], v[60:63]
    v_mfma_f32_4x4x4_16b_bf16 v[64:67], v[22:23], v[48:49], v[64:67]
    s_mov_b32 s48, 13312
    buffer_load_dwordx4 a[8:11], v2, s[28:31], s48 offen
    s_mov_b32 s48, 18432
    buffer_load_dwordx4 a[12:15], v2, s[28:31], s48 offen
    s_waitcnt lgkmcnt(4)
    v_mfma_f32_4x4x4_16b_bf16 v[60:63], v[24:25], v[42:43], v[60:63]
    v_mfma_f32_4x4x4_16b_bf16 v[64:67], v[24:25], v[50:51], v[64:67]
    s_mov_b32 s48, 23552
    buffer_load_dwordx4 a[16:19], v2, s[28:31], s48 offen
    s_mov_b32 s48, 28672
    buffer_load_dwordx4 a[20:23], v2, s[28:31], s48 offen
    s_waitcnt lgkmcnt(3)
    v_mfma_f32_4x4x4_16b_bf16 v[60:63], v[26:27], v[44:45], v[60:63]
    v_mfma_f32_4x4x4_16b_bf16 v[64:67], v[26:27], v[52:53], v[64:67]
    s_mov_b32 s48, 33792
    buffer_load_dwordx4 a[24:27], v2, s[28:31], s48 offen
    s_mov_b32 s48, 38912
    buffer_load_dwordx4 a[28:31], v2, s[28:31], s48 offen
    s_waitcnt lgkmcnt(2)
    v_mfma_f32_4x4x4_16b_bf16 v[60:63], v[28:29], v[46:47], v[60:63]
    v_mfma_f32_4x4x4_16b_bf16 v[64:67], v[28:29], v[54:55], v[64:67]
    s_mov_b32 s48, 44032
    buffer_load_dwordx4 a[32:35], v2, s[28:31], s48 offen
    s_mov_b32 s48, 49152
    buffer_load_dwordx4 a[36:39], v2, s[28:31], s48 offen
    s_waitcnt lgkmcnt(1)
    v_mfma_f32_4x4x4_16b_bf16 v[60:63], v[30:31], v[48:49], v[60:63]
    v_mfma_f32_4x4x4_16b_bf16 v[64:67], v[30:31], v[56:57], v[64:67]
    s_mov_b32 s48, 54272
    buffer_load_dwordx4 a[40:43], v2, s[28:31], s48 offen
    s_mov_b32 s48, 59392
    buffer_load_dwordx4 a[44:47], v2, s[28:31], s48 offen
    s_waitcnt lgkmcnt(0)
    v_mfma_f32_4x4x4_16b_bf16 v[60:63], v[32:33], v[50:51], v[60:63]
    v_mfma_f32_4x4x4_16b_bf16 v[64:67], v[32:33], v[58:59], v[64:67]
    s_mov_b32 s48, 64512
    buffer_load_dwordx4 a[48:51], v2, s[28:31], s48 offen
    s_mov_b32 s48, 69632
    buffer_load_dwordx4 a[52:55], v2, s[28:31], s48 offen
    s_waitcnt vmcnt(28)
    v_lshlrev_b32 v34, 16, v68
    v_and_b32 v35, 0xffff0000, v68
    v_lshlrev_b32 v36, 16, v69
    v_and_b32 v37, 0xffff0000, v69
    v_lshlrev_b32 v38, 16, v70
    v_and_b32 v39, 0xffff0000, v70
    v_lshlrev_b32 v40, 16, v71
    v_and_b32 v41, 0xffff0000, v71
    v_pk_mul_f32 v[60:61], v[60:61], v[34:35]
    v_pk_mul_f32 v[62:63], v[62:63], v[36:37]
    v_cvt_pk_bf16_f32 v42, v60, v61
    v_cvt_pk_bf16_f32 v43, v62, v63
    ds_write_b64 v13, v[42:43] offset:7168
    v_pk_mul_f32 v[64:65], v[64:65], v[38:39]
    v_pk_mul_f32 v[66:67], v[66:67], v[40:41]
    v_cvt_pk_bf16_f32 v46, v64, v65
    v_cvt_pk_bf16_f32 v47, v66, v67
    ds_write_b64 v13, v[46:47] offset:7200
    v_add_u32 v14, 64512, v11
    s_waitcnt vmcnt(22)
    ds_read2_b32 v[16:17], v14 offset0:0 offset1:1
    ds_read2_b32 v[18:19], v14 offset0:2 offset1:3
    ds_read2_b32 v[20:21], v14 offset0:4 offset1:5
    ds_read2_b32 v[22:23], v14 offset0:6 offset1:7
    ds_read2_b32 v[24:25], v14 offset0:8 offset1:9
    ds_read2_b32 v[26:27], v14 offset0:10 offset1:11
    ds_read2_b32 v[28:29], v14 offset0:12 offset1:13
    ds_read2_b32 v[30:31], v14 offset0:14 offset1:15
    ds_read2_b32 v[32:33], v14 offset0:16 offset1:17
    s_waitcnt lgkmcnt(2)
    ds_read_b64 v[34:35], v12 offset:6144
    ds_read_b64 v[36:37], v12 offset:6152
    ds_read_b64 v[38:39], v12 offset:6160
    ds_read_b64 v[40:41], v12 offset:6168
    ds_read_b64 v[42:43], v12 offset:6176
    ds_read_b64 v[44:45], v12 offset:6184
    ds_read_b64 v[46:47], v12 offset:6192
    ds_read_b64 v[48:49], v12 offset:6200
    ds_read_b64 v[50:51], v12 offset:6208
    ds_read_b64 v[52:53], v12 offset:6216
    ds_read_b64 v[54:55], v12 offset:6224
    ds_read_b64 v[56:57], v12 offset:6232
    ds_read_b64 v[58:59], v12 offset:6240
    s_waitcnt lgkmcnt(8)
    v_mfma_f32_4x4x4_16b_bf16 v[60:63], v[16:17], v[34:35], 0
    v_mfma_f32_4x4x4_16b_bf16 v[64:67], v[16:17], v[42:43], 0
    s_mov_b32 s48, 74752
    buffer_load_dwordx4 a[56:59], v2, s[28:31], s48 offen
    s_mov_b32 s48, 79872
    buffer_load_dwordx4 a[60:63], v2, s[28:31], s48 offen
    s_waitcnt lgkmcnt(7)
    v_mfma_f32_4x4x4_16b_bf16 v[60:63], v[18:19], v[36:37], v[60:63]
    v_mfma_f32_4x4x4_16b_bf16 v[64:67], v[18:19], v[44:45], v[64:67]
    s_mov_b32 s48, 84992
    buffer_load_dwordx4 a[64:67], v2, s[28:31], s48 offen
    s_mov_b32 s48, 90112
    buffer_load_dwordx4 a[68:71], v2, s[28:31], s48 offen
    s_waitcnt lgkmcnt(6)
    v_mfma_f32_4x4x4_16b_bf16 v[60:63], v[20:21], v[38:39], v[60:63]
    v_mfma_f32_4x4x4_16b_bf16 v[64:67], v[20:21], v[46:47], v[64:67]
    buffer_load_dwordx4 v[112:115], v9, s[32:35], 0 offen offset:192
    buffer_load_dwordx4 v[116:119], v9, s[32:35], 0 offen offset:224
    s_waitcnt lgkmcnt(5)
    v_mfma_f32_4x4x4_16b_bf16 v[60:63], v[22:23], v[40:41], v[60:63]
    v_mfma_f32_4x4x4_16b_bf16 v[64:67], v[22:23], v[48:49], v[64:67]
    s_waitcnt lgkmcnt(4)
    v_mfma_f32_4x4x4_16b_bf16 v[60:63], v[24:25], v[42:43], v[60:63]
    v_mfma_f32_4x4x4_16b_bf16 v[64:67], v[24:25], v[50:51], v[64:67]
    s_waitcnt lgkmcnt(3)
    v_mfma_f32_4x4x4_16b_bf16 v[60:63], v[26:27], v[44:45], v[60:63]
    v_mfma_f32_4x4x4_16b_bf16 v[64:67], v[26:27], v[52:53], v[64:67]
    s_waitcnt lgkmcnt(2)
    v_mfma_f32_4x4x4_16b_bf16 v[60:63], v[28:29], v[46:47], v[60:63]
    v_mfma_f32_4x4x4_16b_bf16 v[64:67], v[28:29], v[54:55], v[64:67]
    s_waitcnt lgkmcnt(1)
    v_mfma_f32_4x4x4_16b_bf16 v[60:63], v[30:31], v[48:49], v[60:63]
    v_mfma_f32_4x4x4_16b_bf16 v[64:67], v[30:31], v[56:57], v[64:67]
    s_waitcnt lgkmcnt(0)
    v_mfma_f32_4x4x4_16b_bf16 v[60:63], v[32:33], v[50:51], v[60:63]
    v_mfma_f32_4x4x4_16b_bf16 v[64:67], v[32:33], v[58:59], v[64:67]
    s_waitcnt vmcnt(26)
    v_lshlrev_b32 v34, 16, v72
    v_and_b32 v35, 0xffff0000, v72
    v_lshlrev_b32 v36, 16, v73
    v_and_b32 v37, 0xffff0000, v73
    v_lshlrev_b32 v38, 16, v74
    v_and_b32 v39, 0xffff0000, v74
    v_lshlrev_b32 v40, 16, v75
    v_and_b32 v41, 0xffff0000, v75
    v_pk_mul_f32 v[60:61], v[60:61], v[34:35]
    v_pk_mul_f32 v[62:63], v[62:63], v[36:37]
    v_cvt_pk_bf16_f32 v42, v60, v61
    v_cvt_pk_bf16_f32 v43, v62, v63
    ds_write_b64 v13, v[42:43] offset:8192
    v_pk_mul_f32 v[64:65], v[64:65], v[38:39]
    v_pk_mul_f32 v[66:67], v[66:67], v[40:41]
    v_cvt_pk_bf16_f32 v46, v64, v65
    v_cvt_pk_bf16_f32 v47, v66, v67
    ds_write_b64 v13, v[46:47] offset:8224
    s_waitcnt vmcnt(20)
    v_sub_f32 v82, v81, v80
    v_exp_f32 v82, v82
    v_sub_f32 v84, v80, v81
    v_exp_f32 v84, v84
    v_add_f32 v82, 1.0, v82
    v_add_f32 v84, 1.0, v84
    v_rcp_f32 v82, v82
    v_rcp_f32 v84, v84
    v_add_u32 v14, 82944, v2
    v_lshlrev_b32 v16, 16, v88
    v_and_b32 v17, 0xffff0000, v88
    v_lshlrev_b32 v18, 16, v92
    v_and_b32 v19, 0xffff0000, v92
    v_pk_mul_f32 v[16:17], v[16:17], v[82:83] op_sel_hi:[1,0]
    v_pk_fma_f32 v[16:17], v[18:19], v[84:85], v[16:17] op_sel_hi:[1,0,1]
    v_cvt_pk_bf16_f32 v88, v16, v17
    v_lshlrev_b32 v20, 16, v89
    v_and_b32 v21, 0xffff0000, v89
    v_lshlrev_b32 v22, 16, v93
    v_and_b32 v23, 0xffff0000, v93
    v_pk_mul_f32 v[20:21], v[20:21], v[82:83] op_sel_hi:[1,0]
    v_pk_fma_f32 v[20:21], v[22:23], v[84:85], v[20:21] op_sel_hi:[1,0,1]
    v_cvt_pk_bf16_f32 v89, v20, v21
    v_lshlrev_b32 v16, 16, v90
    v_and_b32 v17, 0xffff0000, v90
    v_lshlrev_b32 v18, 16, v94
    v_and_b32 v19, 0xffff0000, v94
    v_pk_mul_f32 v[16:17], v[16:17], v[82:83] op_sel_hi:[1,0]
    v_pk_fma_f32 v[16:17], v[18:19], v[84:85], v[16:17] op_sel_hi:[1,0,1]
    v_cvt_pk_bf16_f32 v90, v16, v17
    v_lshlrev_b32 v20, 16, v91
    v_and_b32 v21, 0xffff0000, v91
    v_lshlrev_b32 v22, 16, v95
    v_and_b32 v23, 0xffff0000, v95
    v_pk_mul_f32 v[20:21], v[20:21], v[82:83] op_sel_hi:[1,0]
    v_pk_fma_f32 v[20:21], v[22:23], v[84:85], v[20:21] op_sel_hi:[1,0,1]
    v_cvt_pk_bf16_f32 v91, v20, v21
    ds_write_b128 v14, v[88:91] offset:7168
    v_lshlrev_b32 v16, 16, v96
    v_and_b32 v17, 0xffff0000, v96
    v_lshlrev_b32 v18, 16, v100
    v_and_b32 v19, 0xffff0000, v100
    v_pk_mul_f32 v[16:17], v[16:17], v[82:83] op_sel_hi:[1,0]
    v_pk_fma_f32 v[16:17], v[18:19], v[84:85], v[16:17] op_sel_hi:[1,0,1]
    v_cvt_pk_bf16_f32 v96, v16, v17
    v_lshlrev_b32 v20, 16, v97
    v_and_b32 v21, 0xffff0000, v97
    v_lshlrev_b32 v22, 16, v101
    v_and_b32 v23, 0xffff0000, v101
    v_pk_mul_f32 v[20:21], v[20:21], v[82:83] op_sel_hi:[1,0]
    v_pk_fma_f32 v[20:21], v[22:23], v[84:85], v[20:21] op_sel_hi:[1,0,1]
    v_cvt_pk_bf16_f32 v97, v20, v21
    v_lshlrev_b32 v16, 16, v98
    v_and_b32 v17, 0xffff0000, v98
    v_lshlrev_b32 v18, 16, v102
    v_and_b32 v19, 0xffff0000, v102
    v_pk_mul_f32 v[16:17], v[16:17], v[82:83] op_sel_hi:[1,0]
    v_pk_fma_f32 v[16:17], v[18:19], v[84:85], v[16:17] op_sel_hi:[1,0,1]
    v_cvt_pk_bf16_f32 v98, v16, v17
    v_lshlrev_b32 v20, 16, v99
    v_and_b32 v21, 0xffff0000, v99
    v_lshlrev_b32 v22, 16, v103
    v_and_b32 v23, 0xffff0000, v103
    v_pk_mul_f32 v[20:21], v[20:21], v[82:83] op_sel_hi:[1,0]
    v_pk_fma_f32 v[20:21], v[22:23], v[84:85], v[20:21] op_sel_hi:[1,0,1]
    v_cvt_pk_bf16_f32 v99, v20, v21
    ds_write_b128 v14, v[96:99] offset:8192
    v_bfe_u32 v3, v1, 2, 2
    v_lshl_add_u32 v3, v8, 3, v3
    v_lshlrev_b32 v3, 6, v3
    v_bfe_u32 v4, v1, 4, 1
    v_lshl_add_u32 v3, v4, 5, v3
    v_and_b32 v4, 3, v1
    v_lshl_add_u32 v3, v4, 3, v3
    v_add_u32 v3, 73728, v3
    s_waitcnt lgkmcnt(0)
    s_barrier
    ds_read_b128 v[16:19], v14 offset:0
    ds_read_b128 v[20:23], v14 offset:1024
    ds_read_b128 v[24:27], v14 offset:2048
    ds_read_b128 v[28:31], v14 offset:3072
    ds_read_b128 v[32:35], v14 offset:4096
    ds_read_b128 v[36:39], v14 offset:5120
    s_waitcnt vmcnt(2)
    s_waitcnt lgkmcnt(5)
    v_mfma_f32_32x32x16_bf16 v[88:103], a[0:3], v[16:19], 0
    ds_read_b128 v[40:43], v14 offset:6144
    s_waitcnt lgkmcnt(5)
    v_mfma_f32_32x32x16_bf16 v[88:103], a[4:7], v[20:23], v[88:103]
    ds_read_b128 v[44:47], v14 offset:7168
    s_waitcnt lgkmcnt(5)
    v_mfma_f32_32x32x16_bf16 v[88:103], a[8:11], v[24:27], v[88:103]
    ds_read_b128 v[48:51], v14 offset:8192
    s_waitcnt lgkmcnt(5)
    v_mfma_f32_32x32x16_bf16 v[88:103], a[12:15], v[28:31], v[88:103]
    ds_read_b64_tr_b16 v[52:53], v3 offset:0
    ds_read_b64_tr_b16 v[54:55], v3 offset:256
    s_waitcnt lgkmcnt(6)
    v_mfma_f32_32x32x16_bf16 v[88:103], a[16:19], v[32:35], v[88:103]
    ds_read_b64_tr_b16 v[56:57], v3 offset:1024
    ds_read_b64_tr_b16 v[58:59], v3 offset:1280
    s_waitcnt lgkmcnt(7)
    v_mfma_f32_32x32x16_bf16 v[88:103], a[20:23], v[36:39], v[88:103]
    ds_read_b64_tr_b16 v[60:61], v3 offset:2048
    ds_read_b64_tr_b16 v[62:63], v3 offset:2304
    s_waitcnt lgkmcnt(8)
    v_mfma_f32_32x32x16_bf16 v[88:103], a[24:27], v[40:43], v[88:103]
    ds_read_b64_tr_b16 v[64:65], v3 offset:3072
    ds_read_b64_tr_b16 v[66:67], v3 offset:3328
    s_waitcnt lgkmcnt(9)
    v_mfma_f32_32x32x16_bf16 v[88:103], a[28:31], v[44:47], v[88:103]
    ds_read_b64_tr_b16 v[68:69], v3 offset:4096
    ds_read_b64_tr_b16 v[70:71], v3 offset:4352
    s_waitcnt lgkmcnt(10)
    v_mfma_f32_32x32x16_bf16 v[88:103], a[32:35], v[48:51], v[88:103]
    ds_read_b64_tr_b16 v[72:73], v3 offset:5120
    ds_read_b64_tr_b16 v[74:75], v3 offset:5376
    s_waitcnt lgkmcnt(10)
    v_mfma_f32_32x32x16_bf16 v[88:103], a[36:39], v[52:55], v[88:103]
    ds_read_b64_tr_b16 v[76:77], v3 offset:6144
    ds_read_b64_tr_b16 v[78:79], v3 offset:6400
    s_waitcnt lgkmcnt(10)
    v_mfma_f32_32x32x16_bf16 v[88:103], a[40:43], v[56:59], v[88:103]
    ds_read_b64_tr_b16 v[80:81], v3 offset:7168
    ds_read_b64_tr_b16 v[82:83], v3 offset:7424
    s_waitcnt lgkmcnt(10)
    v_mfma_f32_32x32x16_bf16 v[88:103], a[44:47], v[60:63], v[88:103]
    ds_read_b64_tr_b16 v[84:85], v3 offset:8192
    ds_read_b64_tr_b16 v[86:87], v3 offset:8448
    s_waitcnt lgkmcnt(10)
    v_mfma_f32_32x32x16_bf16 v[88:103], a[48:51], v[64:67], v[88:103]
    s_waitcnt lgkmcnt(8)
    v_mfma_f32_32x32x16_bf16 v[88:103], a[52:55], v[68:71], v[88:103]
    s_waitcnt lgkmcnt(6)
    v_mfma_f32_32x32x16_bf16 v[88:103], a[56:59], v[72:75], v[88:103]
    s_waitcnt lgkmcnt(4)
    v_mfma_f32_32x32x16_bf16 v[88:103], a[60:63], v[76:79], v[88:103]
    s_waitcnt lgkmcnt(2)
    v_mfma_f32_32x32x16_bf16 v[88:103], a[64:67], v[80:83], v[88:103]
    s_waitcnt lgkmcnt(0)
    v_mfma_f32_32x32x16_bf16 v[88:103], a[68:71], v[84:87], v[88:103]
    s_waitcnt vmcnt(0)
    s_nop 15
    v_lshlrev_b32 v4, 16, v112
    v_and_b32 v5, 0xffff0000, v112
    v_pk_add_f32 v[88:89], v[88:89], v[4:5]
    v_cvt_pk_bf16_f32 v112, v88, v89
    v_lshlrev_b32 v6, 16, v113
    v_and_b32 v7, 0xffff0000, v113
    v_pk_add_f32 v[90:91], v[90:91], v[6:7]
    v_cvt_pk_bf16_f32 v113, v90, v91
    v_lshlrev_b32 v4, 16, v114
    v_and_b32 v5, 0xffff0000, v114
    v_pk_add_f32 v[92:93], v[92:93], v[4:5]
    v_cvt_pk_bf16_f32 v114, v92, v93
    v_lshlrev_b32 v6, 16, v115
    v_and_b32 v7, 0xffff0000, v115
    v_pk_add_f32 v[94:95], v[94:95], v[6:7]
    v_cvt_pk_bf16_f32 v115, v94, v95
    buffer_store_dwordx4 v[112:115], v9, s[36:39], 0 offen offset:192 sc1
    v_lshlrev_b32 v4, 16, v116
    v_and_b32 v5, 0xffff0000, v116
    v_pk_add_f32 v[96:97], v[96:97], v[4:5]
    v_cvt_pk_bf16_f32 v116, v96, v97
    v_lshlrev_b32 v6, 16, v117
    v_and_b32 v7, 0xffff0000, v117
    v_pk_add_f32 v[98:99], v[98:99], v[6:7]
    v_cvt_pk_bf16_f32 v117, v98, v99
    v_lshlrev_b32 v4, 16, v118
    v_and_b32 v5, 0xffff0000, v118
    v_pk_add_f32 v[100:101], v[100:101], v[4:5]
    v_cvt_pk_bf16_f32 v118, v100, v101
    v_lshlrev_b32 v6, 16, v119
    v_and_b32 v7, 0xffff0000, v119
    v_pk_add_f32 v[102:103], v[102:103], v[6:7]
    v_cvt_pk_bf16_f32 v119, v102, v103
    buffer_store_dwordx4 v[116:119], v9, s[36:39], 0 offen offset:224 sc1
    s_endpgm
L_k3_done:
    s_endpgm
L_code_end:
    s_endpgm
.section .rodata,"a"
.p2align 6
.amdhsa_kernel k1_kernel
  .amdhsa_next_free_vgpr 256
  .amdhsa_next_free_sgpr 96
  .amdhsa_accum_offset 256
  .amdhsa_group_segment_fixed_size 0
  .amdhsa_kernarg_size 96
  .amdhsa_user_sgpr_count 2
  .amdhsa_user_sgpr_kernarg_segment_ptr 1
  .amdhsa_system_sgpr_workgroup_id_x 1
.end_amdhsa_kernel
.p2align 6
.amdhsa_kernel k2_kernel
  .amdhsa_next_free_vgpr 512
  .amdhsa_next_free_sgpr 96
  .amdhsa_accum_offset 256
  .amdhsa_group_segment_fixed_size 0
  .amdhsa_kernarg_size 96
  .amdhsa_user_sgpr_count 2
  .amdhsa_user_sgpr_kernarg_segment_ptr 1
  .amdhsa_system_sgpr_workgroup_id_x 1
.end_amdhsa_kernel
.p2align 6
.amdhsa_kernel k3_kernel
  .amdhsa_next_free_vgpr 288
  .amdhsa_next_free_sgpr 96
  .amdhsa_accum_offset 128
  .amdhsa_group_segment_fixed_size 0
  .amdhsa_kernarg_size 96
  .amdhsa_user_sgpr_count 2
  .amdhsa_user_sgpr_kernarg_segment_ptr 1
  .amdhsa_system_sgpr_workgroup_id_x 1
.end_amdhsa_kernel
```
